```python
import torch

def _softmax(x, axis=-1):
    return torch.softmax(x, dim=axis)
def _gelu(x):
    return torch.nn.functional.gelu(x, approximate="tanh")
def _silu(x):
    return torch.nn.functional.silu(x)
def _sigmoid(x):
    return torch.sigmoid(x)
def _layernorm(x, axis=-1, eps=1e-5):
    m = x.mean(dim=axis, keepdim=True)
    v = x.var(dim=axis, keepdim=True, unbiased=False)
    return (x - m) / torch.sqrt(v + eps)
def _scatter_add(tgt, idx, src, axis=0):
    return tgt.clone().index_add_(axis, idx, src)
def _segment_sum(src, seg, n):
    out = torch.zeros((n,) + src.shape[1:], dtype=src.dtype)
    return out.index_add_(0, seg, src)
def _pad(x, pw):
    flat = tuple(v for pair in reversed(pw) for v in pair)
    return torch.nn.functional.pad(x, flat)

kernel_name = 'recurrent_scan__mha_block_cached__mixer_channel_mlp__prompt'

def setup_inputs():

    _w = (lambda a: (lambda t: t.to(torch.bfloat16) if t.is_floating_point() else t)(torch.as_tensor(a)))
    def _A_setup():
        B, Sq, D = 1, 2048, 512
        H, Sk, Dh = 32, 2048, 128
        return {
            "x": _w((lambda *s: torch.randn(*s, dtype=torch.bfloat16) * 0.05)(B, Sq, D)),
            "k_cache": _w((lambda *s: torch.randn(*s, dtype=torch.bfloat16) * 1.6)(B, H, Sk, Dh)),
            "v_cache": _w((lambda *s: torch.randn(*s, dtype=torch.bfloat16) * 0.8)(B, H, Sk, Dh)),
            "wq": _w((lambda *s: torch.randn(*s, dtype=torch.bfloat16) * 1.6)(D, H * Dh) * (D ** -0.5)),
            "wo": _w((lambda *s: torch.randn(*s, dtype=torch.bfloat16) * 0.8)(H * Dh, D) * ((H * Dh) ** -0.5)),
        }
    _A_in = _A_setup()

    def _B_setup():
        B, S, D, F = 1, 2048, 512, 1792
        return {
            "x": _w((lambda *s: torch.randn(*s, dtype=torch.bfloat16) * 0.05)(B, S, D)),
            "w1": _w((lambda *s: torch.randn(*s, dtype=torch.bfloat16) * 1.6)(D, F) * (D ** -0.5)),
            "b1": _w((lambda *s: torch.randn(*s, dtype=torch.bfloat16) * 0.8)(F)),
            "w2": _w((lambda *s: torch.randn(*s, dtype=torch.bfloat16) * 0.2)(F, D) * (F ** -0.5)),
            "b2": _w((lambda *s: torch.randn(*s, dtype=torch.bfloat16) * 0.2)(D)),
        }
    _B_in = _B_setup()

    return {
        "A_x": _A_in["x"],
        "A_k_cache": _A_in["k_cache"],
        "A_v_cache": _A_in["v_cache"],
        "A_wq": _A_in["wq"],
        "A_wo": _A_in["wo"],
        "B_x": _B_in["x"],
        "B_w1": _B_in["w1"],
        "B_b1": _B_in["b1"],
        "B_w2": _B_in["w2"],
        "B_b2": _B_in["b2"],
    }

def reference(A_x, A_k_cache, A_v_cache, A_wq, A_wo, B_x, B_w1, B_b1, B_w2, B_b2):
    def _A_ref(x, k_cache, v_cache, wq, wo):
        B, Sq, D = x.shape
        H, Dh = 32, 128
        q = (lambda x, *d: x.permute(*d))((x @ wq).reshape(B, Sq, H, Dh), 0, 2, 1, 3)
        scores = torch.einsum("bhqd,bhkd->bhqk", q, k_cache) * (Dh ** -0.5)
        p = _softmax(scores, axis=-1)
        o = torch.einsum("bhqk,bhkd->bhqd", p, v_cache)
        return (lambda x, *d: x.permute(*d))(o, 0, 2, 1, 3).reshape(B, Sq, H * Dh) @ wo

    def _B_ref(x, w1, b1, w2, b2):
        y = _layernorm(x, axis=-1)
        h = _gelu(torch.einsum("bsd,df->bsf", y, w1) + b1)
        return torch.einsum("bsf,fd->bsd", h, w2) + b2

    x = A_x
    xn = _layernorm(x, axis=-1)
    s = _A_ref(xn, A_k_cache, A_v_cache, A_wq, A_wo)
    g = _silu(_B_ref(xn, B_w1, B_b1, B_w2, B_b2))
    return x + s * g
```

```asm
; @launch grid=(256,1,1) block=(256,1,1) lds=163840
.amdgcn_target "amdgcn-amd-amdhsa--gfx950"
.text
.p2align 12
.globl recurrent_scan__mha_block_cached__mixer_channel_mlp__prompt_kernel
.p2align 8
.type recurrent_scan__mha_block_cached__mixer_channel_mlp__prompt_kernel,@function
recurrent_scan__mha_block_cached__mixer_channel_mlp__prompt_kernel:
    s_cmp_ge_u32 s2, 256
    s_cbranch_scc1 K2_END
    s_mov_b32 s96, 0
K2_TOP:
    s_load_dwordx16 s[36:51], s[0:1], 0
    s_load_dwordx8 s[52:59], s[0:1], 64
    s_load_dwordx2 s[60:61], s[0:1], 96
    s_getpc_b64 s[8:9]
K2_PC:
    s_lshr_b32 s95, s2, 3
    s_mul_i32 s95, s95, ((K2_LAST - K2_PC) / 4096 + 1) * 128
    v_lshrrev_b32 v4, 3, v0
    v_min_u32 v4, (K2_LAST - K2_PC) / 4096, v4
    v_lshl_add_u32 v4, v4, 7, s95
    v_mov_b32 v5, 0
    v_min_u32 v4, K2_LAST - K2_PC, v4
    v_lshl_add_u64 v[4:5], v[4:5], 0, s[8:9]
    global_load_dword v194, v[4:5], off
    v_lshrrev_b32 v1, 6, v0
    v_and_b32 v2, 63, v0
    s_lshr_b32 s98, s2, 5
    v_readfirstlane_b32 s89, v1
    v_lshrrev_b32 v1, 4, v2
    v_and_b32 v3, 15, v2
    v_xor_b32 v4, v1, v3
    v_lshlrev_b32 v4, 4, v4
    v_lshl_add_u32 v176, v1, 10, v4
    s_lshl_b32 s98, s98, 2
    s_add_u32 s98, s98, s89
    s_lshl_b32 s97, s98, 16
    s_lshl_b32 s98, s98, 2
    s_lshl_b32 s91, s89, 13
    s_lshl_b32 s90, s89, 10
    v_xor_b32 v177, 64, v176
    v_add_u32 v177, 3072, v177
    v_xor_b32 v178, 128, v176
    v_add_u32 v178, 6144, v178
    v_xor_b32 v179, 192, v176
    v_add_u32 v179, 9216, v179
    s_and_b32 s88, s2, 7
    s_lshl_b32 s88, s88, 2
    s_lshr_b32 s95, s2, 3
    s_and_b32 s95, s95, 3
    s_add_u32 s88, s88, s95
    v_lshrrev_b32 v10, 3, v2
    s_lshl_b32 s95, s89, 3
    v_add_u32 v10, s95, v10
    v_mul_u32_u24 v10, 3584, v10
    v_and_b32 v11, 1, v1
    s_and_b32 s99, s89, 1
    s_lshl_b32 s99, s99, 1
    v_or_b32 v11, s99, v11
    v_lshlrev_b32 v11, 1, v11
    v_and_b32 v16, 7, v2
    v_xor_b32 v11, v11, v16
    v_lshl_add_u32 v9, v11, 4, v10
    s_lshl_b32 s100, s88, 7
    s_waitcnt lgkmcnt(0)
    s_add_u32 s28, s36, s97
    s_addc_u32 s29, s37, 0
    s_mov_b32 s30, 65536
    s_mov_b32 s31, 0x20000
    s_lshr_b32 s101, s2, 5
    s_xor_b32 s101, s101, s88
    s_and_b32 s101, s101, 1
    s_lshl_b32 s46, s101, 8
    s_lshl_b32 s47, s101, 20
    s_add_u32 m0, s91, 32768
    s_xor_b32 s94, s46, 0
    buffer_load_dwordx4 v176, s[28:31], s94 offen offset:0 lds
    buffer_load_dwordx4 v177, s[28:31], s94 offen offset:1024 lds
    buffer_load_dwordx4 v178, s[28:31], s94 offen offset:2048 lds
    buffer_load_dwordx4 v179, s[28:31], s94 offen offset:3072 lds
    s_add_u32 s16, s48, s100
    s_addc_u32 s17, s49, 0
    s_mov_b32 s18, 0
    s_mov_b32 s19, 0x20000
    s_add_u32 s4, s50, s100
    s_addc_u32 s5, s51, 0
    s_mov_b32 s6, 0
    s_mov_b32 s7, 0x20000
    s_sub_u32 s18, 1835008, s100
    s_cmp_lt_u32 s88, 28
    s_cselect_b32 s18, s18, 0
    s_cselect_b32 s6, 128, 0
    s_add_u32 m0, s90, 131072
    s_xor_b32 s95, s46, 0
    s_mul_i32 s95, s95, 1792
    buffer_load_dwordx4 v9, s[16:19], s95 offen lds
    s_add_u32 m0, s90, 135168
    s_add_u32 s95, s95, 114688
    buffer_load_dwordx4 v9, s[16:19], s95 offen lds
    s_add_u32 m0, s90, 139264
    s_add_u32 s95, s95, 114688
    buffer_load_dwordx4 v9, s[16:19], s95 offen lds
    s_add_u32 m0, s90, 143360
    s_add_u32 s95, s95, 114688
    buffer_load_dwordx4 v9, s[16:19], s95 offen lds
    s_lshl_b32 s95, s99, 5
    v_lshl_add_u32 v10, v1, 3, s95
    v_xor_b32 v11, 64, v10
    buffer_load_dwordx2 v[196:197], v10, s[4:7], 0 offen offset:0
    buffer_load_dwordx2 v[198:199], v10, s[4:7], 0 offen offset:32
    buffer_load_dwordx2 v[200:201], v11, s[4:7], 0 offen offset:0
    buffer_load_dwordx2 v[202:203], v11, s[4:7], 0 offen offset:32
    s_add_u32 m0, s91, 36864
    s_xor_b32 s94, s46, 16384
    buffer_load_dwordx4 v176, s[28:31], s94 offen offset:0 lds
    buffer_load_dwordx4 v177, s[28:31], s94 offen offset:1024 lds
    buffer_load_dwordx4 v178, s[28:31], s94 offen offset:2048 lds
    buffer_load_dwordx4 v179, s[28:31], s94 offen offset:3072 lds
    s_add_u32 m0, s91, 65536
    s_xor_b32 s94, s46, 32768
    buffer_load_dwordx4 v176, s[28:31], s94 offen offset:0 lds
    buffer_load_dwordx4 v177, s[28:31], s94 offen offset:1024 lds
    buffer_load_dwordx4 v178, s[28:31], s94 offen offset:2048 lds
    buffer_load_dwordx4 v179, s[28:31], s94 offen offset:3072 lds
    s_add_u32 m0, s91, 69632
    s_xor_b32 s94, s46, 49152
    buffer_load_dwordx4 v176, s[28:31], s94 offen offset:0 lds
    buffer_load_dwordx4 v177, s[28:31], s94 offen offset:1024 lds
    buffer_load_dwordx4 v178, s[28:31], s94 offen offset:2048 lds
    buffer_load_dwordx4 v179, s[28:31], s94 offen offset:3072 lds
    s_add_u32 s20, s60, 0
    s_addc_u32 s21, s61, 0
    s_mov_b32 s22, 37748736
    s_mov_b32 s23, 0x20000
    s_lshl_b32 s50, s2, 8
    s_add_u32 s50, s50, 3145728
    v_lshlrev_b32 v212, 2, v2
    v_mov_b32 v213, 0
    v_lshlrev_b32 v23, 4, v2
    s_lshl_b32 s95, s98, 9
    v_lshl_add_u32 v195, v3, 7, s95
    s_lshl_b32 s95, s88, 8
    s_add_u32 s12, s42, s95
    s_addc_u32 s13, s43, 0
    s_mov_b32 s14, 0
    s_mov_b32 s15, 0x20000
    s_sub_u32 s14, 4194304, s95
    s_lshl_b32 s95, s88, 19
    s_add_u32 s4, s38, s95
    s_addc_u32 s5, s39, 0
    s_mov_b32 s6, 524288
    s_mov_b32 s7, 0x20000
    s_add_u32 s8, s40, s95
    s_addc_u32 s9, s41, 0
    s_mov_b32 s10, 524288
    s_mov_b32 s11, 0x20000
    s_add_u32 s24, s60, 4194304
    s_addc_u32 s25, s61, 0
    s_mov_b32 s26, 7340032
    s_mov_b32 s27, 0x20000
    s_cmp_lt_u32 s88, 28
    s_cselect_b32 s26, s26, 0
    s_and_b32 s95, s2, 3
    s_lshl_b32 s95, s95, 6
    s_add_u32 s40, s58, s95
    s_addc_u32 s41, s59, 0
    s_mov_b32 s42, 4
    s_mov_b32 s43, 0x20000
    s_or_b32 s95, s96, s89
    s_cmp_eq_u32 s95, 0
    s_cselect_b32 s42, 4, 0
    s_add_u32 s32, s60, 33554432
    s_addc_u32 s33, s61, 0
    s_mov_b32 s34, 1835008
    s_mov_b32 s35, 0x20000
    s_lshr_b32 s95, s89, 1
    s_lshl_b32 s95, s95, 8
    s_add_u32 s95, s95, s2
    s_cmp_lt_u32 s95, 224
    s_cselect_b32 s34, s34, 0
    v_xor_b32 v4, v1, v3
    v_lshlrev_b32 v4, 4, v4
    v_lshl_add_u32 v4, v3, 8, v4
    v_add_u32 v180, s91, v4
    v_xor_b32 v181, 64, v180
    v_xor_b32 v182, 128, v180
    v_xor_b32 v183, 192, v180
    v_add_u32 v184, 0x10000, v180
    v_add_u32 v185, 0x10000, v181
    v_add_u32 v186, 0x10000, v182
    v_add_u32 v187, 0x10000, v183
    s_lshl_b32 s95, s89, 5
    v_add_u32 v10, s95, v1
    v_lshlrev_b32 v11, 2, v1
    v_xor_b32 v11, v11, v3
    v_lshlrev_b32 v11, 4, v11
    v_lshl_add_u32 v8, v10, 13, v11
    s_lshl_b32 s95, s89, 2
    v_add_u32 v10, s95, v1
    v_xor_b32 v11, v10, v3
    v_lshlrev_b32 v11, 4, v11
    v_lshl_add_u32 v20, v1, 8, v11
    v_and_b32 v11, 7, v10
    v_lshlrev_b32 v11, 1, v11
    v_xor_b32 v11, v11, v3
    v_lshlrev_b32 v11, 4, v11
    v_lshl_add_u32 v21, v1, 8, v11
    s_mov_b32 s93, s91
    v_lshrrev_b32 v10, 2, v3
    v_and_b32 v11, 3, v2
    v_lshl_add_u32 v16, v1, 3, v10
    v_xor_b32 v17, s89, v10
    v_lshl_add_u32 v17, v17, 2, v11
    v_lshlrev_b32 v17, 4, v17
    v_lshl_add_u32 v24, v16, 8, v17
    v_xor_b32 v25, 64, v24
    v_xor_b32 v26, 128, v24
    v_xor_b32 v27, 192, v24
    v_lshrrev_b32 v17, 1, v10
    v_and_b32 v18, 1, v1
    v_lshl_add_u32 v17, v18, 1, v17
    v_xor_b32 v17, s99, v17
    v_lshlrev_b32 v18, 7, v16
    v_lshl_add_u32 v18, v11, 3, v18
    v_add_u32 v18, 98304, v18
    v_lshl_add_u32 v156, v17, 5, v18
    v_xor_b32 v157, 32, v156
    v_xor_b32 v158, 64, v156
    v_xor_b32 v159, 96, v156
    v_and_b32 v16, 2, v2
    v_cmp_eq_u32 vcc, 0, v16
    v_mov_b32 v17, 0x3f803f80
    v_and_b32 v16, 1, v2
    v_cndmask_b32 v4, 0, v17, vcc
    v_cmp_eq_u32 vcc, 0, v16
    v_mov_b32 v5, v4
    v_mov_b32 v6, v4
    v_mov_b32 v7, v4
    v_mov_b32 v17, 0x44444444
    v_mov_b32 v22, 0xeeeeeeee
    v_cndmask_b32 v22, v22, v17, vcc
    v_cmp_eq_u32 vcc, 0, v10
    s_nop 1
    v_cndmask_b32 v160, 0, v4, vcc
    v_mov_b32 v161, v160
    v_mov_b32 v162, v160
    v_mov_b32 v163, v160
    v_cmp_eq_u32 vcc, 1, v10
    s_nop 1
    v_cndmask_b32 v164, 0, v4, vcc
    v_mov_b32 v165, v164
    v_mov_b32 v166, v164
    v_mov_b32 v167, v164
    v_cmp_eq_u32 vcc, 2, v10
    s_nop 1
    v_cndmask_b32 v168, 0, v4, vcc
    v_mov_b32 v169, v168
    v_mov_b32 v170, v168
    v_mov_b32 v171, v168
    v_cmp_eq_u32 vcc, 3, v10
    s_nop 1
    v_cndmask_b32 v172, 0, v4, vcc
    v_mov_b32 v173, v172
    v_mov_b32 v174, v172
    v_mov_b32 v175, v172
    s_add_u32 s95, s91, 131072
    v_add_u32 v188, s95, v23
    v_lshl_add_u32 v16, v10, 4, v3
    v_lshl_add_u32 v16, v16, 2, v11
    v_lshl_add_u32 v16, v1, 8, v16
    v_lshl_add_u32 v189, v16, 2, s95
    v_lshl_add_u32 v190, v3, 4, s95
    s_lshl_b32 s95, s99, 6
    s_add_u32 s95, s95, 137216
    v_lshl_add_u32 v191, v3, 2, s95
    v_lshl_add_u32 v192, v1, 4, s95
    v_xor_b32 v193, 128, v192
    v_lshrrev_b32 v16, 2, v2
    v_lshlrev_b32 v17, 4, v11
    v_lshl_add_u32 v16, v16, 7, v17
    s_add_u32 s95, s91, 131072
    v_add_u32 v11, s95, v16
    v_lshrrev_b32 v16, 3, v2
    v_and_b32 v17, 7, v2
    v_lshlrev_b32 v17, 4, v17
    v_lshl_add_u32 v10, v16, 10, v17
    v_mov_b64 v[144:145], 0
    v_mov_b64 v[146:147], 0
    v_mov_b64 v[148:149], 0
    v_mov_b64 v[150:151], 0
    v_mov_b64 v[152:153], 0
    v_mov_b64 v[154:155], 0
    v_mov_b64 v[16:17], 0
    v_mov_b64 v[18:19], 0
    v_mov_b64 v[28:29], 0
    v_mov_b64 v[30:31], 0
    v_mov_b32 v14, 0xc0135761
    s_mov_b32 s3, 0xbdd2d3e8
    s_mul_i32 s39, s98, 57344
    s_lshl_b32 s95, s88, 12
    s_add_u32 s39, s39, s95
    s_lshl_b32 s95, s99, 10
    s_add_u32 s39, s39, s95
    s_xor_b32 s97, s39, 2048
    s_mov_b32 s101, s88
    s_lshr_b32 s38, s2, 5
    s_lshr_b32 s95, s89, 1
    s_lshl_b32 s100, s101, 1
    s_add_u32 s100, s100, s95
    s_mul_i32 s100, s100, 114688
    s_add_u32 s100, s100, 4194304
    s_and_b32 s95, s89, 1
    s_lshl_b32 s95, s95, 11
    s_mul_i32 s99, s38, 229376
    s_add_u32 s99, s99, s95
    s_add_u32 s99, s99, 33554432
    s_xor_b32 s48, s38, 0
    s_and_b32 s48, s48, 1
    s_lshl_b32 s48, s48, 16
    s_lshl_b32 s95, s89, 17
    s_add_u32 s95, s95, s48
    s_lshl_b32 s48, s38, 19
    s_add_u32 s48, s48, s95
    s_add_u32 s48, s48, 12582912
    s_lshl_b32 s49, s101, 19
    s_add_u32 s49, s49, s95
    s_add_u32 s49, s49, 16777216
    s_buffer_load_dword s76, s[8:11], 54028
    s_buffer_load_dword s77, s[8:11], 187732
    s_buffer_load_dword s78, s[8:11], 320156
    s_buffer_load_dword s79, s[8:11], 486628
    s_lshl_b32 s84, s88, 17
    s_add_u32 s84, s44, s84
    s_addc_u32 s85, s45, 0
    s_load_dword s80, s[84:85], 6184
    s_load_dword s81, s[84:85], 43308
    s_load_dword s82, s[84:85], 80452
    s_load_dword s83, s[84:85], 117596
    s_add_u32 m0, s91, 0
    s_xor_b32 s94, s46, 256
    buffer_load_dwordx4 v176, s[28:31], s94 offen offset:0 lds
    buffer_load_dwordx4 v177, s[28:31], s94 offen offset:1024 lds
    buffer_load_dwordx4 v178, s[28:31], s94 offen offset:2048 lds
    buffer_load_dwordx4 v179, s[28:31], s94 offen offset:3072 lds
    s_add_u32 m0, s91, 4096
    s_xor_b32 s94, s46, 16640
    buffer_load_dwordx4 v176, s[28:31], s94 offen offset:0 lds
    buffer_load_dwordx4 v177, s[28:31], s94 offen offset:1024 lds
    buffer_load_dwordx4 v178, s[28:31], s94 offen offset:2048 lds
    buffer_load_dwordx4 v179, s[28:31], s94 offen offset:3072 lds
    s_add_u32 m0, s90, 147456
    s_xor_b32 s95, s46, 256
    s_mul_i32 s95, s95, 1792
    buffer_load_dwordx4 v9, s[16:19], s95 offen lds
    s_add_u32 m0, s90, 151552
    s_add_u32 s95, s95, 114688
    buffer_load_dwordx4 v9, s[16:19], s95 offen lds
    s_add_u32 m0, s90, 155648
    s_add_u32 s95, s95, 114688
    buffer_load_dwordx4 v9, s[16:19], s95 offen lds
    s_add_u32 m0, s90, 159744
    s_add_u32 s95, s95, 114688
    buffer_load_dwordx4 v9, s[16:19], s95 offen lds
    s_waitcnt vmcnt(32)
    ds_read_b128 a[0:3], v180 offset:32768
    ds_read_b128 a[4:7], v181 offset:32768
    ds_read_b128 a[8:11], v182 offset:32768
    ds_read_b128 a[12:15], v183 offset:32768
    s_waitcnt vmcnt(20)
    ds_read_b128 a[16:19], v180 offset:36864
    ds_read_b128 a[20:23], v181 offset:36864
    ds_read_b128 a[24:27], v182 offset:36864
    ds_read_b128 a[28:31], v183 offset:36864
    s_waitcnt vmcnt(16)
    ds_read_b128 a[32:35], v184 offset:0
    ds_read_b128 a[36:39], v185 offset:0
    ds_read_b128 a[40:43], v186 offset:0
    ds_read_b128 a[44:47], v187 offset:0
    s_waitcnt vmcnt(12)
    s_barrier
    ds_read_b64_tr_b16 v[32:33], v156 offset:32768
    ds_read_b64_tr_b16 v[34:35], v156 offset:33280
    ds_read_b64_tr_b16 v[36:37], v156 offset:36864
    ds_read_b64_tr_b16 v[38:39], v156 offset:37376
    ds_read_b64_tr_b16 v[40:41], v156 offset:40960
    ds_read_b64_tr_b16 v[42:43], v156 offset:41472
    ds_read_b64_tr_b16 v[44:45], v156 offset:45056
    ds_read_b64_tr_b16 v[46:47], v156 offset:45568
    ds_read_b128 a[48:51], v184 offset:4096
    ds_read_b128 a[52:55], v185 offset:4096
    ds_read_b128 a[56:59], v186 offset:4096
    ds_read_b128 a[60:63], v187 offset:4096
    s_waitcnt lgkmcnt(0)
    s_mov_b32 s92, s91
    v_smfmac_f32_16x16x64_bf16 v[148:151], v[4:7], v[32:39], v22
    ds_read_b64_tr_b16 v[48:49], v157 offset:32768
    ds_read_b64_tr_b16 v[50:51], v157 offset:33280
    s_add_u32 m0, s91, 32768
    s_xor_b32 s94, s46, 33024
    v_smfmac_f32_16x16x64_bf16 v[148:151], v[4:7], v[40:47], v22
    buffer_load_dwordx4 v176, s[28:31], s94 offen offset:0 lds
    v_mfma_f32_16x16x32_bf16 v[64:67], v[32:35], a[0:3], 0
    ds_read_b64_tr_b16 v[52:53], v157 offset:36864
    ds_read_b64_tr_b16 v[54:55], v157 offset:37376
    v_mfma_f32_16x16x32_bf16 v[64:67], v[36:39], a[4:7], v[64:67]
    v_mfma_f32_16x16x32_bf16 v[64:67], v[40:43], a[8:11], v[64:67]
    ds_read_b64_tr_b16 v[56:57], v157 offset:40960
    ds_read_b64_tr_b16 v[58:59], v157 offset:41472
    v_mfma_f32_16x16x32_bf16 v[64:67], v[44:47], a[12:15], v[64:67]
    buffer_load_dwordx4 v177, s[28:31], s94 offen offset:1024 lds
    v_mfma_f32_16x16x32_bf16 v[68:71], v[44:47], a[28:31], 0
    ds_read_b64_tr_b16 v[60:61], v157 offset:45056
    ds_read_b64_tr_b16 v[62:63], v157 offset:45568
    v_mfma_f32_16x16x32_bf16 v[68:71], v[40:43], a[24:27], v[68:71]
    v_mfma_f32_16x16x32_bf16 v[68:71], v[36:39], a[20:23], v[68:71]
    v_mfma_f32_16x16x32_bf16 v[68:71], v[32:35], a[16:19], v[68:71]
    buffer_load_dwordx4 v178, s[28:31], s94 offen offset:2048 lds
    v_mfma_f32_16x16x32_bf16 v[72:75], v[32:35], a[32:35], 0
    v_mfma_f32_16x16x32_bf16 v[72:75], v[36:39], a[36:39], v[72:75]
    v_mfma_f32_16x16x32_bf16 v[72:75], v[40:43], a[40:43], v[72:75]
    v_mfma_f32_16x16x32_bf16 v[72:75], v[44:47], a[44:47], v[72:75]
    buffer_load_dwordx4 v179, s[28:31], s94 offen offset:3072 lds
    v_mfma_f32_16x16x32_bf16 v[76:79], v[44:47], a[60:63], 0
    s_waitcnt vmcnt(12)
    ds_read_b128 a[64:67], v180 offset:0
    ds_read_b128 a[68:71], v181 offset:0
    v_mfma_f32_16x16x32_bf16 v[76:79], v[40:43], a[56:59], v[76:79]
    s_add_u32 m0, s91, 36864
    v_mfma_f32_16x16x32_bf16 v[76:79], v[36:39], a[52:55], v[76:79]
    s_xor_b32 s94, s46, 49408
    ds_read_b128 a[72:75], v182 offset:0
    ds_read_b128 a[76:79], v183 offset:0
    v_mfma_f32_16x16x32_bf16 v[76:79], v[32:35], a[48:51], v[76:79]
    buffer_load_dwordx4 v176, s[28:31], s94 offen offset:0 lds
    v_mfma_f32_16x16x32_bf16 v[128:131], a[0:3], a[0:3], 0
    v_mfma_f32_16x16x32_bf16 v[128:131], a[4:7], a[4:7], v[128:131]
    v_mfma_f32_16x16x32_bf16 v[128:131], a[8:11], a[8:11], v[128:131]
    v_mfma_f32_16x16x32_bf16 v[128:131], a[12:15], a[12:15], v[128:131]
    buffer_load_dwordx4 v177, s[28:31], s94 offen offset:1024 lds
    v_smfmac_f32_16x16x64_bf16 v[144:147], v[160:163], a[0:7], v22
    v_smfmac_f32_16x16x64_bf16 v[144:147], v[160:163], a[8:15], v22
    s_waitcnt lgkmcnt(0)
    v_smfmac_f32_16x16x64_bf16 v[152:155], v[4:7], v[48:55], v22
    ds_read_b64_tr_b16 v[32:33], v158 offset:32768
    ds_read_b64_tr_b16 v[34:35], v158 offset:33280
    v_smfmac_f32_16x16x64_bf16 v[152:155], v[4:7], v[56:63], v22
    buffer_load_dwordx4 v178, s[28:31], s94 offen offset:2048 lds
    v_mfma_f32_16x16x32_bf16 v[92:95], v[48:51], a[48:51], 0
    ds_read_b64_tr_b16 v[36:37], v158 offset:36864
    ds_read_b64_tr_b16 v[38:39], v158 offset:37376
    v_mfma_f32_16x16x32_bf16 v[92:95], v[52:55], a[52:55], v[92:95]
    v_mfma_f32_16x16x32_bf16 v[92:95], v[56:59], a[56:59], v[92:95]
    ds_read_b64_tr_b16 v[40:41], v158 offset:40960
    ds_read_b64_tr_b16 v[42:43], v158 offset:41472
    v_mfma_f32_16x16x32_bf16 v[92:95], v[60:63], a[60:63], v[92:95]
    buffer_load_dwordx4 v179, s[28:31], s94 offen offset:3072 lds
    v_mfma_f32_16x16x32_bf16 v[88:91], v[60:63], a[44:47], 0
    ds_read_b64_tr_b16 v[44:45], v158 offset:45056
    ds_read_b64_tr_b16 v[46:47], v158 offset:45568
    v_mfma_f32_16x16x32_bf16 v[88:91], v[56:59], a[40:43], v[88:91]
    s_add_u32 m0, s91, 65536
    v_mfma_f32_16x16x32_bf16 v[88:91], v[52:55], a[36:39], v[88:91]
    s_xor_b32 s94, s46, 512
    v_mfma_f32_16x16x32_bf16 v[88:91], v[48:51], a[32:35], v[88:91]
    buffer_load_dwordx4 v176, s[28:31], s94 offen offset:0 lds
    v_mfma_f32_16x16x32_bf16 v[84:87], v[48:51], a[16:19], 0
    v_mfma_f32_16x16x32_bf16 v[84:87], v[52:55], a[20:23], v[84:87]
    v_mfma_f32_16x16x32_bf16 v[84:87], v[56:59], a[24:27], v[84:87]
    v_mfma_f32_16x16x32_bf16 v[84:87], v[60:63], a[28:31], v[84:87]
    buffer_load_dwordx4 v177, s[28:31], s94 offen offset:1024 lds
    v_mfma_f32_16x16x32_bf16 v[80:83], v[60:63], a[12:15], 0
    s_waitcnt vmcnt(14)
    ds_read_b128 a[80:83], v180 offset:4096
    ds_read_b128 a[84:87], v181 offset:4096
    v_mfma_f32_16x16x32_bf16 v[80:83], v[56:59], a[8:11], v[80:83]
    v_mfma_f32_16x16x32_bf16 v[80:83], v[52:55], a[4:7], v[80:83]
    ds_read_b128 a[88:91], v182 offset:4096
    ds_read_b128 a[92:95], v183 offset:4096
    v_mfma_f32_16x16x32_bf16 v[80:83], v[48:51], a[0:3], v[80:83]
    buffer_load_dwordx4 v178, s[28:31], s94 offen offset:2048 lds
    v_mfma_f32_16x16x32_bf16 v[132:135], a[16:19], a[16:19], 0
    v_mfma_f32_16x16x32_bf16 v[132:135], a[20:23], a[20:23], v[132:135]
    v_mfma_f32_16x16x32_bf16 v[132:135], a[24:27], a[24:27], v[132:135]
    v_mfma_f32_16x16x32_bf16 v[132:135], a[28:31], a[28:31], v[132:135]
    buffer_load_dwordx4 v179, s[28:31], s94 offen offset:3072 lds
    v_smfmac_f32_16x16x64_bf16 v[144:147], v[164:167], a[16:23], v22
    v_smfmac_f32_16x16x64_bf16 v[144:147], v[164:167], a[24:31], v22
    s_waitcnt lgkmcnt(0)
    v_mfma_f32_16x16x32_bf16 v[96:99], v[32:35], a[0:3], 0
    ds_read_b64_tr_b16 v[48:49], v159 offset:32768
    ds_read_b64_tr_b16 v[50:51], v159 offset:33280
    s_add_u32 m0, s91, 69632
    s_xor_b32 s94, s46, 16896
    v_mfma_f32_16x16x32_bf16 v[96:99], v[36:39], a[4:7], v[96:99]
    buffer_load_dwordx4 v176, s[28:31], s94 offen offset:0 lds
    v_mfma_f32_16x16x32_bf16 v[96:99], v[40:43], a[8:11], v[96:99]
    ds_read_b64_tr_b16 v[52:53], v159 offset:36864
    ds_read_b64_tr_b16 v[54:55], v159 offset:37376
    v_mfma_f32_16x16x32_bf16 v[96:99], v[44:47], a[12:15], v[96:99]
    v_mfma_f32_16x16x32_bf16 v[100:103], v[44:47], a[28:31], 0
    ds_read_b64_tr_b16 v[56:57], v159 offset:40960
    ds_read_b64_tr_b16 v[58:59], v159 offset:41472
    v_mfma_f32_16x16x32_bf16 v[100:103], v[40:43], a[24:27], v[100:103]
    buffer_load_dwordx4 v177, s[28:31], s94 offen offset:1024 lds
    v_mfma_f32_16x16x32_bf16 v[100:103], v[36:39], a[20:23], v[100:103]
    ds_read_b64_tr_b16 v[60:61], v159 offset:45056
    ds_read_b64_tr_b16 v[62:63], v159 offset:45568
    v_mfma_f32_16x16x32_bf16 v[100:103], v[32:35], a[16:19], v[100:103]
    v_mfma_f32_16x16x32_bf16 v[104:107], v[32:35], a[32:35], 0
    v_mfma_f32_16x16x32_bf16 v[104:107], v[36:39], a[36:39], v[104:107]
    buffer_load_dwordx4 v178, s[28:31], s94 offen offset:2048 lds
    v_mfma_f32_16x16x32_bf16 v[104:107], v[40:43], a[40:43], v[104:107]
    v_mfma_f32_16x16x32_bf16 v[104:107], v[44:47], a[44:47], v[104:107]
    v_mfma_f32_16x16x32_bf16 v[108:111], v[44:47], a[60:63], 0
    v_mfma_f32_16x16x32_bf16 v[108:111], v[40:43], a[56:59], v[108:111]
    buffer_load_dwordx4 v179, s[28:31], s94 offen offset:3072 lds
    v_mfma_f32_16x16x32_bf16 v[108:111], v[36:39], a[52:55], v[108:111]
    s_waitcnt vmcnt(12)
    ds_read_b128 a[96:99], v180 offset:32768
    ds_read_b128 a[100:103], v181 offset:32768
    v_mfma_f32_16x16x32_bf16 v[108:111], v[32:35], a[48:51], v[108:111]
    s_add_u32 m0, s90, 98304
    v_mfma_f32_16x16x32_bf16 v[136:139], a[32:35], a[32:35], 0
    s_xor_b32 s95, s46, 512
    s_mul_i32 s95, s95, 1792
    ds_read_b128 a[104:107], v182 offset:32768
    ds_read_b128 a[108:111], v183 offset:32768
    v_mfma_f32_16x16x32_bf16 v[136:139], a[36:39], a[36:39], v[136:139]
    buffer_load_dwordx4 v9, s[16:19], s95 offen lds
    v_mfma_f32_16x16x32_bf16 v[136:139], a[40:43], a[40:43], v[136:139]
    v_mfma_f32_16x16x32_bf16 v[136:139], a[44:47], a[44:47], v[136:139]
    v_smfmac_f32_16x16x64_bf16 v[144:147], v[168:171], a[32:39], v22
    v_smfmac_f32_16x16x64_bf16 v[144:147], v[168:171], a[40:47], v22
    s_waitcnt lgkmcnt(0)
    v_mfma_f32_16x16x32_bf16 v[124:127], v[48:51], a[48:51], 0
    s_waitcnt vmcnt(17)
    s_barrier
    s_add_u32 m0, s90, 102400
    v_mfma_f32_16x16x32_bf16 v[124:127], v[52:55], a[52:55], v[124:127]
    s_add_u32 s95, s95, 114688
    ds_read_b64_tr_b16 v[32:33], v156 offset:49152
    ds_read_b64_tr_b16 v[34:35], v156 offset:49664
    v_mfma_f32_16x16x32_bf16 v[124:127], v[56:59], a[56:59], v[124:127]
    buffer_load_dwordx4 v9, s[16:19], s95 offen lds
    v_mfma_f32_16x16x32_bf16 v[124:127], v[60:63], a[60:63], v[124:127]
    ds_read_b64_tr_b16 v[36:37], v156 offset:53248
    ds_read_b64_tr_b16 v[38:39], v156 offset:53760
    v_mfma_f32_16x16x32_bf16 v[120:123], v[60:63], a[44:47], 0
    s_add_u32 m0, s90, 106496
    v_mfma_f32_16x16x32_bf16 v[120:123], v[56:59], a[40:43], v[120:123]
    s_add_u32 s95, s95, 114688
    ds_read_b64_tr_b16 v[40:41], v156 offset:57344
    ds_read_b64_tr_b16 v[42:43], v156 offset:57856
    v_mfma_f32_16x16x32_bf16 v[120:123], v[52:55], a[36:39], v[120:123]
    buffer_load_dwordx4 v9, s[16:19], s95 offen lds
    v_mfma_f32_16x16x32_bf16 v[120:123], v[48:51], a[32:35], v[120:123]
    ds_read_b64_tr_b16 v[44:45], v156 offset:61440
    ds_read_b64_tr_b16 v[46:47], v156 offset:61952
    v_mfma_f32_16x16x32_bf16 v[116:119], v[48:51], a[16:19], 0
    s_add_u32 m0, s90, 110592
    v_mfma_f32_16x16x32_bf16 v[116:119], v[52:55], a[20:23], v[116:119]
    s_add_u32 s95, s95, 114688
    v_mfma_f32_16x16x32_bf16 v[116:119], v[56:59], a[24:27], v[116:119]
    buffer_load_dwordx4 v9, s[16:19], s95 offen lds
    v_mfma_f32_16x16x32_bf16 v[116:119], v[60:63], a[28:31], v[116:119]
    v_mfma_f32_16x16x32_bf16 v[112:115], v[60:63], a[12:15], 0
    s_add_u32 m0, s91, 0
    v_mfma_f32_16x16x32_bf16 v[112:115], v[56:59], a[8:11], v[112:115]
    s_xor_b32 s94, s46, 33280
    v_mfma_f32_16x16x32_bf16 v[112:115], v[52:55], a[4:7], v[112:115]
    buffer_load_dwordx4 v176, s[28:31], s94 offen offset:0 lds
    v_mfma_f32_16x16x32_bf16 v[112:115], v[48:51], a[0:3], v[112:115]
    s_waitcnt vmcnt(13)
    ds_read_b128 a[112:115], v180 offset:36864
    ds_read_b128 a[116:119], v181 offset:36864
    v_mfma_f32_16x16x32_bf16 v[140:143], a[48:51], a[48:51], 0
    v_mfma_f32_16x16x32_bf16 v[140:143], a[52:55], a[52:55], v[140:143]
    ds_read_b128 a[120:123], v182 offset:36864
    ds_read_b128 a[124:127], v183 offset:36864
    v_mfma_f32_16x16x32_bf16 v[140:143], a[56:59], a[56:59], v[140:143]
    buffer_load_dwordx4 v177, s[28:31], s94 offen offset:1024 lds
    v_mfma_f32_16x16x32_bf16 v[140:143], a[60:63], a[60:63], v[140:143]
    v_smfmac_f32_16x16x64_bf16 v[144:147], v[172:175], a[48:55], v22
    v_smfmac_f32_16x16x64_bf16 v[144:147], v[172:175], a[56:63], v22
    s_waitcnt lgkmcnt(0)
    v_smfmac_f32_16x16x64_bf16 v[148:151], v[4:7], v[32:39], v22
    ds_read_b64_tr_b16 v[48:49], v157 offset:49152
    ds_read_b64_tr_b16 v[50:51], v157 offset:49664
    v_smfmac_f32_16x16x64_bf16 v[148:151], v[4:7], v[40:47], v22
    buffer_load_dwordx4 v178, s[28:31], s94 offen offset:2048 lds
    v_mfma_f32_16x16x32_bf16 v[64:67], v[32:35], a[64:67], v[64:67]
    ds_read_b64_tr_b16 v[52:53], v157 offset:53248
    ds_read_b64_tr_b16 v[54:55], v157 offset:53760
    v_mfma_f32_16x16x32_bf16 v[64:67], v[36:39], a[68:71], v[64:67]
    v_mfma_f32_16x16x32_bf16 v[64:67], v[40:43], a[72:75], v[64:67]
    ds_read_b64_tr_b16 v[56:57], v157 offset:57344
    ds_read_b64_tr_b16 v[58:59], v157 offset:57856
    v_mfma_f32_16x16x32_bf16 v[64:67], v[44:47], a[76:79], v[64:67]
    buffer_load_dwordx4 v179, s[28:31], s94 offen offset:3072 lds
    v_mfma_f32_16x16x32_bf16 v[68:71], v[44:47], a[92:95], v[68:71]
    ds_read_b64_tr_b16 v[60:61], v157 offset:61440
    ds_read_b64_tr_b16 v[62:63], v157 offset:61952
    v_mfma_f32_16x16x32_bf16 v[68:71], v[40:43], a[88:91], v[68:71]
    s_add_u32 m0, s91, 4096
    v_mfma_f32_16x16x32_bf16 v[68:71], v[36:39], a[84:87], v[68:71]
    s_xor_b32 s94, s46, 49664
    v_mfma_f32_16x16x32_bf16 v[68:71], v[32:35], a[80:83], v[68:71]
    buffer_load_dwordx4 v176, s[28:31], s94 offen offset:0 lds
    v_mfma_f32_16x16x32_bf16 v[72:75], v[32:35], a[96:99], v[72:75]
    v_mfma_f32_16x16x32_bf16 v[72:75], v[36:39], a[100:103], v[72:75]
    v_mfma_f32_16x16x32_bf16 v[72:75], v[40:43], a[104:107], v[72:75]
    v_mfma_f32_16x16x32_bf16 v[72:75], v[44:47], a[108:111], v[72:75]
    buffer_load_dwordx4 v177, s[28:31], s94 offen offset:1024 lds
    v_mfma_f32_16x16x32_bf16 v[76:79], v[44:47], a[124:127], v[76:79]
    s_waitcnt vmcnt(14)
    ds_read_b128 a[128:131], v184 offset:0
    ds_read_b128 a[132:135], v185 offset:0
    v_mfma_f32_16x16x32_bf16 v[76:79], v[40:43], a[120:123], v[76:79]
    v_mfma_f32_16x16x32_bf16 v[76:79], v[36:39], a[116:119], v[76:79]
    ds_read_b128 a[136:139], v186 offset:0
    ds_read_b128 a[140:143], v187 offset:0
    v_mfma_f32_16x16x32_bf16 v[76:79], v[32:35], a[112:115], v[76:79]
    buffer_load_dwordx4 v178, s[28:31], s94 offen offset:2048 lds
    v_mfma_f32_16x16x32_bf16 v[128:131], a[64:67], a[64:67], v[128:131]
    v_mfma_f32_16x16x32_bf16 v[128:131], a[68:71], a[68:71], v[128:131]
    v_mfma_f32_16x16x32_bf16 v[128:131], a[72:75], a[72:75], v[128:131]
    v_mfma_f32_16x16x32_bf16 v[128:131], a[76:79], a[76:79], v[128:131]
    buffer_load_dwordx4 v179, s[28:31], s94 offen offset:3072 lds
    v_smfmac_f32_16x16x64_bf16 v[144:147], v[160:163], a[64:71], v22
    v_smfmac_f32_16x16x64_bf16 v[144:147], v[160:163], a[72:79], v22
    s_waitcnt lgkmcnt(0)
    v_smfmac_f32_16x16x64_bf16 v[152:155], v[4:7], v[48:55], v22
    ds_read_b64_tr_b16 v[32:33], v158 offset:49152
    ds_read_b64_tr_b16 v[34:35], v158 offset:49664
    s_add_u32 m0, s91, 32768
    s_xor_b32 s94, s46, 768
    v_smfmac_f32_16x16x64_bf16 v[152:155], v[4:7], v[56:63], v22
    buffer_load_dwordx4 v176, s[28:31], s94 offen offset:0 lds
    v_mfma_f32_16x16x32_bf16 v[92:95], v[48:51], a[112:115], v[92:95]
    ds_read_b64_tr_b16 v[36:37], v158 offset:53248
    ds_read_b64_tr_b16 v[38:39], v158 offset:53760
    v_mfma_f32_16x16x32_bf16 v[92:95], v[52:55], a[116:119], v[92:95]
    v_mfma_f32_16x16x32_bf16 v[92:95], v[56:59], a[120:123], v[92:95]
    ds_read_b64_tr_b16 v[40:41], v158 offset:57344
    ds_read_b64_tr_b16 v[42:43], v158 offset:57856
    v_mfma_f32_16x16x32_bf16 v[92:95], v[60:63], a[124:127], v[92:95]
    buffer_load_dwordx4 v177, s[28:31], s94 offen offset:1024 lds
    v_mfma_f32_16x16x32_bf16 v[88:91], v[60:63], a[108:111], v[88:91]
    ds_read_b64_tr_b16 v[44:45], v158 offset:61440
    ds_read_b64_tr_b16 v[46:47], v158 offset:61952
    v_mfma_f32_16x16x32_bf16 v[88:91], v[56:59], a[104:107], v[88:91]
    v_mfma_f32_16x16x32_bf16 v[88:91], v[52:55], a[100:103], v[88:91]
    v_mfma_f32_16x16x32_bf16 v[88:91], v[48:51], a[96:99], v[88:91]
    buffer_load_dwordx4 v178, s[28:31], s94 offen offset:2048 lds
    v_mfma_f32_16x16x32_bf16 v[84:87], v[48:51], a[80:83], v[84:87]
    v_mfma_f32_16x16x32_bf16 v[84:87], v[52:55], a[84:87], v[84:87]
    v_mfma_f32_16x16x32_bf16 v[84:87], v[56:59], a[88:91], v[84:87]
    v_mfma_f32_16x16x32_bf16 v[84:87], v[60:63], a[92:95], v[84:87]
    buffer_load_dwordx4 v179, s[28:31], s94 offen offset:3072 lds
    v_mfma_f32_16x16x32_bf16 v[80:83], v[60:63], a[76:79], v[80:83]
    s_waitcnt vmcnt(16)
    ds_read_b128 a[144:147], v184 offset:4096
    ds_read_b128 a[148:151], v185 offset:4096
    v_mfma_f32_16x16x32_bf16 v[80:83], v[56:59], a[72:75], v[80:83]
    s_add_u32 m0, s90, 114688
    v_mfma_f32_16x16x32_bf16 v[80:83], v[52:55], a[68:71], v[80:83]
    s_xor_b32 s95, s46, 768
    s_mul_i32 s95, s95, 1792
    ds_read_b128 a[152:155], v186 offset:4096
    ds_read_b128 a[156:159], v187 offset:4096
    v_mfma_f32_16x16x32_bf16 v[80:83], v[48:51], a[64:67], v[80:83]
    buffer_load_dwordx4 v9, s[16:19], s95 offen lds
    v_mfma_f32_16x16x32_bf16 v[132:135], a[80:83], a[80:83], v[132:135]
    v_mfma_f32_16x16x32_bf16 v[132:135], a[84:87], a[84:87], v[132:135]
    s_add_u32 m0, s90, 118784
    v_mfma_f32_16x16x32_bf16 v[132:135], a[88:91], a[88:91], v[132:135]
    s_add_u32 s95, s95, 114688
    v_mfma_f32_16x16x32_bf16 v[132:135], a[92:95], a[92:95], v[132:135]
    buffer_load_dwordx4 v9, s[16:19], s95 offen lds
    v_smfmac_f32_16x16x64_bf16 v[144:147], v[164:167], a[80:87], v22
    v_smfmac_f32_16x16x64_bf16 v[144:147], v[164:167], a[88:95], v22
    s_waitcnt lgkmcnt(0)
    v_mfma_f32_16x16x32_bf16 v[96:99], v[32:35], a[64:67], v[96:99]
    ds_read_b64_tr_b16 v[48:49], v159 offset:49152
    ds_read_b64_tr_b16 v[50:51], v159 offset:49664
    s_add_u32 m0, s90, 122880
    s_add_u32 s95, s95, 114688
    v_mfma_f32_16x16x32_bf16 v[96:99], v[36:39], a[68:71], v[96:99]
    buffer_load_dwordx4 v9, s[16:19], s95 offen lds
    v_mfma_f32_16x16x32_bf16 v[96:99], v[40:43], a[72:75], v[96:99]
    ds_read_b64_tr_b16 v[52:53], v159 offset:53248
    ds_read_b64_tr_b16 v[54:55], v159 offset:53760
    v_mfma_f32_16x16x32_bf16 v[96:99], v[44:47], a[76:79], v[96:99]
    s_add_u32 m0, s90, 126976
    v_mfma_f32_16x16x32_bf16 v[100:103], v[44:47], a[92:95], v[100:103]
    s_add_u32 s95, s95, 114688
    ds_read_b64_tr_b16 v[56:57], v159 offset:57344
    ds_read_b64_tr_b16 v[58:59], v159 offset:57856
    v_mfma_f32_16x16x32_bf16 v[100:103], v[40:43], a[88:91], v[100:103]
    buffer_load_dwordx4 v9, s[16:19], s95 offen lds
    v_mfma_f32_16x16x32_bf16 v[100:103], v[36:39], a[84:87], v[100:103]
    ds_read_b64_tr_b16 v[60:61], v159 offset:61440
    ds_read_b64_tr_b16 v[62:63], v159 offset:61952
    v_mfma_f32_16x16x32_bf16 v[100:103], v[32:35], a[80:83], v[100:103]
    s_add_u32 m0, s91, 36864
    v_mfma_f32_16x16x32_bf16 v[104:107], v[32:35], a[96:99], v[104:107]
    s_xor_b32 s94, s46, 17152
    v_mfma_f32_16x16x32_bf16 v[104:107], v[36:39], a[100:103], v[104:107]
    buffer_load_dwordx4 v176, s[28:31], s94 offen offset:0 lds
    v_mfma_f32_16x16x32_bf16 v[104:107], v[40:43], a[104:107], v[104:107]
    v_mfma_f32_16x16x32_bf16 v[104:107], v[44:47], a[108:111], v[104:107]
    v_mfma_f32_16x16x32_bf16 v[108:111], v[44:47], a[124:127], v[108:111]
    v_mfma_f32_16x16x32_bf16 v[108:111], v[40:43], a[120:123], v[108:111]
    buffer_load_dwordx4 v177, s[28:31], s94 offen offset:1024 lds
    v_mfma_f32_16x16x32_bf16 v[108:111], v[36:39], a[116:119], v[108:111]
    s_waitcnt vmcnt(14)
    ds_read_b128 a[160:163], v180 offset:0
    ds_read_b128 a[164:167], v181 offset:0
    v_mfma_f32_16x16x32_bf16 v[108:111], v[32:35], a[112:115], v[108:111]
    v_mfma_f32_16x16x32_bf16 v[136:139], a[96:99], a[96:99], v[136:139]
    ds_read_b128 a[168:171], v182 offset:0
    ds_read_b128 a[172:175], v183 offset:0
    v_mfma_f32_16x16x32_bf16 v[136:139], a[100:103], a[100:103], v[136:139]
    buffer_load_dwordx4 v178, s[28:31], s94 offen offset:2048 lds
    v_mfma_f32_16x16x32_bf16 v[136:139], a[104:107], a[104:107], v[136:139]
    v_mfma_f32_16x16x32_bf16 v[136:139], a[108:111], a[108:111], v[136:139]
    v_smfmac_f32_16x16x64_bf16 v[144:147], v[168:171], a[96:103], v22
    v_smfmac_f32_16x16x64_bf16 v[144:147], v[168:171], a[104:111], v22
    s_waitcnt lgkmcnt(0)
    v_mfma_f32_16x16x32_bf16 v[124:127], v[48:51], a[112:115], v[124:127]
    s_waitcnt vmcnt(19)
    s_barrier
    v_mfma_f32_16x16x32_bf16 v[124:127], v[52:55], a[116:119], v[124:127]
    ds_read_b64_tr_b16 v[32:33], v156 offset:0
    ds_read_b64_tr_b16 v[34:35], v156 offset:512
    v_mfma_f32_16x16x32_bf16 v[124:127], v[56:59], a[120:123], v[124:127]
    buffer_load_dwordx4 v179, s[28:31], s94 offen offset:3072 lds
    v_mfma_f32_16x16x32_bf16 v[124:127], v[60:63], a[124:127], v[124:127]
    ds_read_b64_tr_b16 v[36:37], v156 offset:4096
    ds_read_b64_tr_b16 v[38:39], v156 offset:4608
    v_mfma_f32_16x16x32_bf16 v[120:123], v[60:63], a[108:111], v[120:123]
    s_add_u32 m0, s91, 65536
    v_mfma_f32_16x16x32_bf16 v[120:123], v[56:59], a[104:107], v[120:123]
    s_xor_b32 s94, s46, 33536
    ds_read_b64_tr_b16 v[40:41], v156 offset:8192
    ds_read_b64_tr_b16 v[42:43], v156 offset:8704
    v_mfma_f32_16x16x32_bf16 v[120:123], v[52:55], a[100:103], v[120:123]
    buffer_load_dwordx4 v176, s[28:31], s94 offen offset:0 lds
    v_mfma_f32_16x16x32_bf16 v[120:123], v[48:51], a[96:99], v[120:123]
    ds_read_b64_tr_b16 v[44:45], v156 offset:12288
    ds_read_b64_tr_b16 v[46:47], v156 offset:12800
    v_mfma_f32_16x16x32_bf16 v[116:119], v[48:51], a[80:83], v[116:119]
    v_mfma_f32_16x16x32_bf16 v[116:119], v[52:55], a[84:87], v[116:119]
    v_mfma_f32_16x16x32_bf16 v[116:119], v[56:59], a[88:91], v[116:119]
    buffer_load_dwordx4 v177, s[28:31], s94 offen offset:1024 lds
    v_mfma_f32_16x16x32_bf16 v[116:119], v[60:63], a[92:95], v[116:119]
    v_mfma_f32_16x16x32_bf16 v[112:115], v[60:63], a[76:79], v[112:115]
    v_mfma_f32_16x16x32_bf16 v[112:115], v[56:59], a[72:75], v[112:115]
    v_mfma_f32_16x16x32_bf16 v[112:115], v[52:55], a[68:71], v[112:115]
    buffer_load_dwordx4 v178, s[28:31], s94 offen offset:2048 lds
    v_mfma_f32_16x16x32_bf16 v[112:115], v[48:51], a[64:67], v[112:115]
    s_waitcnt vmcnt(15)
    ds_read_b128 a[176:179], v180 offset:4096
    ds_read_b128 a[180:183], v181 offset:4096
    v_mfma_f32_16x16x32_bf16 v[140:143], a[112:115], a[112:115], v[140:143]
    v_mfma_f32_16x16x32_bf16 v[140:143], a[116:119], a[116:119], v[140:143]
    ds_read_b128 a[184:187], v182 offset:4096
    ds_read_b128 a[188:191], v183 offset:4096
    v_mfma_f32_16x16x32_bf16 v[140:143], a[120:123], a[120:123], v[140:143]
    buffer_load_dwordx4 v179, s[28:31], s94 offen offset:3072 lds
    v_mfma_f32_16x16x32_bf16 v[140:143], a[124:127], a[124:127], v[140:143]
    v_smfmac_f32_16x16x64_bf16 v[144:147], v[172:175], a[112:119], v22
    v_smfmac_f32_16x16x64_bf16 v[144:147], v[172:175], a[120:127], v22
    s_waitcnt lgkmcnt(0)
    v_smfmac_f32_16x16x64_bf16 v[148:151], v[4:7], v[32:39], v22
    ds_read_b64_tr_b16 v[48:49], v157 offset:0
    ds_read_b64_tr_b16 v[50:51], v157 offset:512
    s_add_u32 m0, s91, 69632
    s_xor_b32 s94, s46, 49920
    v_smfmac_f32_16x16x64_bf16 v[148:151], v[4:7], v[40:47], v22
    buffer_load_dwordx4 v176, s[28:31], s94 offen offset:0 lds
    v_lshlrev_b32 v220, 16, v196
    v_mfma_f32_16x16x32_bf16 v[64:67], v[32:35], a[128:131], v[64:67]
    ds_read_b64_tr_b16 v[52:53], v157 offset:4096
    ds_read_b64_tr_b16 v[54:55], v157 offset:4608
    v_mfma_f32_16x16x32_bf16 v[64:67], v[36:39], a[132:135], v[64:67]
    v_and_b32 v221, 0xffff0000, v196
    v_lshlrev_b32 v222, 16, v197
    v_mfma_f32_16x16x32_bf16 v[64:67], v[40:43], a[136:139], v[64:67]
    ds_read_b64_tr_b16 v[56:57], v157 offset:8192
    ds_read_b64_tr_b16 v[58:59], v157 offset:8704
    v_mfma_f32_16x16x32_bf16 v[64:67], v[44:47], a[140:143], v[64:67]
    buffer_load_dwordx4 v177, s[28:31], s94 offen offset:1024 lds
    v_and_b32 v223, 0xffff0000, v197
    v_mfma_f32_16x16x32_bf16 v[68:71], v[44:47], a[156:159], v[68:71]
    ds_read_b64_tr_b16 v[60:61], v157 offset:12288
    ds_read_b64_tr_b16 v[62:63], v157 offset:12800
    v_mfma_f32_16x16x32_bf16 v[68:71], v[40:43], a[152:155], v[68:71]
    v_lshlrev_b32 v228, 16, v198
    v_and_b32 v229, 0xffff0000, v198
    v_mfma_f32_16x16x32_bf16 v[68:71], v[36:39], a[148:151], v[68:71]
    v_lshlrev_b32 v230, 16, v199
    v_and_b32 v231, 0xffff0000, v199
    v_mfma_f32_16x16x32_bf16 v[68:71], v[32:35], a[144:147], v[68:71]
    buffer_load_dwordx4 v178, s[28:31], s94 offen offset:2048 lds
    v_lshlrev_b32 v236, 16, v200
    v_mfma_f32_16x16x32_bf16 v[72:75], v[32:35], a[160:163], v[72:75]
    v_and_b32 v237, 0xffff0000, v200
    v_lshlrev_b32 v238, 16, v201
    v_mfma_f32_16x16x32_bf16 v[72:75], v[36:39], a[164:167], v[72:75]
    v_and_b32 v239, 0xffff0000, v201
    v_lshlrev_b32 v244, 16, v202
    v_mfma_f32_16x16x32_bf16 v[72:75], v[40:43], a[168:171], v[72:75]
    v_and_b32 v245, 0xffff0000, v202
    v_lshlrev_b32 v246, 16, v203
    v_mfma_f32_16x16x32_bf16 v[72:75], v[44:47], a[172:175], v[72:75]
    buffer_load_dwordx4 v179, s[28:31], s94 offen offset:3072 lds
    v_and_b32 v247, 0xffff0000, v203
    v_mfma_f32_16x16x32_bf16 v[76:79], v[44:47], a[188:191], v[76:79]
    s_waitcnt vmcnt(16)
    ds_read_b128 a[192:195], v180 offset:32768
    ds_read_b128 a[196:199], v181 offset:32768
    v_mfma_f32_16x16x32_bf16 v[76:79], v[40:43], a[184:187], v[76:79]
    s_add_u32 m0, s91, 0
    v_mfma_f32_16x16x32_bf16 v[76:79], v[36:39], a[180:183], v[76:79]
    s_xor_b32 s94, s47, 0
    ds_read_b128 a[200:203], v182 offset:32768
    ds_read_b128 a[204:207], v183 offset:32768
    v_mfma_f32_16x16x32_bf16 v[76:79], v[32:35], a[176:179], v[76:79]
    buffer_load_dwordx4 v8, s[12:15], s94 offen offset:0 lds
    v_mfma_f32_16x16x32_bf16 v[128:131], a[128:131], a[128:131], v[128:131]
    v_mfma_f32_16x16x32_bf16 v[128:131], a[132:135], a[132:135], v[128:131]
    v_mfma_f32_16x16x32_bf16 v[128:131], a[136:139], a[136:139], v[128:131]
    s_xor_b32 s94, s47, 31744
    v_mfma_f32_16x16x32_bf16 v[128:131], a[140:143], a[140:143], v[128:131]
    buffer_load_dwordx4 v8, s[12:15], s94 offen offset:1024 lds
    v_smfmac_f32_16x16x64_bf16 v[144:147], v[160:163], a[128:135], v22
    v_smfmac_f32_16x16x64_bf16 v[144:147], v[160:163], a[136:143], v22
    s_waitcnt lgkmcnt(0)
    v_smfmac_f32_16x16x64_bf16 v[152:155], v[4:7], v[48:55], v22
    ds_read_b64_tr_b16 v[32:33], v158 offset:0
    ds_read_b64_tr_b16 v[34:35], v158 offset:512
    s_xor_b32 s94, s47, 63488
    v_smfmac_f32_16x16x64_bf16 v[152:155], v[4:7], v[56:63], v22
    buffer_load_dwordx4 v8, s[12:15], s94 offen offset:2048 lds
    v_mfma_f32_16x16x32_bf16 v[92:95], v[48:51], a[176:179], v[92:95]
    ds_read_b64_tr_b16 v[36:37], v158 offset:4096
    ds_read_b64_tr_b16 v[38:39], v158 offset:4608
    v_mfma_f32_16x16x32_bf16 v[92:95], v[52:55], a[180:183], v[92:95]
    v_mfma_f32_16x16x32_bf16 v[92:95], v[56:59], a[184:187], v[92:95]
    s_xor_b32 s94, s47, 95232
    ds_read_b64_tr_b16 v[40:41], v158 offset:8192
    ds_read_b64_tr_b16 v[42:43], v158 offset:8704
    v_mfma_f32_16x16x32_bf16 v[92:95], v[60:63], a[188:191], v[92:95]
    buffer_load_dwordx4 v8, s[12:15], s94 offen offset:3072 lds
    v_mfma_f32_16x16x32_bf16 v[88:91], v[60:63], a[172:175], v[88:91]
    ds_read_b64_tr_b16 v[44:45], v158 offset:12288
    ds_read_b64_tr_b16 v[46:47], v158 offset:12800
    v_mfma_f32_16x16x32_bf16 v[88:91], v[56:59], a[168:171], v[88:91]
    v_mfma_f32_16x16x32_bf16 v[88:91], v[52:55], a[164:167], v[88:91]
    v_mfma_f32_16x16x32_bf16 v[88:91], v[48:51], a[160:163], v[88:91]
    buffer_load_dword v194, v23, s[40:43], 0 offen sc1
    v_mfma_f32_16x16x32_bf16 v[84:87], v[48:51], a[144:147], v[84:87]
    v_mfma_f32_16x16x32_bf16 v[84:87], v[52:55], a[148:151], v[84:87]
    s_add_u32 m0, s91, 4096
    v_mfma_f32_16x16x32_bf16 v[84:87], v[56:59], a[152:155], v[84:87]
    s_xor_b32 s94, s47, 131072
    v_mfma_f32_16x16x32_bf16 v[84:87], v[60:63], a[156:159], v[84:87]
    buffer_load_dwordx4 v8, s[12:15], s94 offen offset:0 lds
    v_mfma_f32_16x16x32_bf16 v[80:83], v[60:63], a[140:143], v[80:83]
    s_waitcnt vmcnt(14)
    ds_read_b128 a[208:211], v180 offset:36864
    ds_read_b128 a[212:215], v181 offset:36864
    v_mfma_f32_16x16x32_bf16 v[80:83], v[56:59], a[136:139], v[80:83]
    v_mfma_f32_16x16x32_bf16 v[80:83], v[52:55], a[132:135], v[80:83]
    s_xor_b32 s94, s47, 162816
    ds_read_b128 a[216:219], v182 offset:36864
    ds_read_b128 a[220:223], v183 offset:36864
    v_mfma_f32_16x16x32_bf16 v[80:83], v[48:51], a[128:131], v[80:83]
    buffer_load_dwordx4 v8, s[12:15], s94 offen offset:1024 lds
    v_mfma_f32_16x16x32_bf16 v[132:135], a[144:147], a[144:147], v[132:135]
    v_mfma_f32_16x16x32_bf16 v[132:135], a[148:151], a[148:151], v[132:135]
    v_mfma_f32_16x16x32_bf16 v[132:135], a[152:155], a[152:155], v[132:135]
    s_xor_b32 s94, s47, 194560
    v_mfma_f32_16x16x32_bf16 v[132:135], a[156:159], a[156:159], v[132:135]
    buffer_load_dwordx4 v8, s[12:15], s94 offen offset:2048 lds
    v_smfmac_f32_16x16x64_bf16 v[144:147], v[164:167], a[144:151], v22
    v_smfmac_f32_16x16x64_bf16 v[144:147], v[164:167], a[152:159], v22
    s_waitcnt lgkmcnt(0)
    v_mfma_f32_16x16x32_bf16 v[96:99], v[32:35], a[128:131], v[96:99]
    ds_read_b64_tr_b16 v[48:49], v159 offset:0
    ds_read_b64_tr_b16 v[50:51], v159 offset:512
    s_xor_b32 s94, s47, 226304
    v_mfma_f32_16x16x32_bf16 v[96:99], v[36:39], a[132:135], v[96:99]
    buffer_load_dwordx4 v8, s[12:15], s94 offen offset:3072 lds
    v_mfma_f32_16x16x32_bf16 v[96:99], v[40:43], a[136:139], v[96:99]
    ds_read_b64_tr_b16 v[52:53], v159 offset:4096
    ds_read_b64_tr_b16 v[54:55], v159 offset:4608
    v_mfma_f32_16x16x32_bf16 v[96:99], v[44:47], a[140:143], v[96:99]
    v_mfma_f32_16x16x32_bf16 v[100:103], v[44:47], a[156:159], v[100:103]
    ds_read_b64_tr_b16 v[56:57], v159 offset:8192
    ds_read_b64_tr_b16 v[58:59], v159 offset:8704
    v_mfma_f32_16x16x32_bf16 v[100:103], v[40:43], a[152:155], v[100:103]
    v_mfma_f32_16x16x32_bf16 v[100:103], v[36:39], a[148:151], v[100:103]
    ds_read_b64_tr_b16 v[60:61], v159 offset:12288
    ds_read_b64_tr_b16 v[62:63], v159 offset:12800
    v_mfma_f32_16x16x32_bf16 v[100:103], v[32:35], a[144:147], v[100:103]
    v_mfma_f32_16x16x32_bf16 v[104:107], v[32:35], a[160:163], v[104:107]
    v_mfma_f32_16x16x32_bf16 v[104:107], v[36:39], a[164:167], v[104:107]
    v_mfma_f32_16x16x32_bf16 v[104:107], v[40:43], a[168:171], v[104:107]
    v_mfma_f32_16x16x32_bf16 v[104:107], v[44:47], a[172:175], v[104:107]
    v_mfma_f32_16x16x32_bf16 v[108:111], v[44:47], a[188:191], v[108:111]
    v_mfma_f32_16x16x32_bf16 v[108:111], v[40:43], a[184:187], v[108:111]
    v_mfma_f32_16x16x32_bf16 v[108:111], v[36:39], a[180:183], v[108:111]
    s_waitcnt vmcnt(13)
    ds_read_b128 a[224:227], v184 offset:0
    ds_read_b128 a[228:231], v185 offset:0
    v_mfma_f32_16x16x32_bf16 v[108:111], v[32:35], a[176:179], v[108:111]
    v_mfma_f32_16x16x32_bf16 v[136:139], a[160:163], a[160:163], v[136:139]
    ds_read_b128 a[232:235], v186 offset:0
    ds_read_b128 a[236:239], v187 offset:0
    v_mfma_f32_16x16x32_bf16 v[136:139], a[164:167], a[164:167], v[136:139]
    v_mfma_f32_16x16x32_bf16 v[136:139], a[168:171], a[168:171], v[136:139]
    v_mfma_f32_16x16x32_bf16 v[136:139], a[172:175], a[172:175], v[136:139]
    v_smfmac_f32_16x16x64_bf16 v[144:147], v[168:171], a[160:167], v22
    v_smfmac_f32_16x16x64_bf16 v[144:147], v[168:171], a[168:175], v22
    s_waitcnt lgkmcnt(0)
    v_mfma_f32_16x16x32_bf16 v[124:127], v[48:51], a[176:179], v[124:127]
    s_waitcnt vmcnt(21)
    s_barrier
    v_mfma_f32_16x16x32_bf16 v[124:127], v[52:55], a[180:183], v[124:127]
    ds_read_b64_tr_b16 v[32:33], v156 offset:16384
    ds_read_b64_tr_b16 v[34:35], v156 offset:16896
    v_mfma_f32_16x16x32_bf16 v[124:127], v[56:59], a[184:187], v[124:127]
    v_mfma_f32_16x16x32_bf16 v[124:127], v[60:63], a[188:191], v[124:127]
    ds_read_b64_tr_b16 v[36:37], v156 offset:20480
    ds_read_b64_tr_b16 v[38:39], v156 offset:20992
    v_mfma_f32_16x16x32_bf16 v[120:123], v[60:63], a[172:175], v[120:123]
    v_mfma_f32_16x16x32_bf16 v[120:123], v[56:59], a[168:171], v[120:123]
    ds_read_b64_tr_b16 v[40:41], v156 offset:24576
    ds_read_b64_tr_b16 v[42:43], v156 offset:25088
    v_mfma_f32_16x16x32_bf16 v[120:123], v[52:55], a[164:167], v[120:123]
    v_mfma_f32_16x16x32_bf16 v[120:123], v[48:51], a[160:163], v[120:123]
    ds_read_b64_tr_b16 v[44:45], v156 offset:28672
    ds_read_b64_tr_b16 v[46:47], v156 offset:29184
    v_mfma_f32_16x16x32_bf16 v[116:119], v[48:51], a[144:147], v[116:119]
    v_mfma_f32_16x16x32_bf16 v[116:119], v[52:55], a[148:151], v[116:119]
    v_mfma_f32_16x16x32_bf16 v[116:119], v[56:59], a[152:155], v[116:119]
    v_mfma_f32_16x16x32_bf16 v[116:119], v[60:63], a[156:159], v[116:119]
    v_mfma_f32_16x16x32_bf16 v[112:115], v[60:63], a[140:143], v[112:115]
    v_mfma_f32_16x16x32_bf16 v[112:115], v[56:59], a[136:139], v[112:115]
    v_mfma_f32_16x16x32_bf16 v[112:115], v[52:55], a[132:135], v[112:115]
    v_mfma_f32_16x16x32_bf16 v[112:115], v[48:51], a[128:131], v[112:115]
    s_waitcnt vmcnt(9)
    ds_read_b128 a[240:243], v184 offset:4096
    ds_read_b128 a[244:247], v185 offset:4096
    v_mfma_f32_16x16x32_bf16 v[140:143], a[176:179], a[176:179], v[140:143]
    v_mfma_f32_16x16x32_bf16 v[140:143], a[180:183], a[180:183], v[140:143]
    ds_read_b128 a[248:251], v186 offset:4096
    ds_read_b128 a[252:255], v187 offset:4096
    v_mfma_f32_16x16x32_bf16 v[140:143], a[184:187], a[184:187], v[140:143]
    v_mfma_f32_16x16x32_bf16 v[140:143], a[188:191], a[188:191], v[140:143]
    v_smfmac_f32_16x16x64_bf16 v[144:147], v[172:175], a[176:183], v22
    v_smfmac_f32_16x16x64_bf16 v[144:147], v[172:175], a[184:191], v22
    s_waitcnt lgkmcnt(0)
    v_mfma_f32_16x16x32_bf16 v[128:131], a[192:195], a[192:195], v[128:131]
    ds_read_b64_tr_b16 v[48:49], v157 offset:16384
    ds_read_b64_tr_b16 v[50:51], v157 offset:16896
    v_mfma_f32_16x16x32_bf16 v[128:131], a[196:199], a[196:199], v[128:131]
    v_mfma_f32_16x16x32_bf16 v[128:131], a[200:203], a[200:203], v[128:131]
    ds_read_b64_tr_b16 v[52:53], v157 offset:20480
    ds_read_b64_tr_b16 v[54:55], v157 offset:20992
    v_mfma_f32_16x16x32_bf16 v[128:131], a[204:207], a[204:207], v[128:131]
    v_mfma_f32_16x16x32_bf16 v[132:135], a[208:211], a[208:211], v[132:135]
    ds_read_b64_tr_b16 v[56:57], v157 offset:24576
    ds_read_b64_tr_b16 v[58:59], v157 offset:25088
    v_mfma_f32_16x16x32_bf16 v[132:135], a[212:215], a[212:215], v[132:135]
    v_mfma_f32_16x16x32_bf16 v[132:135], a[216:219], a[216:219], v[132:135]
    ds_read_b64_tr_b16 v[60:61], v157 offset:28672
    ds_read_b64_tr_b16 v[62:63], v157 offset:29184
    v_mfma_f32_16x16x32_bf16 v[132:135], a[220:223], a[220:223], v[132:135]
    v_mfma_f32_16x16x32_bf16 v[136:139], a[224:227], a[224:227], v[136:139]
    v_mfma_f32_16x16x32_bf16 v[136:139], a[228:231], a[228:231], v[136:139]
    v_mfma_f32_16x16x32_bf16 v[136:139], a[232:235], a[232:235], v[136:139]
    v_mfma_f32_16x16x32_bf16 v[136:139], a[236:239], a[236:239], v[136:139]
    v_mfma_f32_16x16x32_bf16 v[140:143], a[240:243], a[240:243], v[140:143]
    v_mfma_f32_16x16x32_bf16 v[140:143], a[244:247], a[244:247], v[140:143]
    v_mfma_f32_16x16x32_bf16 v[140:143], a[248:251], a[248:251], v[140:143]
    v_mfma_f32_16x16x32_bf16 v[140:143], a[252:255], a[252:255], v[140:143]
    v_smfmac_f32_16x16x64_bf16 v[144:147], v[160:163], a[192:199], v22
    v_smfmac_f32_16x16x64_bf16 v[144:147], v[160:163], a[200:207], v22
    v_smfmac_f32_16x16x64_bf16 v[144:147], v[164:167], a[208:215], v22
    v_smfmac_f32_16x16x64_bf16 v[144:147], v[164:167], a[216:223], v22
    v_smfmac_f32_16x16x64_bf16 v[144:147], v[168:171], a[224:231], v22
    v_smfmac_f32_16x16x64_bf16 v[144:147], v[168:171], a[232:239], v22
    v_smfmac_f32_16x16x64_bf16 v[144:147], v[172:175], a[240:247], v22
    v_smfmac_f32_16x16x64_bf16 v[144:147], v[172:175], a[248:255], v22
    v_smfmac_f32_16x16x64_bf16 v[148:151], v[4:7], v[32:39], v22
    v_smfmac_f32_16x16x64_bf16 v[148:151], v[4:7], v[40:47], v22
    v_mfma_f32_16x16x32_bf16 v[64:67], v[32:35], a[192:195], v[64:67]
    ds_write_b128 v188, v[128:131] offset:0
    ds_write_b128 v188, v[132:135] offset:1024
    v_mfma_f32_16x16x32_bf16 v[64:67], v[36:39], a[196:199], v[64:67]
    ds_write_b128 v188, v[136:139] offset:2048
    ds_write_b128 v188, v[140:143] offset:3072
    v_mfma_f32_16x16x32_bf16 v[64:67], v[40:43], a[200:203], v[64:67]
    ds_read_b32 v211, v189 offset:0
    v_mfma_f32_16x16x32_bf16 v[64:67], v[44:47], a[204:207], v[64:67]
    v_mfma_f32_16x16x32_bf16 v[68:71], v[44:47], a[220:223], v[68:71]
    v_mfma_f32_16x16x32_bf16 v[68:71], v[40:43], a[216:219], v[68:71]
    v_mfma_f32_16x16x32_bf16 v[68:71], v[36:39], a[212:215], v[68:71]
    v_add_f32 v206, v144, v145
    v_mul_f32 v206, 0x3b000000, v206
    v_mfma_f32_16x16x32_bf16 v[68:71], v[32:35], a[208:211], v[68:71]
    v_mul_f32 v208, v206, v206
    v_cvt_pk_bf16_f32 v12, v206, v206
    v_mfma_f32_16x16x32_bf16 v[72:75], v[32:35], a[224:227], v[72:75]
    v_and_b32 v12, 0xffff0000, v12
    v_mfma_f32_16x16x32_bf16 v[72:75], v[36:39], a[228:231], v[72:75]
    v_mfma_f32_16x16x32_bf16 v[72:75], v[40:43], a[232:235], v[72:75]
    v_mfma_f32_16x16x32_bf16 v[72:75], v[44:47], a[236:239], v[72:75]
    v_mfma_f32_16x16x32_bf16 v[76:79], v[44:47], a[252:255], v[76:79]
    v_mfma_f32_16x16x32_bf16 v[76:79], v[40:43], a[248:251], v[76:79]
    v_mfma_f32_16x16x32_bf16 v[76:79], v[36:39], a[244:247], v[76:79]
    v_mfma_f32_16x16x32_bf16 v[76:79], v[32:35], a[240:243], v[76:79]
    s_waitcnt lgkmcnt(0)
    v_smfmac_f32_16x16x64_bf16 v[152:155], v[4:7], v[48:55], v22
    ds_read_b64_tr_b16 v[32:33], v158 offset:16384
    ds_read_b64_tr_b16 v[34:35], v158 offset:16896
    v_smfmac_f32_16x16x64_bf16 v[152:155], v[4:7], v[56:63], v22
    v_mul_f32 v211, 0x3b000000, v211
    v_sub_f32 v208, v211, v208
    v_mfma_f32_16x16x32_bf16 v[92:95], v[48:51], a[240:243], v[92:95]
    ds_read_b64_tr_b16 v[36:37], v158 offset:20480
    ds_read_b64_tr_b16 v[38:39], v158 offset:20992
    v_mfma_f32_16x16x32_bf16 v[92:95], v[52:55], a[244:247], v[92:95]
    v_max_f32 v208, 0, v208
    v_cvt_pk_bf16_f32 v209, v208, v208
    v_mfma_f32_16x16x32_bf16 v[92:95], v[56:59], a[248:251], v[92:95]
    ds_read_b64_tr_b16 v[40:41], v158 offset:24576
    ds_read_b64_tr_b16 v[42:43], v158 offset:25088
    v_mfma_f32_16x16x32_bf16 v[92:95], v[60:63], a[252:255], v[92:95]
    v_and_b32 v209, 0xffff0000, v209
    v_add_f32 v209, 0x3727c5ac, v209
    v_mfma_f32_16x16x32_bf16 v[88:91], v[60:63], a[236:239], v[88:91]
    ds_read_b64_tr_b16 v[44:45], v158 offset:28672
    ds_read_b64_tr_b16 v[46:47], v158 offset:29184
    v_mfma_f32_16x16x32_bf16 v[88:91], v[56:59], a[232:235], v[88:91]
    v_cvt_pk_bf16_f32 v209, v209, v209
    v_and_b32 v209, 0xffff0000, v209
    v_mfma_f32_16x16x32_bf16 v[88:91], v[52:55], a[228:231], v[88:91]
    v_sqrt_f32 v209, v209
    v_mfma_f32_16x16x32_bf16 v[88:91], v[48:51], a[224:227], v[88:91]
    v_cvt_pk_bf16_f32 v209, v209, v209
    v_and_b32 v209, 0xffff0000, v209
    v_mfma_f32_16x16x32_bf16 v[84:87], v[48:51], a[208:211], v[84:87]
    v_rcp_f32 v210, v209
    v_mfma_f32_16x16x32_bf16 v[84:87], v[52:55], a[212:215], v[84:87]
    v_mul_f32 v208, v208, v210
    v_mul_f32 v208, v208, v210
    v_mfma_f32_16x16x32_bf16 v[84:87], v[56:59], a[216:219], v[84:87]
    v_cvt_pk_bf16_f32 v209, v208, v208
    v_and_b32 v209, 0xffff0000, v209
    v_mfma_f32_16x16x32_bf16 v[84:87], v[60:63], a[220:223], v[84:87]
    v_add_f32 v209, 0x3727c5ac, v209
    v_cvt_pk_bf16_f32 v209, v209, v209
    v_mfma_f32_16x16x32_bf16 v[80:83], v[60:63], a[204:207], v[80:83]
    v_and_b32 v209, 0xffff0000, v209
    v_mfma_f32_16x16x32_bf16 v[80:83], v[56:59], a[200:203], v[80:83]
    v_sqrt_f32 v209, v209
    v_mfma_f32_16x16x32_bf16 v[80:83], v[52:55], a[196:199], v[80:83]
    v_cvt_pk_bf16_f32 v209, v209, v209
    v_and_b32 v209, 0xffff0000, v209
    v_mfma_f32_16x16x32_bf16 v[80:83], v[48:51], a[192:195], v[80:83]
    s_waitcnt lgkmcnt(0)
    v_rcp_f32 v207, v209
    v_mfma_f32_16x16x32_bf16 v[96:99], v[32:35], a[192:195], v[96:99]
    ds_read_b64_tr_b16 v[48:49], v159 offset:16384
    ds_read_b64_tr_b16 v[50:51], v159 offset:16896
    s_add_u32 m0, s91, 32768
    s_xor_b32 s94, s47, 1048576
    v_mfma_f32_16x16x32_bf16 v[96:99], v[36:39], a[196:199], v[96:99]
    buffer_load_dwordx4 v8, s[12:15], s94 offen offset:0 lds
    v_mul_f32 v13, 0x3e0293ee, v210
    v_mfma_f32_16x16x32_bf16 v[96:99], v[40:43], a[200:203], v[96:99]
    ds_read_b64_tr_b16 v[52:53], v159 offset:20480
    ds_read_b64_tr_b16 v[54:55], v159 offset:20992
    v_mfma_f32_16x16x32_bf16 v[96:99], v[44:47], a[204:207], v[96:99]
    v_mul_f32 v207, v207, v210
    ds_write_b64 v188, v[206:207] offset:4096
    v_mfma_f32_16x16x32_bf16 v[100:103], v[44:47], a[220:223], v[100:103]
    s_xor_b32 s94, s47, 1080320
    ds_read_b64_tr_b16 v[56:57], v159 offset:24576
    ds_read_b64_tr_b16 v[58:59], v159 offset:25088
    v_mfma_f32_16x16x32_bf16 v[100:103], v[40:43], a[216:219], v[100:103]
    buffer_load_dwordx4 v8, s[12:15], s94 offen offset:1024 lds
    ds_read_b64 v[248:249], v190 offset:4096
    v_mfma_f32_16x16x32_bf16 v[100:103], v[36:39], a[212:215], v[100:103]
    ds_read_b64_tr_b16 v[60:61], v159 offset:28672
    ds_read_b64_tr_b16 v[62:63], v159 offset:29184
    v_mfma_f32_16x16x32_bf16 v[100:103], v[32:35], a[208:211], v[100:103]
    ds_read_b64 v[250:251], v190 offset:4352
    ds_read_b64 v[252:253], v190 offset:4608
    v_mfma_f32_16x16x32_bf16 v[104:107], v[32:35], a[224:227], v[104:107]
    s_xor_b32 s94, s47, 1112064
    ds_read_b64 v[254:255], v190 offset:4864
    v_add_f32 v208, v148, v149
    v_mfma_f32_16x16x32_bf16 v[104:107], v[36:39], a[228:231], v[104:107]
    buffer_load_dwordx4 v8, s[12:15], s94 offen offset:2048 lds
    v_add_f32 v209, v152, v153
    v_mfma_f32_16x16x32_bf16 v[104:107], v[40:43], a[232:235], v[104:107]
    ds_write_b32 v191, v208
    ds_write_b32 v191, v209 offset:64
    v_mfma_f32_16x16x32_bf16 v[104:107], v[44:47], a[236:239], v[104:107]
    v_mfma_f32_16x16x32_bf16 v[108:111], v[44:47], a[252:255], v[108:111]
    s_xor_b32 s94, s47, 1143808
    v_mfma_f32_16x16x32_bf16 v[108:111], v[40:43], a[248:251], v[108:111]
    buffer_load_dwordx4 v8, s[12:15], s94 offen offset:3072 lds
    v_mfma_f32_16x16x32_bf16 v[108:111], v[36:39], a[244:247], v[108:111]
    v_mfma_f32_16x16x32_bf16 v[108:111], v[32:35], a[240:243], v[108:111]
    s_waitcnt lgkmcnt(0)
    v_mfma_f32_16x16x32_bf16 v[124:127], v[48:51], a[240:243], v[124:127]
    s_waitcnt vmcnt(4)
    s_barrier
    s_add_u32 m0, s91, 36864
    v_mfma_f32_16x16x32_bf16 v[124:127], v[52:55], a[244:247], v[124:127]
    s_xor_b32 s94, s47, 1179648
    ds_read_b64_tr_b16 v[32:33], v24 offset:0
    ds_read_b64_tr_b16 v[34:35], v24 offset:1024
    v_mfma_f32_16x16x32_bf16 v[124:127], v[56:59], a[248:251], v[124:127]
    buffer_load_dwordx4 v8, s[12:15], s94 offen offset:0 lds
    ds_read_b128 v[216:219], v192 offset:0
    v_mfma_f32_16x16x32_bf16 v[124:127], v[60:63], a[252:255], v[124:127]
    ds_read_b64_tr_b16 v[36:37], v24 offset:8192
    ds_read_b64_tr_b16 v[38:39], v24 offset:9216
    v_mfma_f32_16x16x32_bf16 v[120:123], v[60:63], a[236:239], v[120:123]
    ds_read_b128 v[224:227], v192 offset:64
    ds_read_b128 v[232:235], v193 offset:0
    v_mfma_f32_16x16x32_bf16 v[120:123], v[56:59], a[232:235], v[120:123]
    s_xor_b32 s94, s47, 1211392
    ds_read_b64_tr_b16 v[40:41], v24 offset:16384
    ds_read_b64_tr_b16 v[42:43], v24 offset:17408
    v_mfma_f32_16x16x32_bf16 v[120:123], v[52:55], a[228:231], v[120:123]
    buffer_load_dwordx4 v8, s[12:15], s94 offen offset:1024 lds
    ds_read_b128 v[240:243], v193 offset:64
    v_mfma_f32_16x16x32_bf16 v[120:123], v[48:51], a[224:227], v[120:123]
    ds_read_b64_tr_b16 v[44:45], v24 offset:24576
    ds_read_b64_tr_b16 v[46:47], v24 offset:25600
    v_mfma_f32_16x16x32_bf16 v[116:119], v[48:51], a[208:211], v[116:119]
    v_mfma_f32_16x16x32_bf16 v[116:119], v[52:55], a[212:215], v[116:119]
    s_xor_b32 s94, s47, 1243136
    v_mfma_f32_16x16x32_bf16 v[116:119], v[56:59], a[216:219], v[116:119]
    buffer_load_dwordx4 v8, s[12:15], s94 offen offset:2048 lds
    v_mfma_f32_16x16x32_bf16 v[116:119], v[60:63], a[220:223], v[116:119]
    s_waitcnt lgkmcnt(0)
    v_fma_f32 v64, -v248, v216, v64
    v_fma_f32 v65, -v248, v217, v65
    v_mfma_f32_16x16x32_bf16 v[112:115], v[60:63], a[204:207], v[112:115]
    v_fma_f32 v66, -v248, v218, v66
    v_fma_f32 v67, -v248, v219, v67
    v_mfma_f32_16x16x32_bf16 v[112:115], v[56:59], a[200:203], v[112:115]
    s_xor_b32 s94, s47, 1274880
    v_fma_f32 v64, v64, v249, v220
    v_fma_f32 v65, v65, v249, v221
    v_mfma_f32_16x16x32_bf16 v[112:115], v[52:55], a[196:199], v[112:115]
    buffer_load_dwordx4 v8, s[12:15], s94 offen offset:3072 lds
    v_fma_f32 v66, v66, v249, v222
    v_mfma_f32_16x16x32_bf16 v[112:115], v[48:51], a[192:195], v[112:115]
    s_waitcnt lgkmcnt(0)
    v_fma_f32 v67, v67, v249, v223
    v_fma_f32 v68, -v250, v216, v68
    v_smfmac_f32_16x16x64_bf16 v[16:19], v[4:7], v[32:39], v22
    ds_read_b64_tr_b16 v[48:49], v24 offset:8
    ds_read_b64_tr_b16 v[50:51], v24 offset:1032
    s_add_u32 m0, s91, 65536
    s_xor_b32 s94, s47, 2097152
    v_smfmac_f32_16x16x64_bf16 v[16:19], v[4:7], v[40:47], v22
    buffer_load_dwordx4 v8, s[12:15], s94 offen offset:0 lds
    v_fma_f32 v69, -v250, v217, v69
    v_mfma_f32_16x16x32_bf16 v[128:131], v[32:35], a[0:3], 0
    ds_read_b64_tr_b16 v[52:53], v24 offset:8200
    ds_read_b64_tr_b16 v[54:55], v24 offset:9224
    v_mfma_f32_16x16x32_bf16 v[128:131], v[36:39], a[4:7], v[128:131]
    v_fma_f32 v70, -v250, v218, v70
    v_fma_f32 v71, -v250, v219, v71
    v_mfma_f32_16x16x32_bf16 v[128:131], v[40:43], a[8:11], v[128:131]
    s_xor_b32 s94, s47, 2128896
    ds_read_b64_tr_b16 v[56:57], v24 offset:16392
    ds_read_b64_tr_b16 v[58:59], v24 offset:17416
    v_mfma_f32_16x16x32_bf16 v[128:131], v[44:47], a[12:15], v[128:131]
    buffer_load_dwordx4 v8, s[12:15], s94 offen offset:1024 lds
    v_fma_f32 v68, v68, v251, v220
    v_mfma_f32_16x16x32_bf16 v[132:135], v[44:47], a[28:31], 0
    ds_read_b64_tr_b16 v[60:61], v24 offset:24584
    ds_read_b64_tr_b16 v[62:63], v24 offset:25608
    v_mfma_f32_16x16x32_bf16 v[132:135], v[40:43], a[24:27], v[132:135]
    v_fma_f32 v69, v69, v251, v221
    v_fma_f32 v70, v70, v251, v222
    v_mfma_f32_16x16x32_bf16 v[132:135], v[36:39], a[20:23], v[132:135]
    s_xor_b32 s94, s47, 2160640
    v_fma_f32 v71, v71, v251, v223
    v_fma_f32 v72, -v252, v216, v72
    v_mfma_f32_16x16x32_bf16 v[132:135], v[32:35], a[16:19], v[132:135]
    buffer_load_dwordx4 v8, s[12:15], s94 offen offset:2048 lds
    v_fma_f32 v73, -v252, v217, v73
    v_mfma_f32_16x16x32_bf16 v[136:139], v[32:35], a[32:35], 0
    v_fma_f32 v74, -v252, v218, v74
    v_fma_f32 v75, -v252, v219, v75
    v_mfma_f32_16x16x32_bf16 v[136:139], v[36:39], a[36:39], v[136:139]
    v_fma_f32 v72, v72, v253, v220
    v_fma_f32 v73, v73, v253, v221
    v_mfma_f32_16x16x32_bf16 v[136:139], v[40:43], a[40:43], v[136:139]
    s_xor_b32 s94, s47, 2192384
    v_fma_f32 v74, v74, v253, v222
    v_fma_f32 v75, v75, v253, v223
    v_mfma_f32_16x16x32_bf16 v[136:139], v[44:47], a[44:47], v[136:139]
    buffer_load_dwordx4 v8, s[12:15], s94 offen offset:3072 lds
    v_fma_f32 v76, -v254, v216, v76
    v_mfma_f32_16x16x32_bf16 v[140:143], v[44:47], a[60:63], 0
    v_fma_f32 v77, -v254, v217, v77
    v_fma_f32 v78, -v254, v218, v78
    v_mfma_f32_16x16x32_bf16 v[140:143], v[40:43], a[56:59], v[140:143]
    v_fma_f32 v79, -v254, v219, v79
    v_fma_f32 v76, v76, v255, v220
    v_mfma_f32_16x16x32_bf16 v[140:143], v[36:39], a[52:55], v[140:143]
    v_fma_f32 v77, v77, v255, v221
    v_fma_f32 v78, v78, v255, v222
    v_mfma_f32_16x16x32_bf16 v[140:143], v[32:35], a[48:51], v[140:143]
    s_waitcnt lgkmcnt(0)
    v_fma_f32 v79, v79, v255, v223
    v_fma_f32 v80, -v248, v224, v80
    v_smfmac_f32_16x16x64_bf16 v[28:31], v[4:7], v[48:55], v22
    ds_read_b64_tr_b16 v[32:33], v25 offset:0
    ds_read_b64_tr_b16 v[34:35], v25 offset:1024
    s_add_u32 m0, s91, 69632
    s_xor_b32 s94, s47, 2228224
    v_smfmac_f32_16x16x64_bf16 v[28:31], v[4:7], v[56:63], v22
    buffer_load_dwordx4 v8, s[12:15], s94 offen offset:0 lds
    v_fma_f32 v81, -v248, v225, v81
    v_mfma_f32_16x16x32_bf16 v[156:159], v[48:51], a[48:51], 0
    ds_read_b64_tr_b16 v[36:37], v25 offset:8192
    ds_read_b64_tr_b16 v[38:39], v25 offset:9216
    v_mfma_f32_16x16x32_bf16 v[156:159], v[52:55], a[52:55], v[156:159]
    v_fma_f32 v82, -v248, v226, v82
    v_fma_f32 v83, -v248, v227, v83
    v_mfma_f32_16x16x32_bf16 v[156:159], v[56:59], a[56:59], v[156:159]
    s_xor_b32 s94, s47, 2259968
    ds_read_b64_tr_b16 v[40:41], v25 offset:16384
    ds_read_b64_tr_b16 v[42:43], v25 offset:17408
    v_mfma_f32_16x16x32_bf16 v[156:159], v[60:63], a[60:63], v[156:159]
    buffer_load_dwordx4 v8, s[12:15], s94 offen offset:1024 lds
    v_fma_f32 v80, v80, v249, v228
    v_mfma_f32_16x16x32_bf16 v[152:155], v[60:63], a[44:47], 0
    ds_read_b64_tr_b16 v[44:45], v25 offset:24576
    ds_read_b64_tr_b16 v[46:47], v25 offset:25600
    v_mfma_f32_16x16x32_bf16 v[152:155], v[56:59], a[40:43], v[152:155]
    v_fma_f32 v81, v81, v249, v229
    v_fma_f32 v82, v82, v249, v230
    v_mfma_f32_16x16x32_bf16 v[152:155], v[52:55], a[36:39], v[152:155]
    s_xor_b32 s94, s47, 2291712
    v_fma_f32 v83, v83, v249, v231
    v_fma_f32 v84, -v250, v224, v84
    v_mfma_f32_16x16x32_bf16 v[152:155], v[48:51], a[32:35], v[152:155]
    buffer_load_dwordx4 v8, s[12:15], s94 offen offset:2048 lds
    v_fma_f32 v85, -v250, v225, v85
    v_mfma_f32_16x16x32_bf16 v[148:151], v[48:51], a[16:19], 0
    v_fma_f32 v86, -v250, v226, v86
    v_fma_f32 v87, -v250, v227, v87
    v_mfma_f32_16x16x32_bf16 v[148:151], v[52:55], a[20:23], v[148:151]
    v_fma_f32 v84, v84, v251, v228
    v_fma_f32 v85, v85, v251, v229
    v_mfma_f32_16x16x32_bf16 v[148:151], v[56:59], a[24:27], v[148:151]
    s_xor_b32 s94, s47, 2323456
    v_fma_f32 v86, v86, v251, v230
    v_fma_f32 v87, v87, v251, v231
    v_mfma_f32_16x16x32_bf16 v[148:151], v[60:63], a[28:31], v[148:151]
    buffer_load_dwordx4 v8, s[12:15], s94 offen offset:3072 lds
    v_fma_f32 v88, -v252, v224, v88
    v_mfma_f32_16x16x32_bf16 v[144:147], v[60:63], a[12:15], 0
    v_fma_f32 v89, -v252, v225, v89
    v_fma_f32 v90, -v252, v226, v90
    v_mfma_f32_16x16x32_bf16 v[144:147], v[56:59], a[8:11], v[144:147]
    v_fma_f32 v91, -v252, v227, v91
    v_fma_f32 v88, v88, v253, v228
    v_mfma_f32_16x16x32_bf16 v[144:147], v[52:55], a[4:7], v[144:147]
    v_fma_f32 v89, v89, v253, v229
    v_fma_f32 v90, v90, v253, v230
    v_mfma_f32_16x16x32_bf16 v[144:147], v[48:51], a[0:3], v[144:147]
    s_waitcnt lgkmcnt(0)
    v_fma_f32 v91, v91, v253, v231
    v_fma_f32 v92, -v254, v224, v92
    v_mfma_f32_16x16x32_bf16 v[160:163], v[32:35], a[0:3], 0
    ds_read_b64_tr_b16 v[48:49], v25 offset:8
    ds_read_b64_tr_b16 v[50:51], v25 offset:1032
    s_add_u32 m0, s91, 98304
    s_xor_b32 s94, s47, 3145728
    v_mfma_f32_16x16x32_bf16 v[160:163], v[36:39], a[4:7], v[160:163]
    buffer_load_dwordx4 v8, s[12:15], s94 offen offset:0 lds
    v_fma_f32 v93, -v254, v225, v93
    v_mfma_f32_16x16x32_bf16 v[160:163], v[40:43], a[8:11], v[160:163]
    ds_read_b64_tr_b16 v[52:53], v25 offset:8200
    ds_read_b64_tr_b16 v[54:55], v25 offset:9224
    v_mfma_f32_16x16x32_bf16 v[160:163], v[44:47], a[12:15], v[160:163]
    v_fma_f32 v94, -v254, v226, v94
    v_fma_f32 v95, -v254, v227, v95
    v_mfma_f32_16x16x32_bf16 v[164:167], v[44:47], a[28:31], 0
    s_xor_b32 s94, s47, 3177472
    ds_read_b64_tr_b16 v[56:57], v25 offset:16392
    ds_read_b64_tr_b16 v[58:59], v25 offset:17416
    v_mfma_f32_16x16x32_bf16 v[164:167], v[40:43], a[24:27], v[164:167]
    buffer_load_dwordx4 v8, s[12:15], s94 offen offset:1024 lds
    v_fma_f32 v92, v92, v255, v228
    v_mfma_f32_16x16x32_bf16 v[164:167], v[36:39], a[20:23], v[164:167]
    ds_read_b64_tr_b16 v[60:61], v25 offset:24584
    ds_read_b64_tr_b16 v[62:63], v25 offset:25608
    v_mfma_f32_16x16x32_bf16 v[164:167], v[32:35], a[16:19], v[164:167]
    v_fma_f32 v93, v93, v255, v229
    v_fma_f32 v94, v94, v255, v230
    v_mfma_f32_16x16x32_bf16 v[168:171], v[32:35], a[32:35], 0
    s_xor_b32 s94, s47, 3209216
    v_fma_f32 v95, v95, v255, v231
    v_fma_f32 v96, -v248, v232, v96
    v_mfma_f32_16x16x32_bf16 v[168:171], v[36:39], a[36:39], v[168:171]
    buffer_load_dwordx4 v8, s[12:15], s94 offen offset:2048 lds
    v_fma_f32 v97, -v248, v233, v97
    v_mfma_f32_16x16x32_bf16 v[168:171], v[40:43], a[40:43], v[168:171]
    v_fma_f32 v98, -v248, v234, v98
    v_fma_f32 v99, -v248, v235, v99
    v_mfma_f32_16x16x32_bf16 v[168:171], v[44:47], a[44:47], v[168:171]
    v_fma_f32 v96, v96, v249, v236
    v_fma_f32 v97, v97, v249, v237
    v_mfma_f32_16x16x32_bf16 v[172:175], v[44:47], a[60:63], 0
    s_xor_b32 s94, s47, 3240960
    v_fma_f32 v98, v98, v249, v238
    v_fma_f32 v99, v99, v249, v239
    v_mfma_f32_16x16x32_bf16 v[172:175], v[40:43], a[56:59], v[172:175]
    buffer_load_dwordx4 v8, s[12:15], s94 offen offset:3072 lds
    v_fma_f32 v100, -v250, v232, v100
    v_mfma_f32_16x16x32_bf16 v[172:175], v[36:39], a[52:55], v[172:175]
    v_fma_f32 v101, -v250, v233, v101
    v_fma_f32 v102, -v250, v234, v102
    v_mfma_f32_16x16x32_bf16 v[172:175], v[32:35], a[48:51], v[172:175]
    s_waitcnt lgkmcnt(0)
    v_fma_f32 v103, -v250, v235, v103
    v_fma_f32 v100, v100, v251, v236
    v_mfma_f32_16x16x32_bf16 v[188:191], v[48:51], a[48:51], 0
    ds_read_b64_tr_b16 v[32:33], v26 offset:0
    ds_read_b64_tr_b16 v[34:35], v26 offset:1024
    s_add_u32 m0, s91, 102400
    s_xor_b32 s94, s47, 3276800
    v_mfma_f32_16x16x32_bf16 v[188:191], v[52:55], a[52:55], v[188:191]
    buffer_load_dwordx4 v8, s[12:15], s94 offen offset:0 lds
    v_fma_f32 v101, v101, v251, v237
    v_mfma_f32_16x16x32_bf16 v[188:191], v[56:59], a[56:59], v[188:191]
    ds_read_b64_tr_b16 v[36:37], v26 offset:8192
    ds_read_b64_tr_b16 v[38:39], v26 offset:9216
    v_mfma_f32_16x16x32_bf16 v[188:191], v[60:63], a[60:63], v[188:191]
    v_fma_f32 v102, v102, v251, v238
    v_fma_f32 v103, v103, v251, v239
    v_mfma_f32_16x16x32_bf16 v[184:187], v[60:63], a[44:47], 0
    s_xor_b32 s94, s47, 3308544
    ds_read_b64_tr_b16 v[40:41], v26 offset:16384
    ds_read_b64_tr_b16 v[42:43], v26 offset:17408
    v_mfma_f32_16x16x32_bf16 v[184:187], v[56:59], a[40:43], v[184:187]
    buffer_load_dwordx4 v8, s[12:15], s94 offen offset:1024 lds
    v_fma_f32 v104, -v252, v232, v104
    v_mfma_f32_16x16x32_bf16 v[184:187], v[52:55], a[36:39], v[184:187]
    ds_read_b64_tr_b16 v[44:45], v26 offset:24576
    ds_read_b64_tr_b16 v[46:47], v26 offset:25600
    v_mfma_f32_16x16x32_bf16 v[184:187], v[48:51], a[32:35], v[184:187]
    v_fma_f32 v105, -v252, v233, v105
    v_fma_f32 v106, -v252, v234, v106
    v_mfma_f32_16x16x32_bf16 v[180:183], v[48:51], a[16:19], 0
    s_xor_b32 s94, s47, 3340288
    v_fma_f32 v107, -v252, v235, v107
    v_fma_f32 v104, v104, v253, v236
    v_mfma_f32_16x16x32_bf16 v[180:183], v[52:55], a[20:23], v[180:183]
    buffer_load_dwordx4 v8, s[12:15], s94 offen offset:2048 lds
    v_fma_f32 v105, v105, v253, v237
    v_mfma_f32_16x16x32_bf16 v[180:183], v[56:59], a[24:27], v[180:183]
    v_fma_f32 v106, v106, v253, v238
    v_fma_f32 v107, v107, v253, v239
    v_mfma_f32_16x16x32_bf16 v[180:183], v[60:63], a[28:31], v[180:183]
    v_fma_f32 v108, -v254, v232, v108
    v_fma_f32 v109, -v254, v233, v109
    v_mfma_f32_16x16x32_bf16 v[176:179], v[60:63], a[12:15], 0
    s_xor_b32 s94, s47, 3372032
    v_fma_f32 v110, -v254, v234, v110
    v_fma_f32 v111, -v254, v235, v111
    v_mfma_f32_16x16x32_bf16 v[176:179], v[56:59], a[8:11], v[176:179]
    buffer_load_dwordx4 v8, s[12:15], s94 offen offset:3072 lds
    v_fma_f32 v108, v108, v255, v236
    v_mfma_f32_16x16x32_bf16 v[176:179], v[52:55], a[4:7], v[176:179]
    v_fma_f32 v109, v109, v255, v237
    v_fma_f32 v110, v110, v255, v238
    v_mfma_f32_16x16x32_bf16 v[176:179], v[48:51], a[0:3], v[176:179]
    s_waitcnt lgkmcnt(0)
    v_fma_f32 v111, v111, v255, v239
    v_fma_f32 v112, -v248, v240, v112
    v_mfma_f32_16x16x32_bf16 v[192:195], v[32:35], a[0:3], 0
    ds_read_b64_tr_b16 v[48:49], v26 offset:8
    ds_read_b64_tr_b16 v[50:51], v26 offset:1032
    s_cmp_eq_u32 s96, 0
    s_cselect_b32 s95, s50, 37748736
    v_mfma_f32_16x16x32_bf16 v[192:195], v[36:39], a[4:7], v[192:195]
    buffer_store_dword v213, v212, s[20:23], s95 offen sc1
    v_fma_f32 v113, -v248, v241, v113
    v_mfma_f32_16x16x32_bf16 v[192:195], v[40:43], a[8:11], v[192:195]
    ds_read_b64_tr_b16 v[52:53], v26 offset:8200
    ds_read_b64_tr_b16 v[54:55], v26 offset:9224
    v_mfma_f32_16x16x32_bf16 v[192:195], v[44:47], a[12:15], v[192:195]
    s_lshl_b32 s95, s2, 1
    v_fma_f32 v114, -v248, v242, v114
    v_fma_f32 v115, -v248, v243, v115
    v_mfma_f32_16x16x32_bf16 v[196:199], v[44:47], a[28:31], 0
    s_add_u32 s95, s95, s89
    ds_read_b64_tr_b16 v[56:57], v26 offset:16392
    ds_read_b64_tr_b16 v[58:59], v26 offset:17416
    v_mfma_f32_16x16x32_bf16 v[196:199], v[40:43], a[24:27], v[196:199]
    s_and_b32 s95, s95, 7
    v_fma_f32 v112, v112, v249, v244
    v_fma_f32 v113, v113, v249, v245
    v_mfma_f32_16x16x32_bf16 v[196:199], v[36:39], a[20:23], v[196:199]
    s_lshr_b32 s94, s2, 2
    ds_read_b64_tr_b16 v[60:61], v26 offset:24584
    ds_read_b64_tr_b16 v[62:63], v26 offset:25608
    v_mfma_f32_16x16x32_bf16 v[196:199], v[32:35], a[16:19], v[196:199]
    s_lshl_b32 s46, s94, 8
    v_fma_f32 v114, v114, v249, v246
    v_fma_f32 v115, v115, v249, v247
    v_mfma_f32_16x16x32_bf16 v[200:203], v[32:35], a[32:35], 0
    s_add_u32 s46, s46, s95
    v_fma_f32 v116, -v250, v240, v116
    v_fma_f32 v117, -v250, v241, v117
    v_mfma_f32_16x16x32_bf16 v[200:203], v[36:39], a[36:39], v[200:203]
    s_lshl_b32 s46, s46, 7
    v_fma_f32 v118, -v250, v242, v118
    v_fma_f32 v119, -v250, v243, v119
    v_mfma_f32_16x16x32_bf16 v[200:203], v[40:43], a[40:43], v[200:203]
    s_mul_i32 s47, s95, 56
    v_fma_f32 v116, v116, v251, v244
    v_fma_f32 v117, v117, v251, v245
    v_mfma_f32_16x16x32_bf16 v[200:203], v[44:47], a[44:47], v[200:203]
    s_add_u32 s47, s47, s94
    v_fma_f32 v118, v118, v251, v246
    v_fma_f32 v119, v119, v251, v247
    v_mfma_f32_16x16x32_bf16 v[204:207], v[44:47], a[60:63], 0
    s_lshl_b32 s47, s47, 12
    v_fma_f32 v120, -v252, v240, v120
    v_fma_f32 v121, -v252, v241, v121
    v_mfma_f32_16x16x32_bf16 v[204:207], v[40:43], a[56:59], v[204:207]
    s_mov_b32 s28, s52
    s_mov_b32 s29, s53
    v_fma_f32 v122, -v252, v242, v122
    v_fma_f32 v123, -v252, v243, v123
    v_mfma_f32_16x16x32_bf16 v[204:207], v[36:39], a[52:55], v[204:207]
    s_mov_b32 s30, s34
    v_fma_f32 v120, v120, v253, v244
    v_fma_f32 v121, v121, v253, v245
    v_mfma_f32_16x16x32_bf16 v[204:207], v[32:35], a[48:51], v[204:207]
    s_waitcnt lgkmcnt(0)
    v_fma_f32 v122, v122, v253, v246
    v_fma_f32 v123, v123, v253, v247
    v_mfma_f32_16x16x32_bf16 v[220:223], v[48:51], a[48:51], 0
    ds_read_b64_tr_b16 v[32:33], v27 offset:0
    ds_read_b64_tr_b16 v[34:35], v27 offset:1024
    s_add_u32 m0, s91, 131072
    s_add_u32 s95, s46, 0
    v_mfma_f32_16x16x32_bf16 v[220:223], v[52:55], a[52:55], v[220:223]
    buffer_load_dwordx4 v10, s[28:31], s95 offen lds
    v_fma_f32 v124, -v254, v240, v124
    v_mfma_f32_16x16x32_bf16 v[220:223], v[56:59], a[56:59], v[220:223]
    ds_read_b64_tr_b16 v[36:37], v27 offset:8192
    ds_read_b64_tr_b16 v[38:39], v27 offset:9216
    v_mfma_f32_16x16x32_bf16 v[220:223], v[60:63], a[60:63], v[220:223]
    s_add_u32 m0, s91, 132096
    v_fma_f32 v125, -v254, v241, v125
    v_fma_f32 v126, -v254, v242, v126
    v_mfma_f32_16x16x32_bf16 v[216:219], v[60:63], a[44:47], 0
    s_add_u32 s95, s46, 8192
    ds_read_b64_tr_b16 v[40:41], v27 offset:16384
    ds_read_b64_tr_b16 v[42:43], v27 offset:17408
    v_mfma_f32_16x16x32_bf16 v[216:219], v[56:59], a[40:43], v[216:219]
    buffer_load_dwordx4 v10, s[28:31], s95 offen lds
    v_fma_f32 v127, -v254, v243, v127
    v_mfma_f32_16x16x32_bf16 v[216:219], v[52:55], a[36:39], v[216:219]
    ds_read_b64_tr_b16 v[44:45], v27 offset:24576
    ds_read_b64_tr_b16 v[46:47], v27 offset:25600
    v_mfma_f32_16x16x32_bf16 v[216:219], v[48:51], a[32:35], v[216:219]
    s_add_u32 m0, s91, 133120
    v_fma_f32 v124, v124, v255, v244
    v_fma_f32 v125, v125, v255, v245
    v_mfma_f32_16x16x32_bf16 v[212:215], v[48:51], a[16:19], 0
    s_add_u32 s95, s46, 16384
    v_fma_f32 v126, v126, v255, v246
    v_fma_f32 v127, v127, v255, v247
    v_mfma_f32_16x16x32_bf16 v[212:215], v[52:55], a[20:23], v[212:215]
    buffer_load_dwordx4 v10, s[28:31], s95 offen lds
    v_mul_f32 v0, v64, v64
    v_mfma_f32_16x16x32_bf16 v[212:215], v[56:59], a[24:27], v[212:215]
    v_mul_f32 v8, v65, v65
    v_mul_f32 v9, v66, v66
    v_mfma_f32_16x16x32_bf16 v[212:215], v[60:63], a[28:31], v[212:215]
    s_add_u32 m0, s91, 134144
    v_mul_f32 v15, v67, v67
    v_fma_f32 v0, v0, s3, v14
    v_mfma_f32_16x16x32_bf16 v[208:211], v[60:63], a[12:15], 0
    s_add_u32 s95, s46, 24576
    v_fma_f32 v8, v8, s3, v14
    v_fma_f32 v9, v9, s3, v14
    v_mfma_f32_16x16x32_bf16 v[208:211], v[56:59], a[8:11], v[208:211]
    buffer_load_dwordx4 v10, s[28:31], s95 offen lds
    v_fma_f32 v15, v15, s3, v14
    v_mfma_f32_16x16x32_bf16 v[208:211], v[52:55], a[4:7], v[208:211]
    v_mul_f32 v0, v0, v64
    v_mul_f32 v8, v8, v65
    v_mfma_f32_16x16x32_bf16 v[208:211], v[48:51], a[0:3], v[208:211]
    s_waitcnt lgkmcnt(0)
    v_mul_f32 v9, v9, v66
    v_mul_f32 v15, v15, v67
    v_mfma_f32_16x16x32_bf16 v[224:227], v[32:35], a[0:3], 0
    ds_read_b64_tr_b16 v[48:49], v27 offset:8
    ds_read_b64_tr_b16 v[50:51], v27 offset:1032
    v_mfma_f32_16x16x32_bf16 v[224:227], v[36:39], a[4:7], v[224:227]
    v_exp_f32 v0, v0
    v_mfma_f32_16x16x32_bf16 v[224:227], v[40:43], a[8:11], v[224:227]
    ds_read_b64_tr_b16 v[52:53], v27 offset:8200
    ds_read_b64_tr_b16 v[54:55], v27 offset:9224
    v_mfma_f32_16x16x32_bf16 v[224:227], v[44:47], a[12:15], v[224:227]
    v_exp_f32 v8, v8
    v_mfma_f32_16x16x32_bf16 v[228:231], v[44:47], a[28:31], 0
    ds_read_b64_tr_b16 v[56:57], v27 offset:16392
    ds_read_b64_tr_b16 v[58:59], v27 offset:17416
    v_mfma_f32_16x16x32_bf16 v[228:231], v[40:43], a[24:27], v[228:231]
    v_exp_f32 v9, v9
    v_mfma_f32_16x16x32_bf16 v[228:231], v[36:39], a[20:23], v[228:231]
    ds_read_b64_tr_b16 v[60:61], v27 offset:24584
    ds_read_b64_tr_b16 v[62:63], v27 offset:25608
    v_mfma_f32_16x16x32_bf16 v[228:231], v[32:35], a[16:19], v[228:231]
    v_exp_f32 v15, v15
    v_mfma_f32_16x16x32_bf16 v[232:235], v[32:35], a[32:35], 0
    v_add_f32 v0, 1.0, v0
    v_add_f32 v8, 1.0, v8
    v_mfma_f32_16x16x32_bf16 v[232:235], v[36:39], a[36:39], v[232:235]
    v_add_f32 v9, 1.0, v9
    v_add_f32 v15, 1.0, v15
    v_mfma_f32_16x16x32_bf16 v[232:235], v[40:43], a[40:43], v[232:235]
    v_rcp_f32 v0, v0
    v_mfma_f32_16x16x32_bf16 v[232:235], v[44:47], a[44:47], v[232:235]
    v_rcp_f32 v8, v8
    v_mfma_f32_16x16x32_bf16 v[236:239], v[44:47], a[60:63], 0
    v_rcp_f32 v9, v9
    v_mfma_f32_16x16x32_bf16 v[236:239], v[40:43], a[56:59], v[236:239]
    v_rcp_f32 v15, v15
    v_mfma_f32_16x16x32_bf16 v[236:239], v[36:39], a[52:55], v[236:239]
    v_mul_f32 v0, v0, v64
    v_mul_f32 v8, v8, v65
    v_mfma_f32_16x16x32_bf16 v[236:239], v[32:35], a[48:51], v[236:239]
    s_waitcnt lgkmcnt(0)
    v_mul_f32 v9, v9, v66
    v_mul_f32 v15, v15, v67
    v_mfma_f32_16x16x32_bf16 v[252:255], v[48:51], a[48:51], 0
    s_waitcnt vmcnt(21)
    s_barrier
    v_cvt_pk_bf16_f32 v64, v0, v8
    v_cvt_pk_bf16_f32 v65, v9, v15
    v_mfma_f32_16x16x32_bf16 v[252:255], v[52:55], a[52:55], v[252:255]
    s_add_u32 m0, s91, 0
    ds_read_b64_tr_b16 v[32:33], v24 offset:32768
    ds_read_b64_tr_b16 v[34:35], v24 offset:33792
    v_mfma_f32_16x16x32_bf16 v[252:255], v[56:59], a[56:59], v[252:255]
    buffer_load_dwordx4 v20, s[4:7], s92 offen offset:0 nt lds
    v_mul_f32 v0, v80, v80
    v_mfma_f32_16x16x32_bf16 v[252:255], v[60:63], a[60:63], v[252:255]
    ds_read_b64_tr_b16 v[36:37], v24 offset:40960
    ds_read_b64_tr_b16 v[38:39], v24 offset:41984
    v_mfma_f32_16x16x32_bf16 v[248:251], v[60:63], a[44:47], 0
    v_mul_f32 v8, v81, v81
    v_mul_f32 v9, v82, v82
    v_mfma_f32_16x16x32_bf16 v[248:251], v[56:59], a[40:43], v[248:251]
    ds_read_b64_tr_b16 v[40:41], v24 offset:49152
    ds_read_b64_tr_b16 v[42:43], v24 offset:50176
    v_mfma_f32_16x16x32_bf16 v[248:251], v[52:55], a[36:39], v[248:251]
    buffer_load_dwordx4 v20, s[4:7], s92 offen offset:1024 nt lds
    v_mul_f32 v15, v83, v83
    v_mfma_f32_16x16x32_bf16 v[248:251], v[48:51], a[32:35], v[248:251]
    ds_read_b64_tr_b16 v[44:45], v24 offset:57344
    ds_read_b64_tr_b16 v[46:47], v24 offset:58368
    v_mfma_f32_16x16x32_bf16 v[244:247], v[48:51], a[16:19], 0
    v_fma_f32 v0, v0, s3, v14
    v_fma_f32 v8, v8, s3, v14
    v_mfma_f32_16x16x32_bf16 v[244:247], v[52:55], a[20:23], v[244:247]
    v_fma_f32 v9, v9, s3, v14
    v_fma_f32 v15, v15, s3, v14
    v_mfma_f32_16x16x32_bf16 v[244:247], v[56:59], a[24:27], v[244:247]
    buffer_load_dwordx4 v20, s[4:7], s92 offen offset:2048 nt lds
    v_mul_f32 v0, v0, v80
    v_mfma_f32_16x16x32_bf16 v[244:247], v[60:63], a[28:31], v[244:247]
    v_mul_f32 v8, v8, v81
    v_mul_f32 v9, v9, v82
    v_mfma_f32_16x16x32_bf16 v[240:243], v[60:63], a[12:15], 0
    v_mul_f32 v15, v15, v83
    v_mfma_f32_16x16x32_bf16 v[240:243], v[56:59], a[8:11], v[240:243]
    v_exp_f32 v0, v0
    v_mfma_f32_16x16x32_bf16 v[240:243], v[52:55], a[4:7], v[240:243]
    buffer_load_dwordx4 v20, s[4:7], s92 offen offset:3072 nt lds
    v_mfma_f32_16x16x32_bf16 v[240:243], v[48:51], a[0:3], v[240:243]
    s_waitcnt lgkmcnt(0)
    s_add_u32 s92, s92, 4096
    v_exp_f32 v8, v8
    v_smfmac_f32_16x16x64_bf16 v[16:19], v[4:7], v[32:39], v22
    ds_read_b64_tr_b16 v[48:49], v24 offset:32776
    ds_read_b64_tr_b16 v[50:51], v24 offset:33800
    s_add_u32 m0, s91, 4096
    v_smfmac_f32_16x16x64_bf16 v[16:19], v[4:7], v[40:47], v22
    buffer_load_dwordx4 v20, s[4:7], s92 offen offset:0 nt lds
    v_mfma_f32_16x16x32_bf16 v[128:131], v[32:35], a[64:67], v[128:131]
    ds_read_b64_tr_b16 v[52:53], v24 offset:40968
    ds_read_b64_tr_b16 v[54:55], v24 offset:41992
    v_mfma_f32_16x16x32_bf16 v[128:131], v[36:39], a[68:71], v[128:131]
    v_exp_f32 v9, v9
    v_mfma_f32_16x16x32_bf16 v[128:131], v[40:43], a[72:75], v[128:131]
    ds_read_b64_tr_b16 v[56:57], v24 offset:49160
    ds_read_b64_tr_b16 v[58:59], v24 offset:50184
    v_mfma_f32_16x16x32_bf16 v[128:131], v[44:47], a[76:79], v[128:131]
    buffer_load_dwordx4 v20, s[4:7], s92 offen offset:1024 nt lds
    v_mfma_f32_16x16x32_bf16 v[132:135], v[44:47], a[92:95], v[132:135]
    ds_read_b64_tr_b16 v[60:61], v24 offset:57352
    ds_read_b64_tr_b16 v[62:63], v24 offset:58376
    v_mfma_f32_16x16x32_bf16 v[132:135], v[40:43], a[88:91], v[132:135]
    v_exp_f32 v15, v15
    v_mfma_f32_16x16x32_bf16 v[132:135], v[36:39], a[84:87], v[132:135]
    v_add_f32 v0, 1.0, v0
    v_add_f32 v8, 1.0, v8
    v_mfma_f32_16x16x32_bf16 v[132:135], v[32:35], a[80:83], v[132:135]
    buffer_load_dwordx4 v20, s[4:7], s92 offen offset:2048 nt lds
    v_add_f32 v9, 1.0, v9
    v_mfma_f32_16x16x32_bf16 v[136:139], v[32:35], a[96:99], v[136:139]
    v_add_f32 v15, 1.0, v15
    v_mfma_f32_16x16x32_bf16 v[136:139], v[36:39], a[100:103], v[136:139]
    v_rcp_f32 v0, v0
    v_mfma_f32_16x16x32_bf16 v[136:139], v[40:43], a[104:107], v[136:139]
    v_rcp_f32 v8, v8
    v_mfma_f32_16x16x32_bf16 v[136:139], v[44:47], a[108:111], v[136:139]
    buffer_load_dwordx4 v20, s[4:7], s92 offen offset:3072 nt lds
    v_mfma_f32_16x16x32_bf16 v[140:143], v[44:47], a[124:127], v[140:143]
    s_add_u32 s92, s92, 28672
    v_rcp_f32 v9, v9
    v_mfma_f32_16x16x32_bf16 v[140:143], v[40:43], a[120:123], v[140:143]
    v_rcp_f32 v15, v15
    v_mfma_f32_16x16x32_bf16 v[140:143], v[36:39], a[116:119], v[140:143]
    v_mul_f32 v0, v0, v80
    v_mul_f32 v8, v8, v81
    v_mfma_f32_16x16x32_bf16 v[140:143], v[32:35], a[112:115], v[140:143]
    s_waitcnt lgkmcnt(0)
    v_mul_f32 v9, v9, v82
    v_mul_f32 v15, v15, v83
    v_smfmac_f32_16x16x64_bf16 v[28:31], v[4:7], v[48:55], v22
    ds_read_b64_tr_b16 v[32:33], v25 offset:32768
    ds_read_b64_tr_b16 v[34:35], v25 offset:33792
    v_smfmac_f32_16x16x64_bf16 v[28:31], v[4:7], v[56:63], v22
    v_cvt_pk_bf16_f32 v66, v0, v8
    v_cvt_pk_bf16_f32 v67, v9, v15
    v_mfma_f32_16x16x32_bf16 v[156:159], v[48:51], a[112:115], v[156:159]
    ds_read_b64_tr_b16 v[36:37], v25 offset:40960
    ds_read_b64_tr_b16 v[38:39], v25 offset:41984
    v_mfma_f32_16x16x32_bf16 v[156:159], v[52:55], a[116:119], v[156:159]
    buffer_store_dwordx4 v[64:67], v23, s[24:27], s39 offen offset:0 sc1
    v_mul_f32 v80, v96, v96
    v_mfma_f32_16x16x32_bf16 v[156:159], v[56:59], a[120:123], v[156:159]
    ds_read_b64_tr_b16 v[40:41], v25 offset:49152
    ds_read_b64_tr_b16 v[42:43], v25 offset:50176
    v_mfma_f32_16x16x32_bf16 v[156:159], v[60:63], a[124:127], v[156:159]
    v_mul_f32 v81, v97, v97
    v_mul_f32 v82, v98, v98
    v_mfma_f32_16x16x32_bf16 v[152:155], v[60:63], a[108:111], v[152:155]
    ds_read_b64_tr_b16 v[44:45], v25 offset:57344
    ds_read_b64_tr_b16 v[46:47], v25 offset:58368
    v_mfma_f32_16x16x32_bf16 v[152:155], v[56:59], a[104:107], v[152:155]
    v_mul_f32 v83, v99, v99
    v_fma_f32 v80, v80, s3, v14
    v_mfma_f32_16x16x32_bf16 v[152:155], v[52:55], a[100:103], v[152:155]
    v_fma_f32 v81, v81, s3, v14
    v_fma_f32 v82, v82, s3, v14
    v_mfma_f32_16x16x32_bf16 v[152:155], v[48:51], a[96:99], v[152:155]
    v_fma_f32 v83, v83, s3, v14
    v_mul_f32 v80, v80, v96
    v_mfma_f32_16x16x32_bf16 v[148:151], v[48:51], a[80:83], v[148:151]
    v_mul_f32 v81, v81, v97
    v_mul_f32 v82, v82, v98
    v_mfma_f32_16x16x32_bf16 v[148:151], v[52:55], a[84:87], v[148:151]
    v_mul_f32 v83, v83, v99
    v_mfma_f32_16x16x32_bf16 v[148:151], v[56:59], a[88:91], v[148:151]
    v_exp_f32 v80, v80
    v_mfma_f32_16x16x32_bf16 v[148:151], v[60:63], a[92:95], v[148:151]
    v_exp_f32 v81, v81
    v_mfma_f32_16x16x32_bf16 v[144:147], v[60:63], a[76:79], v[144:147]
    v_exp_f32 v82, v82
    v_mfma_f32_16x16x32_bf16 v[144:147], v[56:59], a[72:75], v[144:147]
    v_exp_f32 v83, v83
    v_mfma_f32_16x16x32_bf16 v[144:147], v[52:55], a[68:71], v[144:147]
    v_add_f32 v80, 1.0, v80
    v_add_f32 v81, 1.0, v81
    v_mfma_f32_16x16x32_bf16 v[144:147], v[48:51], a[64:67], v[144:147]
    s_waitcnt lgkmcnt(0)
    v_add_f32 v82, 1.0, v82
    v_add_f32 v83, 1.0, v83
    v_mfma_f32_16x16x32_bf16 v[160:163], v[32:35], a[64:67], v[160:163]
    ds_read_b64_tr_b16 v[48:49], v25 offset:32776
    ds_read_b64_tr_b16 v[50:51], v25 offset:33800
    v_mfma_f32_16x16x32_bf16 v[160:163], v[36:39], a[68:71], v[160:163]
    v_rcp_f32 v80, v80
    v_mfma_f32_16x16x32_bf16 v[160:163], v[40:43], a[72:75], v[160:163]
    ds_read_b64_tr_b16 v[52:53], v25 offset:40968
    ds_read_b64_tr_b16 v[54:55], v25 offset:41992
    v_mfma_f32_16x16x32_bf16 v[160:163], v[44:47], a[76:79], v[160:163]
    v_rcp_f32 v81, v81
    v_mfma_f32_16x16x32_bf16 v[164:167], v[44:47], a[92:95], v[164:167]
    ds_read_b64_tr_b16 v[56:57], v25 offset:49160
    ds_read_b64_tr_b16 v[58:59], v25 offset:50184
    v_mfma_f32_16x16x32_bf16 v[164:167], v[40:43], a[88:91], v[164:167]
    v_rcp_f32 v82, v82
    v_mfma_f32_16x16x32_bf16 v[164:167], v[36:39], a[84:87], v[164:167]
    ds_read_b64_tr_b16 v[60:61], v25 offset:57352
    ds_read_b64_tr_b16 v[62:63], v25 offset:58376
    v_mfma_f32_16x16x32_bf16 v[164:167], v[32:35], a[80:83], v[164:167]
    v_rcp_f32 v83, v83
    v_mfma_f32_16x16x32_bf16 v[168:171], v[32:35], a[96:99], v[168:171]
    v_mul_f32 v80, v80, v96
    v_mul_f32 v81, v81, v97
    v_mfma_f32_16x16x32_bf16 v[168:171], v[36:39], a[100:103], v[168:171]
    v_mul_f32 v82, v82, v98
    v_mul_f32 v83, v83, v99
    v_mfma_f32_16x16x32_bf16 v[168:171], v[40:43], a[104:107], v[168:171]
    v_cvt_pk_bf16_f32 v96, v80, v81
    v_cvt_pk_bf16_f32 v97, v82, v83
    v_mfma_f32_16x16x32_bf16 v[168:171], v[44:47], a[108:111], v[168:171]
    v_mul_f32 v80, v112, v112
    v_mul_f32 v81, v113, v113
    v_mfma_f32_16x16x32_bf16 v[172:175], v[44:47], a[124:127], v[172:175]
    v_mul_f32 v82, v114, v114
    v_mul_f32 v83, v115, v115
    v_mfma_f32_16x16x32_bf16 v[172:175], v[40:43], a[120:123], v[172:175]
    v_fma_f32 v80, v80, s3, v14
    v_fma_f32 v81, v81, s3, v14
    v_mfma_f32_16x16x32_bf16 v[172:175], v[36:39], a[116:119], v[172:175]
    v_fma_f32 v82, v82, s3, v14
    v_fma_f32 v83, v83, s3, v14
    v_mfma_f32_16x16x32_bf16 v[172:175], v[32:35], a[112:115], v[172:175]
    s_waitcnt lgkmcnt(0)
    v_mul_f32 v80, v80, v112
    v_mul_f32 v81, v81, v113
    v_mfma_f32_16x16x32_bf16 v[188:191], v[48:51], a[112:115], v[188:191]
    ds_read_b64_tr_b16 v[32:33], v26 offset:32768
    ds_read_b64_tr_b16 v[34:35], v26 offset:33792
    v_mfma_f32_16x16x32_bf16 v[188:191], v[52:55], a[116:119], v[188:191]
    v_mul_f32 v82, v82, v114
    v_mul_f32 v83, v83, v115
    v_mfma_f32_16x16x32_bf16 v[188:191], v[56:59], a[120:123], v[188:191]
    ds_read_b64_tr_b16 v[36:37], v26 offset:40960
    ds_read_b64_tr_b16 v[38:39], v26 offset:41984
    v_mfma_f32_16x16x32_bf16 v[188:191], v[60:63], a[124:127], v[188:191]
    v_exp_f32 v80, v80
    v_mfma_f32_16x16x32_bf16 v[184:187], v[60:63], a[108:111], v[184:187]
    ds_read_b64_tr_b16 v[40:41], v26 offset:49152
    ds_read_b64_tr_b16 v[42:43], v26 offset:50176
    v_mfma_f32_16x16x32_bf16 v[184:187], v[56:59], a[104:107], v[184:187]
    v_exp_f32 v81, v81
    v_mfma_f32_16x16x32_bf16 v[184:187], v[52:55], a[100:103], v[184:187]
    ds_read_b64_tr_b16 v[44:45], v26 offset:57344
    ds_read_b64_tr_b16 v[46:47], v26 offset:58368
    v_mfma_f32_16x16x32_bf16 v[184:187], v[48:51], a[96:99], v[184:187]
    v_exp_f32 v82, v82
    v_mfma_f32_16x16x32_bf16 v[180:183], v[48:51], a[80:83], v[180:183]
    v_exp_f32 v83, v83
    v_mfma_f32_16x16x32_bf16 v[180:183], v[52:55], a[84:87], v[180:183]
    v_add_f32 v80, 1.0, v80
    v_add_f32 v81, 1.0, v81
    v_mfma_f32_16x16x32_bf16 v[180:183], v[56:59], a[88:91], v[180:183]
    v_add_f32 v82, 1.0, v82
    v_add_f32 v83, 1.0, v83
    v_mfma_f32_16x16x32_bf16 v[180:183], v[60:63], a[92:95], v[180:183]
    v_rcp_f32 v80, v80
    v_mfma_f32_16x16x32_bf16 v[176:179], v[60:63], a[76:79], v[176:179]
    v_rcp_f32 v81, v81
    v_mfma_f32_16x16x32_bf16 v[176:179], v[56:59], a[72:75], v[176:179]
    v_rcp_f32 v82, v82
    v_mfma_f32_16x16x32_bf16 v[176:179], v[52:55], a[68:71], v[176:179]
    v_rcp_f32 v83, v83
    v_mfma_f32_16x16x32_bf16 v[176:179], v[48:51], a[64:67], v[176:179]
    s_waitcnt lgkmcnt(0)
    v_mul_f32 v80, v80, v112
    v_mul_f32 v81, v81, v113
    v_mfma_f32_16x16x32_bf16 v[192:195], v[32:35], a[64:67], v[192:195]
    ds_read_b64_tr_b16 v[48:49], v26 offset:32776
    ds_read_b64_tr_b16 v[50:51], v26 offset:33800
    v_mfma_f32_16x16x32_bf16 v[192:195], v[36:39], a[68:71], v[192:195]
    v_mul_f32 v82, v82, v114
    v_mul_f32 v83, v83, v115
    v_mfma_f32_16x16x32_bf16 v[192:195], v[40:43], a[72:75], v[192:195]
    ds_read_b64_tr_b16 v[52:53], v26 offset:40968
    ds_read_b64_tr_b16 v[54:55], v26 offset:41992
    v_mfma_f32_16x16x32_bf16 v[192:195], v[44:47], a[76:79], v[192:195]
    v_cvt_pk_bf16_f32 v98, v80, v81
    v_cvt_pk_bf16_f32 v99, v82, v83
    v_mfma_f32_16x16x32_bf16 v[196:199], v[44:47], a[92:95], v[196:199]
    ds_read_b64_tr_b16 v[56:57], v26 offset:49160
    ds_read_b64_tr_b16 v[58:59], v26 offset:50184
    v_mfma_f32_16x16x32_bf16 v[196:199], v[40:43], a[88:91], v[196:199]
    buffer_store_dwordx4 v[96:99], v23, s[24:27], s97 offen offset:0 sc1
    v_mul_f32 v80, v68, v68
    v_mfma_f32_16x16x32_bf16 v[196:199], v[36:39], a[84:87], v[196:199]
    ds_read_b64_tr_b16 v[60:61], v26 offset:57352
    ds_read_b64_tr_b16 v[62:63], v26 offset:58376
    v_mfma_f32_16x16x32_bf16 v[196:199], v[32:35], a[80:83], v[196:199]
    v_mul_f32 v81, v69, v69
    v_mul_f32 v82, v70, v70
    v_mfma_f32_16x16x32_bf16 v[200:203], v[32:35], a[96:99], v[200:203]
    v_mul_f32 v83, v71, v71
    v_fma_f32 v80, v80, s3, v14
    v_mfma_f32_16x16x32_bf16 v[200:203], v[36:39], a[100:103], v[200:203]
    v_fma_f32 v81, v81, s3, v14
    v_fma_f32 v82, v82, s3, v14
    v_mfma_f32_16x16x32_bf16 v[200:203], v[40:43], a[104:107], v[200:203]
    v_fma_f32 v83, v83, s3, v14
    v_mul_f32 v80, v80, v68
    v_mfma_f32_16x16x32_bf16 v[200:203], v[44:47], a[108:111], v[200:203]
    v_mul_f32 v81, v81, v69
    v_mul_f32 v82, v82, v70
    v_mfma_f32_16x16x32_bf16 v[204:207], v[44:47], a[124:127], v[204:207]
    v_mul_f32 v83, v83, v71
    v_mfma_f32_16x16x32_bf16 v[204:207], v[40:43], a[120:123], v[204:207]
    v_exp_f32 v80, v80
    v_mfma_f32_16x16x32_bf16 v[204:207], v[36:39], a[116:119], v[204:207]
    v_exp_f32 v81, v81
    v_mfma_f32_16x16x32_bf16 v[204:207], v[32:35], a[112:115], v[204:207]
    s_waitcnt lgkmcnt(0)
    v_exp_f32 v82, v82
    v_mfma_f32_16x16x32_bf16 v[220:223], v[48:51], a[112:115], v[220:223]
    ds_read_b64_tr_b16 v[32:33], v27 offset:32768
    ds_read_b64_tr_b16 v[34:35], v27 offset:33792
    v_mfma_f32_16x16x32_bf16 v[220:223], v[52:55], a[116:119], v[220:223]
    v_exp_f32 v83, v83
    v_mfma_f32_16x16x32_bf16 v[220:223], v[56:59], a[120:123], v[220:223]
    ds_read_b64_tr_b16 v[36:37], v27 offset:40960
    ds_read_b64_tr_b16 v[38:39], v27 offset:41984
    v_mfma_f32_16x16x32_bf16 v[220:223], v[60:63], a[124:127], v[220:223]
    v_add_f32 v80, 1.0, v80
    v_add_f32 v81, 1.0, v81
    v_mfma_f32_16x16x32_bf16 v[216:219], v[60:63], a[108:111], v[216:219]
    ds_read_b64_tr_b16 v[40:41], v27 offset:49152
    ds_read_b64_tr_b16 v[42:43], v27 offset:50176
    v_mfma_f32_16x16x32_bf16 v[216:219], v[56:59], a[104:107], v[216:219]
    v_add_f32 v82, 1.0, v82
    v_add_f32 v83, 1.0, v83
    v_mfma_f32_16x16x32_bf16 v[216:219], v[52:55], a[100:103], v[216:219]
    ds_read_b64_tr_b16 v[44:45], v27 offset:57344
    ds_read_b64_tr_b16 v[46:47], v27 offset:58368
    v_mfma_f32_16x16x32_bf16 v[216:219], v[48:51], a[96:99], v[216:219]
    v_rcp_f32 v80, v80
    v_mfma_f32_16x16x32_bf16 v[212:215], v[48:51], a[80:83], v[212:215]
    v_rcp_f32 v81, v81
    v_mfma_f32_16x16x32_bf16 v[212:215], v[52:55], a[84:87], v[212:215]
    v_rcp_f32 v82, v82
    v_mfma_f32_16x16x32_bf16 v[212:215], v[56:59], a[88:91], v[212:215]
    v_rcp_f32 v83, v83
    v_mfma_f32_16x16x32_bf16 v[212:215], v[60:63], a[92:95], v[212:215]
    v_mul_f32 v80, v80, v68
    v_mul_f32 v81, v81, v69
    v_mfma_f32_16x16x32_bf16 v[208:211], v[60:63], a[76:79], v[208:211]
    v_mul_f32 v82, v82, v70
    v_mul_f32 v83, v83, v71
    v_mfma_f32_16x16x32_bf16 v[208:211], v[56:59], a[72:75], v[208:211]
    v_cvt_pk_bf16_f32 v68, v80, v81
    v_cvt_pk_bf16_f32 v69, v82, v83
    v_mfma_f32_16x16x32_bf16 v[208:211], v[52:55], a[68:71], v[208:211]
    v_mul_f32 v80, v84, v84
    v_mul_f32 v81, v85, v85
    v_mfma_f32_16x16x32_bf16 v[208:211], v[48:51], a[64:67], v[208:211]
    s_waitcnt lgkmcnt(0)
    v_mul_f32 v82, v86, v86
    v_mul_f32 v83, v87, v87
    v_mfma_f32_16x16x32_bf16 v[224:227], v[32:35], a[64:67], v[224:227]
    ds_read_b64_tr_b16 v[48:49], v27 offset:32776
    ds_read_b64_tr_b16 v[50:51], v27 offset:33800
    v_mfma_f32_16x16x32_bf16 v[224:227], v[36:39], a[68:71], v[224:227]
    v_fma_f32 v80, v80, s3, v14
    v_fma_f32 v81, v81, s3, v14
    v_mfma_f32_16x16x32_bf16 v[224:227], v[40:43], a[72:75], v[224:227]
    ds_read_b64_tr_b16 v[52:53], v27 offset:40968
    ds_read_b64_tr_b16 v[54:55], v27 offset:41992
    v_mfma_f32_16x16x32_bf16 v[224:227], v[44:47], a[76:79], v[224:227]
    v_fma_f32 v82, v82, s3, v14
    v_fma_f32 v83, v83, s3, v14
    v_mfma_f32_16x16x32_bf16 v[228:231], v[44:47], a[92:95], v[228:231]
    ds_read_b64_tr_b16 v[56:57], v27 offset:49160
    ds_read_b64_tr_b16 v[58:59], v27 offset:50184
    v_mfma_f32_16x16x32_bf16 v[228:231], v[40:43], a[88:91], v[228:231]
    v_mul_f32 v80, v80, v84
    v_mul_f32 v81, v81, v85
    v_mfma_f32_16x16x32_bf16 v[228:231], v[36:39], a[84:87], v[228:231]
    ds_read_b64_tr_b16 v[60:61], v27 offset:57352
    ds_read_b64_tr_b16 v[62:63], v27 offset:58376
    v_mfma_f32_16x16x32_bf16 v[228:231], v[32:35], a[80:83], v[228:231]
    v_mul_f32 v82, v82, v86
    v_mul_f32 v83, v83, v87
    v_mfma_f32_16x16x32_bf16 v[232:235], v[32:35], a[96:99], v[232:235]
    v_exp_f32 v80, v80
    v_mfma_f32_16x16x32_bf16 v[232:235], v[36:39], a[100:103], v[232:235]
    v_exp_f32 v81, v81
    v_mfma_f32_16x16x32_bf16 v[232:235], v[40:43], a[104:107], v[232:235]
    v_exp_f32 v82, v82
    v_mfma_f32_16x16x32_bf16 v[232:235], v[44:47], a[108:111], v[232:235]
    v_exp_f32 v83, v83
    v_mfma_f32_16x16x32_bf16 v[236:239], v[44:47], a[124:127], v[236:239]
    v_add_f32 v80, 1.0, v80
    v_add_f32 v81, 1.0, v81
    v_mfma_f32_16x16x32_bf16 v[236:239], v[40:43], a[120:123], v[236:239]
    v_add_f32 v82, 1.0, v82
    v_add_f32 v83, 1.0, v83
    v_mfma_f32_16x16x32_bf16 v[236:239], v[36:39], a[116:119], v[236:239]
    v_rcp_f32 v80, v80
    v_mfma_f32_16x16x32_bf16 v[236:239], v[32:35], a[112:115], v[236:239]
    s_waitcnt lgkmcnt(0)
    v_rcp_f32 v81, v81
    v_mfma_f32_16x16x32_bf16 v[252:255], v[48:51], a[112:115], v[252:255]
    s_waitcnt vmcnt(23)
    s_barrier
    v_add_u32 v24, 0x10000, v24
    v_add_u32 v25, 0x10000, v25
    v_mfma_f32_16x16x32_bf16 v[252:255], v[52:55], a[116:119], v[252:255]
    s_add_u32 m0, s91, 32768
    ds_read_b64_tr_b16 v[32:33], v24 offset:0
    ds_read_b64_tr_b16 v[34:35], v24 offset:1024
    v_mfma_f32_16x16x32_bf16 v[252:255], v[56:59], a[120:123], v[252:255]
    buffer_load_dwordx4 v20, s[4:7], s92 offen offset:0 nt lds
    v_mfma_f32_16x16x32_bf16 v[252:255], v[60:63], a[124:127], v[252:255]
    ds_read_b64_tr_b16 v[36:37], v24 offset:8192
    ds_read_b64_tr_b16 v[38:39], v24 offset:9216
    v_mfma_f32_16x16x32_bf16 v[248:251], v[60:63], a[108:111], v[248:251]
    v_rcp_f32 v82, v82
    v_mfma_f32_16x16x32_bf16 v[248:251], v[56:59], a[104:107], v[248:251]
    ds_read_b64_tr_b16 v[40:41], v24 offset:16384
    ds_read_b64_tr_b16 v[42:43], v24 offset:17408
    v_mfma_f32_16x16x32_bf16 v[248:251], v[52:55], a[100:103], v[248:251]
    buffer_load_dwordx4 v20, s[4:7], s92 offen offset:1024 nt lds
    v_mfma_f32_16x16x32_bf16 v[248:251], v[48:51], a[96:99], v[248:251]
    ds_read_b64_tr_b16 v[44:45], v24 offset:24576
    ds_read_b64_tr_b16 v[46:47], v24 offset:25600
    v_mfma_f32_16x16x32_bf16 v[244:247], v[48:51], a[80:83], v[244:247]
    v_rcp_f32 v83, v83
    v_mfma_f32_16x16x32_bf16 v[244:247], v[52:55], a[84:87], v[244:247]
    v_mul_f32 v80, v80, v84
    v_mul_f32 v81, v81, v85
    v_mfma_f32_16x16x32_bf16 v[244:247], v[56:59], a[88:91], v[244:247]
    buffer_load_dwordx4 v20, s[4:7], s92 offen offset:2048 nt lds
    v_mul_f32 v82, v82, v86
    v_mfma_f32_16x16x32_bf16 v[244:247], v[60:63], a[92:95], v[244:247]
    v_mul_f32 v83, v83, v87
    v_cvt_pk_bf16_f32 v70, v80, v81
    v_mfma_f32_16x16x32_bf16 v[240:243], v[60:63], a[76:79], v[240:243]
    v_cvt_pk_bf16_f32 v71, v82, v83
    buffer_store_dwordx4 v[68:71], v23, s[24:27], s39 offen offset:1024 sc1
    v_mfma_f32_16x16x32_bf16 v[240:243], v[56:59], a[72:75], v[240:243]
    v_mul_f32 v80, v100, v100
    v_mul_f32 v81, v101, v101
    v_mfma_f32_16x16x32_bf16 v[240:243], v[52:55], a[68:71], v[240:243]
    buffer_load_dwordx4 v20, s[4:7], s92 offen offset:3072 nt lds
    v_mul_f32 v82, v102, v102
    v_mfma_f32_16x16x32_bf16 v[240:243], v[48:51], a[64:67], v[240:243]
    s_waitcnt lgkmcnt(0)
    s_add_u32 s92, s92, 4096
    v_mul_f32 v83, v103, v103
    v_fma_f32 v80, v80, s3, v14
    v_smfmac_f32_16x16x64_bf16 v[16:19], v[4:7], v[32:39], v22
    ds_read_b64_tr_b16 v[48:49], v24 offset:8
    ds_read_b64_tr_b16 v[50:51], v24 offset:1032
    s_add_u32 m0, s91, 36864
    v_smfmac_f32_16x16x64_bf16 v[16:19], v[4:7], v[40:47], v22
    buffer_load_dwordx4 v20, s[4:7], s92 offen offset:0 nt lds
    v_fma_f32 v81, v81, s3, v14
    v_mfma_f32_16x16x32_bf16 v[128:131], v[32:35], a[128:131], v[128:131]
    ds_read_b64_tr_b16 v[52:53], v24 offset:8200
    ds_read_b64_tr_b16 v[54:55], v24 offset:9224
    v_mfma_f32_16x16x32_bf16 v[128:131], v[36:39], a[132:135], v[128:131]
    v_add_u32 v26, 0x10000, v26
    v_add_u32 v27, 0x10000, v27
    v_mfma_f32_16x16x32_bf16 v[128:131], v[40:43], a[136:139], v[128:131]
    ds_read_b64_tr_b16 v[56:57], v24 offset:16392
    ds_read_b64_tr_b16 v[58:59], v24 offset:17416
    v_mfma_f32_16x16x32_bf16 v[128:131], v[44:47], a[140:143], v[128:131]
    buffer_load_dwordx4 v20, s[4:7], s92 offen offset:1024 nt lds
    v_fma_f32 v82, v82, s3, v14
    v_mfma_f32_16x16x32_bf16 v[132:135], v[44:47], a[156:159], v[132:135]
    ds_read_b64_tr_b16 v[60:61], v24 offset:24584
    ds_read_b64_tr_b16 v[62:63], v24 offset:25608
    v_mfma_f32_16x16x32_bf16 v[132:135], v[40:43], a[152:155], v[132:135]
    v_fma_f32 v83, v83, s3, v14
    v_mul_f32 v80, v80, v100
    v_mfma_f32_16x16x32_bf16 v[132:135], v[36:39], a[148:151], v[132:135]
    v_mul_f32 v81, v81, v101
    v_mul_f32 v82, v82, v102
    v_mfma_f32_16x16x32_bf16 v[132:135], v[32:35], a[144:147], v[132:135]
    buffer_load_dwordx4 v20, s[4:7], s92 offen offset:2048 nt lds
    v_mul_f32 v83, v83, v103
    v_mfma_f32_16x16x32_bf16 v[136:139], v[32:35], a[160:163], v[136:139]
    v_exp_f32 v80, v80
    v_mfma_f32_16x16x32_bf16 v[136:139], v[36:39], a[164:167], v[136:139]
    v_exp_f32 v81, v81
    v_mfma_f32_16x16x32_bf16 v[136:139], v[40:43], a[168:171], v[136:139]
    v_exp_f32 v82, v82
    v_mfma_f32_16x16x32_bf16 v[136:139], v[44:47], a[172:175], v[136:139]
    buffer_load_dwordx4 v20, s[4:7], s92 offen offset:3072 nt lds
    v_mfma_f32_16x16x32_bf16 v[140:143], v[44:47], a[188:191], v[140:143]
    s_add_u32 s92, s92, 28672
    v_exp_f32 v83, v83
    v_mfma_f32_16x16x32_bf16 v[140:143], v[40:43], a[184:187], v[140:143]
    v_add_f32 v80, 1.0, v80
    v_add_f32 v81, 1.0, v81
    v_mfma_f32_16x16x32_bf16 v[140:143], v[36:39], a[180:183], v[140:143]
    v_add_f32 v82, 1.0, v82
    v_add_f32 v83, 1.0, v83
    v_mfma_f32_16x16x32_bf16 v[140:143], v[32:35], a[176:179], v[140:143]
    s_waitcnt lgkmcnt(0)
    v_rcp_f32 v80, v80
    v_smfmac_f32_16x16x64_bf16 v[28:31], v[4:7], v[48:55], v22
    ds_read_b64_tr_b16 v[32:33], v25 offset:0
    ds_read_b64_tr_b16 v[34:35], v25 offset:1024
    v_smfmac_f32_16x16x64_bf16 v[28:31], v[4:7], v[56:63], v22
    v_rcp_f32 v81, v81
    v_mfma_f32_16x16x32_bf16 v[156:159], v[48:51], a[176:179], v[156:159]
    ds_read_b64_tr_b16 v[36:37], v25 offset:8192
    ds_read_b64_tr_b16 v[38:39], v25 offset:9216
    v_mfma_f32_16x16x32_bf16 v[156:159], v[52:55], a[180:183], v[156:159]
    v_rcp_f32 v82, v82
    v_mfma_f32_16x16x32_bf16 v[156:159], v[56:59], a[184:187], v[156:159]
    ds_read_b64_tr_b16 v[40:41], v25 offset:16384
    ds_read_b64_tr_b16 v[42:43], v25 offset:17408
    v_mfma_f32_16x16x32_bf16 v[156:159], v[60:63], a[188:191], v[156:159]
    v_rcp_f32 v83, v83
    v_mfma_f32_16x16x32_bf16 v[152:155], v[60:63], a[172:175], v[152:155]
    ds_read_b64_tr_b16 v[44:45], v25 offset:24576
    ds_read_b64_tr_b16 v[46:47], v25 offset:25600
    v_mfma_f32_16x16x32_bf16 v[152:155], v[56:59], a[168:171], v[152:155]
    v_mul_f32 v80, v80, v100
    v_mul_f32 v81, v81, v101
    v_mfma_f32_16x16x32_bf16 v[152:155], v[52:55], a[164:167], v[152:155]
    v_mul_f32 v82, v82, v102
    v_mul_f32 v83, v83, v103
    v_mfma_f32_16x16x32_bf16 v[152:155], v[48:51], a[160:163], v[152:155]
    v_cvt_pk_bf16_f32 v100, v80, v81
    v_cvt_pk_bf16_f32 v101, v82, v83
    v_mfma_f32_16x16x32_bf16 v[148:151], v[48:51], a[144:147], v[148:151]
    v_mul_f32 v80, v116, v116
    v_mul_f32 v81, v117, v117
    v_mfma_f32_16x16x32_bf16 v[148:151], v[52:55], a[148:151], v[148:151]
    v_mul_f32 v82, v118, v118
    v_mul_f32 v83, v119, v119
    v_mfma_f32_16x16x32_bf16 v[148:151], v[56:59], a[152:155], v[148:151]
    v_fma_f32 v80, v80, s3, v14
    v_fma_f32 v81, v81, s3, v14
    v_mfma_f32_16x16x32_bf16 v[148:151], v[60:63], a[156:159], v[148:151]
    v_fma_f32 v82, v82, s3, v14
    v_fma_f32 v83, v83, s3, v14
    v_mfma_f32_16x16x32_bf16 v[144:147], v[60:63], a[140:143], v[144:147]
    v_mul_f32 v80, v80, v116
    v_mul_f32 v81, v81, v117
    v_mfma_f32_16x16x32_bf16 v[144:147], v[56:59], a[136:139], v[144:147]
    v_mul_f32 v82, v82, v118
    v_mul_f32 v83, v83, v119
    v_mfma_f32_16x16x32_bf16 v[144:147], v[52:55], a[132:135], v[144:147]
    v_exp_f32 v80, v80
    v_mfma_f32_16x16x32_bf16 v[144:147], v[48:51], a[128:131], v[144:147]
    s_waitcnt lgkmcnt(0)
    v_exp_f32 v81, v81
    v_mfma_f32_16x16x32_bf16 v[160:163], v[32:35], a[128:131], v[160:163]
    ds_read_b64_tr_b16 v[48:49], v25 offset:8
    ds_read_b64_tr_b16 v[50:51], v25 offset:1032
    v_mfma_f32_16x16x32_bf16 v[160:163], v[36:39], a[132:135], v[160:163]
    v_exp_f32 v82, v82
    v_mfma_f32_16x16x32_bf16 v[160:163], v[40:43], a[136:139], v[160:163]
    ds_read_b64_tr_b16 v[52:53], v25 offset:8200
    ds_read_b64_tr_b16 v[54:55], v25 offset:9224
    v_mfma_f32_16x16x32_bf16 v[160:163], v[44:47], a[140:143], v[160:163]
    v_exp_f32 v83, v83
    v_mfma_f32_16x16x32_bf16 v[164:167], v[44:47], a[156:159], v[164:167]
    ds_read_b64_tr_b16 v[56:57], v25 offset:16392
    ds_read_b64_tr_b16 v[58:59], v25 offset:17416
    v_mfma_f32_16x16x32_bf16 v[164:167], v[40:43], a[152:155], v[164:167]
    v_add_f32 v80, 1.0, v80
    v_add_f32 v81, 1.0, v81
    v_mfma_f32_16x16x32_bf16 v[164:167], v[36:39], a[148:151], v[164:167]
    ds_read_b64_tr_b16 v[60:61], v25 offset:24584
    ds_read_b64_tr_b16 v[62:63], v25 offset:25608
    v_mfma_f32_16x16x32_bf16 v[164:167], v[32:35], a[144:147], v[164:167]
    v_add_f32 v82, 1.0, v82
    v_add_f32 v83, 1.0, v83
    v_mfma_f32_16x16x32_bf16 v[168:171], v[32:35], a[160:163], v[168:171]
    s_waitcnt vmcnt(19)
    ds_read_b64_tr_b16 a[0:1], v11 offset:0
    ds_read_b64_tr_b16 a[2:3], v11 offset:2048
    v_mfma_f32_16x16x32_bf16 v[168:171], v[36:39], a[164:167], v[168:171]
    v_rcp_f32 v80, v80
    v_mfma_f32_16x16x32_bf16 v[168:171], v[40:43], a[168:171], v[168:171]
    ds_read_b64_tr_b16 a[4:5], v11 offset:8
    ds_read_b64_tr_b16 a[6:7], v11 offset:2056
    v_mfma_f32_16x16x32_bf16 v[168:171], v[44:47], a[172:175], v[168:171]
    v_rcp_f32 v81, v81
    v_mfma_f32_16x16x32_bf16 v[172:175], v[44:47], a[188:191], v[172:175]
    v_rcp_f32 v82, v82
    v_mfma_f32_16x16x32_bf16 v[172:175], v[40:43], a[184:187], v[172:175]
    v_rcp_f32 v83, v83
    v_mfma_f32_16x16x32_bf16 v[172:175], v[36:39], a[180:183], v[172:175]
    v_mul_f32 v80, v80, v116
    v_mul_f32 v81, v81, v117
    v_mfma_f32_16x16x32_bf16 v[172:175], v[32:35], a[176:179], v[172:175]
    s_waitcnt lgkmcnt(0)
    v_mul_f32 v82, v82, v118
    v_mul_f32 v83, v83, v119
    v_mfma_f32_16x16x32_bf16 v[188:191], v[48:51], a[176:179], v[188:191]
    ds_read_b64_tr_b16 v[32:33], v26 offset:0
    ds_read_b64_tr_b16 v[34:35], v26 offset:1024
    v_mfma_f32_16x16x32_bf16 v[188:191], v[52:55], a[180:183], v[188:191]
    v_cvt_pk_bf16_f32 v102, v80, v81
    v_cvt_pk_bf16_f32 v103, v82, v83
    v_mfma_f32_16x16x32_bf16 v[188:191], v[56:59], a[184:187], v[188:191]
    ds_read_b64_tr_b16 v[36:37], v26 offset:8192
    ds_read_b64_tr_b16 v[38:39], v26 offset:9216
    v_mfma_f32_16x16x32_bf16 v[188:191], v[60:63], a[188:191], v[188:191]
    buffer_store_dwordx4 v[100:103], v23, s[24:27], s97 offen offset:1024 sc1
    s_add_u32 s39, s39, 114688
    s_add_u32 s97, s97, 114688
    v_mul_f32 v80, v72, v72
    v_mfma_f32_16x16x32_bf16 v[184:187], v[60:63], a[172:175], v[184:187]
    ds_read_b64_tr_b16 v[40:41], v26 offset:16384
    ds_read_b64_tr_b16 v[42:43], v26 offset:17408
    v_mfma_f32_16x16x32_bf16 v[184:187], v[56:59], a[168:171], v[184:187]
    v_mul_f32 v81, v73, v73
    v_mul_f32 v82, v74, v74
    v_mfma_f32_16x16x32_bf16 v[184:187], v[52:55], a[164:167], v[184:187]
    ds_read_b64_tr_b16 v[44:45], v26 offset:24576
    ds_read_b64_tr_b16 v[46:47], v26 offset:25600
    v_mfma_f32_16x16x32_bf16 v[184:187], v[48:51], a[160:163], v[184:187]
    v_mul_f32 v83, v75, v75
    v_fma_f32 v80, v80, s3, v14
    v_mfma_f32_16x16x32_bf16 v[180:183], v[48:51], a[144:147], v[180:183]
    ds_read_b64_tr_b16 a[8:9], v11 offset:64
    ds_read_b64_tr_b16 a[10:11], v11 offset:2112
    v_mfma_f32_16x16x32_bf16 v[180:183], v[52:55], a[148:151], v[180:183]
    v_fma_f32 v81, v81, s3, v14
    v_fma_f32 v82, v82, s3, v14
    v_mfma_f32_16x16x32_bf16 v[180:183], v[56:59], a[152:155], v[180:183]
    ds_read_b64_tr_b16 a[12:13], v11 offset:72
    ds_read_b64_tr_b16 a[14:15], v11 offset:2120
    v_mfma_f32_16x16x32_bf16 v[180:183], v[60:63], a[156:159], v[180:183]
    v_fma_f32 v83, v83, s3, v14
    v_mul_f32 v80, v80, v72
    v_mfma_f32_16x16x32_bf16 v[176:179], v[60:63], a[140:143], v[176:179]
    v_mul_f32 v81, v81, v73
    v_mul_f32 v82, v82, v74
    v_mfma_f32_16x16x32_bf16 v[176:179], v[56:59], a[136:139], v[176:179]
    v_mul_f32 v83, v83, v75
    v_mfma_f32_16x16x32_bf16 v[176:179], v[52:55], a[132:135], v[176:179]
    v_exp_f32 v80, v80
    v_mfma_f32_16x16x32_bf16 v[176:179], v[48:51], a[128:131], v[176:179]
    s_waitcnt lgkmcnt(0)
    v_exp_f32 v81, v81
    v_mfma_f32_16x16x32_bf16 v[192:195], v[32:35], a[128:131], v[192:195]
    ds_read_b64_tr_b16 v[48:49], v26 offset:8
    ds_read_b64_tr_b16 v[50:51], v26 offset:1032
    v_mfma_f32_16x16x32_bf16 v[192:195], v[36:39], a[132:135], v[192:195]
    buffer_store_dwordx4 a[0:3], v23, s[32:35], s47 offen offset:0 sc1
    v_mfma_f32_16x16x32_bf16 v[192:195], v[40:43], a[136:139], v[192:195]
    ds_read_b64_tr_b16 v[52:53], v26 offset:8200
    ds_read_b64_tr_b16 v[54:55], v26 offset:9224
    v_mfma_f32_16x16x32_bf16 v[192:195], v[44:47], a[140:143], v[192:195]
    v_exp_f32 v82, v82
    v_mfma_f32_16x16x32_bf16 v[196:199], v[44:47], a[156:159], v[196:199]
    ds_read_b64_tr_b16 v[56:57], v26 offset:16392
    ds_read_b64_tr_b16 v[58:59], v26 offset:17416
    v_mfma_f32_16x16x32_bf16 v[196:199], v[40:43], a[152:155], v[196:199]
    buffer_store_dwordx4 a[4:7], v23, s[32:35], s47 offen offset:1024 sc1
    v_mfma_f32_16x16x32_bf16 v[196:199], v[36:39], a[148:151], v[196:199]
    ds_read_b64_tr_b16 v[60:61], v26 offset:24584
    ds_read_b64_tr_b16 v[62:63], v26 offset:25608
    v_mfma_f32_16x16x32_bf16 v[196:199], v[32:35], a[144:147], v[196:199]
    v_exp_f32 v83, v83
    v_mfma_f32_16x16x32_bf16 v[200:203], v[32:35], a[160:163], v[200:203]
    v_add_f32 v80, 1.0, v80
    v_add_f32 v81, 1.0, v81
    v_mfma_f32_16x16x32_bf16 v[200:203], v[36:39], a[164:167], v[200:203]
    buffer_store_dwordx4 a[8:11], v23, s[32:35], s47 offen offset:2048 sc1
    v_add_f32 v82, 1.0, v82
    v_mfma_f32_16x16x32_bf16 v[200:203], v[40:43], a[168:171], v[200:203]
    v_add_f32 v83, 1.0, v83
    v_mfma_f32_16x16x32_bf16 v[200:203], v[44:47], a[172:175], v[200:203]
    v_rcp_f32 v80, v80
    v_mfma_f32_16x16x32_bf16 v[204:207], v[44:47], a[188:191], v[204:207]
    v_rcp_f32 v81, v81
    v_mfma_f32_16x16x32_bf16 v[204:207], v[40:43], a[184:187], v[204:207]
    buffer_store_dwordx4 a[12:15], v23, s[32:35], s47 offen offset:3072 sc1
    v_mfma_f32_16x16x32_bf16 v[204:207], v[36:39], a[180:183], v[204:207]
    v_rcp_f32 v82, v82
    v_mfma_f32_16x16x32_bf16 v[204:207], v[32:35], a[176:179], v[204:207]
    s_waitcnt lgkmcnt(0)
    v_rcp_f32 v83, v83
    v_mfma_f32_16x16x32_bf16 v[220:223], v[48:51], a[176:179], v[220:223]
    ds_read_b64_tr_b16 v[32:33], v27 offset:0
    ds_read_b64_tr_b16 v[34:35], v27 offset:1024
    v_mfma_f32_16x16x32_bf16 v[220:223], v[52:55], a[180:183], v[220:223]
    v_mul_f32 v80, v80, v72
    v_mul_f32 v81, v81, v73
    v_mfma_f32_16x16x32_bf16 v[220:223], v[56:59], a[184:187], v[220:223]
    ds_read_b64_tr_b16 v[36:37], v27 offset:8192
    ds_read_b64_tr_b16 v[38:39], v27 offset:9216
    v_mfma_f32_16x16x32_bf16 v[220:223], v[60:63], a[188:191], v[220:223]
    v_mul_f32 v82, v82, v74
    v_mul_f32 v83, v83, v75
    v_mfma_f32_16x16x32_bf16 v[216:219], v[60:63], a[172:175], v[216:219]
    ds_read_b64_tr_b16 v[40:41], v27 offset:16384
    ds_read_b64_tr_b16 v[42:43], v27 offset:17408
    v_mfma_f32_16x16x32_bf16 v[216:219], v[56:59], a[168:171], v[216:219]
    v_cvt_pk_bf16_f32 v72, v80, v81
    v_cvt_pk_bf16_f32 v73, v82, v83
    v_mfma_f32_16x16x32_bf16 v[216:219], v[52:55], a[164:167], v[216:219]
    ds_read_b64_tr_b16 v[44:45], v27 offset:24576
    ds_read_b64_tr_b16 v[46:47], v27 offset:25600
    v_mfma_f32_16x16x32_bf16 v[216:219], v[48:51], a[160:163], v[216:219]
    v_mul_f32 v80, v88, v88
    v_mul_f32 v81, v89, v89
    v_mfma_f32_16x16x32_bf16 v[212:215], v[48:51], a[144:147], v[212:215]
    v_mul_f32 v82, v90, v90
    v_mul_f32 v83, v91, v91
    v_mfma_f32_16x16x32_bf16 v[212:215], v[52:55], a[148:151], v[212:215]
    v_fma_f32 v80, v80, s3, v14
    v_fma_f32 v81, v81, s3, v14
    v_mfma_f32_16x16x32_bf16 v[212:215], v[56:59], a[152:155], v[212:215]
    v_fma_f32 v82, v82, s3, v14
    v_fma_f32 v83, v83, s3, v14
    v_mfma_f32_16x16x32_bf16 v[212:215], v[60:63], a[156:159], v[212:215]
    v_mul_f32 v80, v80, v88
    v_mul_f32 v81, v81, v89
    v_mfma_f32_16x16x32_bf16 v[208:211], v[60:63], a[140:143], v[208:211]
    v_mul_f32 v82, v82, v90
    v_mul_f32 v83, v83, v91
    v_mfma_f32_16x16x32_bf16 v[208:211], v[56:59], a[136:139], v[208:211]
    v_exp_f32 v80, v80
    v_mfma_f32_16x16x32_bf16 v[208:211], v[52:55], a[132:135], v[208:211]
    v_exp_f32 v81, v81
    v_mfma_f32_16x16x32_bf16 v[208:211], v[48:51], a[128:131], v[208:211]
    s_waitcnt lgkmcnt(0)
    v_exp_f32 v82, v82
    v_mfma_f32_16x16x32_bf16 v[224:227], v[32:35], a[128:131], v[224:227]
    ds_read_b64_tr_b16 v[48:49], v27 offset:8
    ds_read_b64_tr_b16 v[50:51], v27 offset:1032
    v_mfma_f32_16x16x32_bf16 v[224:227], v[36:39], a[132:135], v[224:227]
    v_exp_f32 v83, v83
    v_mfma_f32_16x16x32_bf16 v[224:227], v[40:43], a[136:139], v[224:227]
    ds_read_b64_tr_b16 v[52:53], v27 offset:8200
    ds_read_b64_tr_b16 v[54:55], v27 offset:9224
    v_mfma_f32_16x16x32_bf16 v[224:227], v[44:47], a[140:143], v[224:227]
    v_add_f32 v80, 1.0, v80
    v_add_f32 v81, 1.0, v81
    v_mfma_f32_16x16x32_bf16 v[228:231], v[44:47], a[156:159], v[228:231]
    ds_read_b64_tr_b16 v[56:57], v27 offset:16392
    ds_read_b64_tr_b16 v[58:59], v27 offset:17416
    v_mfma_f32_16x16x32_bf16 v[228:231], v[40:43], a[152:155], v[228:231]
    v_add_f32 v82, 1.0, v82
    v_add_f32 v83, 1.0, v83
    v_mfma_f32_16x16x32_bf16 v[228:231], v[36:39], a[148:151], v[228:231]
    ds_read_b64_tr_b16 v[60:61], v27 offset:24584
    ds_read_b64_tr_b16 v[62:63], v27 offset:25608
    v_mfma_f32_16x16x32_bf16 v[228:231], v[32:35], a[144:147], v[228:231]
    v_rcp_f32 v80, v80
    v_mfma_f32_16x16x32_bf16 v[232:235], v[32:35], a[160:163], v[232:235]
    v_rcp_f32 v81, v81
    v_mfma_f32_16x16x32_bf16 v[232:235], v[36:39], a[164:167], v[232:235]
    v_rcp_f32 v82, v82
    v_mfma_f32_16x16x32_bf16 v[232:235], v[40:43], a[168:171], v[232:235]
    v_rcp_f32 v83, v83
    v_mfma_f32_16x16x32_bf16 v[232:235], v[44:47], a[172:175], v[232:235]
    v_mul_f32 v80, v80, v88
    v_mul_f32 v81, v81, v89
    v_mfma_f32_16x16x32_bf16 v[236:239], v[44:47], a[188:191], v[236:239]
    v_mul_f32 v82, v82, v90
    v_mul_f32 v83, v83, v91
    v_mfma_f32_16x16x32_bf16 v[236:239], v[40:43], a[184:187], v[236:239]
    v_cvt_pk_bf16_f32 v74, v80, v81
    v_cvt_pk_bf16_f32 v75, v82, v83
    v_mfma_f32_16x16x32_bf16 v[236:239], v[36:39], a[180:183], v[236:239]
    buffer_store_dwordx4 v[72:75], v23, s[24:27], s39 offen offset:0 sc1
    v_mul_f32 v80, v104, v104
    v_mfma_f32_16x16x32_bf16 v[236:239], v[32:35], a[176:179], v[236:239]
    s_waitcnt lgkmcnt(0)
    v_mul_f32 v81, v105, v105
    v_mul_f32 v82, v106, v106
    v_mfma_f32_16x16x32_bf16 v[252:255], v[48:51], a[176:179], v[252:255]
    s_waitcnt vmcnt(30)
    s_barrier
    v_mul_f32 v83, v107, v107
    v_fma_f32 v80, v80, s3, v14
    v_mfma_f32_16x16x32_bf16 v[252:255], v[52:55], a[180:183], v[252:255]
    s_add_u32 m0, s91, 65536
    ds_read_b64_tr_b16 v[32:33], v24 offset:32768
    ds_read_b64_tr_b16 v[34:35], v24 offset:33792
    v_mfma_f32_16x16x32_bf16 v[252:255], v[56:59], a[184:187], v[252:255]
    buffer_load_dwordx4 v21, s[8:11], s93 offen offset:0 nt lds
    v_fma_f32 v81, v81, s3, v14
    v_mfma_f32_16x16x32_bf16 v[252:255], v[60:63], a[188:191], v[252:255]
    ds_read_b64_tr_b16 v[36:37], v24 offset:40960
    ds_read_b64_tr_b16 v[38:39], v24 offset:41984
    v_mfma_f32_16x16x32_bf16 v[248:251], v[60:63], a[172:175], v[248:251]
    v_fma_f32 v82, v82, s3, v14
    v_fma_f32 v83, v83, s3, v14
    v_mfma_f32_16x16x32_bf16 v[248:251], v[56:59], a[168:171], v[248:251]
    ds_read_b64_tr_b16 v[40:41], v24 offset:49152
    ds_read_b64_tr_b16 v[42:43], v24 offset:50176
    v_mfma_f32_16x16x32_bf16 v[248:251], v[52:55], a[164:167], v[248:251]
    buffer_load_dwordx4 v21, s[8:11], s93 offen offset:1024 nt lds
    v_mul_f32 v80, v80, v104
    v_mfma_f32_16x16x32_bf16 v[248:251], v[48:51], a[160:163], v[248:251]
    ds_read_b64_tr_b16 v[44:45], v24 offset:57344
    ds_read_b64_tr_b16 v[46:47], v24 offset:58368
    v_mfma_f32_16x16x32_bf16 v[244:247], v[48:51], a[144:147], v[244:247]
    v_mul_f32 v81, v81, v105
    v_mul_f32 v82, v82, v106
    v_mfma_f32_16x16x32_bf16 v[244:247], v[52:55], a[148:151], v[244:247]
    v_mul_f32 v83, v83, v107
    v_mfma_f32_16x16x32_bf16 v[244:247], v[56:59], a[152:155], v[244:247]
    buffer_load_dwordx4 v21, s[8:11], s93 offen offset:2048 nt lds
    v_mfma_f32_16x16x32_bf16 v[244:247], v[60:63], a[156:159], v[244:247]
    v_exp_f32 v80, v80
    v_mfma_f32_16x16x32_bf16 v[240:243], v[60:63], a[140:143], v[240:243]
    v_exp_f32 v81, v81
    v_mfma_f32_16x16x32_bf16 v[240:243], v[56:59], a[136:139], v[240:243]
    v_exp_f32 v82, v82
    v_mfma_f32_16x16x32_bf16 v[240:243], v[52:55], a[132:135], v[240:243]
    buffer_load_dwordx4 v21, s[8:11], s93 offen offset:3072 nt lds
    v_mfma_f32_16x16x32_bf16 v[240:243], v[48:51], a[128:131], v[240:243]
    s_waitcnt lgkmcnt(0)
    s_add_u32 s93, s93, 4096
    v_exp_f32 v83, v83
    v_smfmac_f32_16x16x64_bf16 v[16:19], v[4:7], v[32:39], v22
    ds_read_b64_tr_b16 v[48:49], v24 offset:32776
    ds_read_b64_tr_b16 v[50:51], v24 offset:33800
    s_add_u32 m0, s91, 69632
    v_smfmac_f32_16x16x64_bf16 v[16:19], v[4:7], v[40:47], v22
    buffer_load_dwordx4 v21, s[8:11], s93 offen offset:0 nt lds
    v_add_f32 v80, 1.0, v80
    v_mfma_f32_16x16x32_bf16 v[128:131], v[32:35], a[192:195], v[128:131]
    ds_read_b64_tr_b16 v[52:53], v24 offset:40968
    ds_read_b64_tr_b16 v[54:55], v24 offset:41992
    v_mfma_f32_16x16x32_bf16 v[128:131], v[36:39], a[196:199], v[128:131]
    v_add_f32 v81, 1.0, v81
    v_add_f32 v82, 1.0, v82
    v_mfma_f32_16x16x32_bf16 v[128:131], v[40:43], a[200:203], v[128:131]
    ds_read_b64_tr_b16 v[56:57], v24 offset:49160
    ds_read_b64_tr_b16 v[58:59], v24 offset:50184
    s_lshl_b32 s95, s89, 7
    s_add_u32 s95, s95, 137216
    v_mfma_f32_16x16x32_bf16 v[128:131], v[44:47], a[204:207], v[128:131]
    buffer_load_dwordx4 v21, s[8:11], s93 offen offset:1024 nt lds
    v_lshl_add_u32 v9, v3, 2, s95
    v_mfma_f32_16x16x32_bf16 v[132:135], v[44:47], a[220:223], v[132:135]
    ds_read_b64_tr_b16 v[60:61], v24 offset:57352
    ds_read_b64_tr_b16 v[62:63], v24 offset:58376
    v_mfma_f32_16x16x32_bf16 v[132:135], v[40:43], a[216:219], v[132:135]
    v_lshl_add_u32 v15, v1, 4, s95
    s_add_u32 s95, s91, 131072
    v_add_u32 v10, s95, v23
    v_mfma_f32_16x16x32_bf16 v[132:135], v[36:39], a[212:215], v[132:135]
    v_lshl_add_u32 v11, v3, 4, s95
    ds_write_b64 v10, v[12:13]
    v_mfma_f32_16x16x32_bf16 v[132:135], v[32:35], a[208:211], v[132:135]
    buffer_load_dwordx4 v21, s[8:11], s93 offen offset:2048 nt lds
    ds_read_b64 v[64:65], v11 offset:0
    v_mfma_f32_16x16x32_bf16 v[136:139], v[32:35], a[224:227], v[136:139]
    ds_read_b64 v[66:67], v11 offset:256
    ds_read_b64 v[96:97], v11 offset:512
    v_mfma_f32_16x16x32_bf16 v[136:139], v[36:39], a[228:231], v[136:139]
    ds_read_b64 v[98:99], v11 offset:768
    v_add_f32 v83, 1.0, v83
    v_mfma_f32_16x16x32_bf16 v[136:139], v[40:43], a[232:235], v[136:139]
    v_rcp_f32 v80, v80
    v_mfma_f32_16x16x32_bf16 v[136:139], v[44:47], a[236:239], v[136:139]
    buffer_load_dwordx4 v21, s[8:11], s93 offen offset:3072 nt lds
    v_mfma_f32_16x16x32_bf16 v[140:143], v[44:47], a[252:255], v[140:143]
    s_add_u32 s93, s93, 28672
    v_rcp_f32 v81, v81
    v_mfma_f32_16x16x32_bf16 v[140:143], v[40:43], a[248:251], v[140:143]
    v_rcp_f32 v82, v82
    v_mfma_f32_16x16x32_bf16 v[140:143], v[36:39], a[244:247], v[140:143]
    v_rcp_f32 v83, v83
    v_mfma_f32_16x16x32_bf16 v[140:143], v[32:35], a[240:243], v[140:143]
    s_waitcnt lgkmcnt(0)
    v_mul_f32 v80, v80, v104
    v_mul_f32 v81, v81, v105
    v_smfmac_f32_16x16x64_bf16 v[28:31], v[4:7], v[48:55], v22
    ds_read_b64_tr_b16 v[32:33], v25 offset:32768
    ds_read_b64_tr_b16 v[34:35], v25 offset:33792
    v_smfmac_f32_16x16x64_bf16 v[28:31], v[4:7], v[56:63], v22
    v_mul_f32 v82, v82, v106
    v_mul_f32 v83, v83, v107
    v_mfma_f32_16x16x32_bf16 v[156:159], v[48:51], a[240:243], v[156:159]
    ds_read_b64_tr_b16 v[36:37], v25 offset:40960
    ds_read_b64_tr_b16 v[38:39], v25 offset:41984
    v_mfma_f32_16x16x32_bf16 v[156:159], v[52:55], a[244:247], v[156:159]
    v_cvt_pk_bf16_f32 v104, v80, v81
    v_cvt_pk_bf16_f32 v105, v82, v83
    v_mfma_f32_16x16x32_bf16 v[156:159], v[56:59], a[248:251], v[156:159]
    ds_read_b64_tr_b16 v[40:41], v25 offset:49152
    ds_read_b64_tr_b16 v[42:43], v25 offset:50176
    v_mfma_f32_16x16x32_bf16 v[156:159], v[60:63], a[252:255], v[156:159]
    v_mul_f32 v80, v120, v120
    v_mul_f32 v81, v121, v121
    v_mfma_f32_16x16x32_bf16 v[152:155], v[60:63], a[236:239], v[152:155]
    ds_read_b64_tr_b16 v[44:45], v25 offset:57344
    ds_read_b64_tr_b16 v[46:47], v25 offset:58368
    v_mfma_f32_16x16x32_bf16 v[152:155], v[56:59], a[232:235], v[152:155]
    v_mul_f32 v82, v122, v122
    v_mul_f32 v83, v123, v123
    v_mfma_f32_16x16x32_bf16 v[152:155], v[52:55], a[228:231], v[152:155]
    v_fma_f32 v80, v80, s3, v14
    v_fma_f32 v81, v81, s3, v14
    v_mfma_f32_16x16x32_bf16 v[152:155], v[48:51], a[224:227], v[152:155]
    v_fma_f32 v82, v82, s3, v14
    v_fma_f32 v83, v83, s3, v14
    v_mfma_f32_16x16x32_bf16 v[148:151], v[48:51], a[208:211], v[148:151]
    v_mul_f32 v80, v80, v120
    v_mul_f32 v81, v81, v121
    v_mfma_f32_16x16x32_bf16 v[148:151], v[52:55], a[212:215], v[148:151]
    v_mul_f32 v82, v82, v122
    v_mul_f32 v83, v83, v123
    v_mfma_f32_16x16x32_bf16 v[148:151], v[56:59], a[216:219], v[148:151]
    v_add_f32 v16, v16, v17
    v_add_f32 v28, v28, v29
    v_mfma_f32_16x16x32_bf16 v[148:151], v[60:63], a[220:223], v[148:151]
    v_exp_f32 v80, v80
    v_mfma_f32_16x16x32_bf16 v[144:147], v[60:63], a[204:207], v[144:147]
    v_exp_f32 v81, v81
    v_mfma_f32_16x16x32_bf16 v[144:147], v[56:59], a[200:203], v[144:147]
    v_exp_f32 v82, v82
    v_mfma_f32_16x16x32_bf16 v[144:147], v[52:55], a[196:199], v[144:147]
    v_exp_f32 v83, v83
    v_mfma_f32_16x16x32_bf16 v[144:147], v[48:51], a[192:195], v[144:147]
    s_waitcnt lgkmcnt(0)
    v_add_f32 v80, 1.0, v80
    v_add_f32 v81, 1.0, v81
    v_mfma_f32_16x16x32_bf16 v[160:163], v[32:35], a[192:195], v[160:163]
    ds_read_b64_tr_b16 v[48:49], v25 offset:32776
    ds_read_b64_tr_b16 v[50:51], v25 offset:33800
    v_mfma_f32_16x16x32_bf16 v[160:163], v[36:39], a[196:199], v[160:163]
    ds_write_b32 v9, v16
    ds_write_b32 v9, v28 offset:64
    v_mfma_f32_16x16x32_bf16 v[160:163], v[40:43], a[200:203], v[160:163]
    ds_read_b64_tr_b16 v[52:53], v25 offset:40968
    ds_read_b64_tr_b16 v[54:55], v25 offset:41992
    v_mfma_f32_16x16x32_bf16 v[160:163], v[44:47], a[204:207], v[160:163]
    v_xor_b32 v9, 128, v15
    v_xor_b32 v10, 256, v15
    v_mfma_f32_16x16x32_bf16 v[164:167], v[44:47], a[220:223], v[164:167]
    ds_read_b64_tr_b16 v[56:57], v25 offset:49160
    ds_read_b64_tr_b16 v[58:59], v25 offset:50184
    v_mfma_f32_16x16x32_bf16 v[164:167], v[40:43], a[216:219], v[164:167]
    v_xor_b32 v11, 384, v15
    v_add_f32 v82, 1.0, v82
    v_mfma_f32_16x16x32_bf16 v[164:167], v[36:39], a[212:215], v[164:167]
    ds_read_b64_tr_b16 v[60:61], v25 offset:57352
    ds_read_b64_tr_b16 v[62:63], v25 offset:58376
    v_mfma_f32_16x16x32_bf16 v[164:167], v[32:35], a[208:211], v[164:167]
    v_add_f32 v83, 1.0, v83
    v_mfma_f32_16x16x32_bf16 v[168:171], v[32:35], a[224:227], v[168:171]
    v_rcp_f32 v80, v80
    v_mfma_f32_16x16x32_bf16 v[168:171], v[36:39], a[228:231], v[168:171]
    v_rcp_f32 v81, v81
    v_mfma_f32_16x16x32_bf16 v[168:171], v[40:43], a[232:235], v[168:171]
    v_rcp_f32 v82, v82
    v_mfma_f32_16x16x32_bf16 v[168:171], v[44:47], a[236:239], v[168:171]
    v_rcp_f32 v83, v83
    v_mfma_f32_16x16x32_bf16 v[172:175], v[44:47], a[252:255], v[172:175]
    v_mul_f32 v80, v80, v120
    v_mul_f32 v81, v81, v121
    v_mfma_f32_16x16x32_bf16 v[172:175], v[40:43], a[248:251], v[172:175]
    v_mul_f32 v82, v82, v122
    v_mul_f32 v83, v83, v123
    v_mfma_f32_16x16x32_bf16 v[172:175], v[36:39], a[244:247], v[172:175]
    v_cvt_pk_bf16_f32 v106, v80, v81
    v_cvt_pk_bf16_f32 v107, v82, v83
    v_mfma_f32_16x16x32_bf16 v[172:175], v[32:35], a[240:243], v[172:175]
    s_waitcnt lgkmcnt(0)
    buffer_store_dwordx4 v[104:107], v23, s[24:27], s97 offen offset:0 sc1
    v_mul_f32 v80, v76, v76
    v_mfma_f32_16x16x32_bf16 v[188:191], v[48:51], a[240:243], v[188:191]
    ds_read_b64_tr_b16 v[32:33], v26 offset:32768
    ds_read_b64_tr_b16 v[34:35], v26 offset:33792
    v_mfma_f32_16x16x32_bf16 v[188:191], v[52:55], a[244:247], v[188:191]
    v_mul_f32 v81, v77, v77
    v_mul_f32 v82, v78, v78
    v_mfma_f32_16x16x32_bf16 v[188:191], v[56:59], a[248:251], v[188:191]
    ds_read_b64_tr_b16 v[36:37], v26 offset:40960
    ds_read_b64_tr_b16 v[38:39], v26 offset:41984
    v_mfma_f32_16x16x32_bf16 v[188:191], v[60:63], a[252:255], v[188:191]
    v_mul_f32 v83, v79, v79
    v_fma_f32 v80, v80, s3, v14
    v_mfma_f32_16x16x32_bf16 v[184:187], v[60:63], a[236:239], v[184:187]
    ds_read_b64_tr_b16 v[40:41], v26 offset:49152
    ds_read_b64_tr_b16 v[42:43], v26 offset:50176
    v_mfma_f32_16x16x32_bf16 v[184:187], v[56:59], a[232:235], v[184:187]
    v_fma_f32 v81, v81, s3, v14
    v_fma_f32 v82, v82, s3, v14
    v_mfma_f32_16x16x32_bf16 v[184:187], v[52:55], a[228:231], v[184:187]
    ds_read_b64_tr_b16 v[44:45], v26 offset:57344
    ds_read_b64_tr_b16 v[46:47], v26 offset:58368
    v_mfma_f32_16x16x32_bf16 v[184:187], v[48:51], a[224:227], v[184:187]
    v_fma_f32 v83, v83, s3, v14
    v_mul_f32 v80, v80, v76
    v_mfma_f32_16x16x32_bf16 v[180:183], v[48:51], a[208:211], v[180:183]
    v_mul_f32 v81, v81, v77
    v_mul_f32 v82, v82, v78
    v_mfma_f32_16x16x32_bf16 v[180:183], v[52:55], a[212:215], v[180:183]
    v_mul_f32 v83, v83, v79
    v_mfma_f32_16x16x32_bf16 v[180:183], v[56:59], a[216:219], v[180:183]
    v_exp_f32 v80, v80
    v_mfma_f32_16x16x32_bf16 v[180:183], v[60:63], a[220:223], v[180:183]
    v_exp_f32 v81, v81
    v_mfma_f32_16x16x32_bf16 v[176:179], v[60:63], a[204:207], v[176:179]
    v_exp_f32 v82, v82
    v_mfma_f32_16x16x32_bf16 v[176:179], v[56:59], a[200:203], v[176:179]
    v_exp_f32 v83, v83
    v_mfma_f32_16x16x32_bf16 v[176:179], v[52:55], a[196:199], v[176:179]
    v_add_f32 v80, 1.0, v80
    v_add_f32 v81, 1.0, v81
    v_mfma_f32_16x16x32_bf16 v[176:179], v[48:51], a[192:195], v[176:179]
    s_waitcnt lgkmcnt(0)
    v_add_f32 v82, 1.0, v82
    v_add_f32 v83, 1.0, v83
    v_mfma_f32_16x16x32_bf16 v[192:195], v[32:35], a[192:195], v[192:195]
    s_waitcnt vmcnt(26)
    s_barrier
    v_rcp_f32 v80, v80
    v_mfma_f32_16x16x32_bf16 v[192:195], v[36:39], a[196:199], v[192:195]
    ds_read_b64_tr_b16 v[48:49], v26 offset:32776
    ds_read_b64_tr_b16 v[50:51], v26 offset:33800
    v_mfma_f32_16x16x32_bf16 v[192:195], v[40:43], a[200:203], v[192:195]
    v_rcp_f32 v81, v81
    v_mfma_f32_16x16x32_bf16 v[192:195], v[44:47], a[204:207], v[192:195]
    ds_read_b64_tr_b16 v[52:53], v26 offset:40968
    ds_read_b64_tr_b16 v[54:55], v26 offset:41992
    v_mfma_f32_16x16x32_bf16 v[196:199], v[44:47], a[220:223], v[196:199]
    v_rcp_f32 v82, v82
    v_mfma_f32_16x16x32_bf16 v[196:199], v[40:43], a[216:219], v[196:199]
    ds_read_b64_tr_b16 v[56:57], v26 offset:49160
    ds_read_b64_tr_b16 v[58:59], v26 offset:50184
    v_mfma_f32_16x16x32_bf16 v[196:199], v[36:39], a[212:215], v[196:199]
    v_rcp_f32 v83, v83
    v_mfma_f32_16x16x32_bf16 v[196:199], v[32:35], a[208:211], v[196:199]
    ds_read_b64_tr_b16 v[60:61], v26 offset:57352
    ds_read_b64_tr_b16 v[62:63], v26 offset:58376
    v_mfma_f32_16x16x32_bf16 v[200:203], v[32:35], a[224:227], v[200:203]
    v_mul_f32 v80, v80, v76
    v_mul_f32 v81, v81, v77
    v_mfma_f32_16x16x32_bf16 v[200:203], v[36:39], a[228:231], v[200:203]
    v_mul_f32 v82, v82, v78
    v_mul_f32 v83, v83, v79
    v_mfma_f32_16x16x32_bf16 v[200:203], v[40:43], a[232:235], v[200:203]
    v_cvt_pk_bf16_f32 v76, v80, v81
    v_cvt_pk_bf16_f32 v77, v82, v83
    v_mfma_f32_16x16x32_bf16 v[200:203], v[44:47], a[236:239], v[200:203]
    v_mul_f32 v80, v92, v92
    v_mul_f32 v81, v93, v93
    v_mfma_f32_16x16x32_bf16 v[204:207], v[44:47], a[252:255], v[204:207]
    v_mul_f32 v82, v94, v94
    v_mul_f32 v83, v95, v95
    v_mfma_f32_16x16x32_bf16 v[204:207], v[40:43], a[248:251], v[204:207]
    v_fma_f32 v80, v80, s3, v14
    v_fma_f32 v81, v81, s3, v14
    v_mfma_f32_16x16x32_bf16 v[204:207], v[36:39], a[244:247], v[204:207]
    v_fma_f32 v82, v82, s3, v14
    v_fma_f32 v83, v83, s3, v14
    v_mfma_f32_16x16x32_bf16 v[204:207], v[32:35], a[240:243], v[204:207]
    s_waitcnt lgkmcnt(0)
    v_mul_f32 v80, v80, v92
    v_mul_f32 v81, v81, v93
    v_mfma_f32_16x16x32_bf16 v[220:223], v[48:51], a[240:243], v[220:223]
    ds_read_b64_tr_b16 v[32:33], v27 offset:32768
    ds_read_b64_tr_b16 v[34:35], v27 offset:33792
    v_mfma_f32_16x16x32_bf16 v[220:223], v[52:55], a[244:247], v[220:223]
    s_and_b32 s95, s2, 1
    v_mul_f32 v82, v82, v94
    v_mul_f32 v83, v83, v95
    v_mfma_f32_16x16x32_bf16 v[220:223], v[56:59], a[248:251], v[220:223]
    s_lshl_b32 s95, s95, 2
    ds_read_b64_tr_b16 v[36:37], v27 offset:40960
    ds_read_b64_tr_b16 v[38:39], v27 offset:41984
    v_mfma_f32_16x16x32_bf16 v[220:223], v[60:63], a[252:255], v[220:223]
    s_add_u32 s95, s95, s89
    v_exp_f32 v80, v80
    v_mfma_f32_16x16x32_bf16 v[216:219], v[60:63], a[236:239], v[216:219]
    s_lshr_b32 s94, s2, 1
    ds_read_b64_tr_b16 v[40:41], v27 offset:49152
    ds_read_b64_tr_b16 v[42:43], v27 offset:50176
    v_mfma_f32_16x16x32_bf16 v[216:219], v[56:59], a[232:235], v[216:219]
    s_lshl_b32 s46, s94, 8
    v_exp_f32 v81, v81
    v_mfma_f32_16x16x32_bf16 v[216:219], v[52:55], a[228:231], v[216:219]
    s_add_u32 s46, s46, s95
    ds_read_b64_tr_b16 v[44:45], v27 offset:57344
    ds_read_b64_tr_b16 v[46:47], v27 offset:58368
    v_mfma_f32_16x16x32_bf16 v[216:219], v[48:51], a[224:227], v[216:219]
    s_lshl_b32 s46, s46, 7
    v_exp_f32 v82, v82
    v_mfma_f32_16x16x32_bf16 v[212:215], v[48:51], a[208:211], v[212:215]
    s_lshl_b32 s47, s95, 7
    v_exp_f32 v83, v83
    v_mfma_f32_16x16x32_bf16 v[212:215], v[52:55], a[212:215], v[212:215]
    s_add_u32 s47, s47, s94
    v_add_f32 v80, 1.0, v80
    v_add_f32 v81, 1.0, v81
    v_mfma_f32_16x16x32_bf16 v[212:215], v[56:59], a[216:219], v[212:215]
    s_lshl_b32 s47, s47, 12
    v_add_f32 v82, 1.0, v82
    v_add_f32 v83, 1.0, v83
    v_mfma_f32_16x16x32_bf16 v[212:215], v[60:63], a[220:223], v[212:215]
    s_add_u32 s47, s47, 12582912
    v_rcp_f32 v80, v80
    v_mfma_f32_16x16x32_bf16 v[208:211], v[60:63], a[204:207], v[208:211]
    s_mov_b32 s12, s44
    v_rcp_f32 v81, v81
    v_mfma_f32_16x16x32_bf16 v[208:211], v[56:59], a[200:203], v[208:211]
    s_mov_b32 s13, s45
    v_rcp_f32 v82, v82
    v_mfma_f32_16x16x32_bf16 v[208:211], v[52:55], a[196:199], v[208:211]
    s_mov_b32 s14, 4194304
    v_rcp_f32 v83, v83
    v_mfma_f32_16x16x32_bf16 v[208:211], v[48:51], a[192:195], v[208:211]
    s_waitcnt lgkmcnt(0)
    v_mul_f32 v80, v80, v92
    v_mul_f32 v81, v81, v93
    v_mfma_f32_16x16x32_bf16 v[224:227], v[32:35], a[192:195], v[224:227]
    ds_read_b64_tr_b16 v[48:49], v27 offset:32776
    ds_read_b64_tr_b16 v[50:51], v27 offset:33800
    v_mfma_f32_16x16x32_bf16 v[224:227], v[36:39], a[196:199], v[224:227]
    s_and_b32 s76, s76, 0x7fff7fff
    s_lshl_b32 s86, s76, 16
    v_mul_f32 v82, v82, v94
    v_mul_f32 v83, v83, v95
    v_mfma_f32_16x16x32_bf16 v[224:227], v[40:43], a[200:203], v[224:227]
    s_max_u32 s76, s76, s86
    s_and_b32 s77, s77, 0x7fff7fff
    ds_read_b64_tr_b16 v[52:53], v27 offset:40968
    ds_read_b64_tr_b16 v[54:55], v27 offset:41992
    v_mfma_f32_16x16x32_bf16 v[224:227], v[44:47], a[204:207], v[224:227]
    s_lshl_b32 s86, s77, 16
    s_max_u32 s77, s77, s86
    v_cvt_pk_bf16_f32 v78, v80, v81
    v_cvt_pk_bf16_f32 v79, v82, v83
    v_mfma_f32_16x16x32_bf16 v[228:231], v[44:47], a[220:223], v[228:231]
    s_and_b32 s78, s78, 0x7fff7fff
    s_lshl_b32 s86, s78, 16
    ds_read_b64_tr_b16 v[56:57], v27 offset:49160
    ds_read_b64_tr_b16 v[58:59], v27 offset:50184
    v_mfma_f32_16x16x32_bf16 v[228:231], v[40:43], a[216:219], v[228:231]
    s_max_u32 s78, s78, s86
    s_and_b32 s79, s79, 0x7fff7fff
    buffer_store_dwordx4 v[76:79], v23, s[24:27], s39 offen offset:1024 sc1
    v_mul_f32 v80, v108, v108
    v_mfma_f32_16x16x32_bf16 v[228:231], v[36:39], a[212:215], v[228:231]
    s_lshl_b32 s86, s79, 16
    s_max_u32 s79, s79, s86
    ds_read_b64_tr_b16 v[60:61], v27 offset:57352
    ds_read_b64_tr_b16 v[62:63], v27 offset:58376
    v_mfma_f32_16x16x32_bf16 v[228:231], v[32:35], a[208:211], v[228:231]
    s_min_u32 s86, s76, s77
    s_min_u32 s87, s78, s79
    v_mul_f32 v81, v109, v109
    v_mul_f32 v82, v110, v110
    v_mfma_f32_16x16x32_bf16 v[232:235], v[32:35], a[224:227], v[232:235]
    s_min_u32 s86, s86, s87
    s_lshr_b32 s86, s86, 16
    v_mul_f32 v83, v111, v111
    v_fma_f32 v80, v80, s3, v14
    v_mfma_f32_16x16x32_bf16 v[232:235], v[36:39], a[228:231], v[232:235]
    s_add_u32 s86, s86, 1152
    s_min_u32 s86, s86, 0x5f80
    v_fma_f32 v81, v81, s3, v14
    v_fma_f32 v82, v82, s3, v14
    v_mfma_f32_16x16x32_bf16 v[232:235], v[40:43], a[232:235], v[232:235]
    s_pack_ll_b32_b16 s86, s86, s86
    v_fma_f32 v83, v83, s3, v14
    v_mul_f32 v80, v80, v108
    v_mfma_f32_16x16x32_bf16 v[232:235], v[44:47], a[236:239], v[232:235]
    v_mul_f32 v81, v81, v109
    v_mul_f32 v82, v82, v110
    v_mfma_f32_16x16x32_bf16 v[236:239], v[44:47], a[252:255], v[236:239]
    v_mul_f32 v83, v83, v111
    v_mfma_f32_16x16x32_bf16 v[236:239], v[40:43], a[248:251], v[236:239]
    v_exp_f32 v80, v80
    v_mfma_f32_16x16x32_bf16 v[236:239], v[36:39], a[244:247], v[236:239]
    v_exp_f32 v81, v81
    v_mfma_f32_16x16x32_bf16 v[236:239], v[32:35], a[240:243], v[236:239]
    s_waitcnt lgkmcnt(0)
    v_exp_f32 v82, v82
    v_mfma_f32_16x16x32_bf16 v[252:255], v[48:51], a[240:243], v[252:255]
    v_exp_f32 v83, v83
    v_mfma_f32_16x16x32_bf16 v[252:255], v[52:55], a[244:247], v[252:255]
    s_and_b32 s80, s80, 0x7f807f80
    s_lshl_b32 s84, s80, 16
    ds_read_b128 v[32:35], v15 offset:0
    ds_read_b128 v[36:39], v15 offset:64
    v_mfma_f32_16x16x32_bf16 v[252:255], v[56:59], a[248:251], v[252:255]
    s_max_u32 s80, s80, s84
    s_add_u32 s80, s80, s76
    ds_read_b128 v[40:43], v9 offset:0
    ds_read_b128 v[44:47], v9 offset:64
    v_mfma_f32_16x16x32_bf16 v[252:255], v[60:63], a[252:255], v[252:255]
    s_and_b32 s81, s81, 0x7f807f80
    s_lshl_b32 s84, s81, 16
    v_add_f32 v80, 1.0, v80
    v_add_f32 v81, 1.0, v81
    v_mfma_f32_16x16x32_bf16 v[248:251], v[60:63], a[236:239], v[248:251]
    s_max_u32 s81, s81, s84
    s_add_u32 s81, s81, s77
    v_add_f32 v82, 1.0, v82
    v_add_f32 v83, 1.0, v83
    v_mfma_f32_16x16x32_bf16 v[248:251], v[56:59], a[232:235], v[248:251]
    s_and_b32 s82, s82, 0x7f807f80
    s_lshl_b32 s84, s82, 16
    v_rcp_f32 v80, v80
    v_mfma_f32_16x16x32_bf16 v[248:251], v[52:55], a[228:231], v[248:251]
    s_max_u32 s82, s82, s84
    s_add_u32 s82, s82, s78
    v_rcp_f32 v81, v81
    v_mfma_f32_16x16x32_bf16 v[248:251], v[48:51], a[224:227], v[248:251]
    s_and_b32 s83, s83, 0x7f807f80
    s_lshl_b32 s84, s83, 16
    v_rcp_f32 v82, v82
    v_mfma_f32_16x16x32_bf16 v[244:247], v[48:51], a[208:211], v[244:247]
    s_max_u32 s83, s83, s84
    s_add_u32 s83, s83, s79
    v_rcp_f32 v83, v83
    v_mfma_f32_16x16x32_bf16 v[244:247], v[52:55], a[212:215], v[244:247]
    s_min_u32 s84, s80, s81
    s_min_u32 s85, s82, s83
    v_mul_f32 v80, v80, v108
    v_mul_f32 v81, v81, v109
    v_mfma_f32_16x16x32_bf16 v[244:247], v[56:59], a[216:219], v[244:247]
    s_min_u32 s84, s84, s85
    s_lshr_b32 s84, s84, 23
    v_mul_f32 v82, v82, v110
    v_mul_f32 v83, v83, v111
    v_mfma_f32_16x16x32_bf16 v[244:247], v[60:63], a[220:223], v[244:247]
    s_sub_u32 s84, s84, 119
    s_max_i32 s84, s84, 0
    v_cvt_pk_bf16_f32 v108, v80, v81
    v_cvt_pk_bf16_f32 v109, v82, v83
    v_mfma_f32_16x16x32_bf16 v[240:243], v[60:63], a[204:207], v[240:243]
    s_min_u32 s84, s84, 0xfc
    s_lshl_b32 s84, s84, 23
    v_mul_f32 v80, v124, v124
    v_mul_f32 v81, v125, v125
    v_mfma_f32_16x16x32_bf16 v[240:243], v[56:59], a[200:203], v[240:243]
    s_or_b32 s87, s84, 0x2aaaaa
    v_mul_f32 v82, v126, v126
    v_mul_f32 v83, v127, v127
    v_mfma_f32_16x16x32_bf16 v[240:243], v[52:55], a[196:199], v[240:243]
    v_fma_f32 v80, v80, s3, v14
    v_fma_f32 v81, v81, s3, v14
    v_mfma_f32_16x16x32_bf16 v[240:243], v[48:51], a[192:195], v[240:243]
    s_waitcnt lgkmcnt(0)
    v_fma_f32 v82, v82, s3, v14
    v_fma_f32 v83, v83, s3, v14
    ds_read_b128 v[68:71], v10 offset:0
    ds_read_b128 v[72:75], v10 offset:64
    ds_read_b128 v[76:79], v11 offset:0
    ds_read_b128 v[88:91], v11 offset:64
    v_lshrrev_b32 v24, 2, v3
    v_and_b32 v25, 3, v3
    v_lshlrev_b32 v25, 8, v25
    v_lshl_add_u32 v25, v24, 13, v25
    v_and_b32 v24, 0xff, v20
    v_add_u32 v8, v24, v25
    v_xor_b32 v9, 64, v8
    v_xor_b32 v10, 128, v8
    v_xor_b32 v11, 192, v8
    v_mov_b32_dpp v24, v8 row_newbcast:0 row_mask:0xf bank_mask:0xf
    v_mov_b32_dpp v25, v9 row_newbcast:0 row_mask:0xf bank_mask:0xf
    v_mov_b32_dpp v26, v10 row_newbcast:0 row_mask:0xf bank_mask:0xf
    v_mov_b32_dpp v27, v11 row_newbcast:0 row_mask:0xf bank_mask:0xf
    ds_read_b128 v[112:115], v24
    ds_read_b128 v[116:119], v25
    ds_read_b128 v[120:123], v26
    ds_read_b128 v[84:87], v27
    ds_read_b128 a[192:195], v8 offset:0
    ds_read_b128 a[196:199], v9 offset:0
    ds_read_b128 a[200:203], v10 offset:0
    ds_read_b128 a[204:207], v11 offset:0
    v_mul_f32 v80, v80, v124
    v_mul_f32 v81, v81, v125
    v_mul_f32 v82, v82, v126
    v_mul_f32 v83, v83, v127
    v_exp_f32 v80, v80
    v_exp_f32 v81, v81
    v_exp_f32 v82, v82
    v_exp_f32 v83, v83
    v_add_f32 v80, 1.0, v80
    v_add_f32 v81, 1.0, v81
    v_add_f32 v82, 1.0, v82
    v_add_f32 v83, 1.0, v83
    v_rcp_f32 v80, v80
    v_rcp_f32 v81, v81
    v_rcp_f32 v82, v82
    v_rcp_f32 v83, v83
    v_mul_f32 v80, v80, v124
    v_mul_f32 v81, v81, v125
    v_mul_f32 v82, v82, v126
    v_mul_f32 v83, v83, v127
    v_cvt_pk_bf16_f32 v110, v80, v81
    v_cvt_pk_bf16_f32 v111, v82, v83
    buffer_store_dwordx4 v[108:111], v23, s[24:27], s97 offen offset:1024 sc1
    v_pk_fma_f32 v[128:129], v[32:33], v[64:65], v[128:129] op_sel_hi:[1,0,1] neg_lo:[0,1,0] neg_hi:[0,1,0]
    v_pk_fma_f32 v[130:131], v[34:35], v[64:65], v[130:131] op_sel_hi:[1,0,1] neg_lo:[0,1,0] neg_hi:[0,1,0]
    v_pk_fma_f32 v[144:145], v[36:37], v[64:65], v[144:145] op_sel_hi:[1,0,1] neg_lo:[0,1,0] neg_hi:[0,1,0]
    v_pk_fma_f32 v[146:147], v[38:39], v[64:65], v[146:147] op_sel_hi:[1,0,1] neg_lo:[0,1,0] neg_hi:[0,1,0]
    v_pk_mul_f32 v[128:129], v[128:129], v[64:65] op_sel:[0,1]
    v_pk_mul_f32 v[130:131], v[130:131], v[64:65] op_sel:[0,1]
    v_pk_mul_f32 v[144:145], v[144:145], v[64:65] op_sel:[0,1]
    v_pk_mul_f32 v[146:147], v[146:147], v[64:65] op_sel:[0,1]
    v_cvt_pk_bf16_f32 v128, v128, v129
    v_cvt_pk_bf16_f32 v129, v130, v131
    v_cvt_pk_bf16_f32 v130, v144, v145
    v_cvt_pk_bf16_f32 v131, v146, v147
    v_accvgpr_write_b32 a128, v128
    v_accvgpr_write_b32 a129, v129
    v_accvgpr_write_b32 a130, v130
    v_accvgpr_write_b32 a131, v131
    v_pk_fma_f32 v[132:133], v[32:33], v[66:67], v[132:133] op_sel_hi:[1,0,1] neg_lo:[0,1,0] neg_hi:[0,1,0]
    v_pk_fma_f32 v[134:135], v[34:35], v[66:67], v[134:135] op_sel_hi:[1,0,1] neg_lo:[0,1,0] neg_hi:[0,1,0]
    v_pk_fma_f32 v[148:149], v[36:37], v[66:67], v[148:149] op_sel_hi:[1,0,1] neg_lo:[0,1,0] neg_hi:[0,1,0]
    v_pk_fma_f32 v[150:151], v[38:39], v[66:67], v[150:151] op_sel_hi:[1,0,1] neg_lo:[0,1,0] neg_hi:[0,1,0]
    v_pk_mul_f32 v[132:133], v[132:133], v[66:67] op_sel:[0,1]
    v_pk_mul_f32 v[134:135], v[134:135], v[66:67] op_sel:[0,1]
    v_pk_mul_f32 v[148:149], v[148:149], v[66:67] op_sel:[0,1]
    v_pk_mul_f32 v[150:151], v[150:151], v[66:67] op_sel:[0,1]
    v_cvt_pk_bf16_f32 v132, v132, v133
    v_cvt_pk_bf16_f32 v133, v134, v135
    v_cvt_pk_bf16_f32 v134, v148, v149
    v_cvt_pk_bf16_f32 v135, v150, v151
    v_accvgpr_write_b32 a144, v132
    v_accvgpr_write_b32 a145, v133
    v_accvgpr_write_b32 a146, v134
    v_accvgpr_write_b32 a147, v135
    v_pk_fma_f32 v[136:137], v[32:33], v[96:97], v[136:137] op_sel_hi:[1,0,1] neg_lo:[0,1,0] neg_hi:[0,1,0]
    v_pk_fma_f32 v[138:139], v[34:35], v[96:97], v[138:139] op_sel_hi:[1,0,1] neg_lo:[0,1,0] neg_hi:[0,1,0]
    v_pk_fma_f32 v[152:153], v[36:37], v[96:97], v[152:153] op_sel_hi:[1,0,1] neg_lo:[0,1,0] neg_hi:[0,1,0]
    v_pk_fma_f32 v[154:155], v[38:39], v[96:97], v[154:155] op_sel_hi:[1,0,1] neg_lo:[0,1,0] neg_hi:[0,1,0]
    v_pk_mul_f32 v[136:137], v[136:137], v[96:97] op_sel:[0,1]
    v_pk_mul_f32 v[138:139], v[138:139], v[96:97] op_sel:[0,1]
    v_pk_mul_f32 v[152:153], v[152:153], v[96:97] op_sel:[0,1]
    v_pk_mul_f32 v[154:155], v[154:155], v[96:97] op_sel:[0,1]
    v_cvt_pk_bf16_f32 v136, v136, v137
    v_cvt_pk_bf16_f32 v137, v138, v139
    v_cvt_pk_bf16_f32 v138, v152, v153
    v_cvt_pk_bf16_f32 v139, v154, v155
    v_accvgpr_write_b32 a160, v136
    v_accvgpr_write_b32 a161, v137
    v_accvgpr_write_b32 a162, v138
    v_accvgpr_write_b32 a163, v139
    v_pk_fma_f32 v[140:141], v[32:33], v[98:99], v[140:141] op_sel_hi:[1,0,1] neg_lo:[0,1,0] neg_hi:[0,1,0]
    v_pk_fma_f32 v[142:143], v[34:35], v[98:99], v[142:143] op_sel_hi:[1,0,1] neg_lo:[0,1,0] neg_hi:[0,1,0]
    v_pk_fma_f32 v[156:157], v[36:37], v[98:99], v[156:157] op_sel_hi:[1,0,1] neg_lo:[0,1,0] neg_hi:[0,1,0]
    v_pk_fma_f32 v[158:159], v[38:39], v[98:99], v[158:159] op_sel_hi:[1,0,1] neg_lo:[0,1,0] neg_hi:[0,1,0]
    v_pk_mul_f32 v[140:141], v[140:141], v[98:99] op_sel:[0,1]
    v_pk_mul_f32 v[142:143], v[142:143], v[98:99] op_sel:[0,1]
    v_pk_mul_f32 v[156:157], v[156:157], v[98:99] op_sel:[0,1]
    v_pk_mul_f32 v[158:159], v[158:159], v[98:99] op_sel:[0,1]
    v_cvt_pk_bf16_f32 v140, v140, v141
    v_cvt_pk_bf16_f32 v141, v142, v143
    v_cvt_pk_bf16_f32 v142, v156, v157
    v_cvt_pk_bf16_f32 v143, v158, v159
    v_accvgpr_write_b32 a176, v140
    v_accvgpr_write_b32 a177, v141
    v_accvgpr_write_b32 a178, v142
    v_accvgpr_write_b32 a179, v143
    s_waitcnt lgkmcnt(0)
    v_xor_b32 v112, 0x80008000, v112
    v_xor_b32 v113, 0x80008000, v113
    v_xor_b32 v114, 0x80008000, v114
    v_xor_b32 v115, 0x80008000, v115
    v_xor_b32 v116, 0x80008000, v116
    v_xor_b32 v117, 0x80008000, v117
    v_xor_b32 v118, 0x80008000, v118
    v_xor_b32 v119, 0x80008000, v119
    v_xor_b32 v120, 0x80008000, v120
    v_xor_b32 v121, 0x80008000, v121
    v_xor_b32 v122, 0x80008000, v122
    v_xor_b32 v123, 0x80008000, v123
    v_xor_b32 v84, 0x80008000, v84
    v_xor_b32 v85, 0x80008000, v85
    v_xor_b32 v86, 0x80008000, v86
    v_xor_b32 v87, 0x80008000, v87
    v_mov_b32 v92, 0xc2340000
    v_mov_b32 v93, 0xc2340000
    v_mov_b32 v94, 0xc2340000
    v_mov_b32 v95, 0xc2340000
    v_pk_fma_f32 v[160:161], v[40:41], v[64:65], v[160:161] op_sel_hi:[1,0,1] neg_lo:[0,1,0] neg_hi:[0,1,0]
    v_pk_fma_f32 v[162:163], v[42:43], v[64:65], v[162:163] op_sel_hi:[1,0,1] neg_lo:[0,1,0] neg_hi:[0,1,0]
    v_pk_fma_f32 v[176:177], v[44:45], v[64:65], v[176:177] op_sel_hi:[1,0,1] neg_lo:[0,1,0] neg_hi:[0,1,0]
    v_pk_fma_f32 v[178:179], v[46:47], v[64:65], v[178:179] op_sel_hi:[1,0,1] neg_lo:[0,1,0] neg_hi:[0,1,0]
    v_pk_mul_f32 v[160:161], v[160:161], v[64:65] op_sel:[0,1]
    v_pk_mul_f32 v[162:163], v[162:163], v[64:65] op_sel:[0,1]
    v_pk_mul_f32 v[176:177], v[176:177], v[64:65] op_sel:[0,1]
    v_pk_mul_f32 v[178:179], v[178:179], v[64:65] op_sel:[0,1]
    v_cvt_pk_bf16_f32 v160, v160, v161
    v_cvt_pk_bf16_f32 v161, v162, v163
    v_cvt_pk_bf16_f32 v162, v176, v177
    v_cvt_pk_bf16_f32 v163, v178, v179
    v_accvgpr_write_b32 a132, v160
    v_accvgpr_write_b32 a133, v161
    v_accvgpr_write_b32 a134, v162
    v_accvgpr_write_b32 a135, v163
    v_pk_fma_f32 v[164:165], v[40:41], v[66:67], v[164:165] op_sel_hi:[1,0,1] neg_lo:[0,1,0] neg_hi:[0,1,0]
    v_pk_fma_f32 v[166:167], v[42:43], v[66:67], v[166:167] op_sel_hi:[1,0,1] neg_lo:[0,1,0] neg_hi:[0,1,0]
    v_pk_fma_f32 v[180:181], v[44:45], v[66:67], v[180:181] op_sel_hi:[1,0,1] neg_lo:[0,1,0] neg_hi:[0,1,0]
    v_pk_fma_f32 v[182:183], v[46:47], v[66:67], v[182:183] op_sel_hi:[1,0,1] neg_lo:[0,1,0] neg_hi:[0,1,0]
    v_pk_mul_f32 v[164:165], v[164:165], v[66:67] op_sel:[0,1]
    v_pk_mul_f32 v[166:167], v[166:167], v[66:67] op_sel:[0,1]
    v_pk_mul_f32 v[180:181], v[180:181], v[66:67] op_sel:[0,1]
    v_pk_mul_f32 v[182:183], v[182:183], v[66:67] op_sel:[0,1]
    v_cvt_pk_bf16_f32 v164, v164, v165
    v_cvt_pk_bf16_f32 v165, v166, v167
    v_cvt_pk_bf16_f32 v166, v180, v181
    v_cvt_pk_bf16_f32 v167, v182, v183
    v_accvgpr_write_b32 a148, v164
    v_accvgpr_write_b32 a149, v165
    v_accvgpr_write_b32 a150, v166
    v_accvgpr_write_b32 a151, v167
    v_pk_fma_f32 v[168:169], v[40:41], v[96:97], v[168:169] op_sel_hi:[1,0,1] neg_lo:[0,1,0] neg_hi:[0,1,0]
    v_pk_fma_f32 v[170:171], v[42:43], v[96:97], v[170:171] op_sel_hi:[1,0,1] neg_lo:[0,1,0] neg_hi:[0,1,0]
    v_pk_fma_f32 v[184:185], v[44:45], v[96:97], v[184:185] op_sel_hi:[1,0,1] neg_lo:[0,1,0] neg_hi:[0,1,0]
    v_pk_fma_f32 v[186:187], v[46:47], v[96:97], v[186:187] op_sel_hi:[1,0,1] neg_lo:[0,1,0] neg_hi:[0,1,0]
    v_pk_mul_f32 v[168:169], v[168:169], v[96:97] op_sel:[0,1]
    v_pk_mul_f32 v[170:171], v[170:171], v[96:97] op_sel:[0,1]
    v_pk_mul_f32 v[184:185], v[184:185], v[96:97] op_sel:[0,1]
    v_pk_mul_f32 v[186:187], v[186:187], v[96:97] op_sel:[0,1]
    v_cvt_pk_bf16_f32 v168, v168, v169
    v_cvt_pk_bf16_f32 v169, v170, v171
    v_cvt_pk_bf16_f32 v170, v184, v185
    v_cvt_pk_bf16_f32 v171, v186, v187
    v_accvgpr_write_b32 a164, v168
    v_accvgpr_write_b32 a165, v169
    v_accvgpr_write_b32 a166, v170
    v_accvgpr_write_b32 a167, v171
    v_pk_fma_f32 v[172:173], v[40:41], v[98:99], v[172:173] op_sel_hi:[1,0,1] neg_lo:[0,1,0] neg_hi:[0,1,0]
    v_pk_fma_f32 v[174:175], v[42:43], v[98:99], v[174:175] op_sel_hi:[1,0,1] neg_lo:[0,1,0] neg_hi:[0,1,0]
    v_pk_fma_f32 v[188:189], v[44:45], v[98:99], v[188:189] op_sel_hi:[1,0,1] neg_lo:[0,1,0] neg_hi:[0,1,0]
    v_pk_fma_f32 v[190:191], v[46:47], v[98:99], v[190:191] op_sel_hi:[1,0,1] neg_lo:[0,1,0] neg_hi:[0,1,0]
    v_pk_mul_f32 v[172:173], v[172:173], v[98:99] op_sel:[0,1]
    v_pk_mul_f32 v[174:175], v[174:175], v[98:99] op_sel:[0,1]
    v_pk_mul_f32 v[188:189], v[188:189], v[98:99] op_sel:[0,1]
    v_pk_mul_f32 v[190:191], v[190:191], v[98:99] op_sel:[0,1]
    v_cvt_pk_bf16_f32 v172, v172, v173
    v_cvt_pk_bf16_f32 v173, v174, v175
    v_cvt_pk_bf16_f32 v174, v188, v189
    v_cvt_pk_bf16_f32 v175, v190, v191
    v_accvgpr_write_b32 a180, v172
    v_accvgpr_write_b32 a181, v173
    v_accvgpr_write_b32 a182, v174
    v_accvgpr_write_b32 a183, v175
    v_pk_fma_f32 v[192:193], v[68:69], v[64:65], v[192:193] op_sel_hi:[1,0,1] neg_lo:[0,1,0] neg_hi:[0,1,0]
    v_pk_fma_f32 v[194:195], v[70:71], v[64:65], v[194:195] op_sel_hi:[1,0,1] neg_lo:[0,1,0] neg_hi:[0,1,0]
    v_pk_fma_f32 v[208:209], v[72:73], v[64:65], v[208:209] op_sel_hi:[1,0,1] neg_lo:[0,1,0] neg_hi:[0,1,0]
    v_pk_fma_f32 v[210:211], v[74:75], v[64:65], v[210:211] op_sel_hi:[1,0,1] neg_lo:[0,1,0] neg_hi:[0,1,0]
    v_pk_mul_f32 v[192:193], v[192:193], v[64:65] op_sel:[0,1]
    v_pk_mul_f32 v[194:195], v[194:195], v[64:65] op_sel:[0,1]
    v_pk_mul_f32 v[208:209], v[208:209], v[64:65] op_sel:[0,1]
    v_pk_mul_f32 v[210:211], v[210:211], v[64:65] op_sel:[0,1]
    v_cvt_pk_bf16_f32 v192, v192, v193
    v_cvt_pk_bf16_f32 v193, v194, v195
    v_cvt_pk_bf16_f32 v194, v208, v209
    v_cvt_pk_bf16_f32 v195, v210, v211
    v_accvgpr_write_b32 a136, v192
    v_accvgpr_write_b32 a137, v193
    v_accvgpr_write_b32 a138, v194
    v_accvgpr_write_b32 a139, v195
    v_pk_fma_f32 v[196:197], v[68:69], v[66:67], v[196:197] op_sel_hi:[1,0,1] neg_lo:[0,1,0] neg_hi:[0,1,0]
    v_pk_fma_f32 v[198:199], v[70:71], v[66:67], v[198:199] op_sel_hi:[1,0,1] neg_lo:[0,1,0] neg_hi:[0,1,0]
    v_pk_fma_f32 v[212:213], v[72:73], v[66:67], v[212:213] op_sel_hi:[1,0,1] neg_lo:[0,1,0] neg_hi:[0,1,0]
    v_pk_fma_f32 v[214:215], v[74:75], v[66:67], v[214:215] op_sel_hi:[1,0,1] neg_lo:[0,1,0] neg_hi:[0,1,0]
    v_pk_mul_f32 v[196:197], v[196:197], v[66:67] op_sel:[0,1]
    v_pk_mul_f32 v[198:199], v[198:199], v[66:67] op_sel:[0,1]
    v_pk_mul_f32 v[212:213], v[212:213], v[66:67] op_sel:[0,1]
    v_pk_mul_f32 v[214:215], v[214:215], v[66:67] op_sel:[0,1]
    v_cvt_pk_bf16_f32 v196, v196, v197
    v_cvt_pk_bf16_f32 v197, v198, v199
    v_cvt_pk_bf16_f32 v198, v212, v213
    v_cvt_pk_bf16_f32 v199, v214, v215
    v_accvgpr_write_b32 a152, v196
    v_accvgpr_write_b32 a153, v197
    v_accvgpr_write_b32 a154, v198
    v_accvgpr_write_b32 a155, v199
    v_pk_fma_f32 v[200:201], v[68:69], v[96:97], v[200:201] op_sel_hi:[1,0,1] neg_lo:[0,1,0] neg_hi:[0,1,0]
    v_pk_fma_f32 v[202:203], v[70:71], v[96:97], v[202:203] op_sel_hi:[1,0,1] neg_lo:[0,1,0] neg_hi:[0,1,0]
    v_pk_fma_f32 v[216:217], v[72:73], v[96:97], v[216:217] op_sel_hi:[1,0,1] neg_lo:[0,1,0] neg_hi:[0,1,0]
    v_pk_fma_f32 v[218:219], v[74:75], v[96:97], v[218:219] op_sel_hi:[1,0,1] neg_lo:[0,1,0] neg_hi:[0,1,0]
    v_pk_mul_f32 v[200:201], v[200:201], v[96:97] op_sel:[0,1]
    v_pk_mul_f32 v[202:203], v[202:203], v[96:97] op_sel:[0,1]
    v_pk_mul_f32 v[216:217], v[216:217], v[96:97] op_sel:[0,1]
    v_pk_mul_f32 v[218:219], v[218:219], v[96:97] op_sel:[0,1]
    v_cvt_pk_bf16_f32 v200, v200, v201
    v_cvt_pk_bf16_f32 v201, v202, v203
    v_cvt_pk_bf16_f32 v202, v216, v217
    v_cvt_pk_bf16_f32 v203, v218, v219
    v_accvgpr_write_b32 a168, v200
    v_accvgpr_write_b32 a169, v201
    v_accvgpr_write_b32 a170, v202
    v_accvgpr_write_b32 a171, v203
    v_pk_fma_f32 v[204:205], v[68:69], v[98:99], v[204:205] op_sel_hi:[1,0,1] neg_lo:[0,1,0] neg_hi:[0,1,0]
    v_pk_fma_f32 v[206:207], v[70:71], v[98:99], v[206:207] op_sel_hi:[1,0,1] neg_lo:[0,1,0] neg_hi:[0,1,0]
    v_pk_fma_f32 v[220:221], v[72:73], v[98:99], v[220:221] op_sel_hi:[1,0,1] neg_lo:[0,1,0] neg_hi:[0,1,0]
    v_pk_fma_f32 v[222:223], v[74:75], v[98:99], v[222:223] op_sel_hi:[1,0,1] neg_lo:[0,1,0] neg_hi:[0,1,0]
    v_pk_mul_f32 v[204:205], v[204:205], v[98:99] op_sel:[0,1]
    v_pk_mul_f32 v[206:207], v[206:207], v[98:99] op_sel:[0,1]
    v_pk_mul_f32 v[220:221], v[220:221], v[98:99] op_sel:[0,1]
    v_pk_mul_f32 v[222:223], v[222:223], v[98:99] op_sel:[0,1]
    v_cvt_pk_bf16_f32 v204, v204, v205
    v_cvt_pk_bf16_f32 v205, v206, v207
    v_cvt_pk_bf16_f32 v206, v220, v221
    v_cvt_pk_bf16_f32 v207, v222, v223
    v_accvgpr_write_b32 a184, v204
    v_accvgpr_write_b32 a185, v205
    v_accvgpr_write_b32 a186, v206
    v_accvgpr_write_b32 a187, v207
    v_pk_fma_f32 v[224:225], v[76:77], v[64:65], v[224:225] op_sel_hi:[1,0,1] neg_lo:[0,1,0] neg_hi:[0,1,0]
    v_pk_fma_f32 v[226:227], v[78:79], v[64:65], v[226:227] op_sel_hi:[1,0,1] neg_lo:[0,1,0] neg_hi:[0,1,0]
    v_pk_fma_f32 v[240:241], v[88:89], v[64:65], v[240:241] op_sel_hi:[1,0,1] neg_lo:[0,1,0] neg_hi:[0,1,0]
    v_pk_fma_f32 v[242:243], v[90:91], v[64:65], v[242:243] op_sel_hi:[1,0,1] neg_lo:[0,1,0] neg_hi:[0,1,0]
    v_pk_mul_f32 v[224:225], v[224:225], v[64:65] op_sel:[0,1]
    v_pk_mul_f32 v[226:227], v[226:227], v[64:65] op_sel:[0,1]
    v_pk_mul_f32 v[240:241], v[240:241], v[64:65] op_sel:[0,1]
    v_pk_mul_f32 v[242:243], v[242:243], v[64:65] op_sel:[0,1]
    v_cvt_pk_bf16_f32 v224, v224, v225
    v_cvt_pk_bf16_f32 v225, v226, v227
    v_cvt_pk_bf16_f32 v226, v240, v241
    v_cvt_pk_bf16_f32 v227, v242, v243
    v_accvgpr_write_b32 a140, v224
    v_accvgpr_write_b32 a141, v225
    v_accvgpr_write_b32 a142, v226
    v_accvgpr_write_b32 a143, v227
    v_pk_fma_f32 v[228:229], v[76:77], v[66:67], v[228:229] op_sel_hi:[1,0,1] neg_lo:[0,1,0] neg_hi:[0,1,0]
    v_pk_fma_f32 v[230:231], v[78:79], v[66:67], v[230:231] op_sel_hi:[1,0,1] neg_lo:[0,1,0] neg_hi:[0,1,0]
    v_pk_fma_f32 v[244:245], v[88:89], v[66:67], v[244:245] op_sel_hi:[1,0,1] neg_lo:[0,1,0] neg_hi:[0,1,0]
    v_pk_fma_f32 v[246:247], v[90:91], v[66:67], v[246:247] op_sel_hi:[1,0,1] neg_lo:[0,1,0] neg_hi:[0,1,0]
    v_pk_mul_f32 v[228:229], v[228:229], v[66:67] op_sel:[0,1]
    v_pk_mul_f32 v[230:231], v[230:231], v[66:67] op_sel:[0,1]
    v_pk_mul_f32 v[244:245], v[244:245], v[66:67] op_sel:[0,1]
    v_pk_mul_f32 v[246:247], v[246:247], v[66:67] op_sel:[0,1]
    v_cvt_pk_bf16_f32 v228, v228, v229
    v_cvt_pk_bf16_f32 v229, v230, v231
    v_cvt_pk_bf16_f32 v230, v244, v245
    v_cvt_pk_bf16_f32 v231, v246, v247
    v_accvgpr_write_b32 a156, v228
    v_accvgpr_write_b32 a157, v229
    v_accvgpr_write_b32 a158, v230
    v_accvgpr_write_b32 a159, v231
    v_pk_fma_f32 v[232:233], v[76:77], v[96:97], v[232:233] op_sel_hi:[1,0,1] neg_lo:[0,1,0] neg_hi:[0,1,0]
    v_pk_fma_f32 v[234:235], v[78:79], v[96:97], v[234:235] op_sel_hi:[1,0,1] neg_lo:[0,1,0] neg_hi:[0,1,0]
    v_pk_fma_f32 v[248:249], v[88:89], v[96:97], v[248:249] op_sel_hi:[1,0,1] neg_lo:[0,1,0] neg_hi:[0,1,0]
    v_pk_fma_f32 v[250:251], v[90:91], v[96:97], v[250:251] op_sel_hi:[1,0,1] neg_lo:[0,1,0] neg_hi:[0,1,0]
    v_pk_mul_f32 v[232:233], v[232:233], v[96:97] op_sel:[0,1]
    v_pk_mul_f32 v[234:235], v[234:235], v[96:97] op_sel:[0,1]
    v_pk_mul_f32 v[248:249], v[248:249], v[96:97] op_sel:[0,1]
    v_pk_mul_f32 v[250:251], v[250:251], v[96:97] op_sel:[0,1]
    v_cvt_pk_bf16_f32 v232, v232, v233
    v_cvt_pk_bf16_f32 v233, v234, v235
    v_cvt_pk_bf16_f32 v234, v248, v249
    v_cvt_pk_bf16_f32 v235, v250, v251
    v_accvgpr_write_b32 a172, v232
    v_accvgpr_write_b32 a173, v233
    v_accvgpr_write_b32 a174, v234
    v_accvgpr_write_b32 a175, v235
    v_pk_fma_f32 v[236:237], v[76:77], v[98:99], v[236:237] op_sel_hi:[1,0,1] neg_lo:[0,1,0] neg_hi:[0,1,0]
    v_pk_fma_f32 v[238:239], v[78:79], v[98:99], v[238:239] op_sel_hi:[1,0,1] neg_lo:[0,1,0] neg_hi:[0,1,0]
    v_pk_fma_f32 v[252:253], v[88:89], v[98:99], v[252:253] op_sel_hi:[1,0,1] neg_lo:[0,1,0] neg_hi:[0,1,0]
    v_pk_fma_f32 v[254:255], v[90:91], v[98:99], v[254:255] op_sel_hi:[1,0,1] neg_lo:[0,1,0] neg_hi:[0,1,0]
    v_pk_mul_f32 v[236:237], v[236:237], v[98:99] op_sel:[0,1]
    v_pk_mul_f32 v[238:239], v[238:239], v[98:99] op_sel:[0,1]
    v_pk_mul_f32 v[252:253], v[252:253], v[98:99] op_sel:[0,1]
    v_pk_mul_f32 v[254:255], v[254:255], v[98:99] op_sel:[0,1]
    v_cvt_pk_bf16_f32 v236, v236, v237
    v_cvt_pk_bf16_f32 v237, v238, v239
    v_cvt_pk_bf16_f32 v238, v252, v253
    v_cvt_pk_bf16_f32 v239, v254, v255
    v_accvgpr_write_b32 a188, v236
    v_accvgpr_write_b32 a189, v237
    v_accvgpr_write_b32 a190, v238
    v_accvgpr_write_b32 a191, v239
    v_mfma_f32_16x16x32_bf16 v[48:51], v[112:115], a[128:131], v[92:95]
    v_lshrrev_b32 v24, 2, v2
    v_and_b32 v25, 7, v24
    v_and_b32 v26, 3, v2
    v_mfma_f32_16x16x32_bf16 v[48:51], v[116:119], a[132:135], v[48:51]
    v_and_b32 v24, 3, v24
    v_lshlrev_b32 v24, 8, v24
    v_lshl_add_u32 v24, v1, 13, v24
    v_mfma_f32_16x16x32_bf16 v[48:51], v[120:123], a[136:139], v[48:51]
    v_lshl_add_u32 v24, v26, 3, v24
    v_add_u32 v24, 0x10000, v24
    v_lshl_add_u32 v12, v25, 5, v24
    v_mfma_f32_16x16x32_bf16 v[48:51], v[84:87], a[140:143], v[48:51]
    v_xor_b32 v13, 32, v12
    v_xor_b32 v14, 64, v12
    v_xor_b32 v15, 96, v12
    v_mfma_f32_16x16x32_bf16 v[52:55], v[112:115], a[144:147], v[92:95]
    v_xor_b32 v16, 128, v12
    v_xor_b32 v17, 160, v12
    v_xor_b32 v18, 192, v12
    v_mfma_f32_16x16x32_bf16 v[52:55], v[116:119], a[148:151], v[52:55]
    v_xor_b32 v19, 224, v12
    v_mov_b32 v64, 0
    v_mov_b32 v65, 0
    v_mfma_f32_16x16x32_bf16 v[52:55], v[120:123], a[152:155], v[52:55]
    v_mov_b32 v68, 0
    v_mov_b32 v69, 0
    v_mov_b32 v72, 0
    v_mfma_f32_16x16x32_bf16 v[52:55], v[84:87], a[156:159], v[52:55]
    v_mov_b32 v73, 0
    v_mov_b32 v76, 0
    v_mov_b32 v77, 0
    v_mfma_f32_16x16x32_bf16 v[56:59], v[112:115], a[160:163], v[92:95]
    v_mov_b32 v108, s86
    v_mov_b32 v109, s86
    v_mov_b32 v110, s86
    v_mfma_f32_16x16x32_bf16 v[56:59], v[116:119], a[164:167], v[56:59]
    v_mov_b32 v111, s86
    v_and_b32 v24, 3, v2
    v_mov_b32 v25, 1
    v_mfma_f32_16x16x32_bf16 v[56:59], v[120:123], a[168:171], v[56:59]
    v_lshlrev_b32 v24, 6, v24
    s_lshr_b32 s95, s2, 5
    s_lshl_b32 s95, s95, 5
    v_mfma_f32_16x16x32_bf16 v[56:59], v[84:87], a[172:175], v[56:59]
    v_lshlrev_b32 v28, 8, v2
    v_lshlrev_b32 v30, 6, v2
    s_lshl_b32 s95, s95, 7
    v_mfma_f32_16x16x32_bf16 v[60:63], v[112:115], a[176:179], v[92:95]
    s_mov_b32 s28, s4
    s_mov_b32 s29, s5
    s_mov_b32 s30, 0x80000
    v_mfma_f32_16x16x32_bf16 v[60:63], v[116:119], a[180:183], v[60:63]
    s_mov_b32 s31, 0x20000
    s_mov_b32 s51, 0x80000
    s_mov_b32 s45, 32768
    v_mfma_f32_16x16x32_bf16 v[60:63], v[120:123], a[184:187], v[60:63]
    s_add_u32 s44, s95, 65536
    s_cmp_eq_u32 s89, 0
    s_cbranch_scc1 K2_TW
    s_mov_b32 s28, s8
    s_mov_b32 s29, s9
    s_add_u32 s44, s95, 32768
    s_cmp_eq_u32 s89, 1
    s_cbranch_scc1 K2_TW
    s_mov_b32 s28, s20
    s_mov_b32 s29, s21
    s_mov_b32 s30, 0
    s_mov_b32 s51, 37748736
    s_mov_b32 s45, 20480
    s_and_b32 s95, s101, 3
    s_mul_i32 s95, s95, 5120
    s_add_u32 s44, s99, s95
    s_sub_u32 s44, s44, 79872
    v_mul_u32_u24 v30, 80, v2
    s_cmp_eq_u32 s89, 3
    s_cbranch_scc1 K2_TW
    s_mov_b32 s45, 10240
    s_mul_i32 s95, s38, 1280
    s_add_u32 s44, s100, s95
    s_sub_u32 s44, s44, 153600
    v_lshrrev_b32 v27, 5, v2
    v_mul_u32_u24 v27, 114688, v27
    v_and_b32 v30, 31, v2
    v_mad_u32_u24 v30, v30, 40, v27
K2_TW:
    v_mfma_f32_16x16x32_bf16 v[60:63], v[84:87], a[188:191], v[60:63]
    v_lshrrev_b32 v27, 3, v2
    v_and_b32 v31, 7, v2
    v_lshlrev_b32 v31, 7, v31
    v_lshl_add_u32 v31, v27, 12, v31
    s_and_b32 s95, s101, 3
    s_lshl_b32 s95, s95, 10
    v_add_u32 v31, s95, v31
    s_getpc_b64 vcc
K2_PC2:
    s_lshr_b32 s95, s2, 3
    s_mul_i32 s95, s95, ((K2_END - K2_PC2) / 4096 + 1) * 128
    v_lshrrev_b32 v26, 4, v2
    v_lshl_add_u32 v26, s89, 2, v26
    v_min_u32 v26, (K2_END - K2_PC2) / 4096, v26
    v_lshl_add_u32 v26, v26, 7, s95
    v_mov_b32 v27, 0
    v_min_u32 v26, K2_END - K2_PC2, v26
    v_lshl_add_u64 v[26:27], v[26:27], 0, vcc
    global_load_dword v0, v[26:27], off
    buffer_load_dword v0, v30, s[28:31], s44 offen sc1
    s_add_u32 s44, s44, s45
    buffer_load_dword v0, v30, s[28:31], s44 offen sc1
    s_add_u32 s44, s44, s45
    s_cmp_lg_u32 s96, 0
    s_cbranch_scc1 K2_MAXP
K2_ATT:
    v_mfma_f32_16x16x32_bf16 v[32:35], a[192:195], a[128:131], v[48:51]
    v_mfma_f32_16x16x32_bf16 v[32:35], a[196:199], a[132:135], v[32:35]
    ds_read_b128 a[208:211], v8 offset:1024
    v_mfma_f32_16x16x32_bf16 v[32:35], a[200:203], a[136:139], v[32:35]
    ds_read_b128 a[212:215], v9 offset:1024
    v_mfma_f32_16x16x32_bf16 v[32:35], a[204:207], a[140:143], v[32:35]
    ds_read_b128 a[216:219], v10 offset:1024
    v_mfma_f32_16x16x32_bf16 v[36:39], a[192:195], a[144:147], v[52:55]
    ds_read_b128 a[220:223], v11 offset:1024
    v_mfma_f32_16x16x32_bf16 v[36:39], a[196:199], a[148:151], v[36:39]
    v_mfma_f32_16x16x32_bf16 v[36:39], a[200:203], a[152:155], v[36:39]
    v_mfma_f32_16x16x32_bf16 v[36:39], a[204:207], a[156:159], v[36:39]
    s_nop 0
    v_mfma_f32_16x16x32_bf16 v[40:43], a[192:195], a[160:163], v[56:59]
    v_exp_f32 v32, v32
    v_mfma_f32_16x16x32_bf16 v[40:43], a[196:199], a[164:167], v[40:43]
    v_exp_f32 v33, v33
    v_mfma_f32_16x16x32_bf16 v[40:43], a[200:203], a[168:171], v[40:43]
    v_exp_f32 v34, v34
    v_cvt_pk_bf16_f32 v128, v32, v33
    v_mfma_f32_16x16x32_bf16 v[40:43], a[204:207], a[172:175], v[40:43]
    v_exp_f32 v35, v35
    v_mfma_f32_16x16x32_bf16 v[44:47], a[192:195], a[176:179], v[60:63]
    v_cvt_pk_bf16_f32 v129, v34, v35
    v_exp_f32 v36, v36
    v_mfma_f32_16x16x32_bf16 v[44:47], a[196:199], a[180:183], v[44:47]
    v_exp_f32 v37, v37
    v_mfma_f32_16x16x32_bf16 v[44:47], a[200:203], a[184:187], v[44:47]
    v_exp_f32 v38, v38
    v_cvt_pk_bf16_f32 v144, v36, v37
    v_mfma_f32_16x16x32_bf16 v[44:47], a[204:207], a[188:191], v[44:47]
    s_waitcnt lgkmcnt(0)
    v_exp_f32 v39, v39
    s_nop 0
    v_cvt_pk_bf16_f32 v145, v38, v39
    v_mfma_f32_16x16x32_bf16 v[32:35], a[208:211], a[128:131], v[48:51]
    v_exp_f32 v40, v40
    v_mfma_f32_16x16x32_bf16 v[32:35], a[212:215], a[132:135], v[32:35]
    ds_read_b128 a[192:195], v8 offset:2048
    v_exp_f32 v41, v41
    v_mfma_f32_16x16x32_bf16 v[32:35], a[216:219], a[136:139], v[32:35]
    ds_read_b128 a[196:199], v9 offset:2048
    v_exp_f32 v42, v42
    v_cvt_pk_bf16_f32 v160, v40, v41
    v_mfma_f32_16x16x32_bf16 v[32:35], a[220:223], a[140:143], v[32:35]
    ds_read_b128 a[200:203], v10 offset:2048
    v_exp_f32 v43, v43
    v_mfma_f32_16x16x32_bf16 v[36:39], a[208:211], a[144:147], v[52:55]
    ds_read_b128 a[204:207], v11 offset:2048
    v_cvt_pk_bf16_f32 v161, v42, v43
    v_exp_f32 v44, v44
    v_mfma_f32_16x16x32_bf16 v[36:39], a[212:215], a[148:151], v[36:39]
    v_exp_f32 v45, v45
    v_mfma_f32_16x16x32_bf16 v[36:39], a[216:219], a[152:155], v[36:39]
    v_exp_f32 v46, v46
    v_cvt_pk_bf16_f32 v176, v44, v45
    v_mfma_f32_16x16x32_bf16 v[36:39], a[220:223], a[156:159], v[36:39]
    v_exp_f32 v47, v47
    v_mfma_f32_16x16x32_bf16 v[40:43], a[208:211], a[160:163], v[56:59]
    v_cvt_pk_bf16_f32 v177, v46, v47
    v_exp_f32 v32, v32
    v_mfma_f32_16x16x32_bf16 v[40:43], a[212:215], a[164:167], v[40:43]
    v_exp_f32 v33, v33
    v_mfma_f32_16x16x32_bf16 v[40:43], a[216:219], a[168:171], v[40:43]
    v_exp_f32 v34, v34
    v_cvt_pk_bf16_f32 v130, v32, v33
    v_mfma_f32_16x16x32_bf16 v[40:43], a[220:223], a[172:175], v[40:43]
    v_exp_f32 v35, v35
    v_mfma_f32_16x16x32_bf16 v[44:47], a[208:211], a[176:179], v[60:63]
    v_cvt_pk_bf16_f32 v131, v34, v35
    v_exp_f32 v36, v36
    v_mfma_f32_16x16x32_bf16 v[44:47], a[212:215], a[180:183], v[44:47]
    v_exp_f32 v37, v37
    v_mfma_f32_16x16x32_bf16 v[44:47], a[216:219], a[184:187], v[44:47]
    v_exp_f32 v38, v38
    v_cvt_pk_bf16_f32 v146, v36, v37
    v_mfma_f32_16x16x32_bf16 v[44:47], a[220:223], a[188:191], v[44:47]
    s_waitcnt lgkmcnt(0)
    v_exp_f32 v39, v39
    s_nop 0
    v_cvt_pk_bf16_f32 v147, v38, v39
    v_mfma_f32_16x16x32_bf16 v[32:35], a[192:195], a[128:131], v[48:51]
    v_exp_f32 v40, v40
    v_mfma_f32_16x16x32_bf16 v[32:35], a[196:199], a[132:135], v[32:35]
    ds_read_b128 a[208:211], v8 offset:3072
    v_exp_f32 v41, v41
    v_mfma_f32_16x16x32_bf16 v[32:35], a[200:203], a[136:139], v[32:35]
    ds_read_b128 a[212:215], v9 offset:3072
    v_exp_f32 v42, v42
    v_cvt_pk_bf16_f32 v162, v40, v41
    v_mfma_f32_16x16x32_bf16 v[32:35], a[204:207], a[140:143], v[32:35]
    ds_read_b128 a[216:219], v10 offset:3072
    v_exp_f32 v43, v43
    v_mfma_f32_16x16x32_bf16 v[36:39], a[192:195], a[144:147], v[52:55]
    ds_read_b128 a[220:223], v11 offset:3072
    v_cvt_pk_bf16_f32 v163, v42, v43
    v_exp_f32 v44, v44
    v_mfma_f32_16x16x32_bf16 v[36:39], a[196:199], a[148:151], v[36:39]
    v_exp_f32 v45, v45
    v_mfma_f32_16x16x32_bf16 v[36:39], a[200:203], a[152:155], v[36:39]
    v_exp_f32 v46, v46
    v_cvt_pk_bf16_f32 v178, v44, v45
    v_mfma_f32_16x16x32_bf16 v[36:39], a[204:207], a[156:159], v[36:39]
    v_exp_f32 v47, v47
    v_mfma_f32_16x16x32_bf16 v[40:43], a[192:195], a[160:163], v[56:59]
    v_cvt_pk_bf16_f32 v179, v46, v47
    v_exp_f32 v32, v32
    v_mfma_f32_16x16x32_bf16 v[40:43], a[196:199], a[164:167], v[40:43]
    v_exp_f32 v33, v33
    v_mfma_f32_16x16x32_bf16 v[40:43], a[200:203], a[168:171], v[40:43]
    v_exp_f32 v34, v34
    v_cvt_pk_bf16_f32 v132, v32, v33
    v_mfma_f32_16x16x32_bf16 v[40:43], a[204:207], a[172:175], v[40:43]
    v_exp_f32 v35, v35
    v_mfma_f32_16x16x32_bf16 v[44:47], a[192:195], a[176:179], v[60:63]
    v_cvt_pk_bf16_f32 v133, v34, v35
    v_exp_f32 v36, v36
    v_mfma_f32_16x16x32_bf16 v[44:47], a[196:199], a[180:183], v[44:47]
    v_exp_f32 v37, v37
    v_mfma_f32_16x16x32_bf16 v[44:47], a[200:203], a[184:187], v[44:47]
    v_exp_f32 v38, v38
    v_cvt_pk_bf16_f32 v148, v36, v37
    v_mfma_f32_16x16x32_bf16 v[44:47], a[204:207], a[188:191], v[44:47]
    s_waitcnt lgkmcnt(0)
    v_exp_f32 v39, v39
    s_nop 0
    v_cvt_pk_bf16_f32 v149, v38, v39
    v_mfma_f32_16x16x32_bf16 v[32:35], a[208:211], a[128:131], v[48:51]
    v_exp_f32 v40, v40
    v_mfma_f32_16x16x32_bf16 v[32:35], a[212:215], a[132:135], v[32:35]
    ds_read_b128 a[192:195], v8 offset:4096
    v_exp_f32 v41, v41
    v_mfma_f32_16x16x32_bf16 v[32:35], a[216:219], a[136:139], v[32:35]
    ds_read_b128 a[196:199], v9 offset:4096
    v_exp_f32 v42, v42
    v_cvt_pk_bf16_f32 v164, v40, v41
    v_mfma_f32_16x16x32_bf16 v[32:35], a[220:223], a[140:143], v[32:35]
    ds_read_b128 a[200:203], v10 offset:4096
    v_exp_f32 v43, v43
    v_mfma_f32_16x16x32_bf16 v[36:39], a[208:211], a[144:147], v[52:55]
    ds_read_b128 a[204:207], v11 offset:4096
    v_cvt_pk_bf16_f32 v165, v42, v43
    v_exp_f32 v44, v44
    v_mfma_f32_16x16x32_bf16 v[36:39], a[212:215], a[148:151], v[36:39]
    v_exp_f32 v45, v45
    v_mfma_f32_16x16x32_bf16 v[36:39], a[216:219], a[152:155], v[36:39]
    v_exp_f32 v46, v46
    v_cvt_pk_bf16_f32 v180, v44, v45
    v_mfma_f32_16x16x32_bf16 v[36:39], a[220:223], a[156:159], v[36:39]
    v_exp_f32 v47, v47
    v_mfma_f32_16x16x32_bf16 v[40:43], a[208:211], a[160:163], v[56:59]
    v_cvt_pk_bf16_f32 v181, v46, v47
    v_exp_f32 v32, v32
    v_mfma_f32_16x16x32_bf16 v[40:43], a[212:215], a[164:167], v[40:43]
    v_exp_f32 v33, v33
    v_mfma_f32_16x16x32_bf16 v[40:43], a[216:219], a[168:171], v[40:43]
    v_exp_f32 v34, v34
    v_cvt_pk_bf16_f32 v134, v32, v33
    v_mfma_f32_16x16x32_bf16 v[40:43], a[220:223], a[172:175], v[40:43]
    v_exp_f32 v35, v35
    v_mfma_f32_16x16x32_bf16 v[44:47], a[208:211], a[176:179], v[60:63]
    v_cvt_pk_bf16_f32 v135, v34, v35
    v_exp_f32 v36, v36
    v_mfma_f32_16x16x32_bf16 v[44:47], a[212:215], a[180:183], v[44:47]
    v_exp_f32 v37, v37
    v_mfma_f32_16x16x32_bf16 v[44:47], a[216:219], a[184:187], v[44:47]
    v_exp_f32 v38, v38
    v_cvt_pk_bf16_f32 v150, v36, v37
    v_mfma_f32_16x16x32_bf16 v[44:47], a[220:223], a[188:191], v[44:47]
    s_waitcnt lgkmcnt(0)
    v_exp_f32 v39, v39
    s_nop 0
    v_cvt_pk_bf16_f32 v151, v38, v39
    v_mfma_f32_16x16x32_bf16 v[32:35], a[192:195], a[128:131], v[48:51]
    v_exp_f32 v40, v40
    v_mfma_f32_16x16x32_bf16 v[32:35], a[196:199], a[132:135], v[32:35]
    ds_read_b128 a[208:211], v8 offset:5120
    v_exp_f32 v41, v41
    v_mfma_f32_16x16x32_bf16 v[32:35], a[200:203], a[136:139], v[32:35]
    ds_read_b128 a[212:215], v9 offset:5120
    v_exp_f32 v42, v42
    v_cvt_pk_bf16_f32 v166, v40, v41
    v_mfma_f32_16x16x32_bf16 v[32:35], a[204:207], a[140:143], v[32:35]
    ds_read_b128 a[216:219], v10 offset:5120
    v_exp_f32 v43, v43
    v_mfma_f32_16x16x32_bf16 v[36:39], a[192:195], a[144:147], v[52:55]
    ds_read_b128 a[220:223], v11 offset:5120
    v_cvt_pk_bf16_f32 v167, v42, v43
    v_exp_f32 v44, v44
    v_mfma_f32_16x16x32_bf16 v[36:39], a[196:199], a[148:151], v[36:39]
    v_exp_f32 v45, v45
    v_mfma_f32_16x16x32_bf16 v[36:39], a[200:203], a[152:155], v[36:39]
    v_exp_f32 v46, v46
    v_cvt_pk_bf16_f32 v182, v44, v45
    v_mfma_f32_16x16x32_bf16 v[36:39], a[204:207], a[156:159], v[36:39]
    v_exp_f32 v47, v47
    v_mfma_f32_16x16x32_bf16 v[40:43], a[192:195], a[160:163], v[56:59]
    v_cvt_pk_bf16_f32 v183, v46, v47
    v_exp_f32 v32, v32
    v_mfma_f32_16x16x32_bf16 v[40:43], a[196:199], a[164:167], v[40:43]
    v_exp_f32 v33, v33
    v_mfma_f32_16x16x32_bf16 v[40:43], a[200:203], a[168:171], v[40:43]
    v_exp_f32 v34, v34
    v_cvt_pk_bf16_f32 v136, v32, v33
    v_mfma_f32_16x16x32_bf16 v[40:43], a[204:207], a[172:175], v[40:43]
    v_exp_f32 v35, v35
    v_mfma_f32_16x16x32_bf16 v[44:47], a[192:195], a[176:179], v[60:63]
    v_cvt_pk_bf16_f32 v137, v34, v35
    v_exp_f32 v36, v36
    v_mfma_f32_16x16x32_bf16 v[44:47], a[196:199], a[180:183], v[44:47]
    v_exp_f32 v37, v37
    v_mfma_f32_16x16x32_bf16 v[44:47], a[200:203], a[184:187], v[44:47]
    v_exp_f32 v38, v38
    v_cvt_pk_bf16_f32 v152, v36, v37
    v_mfma_f32_16x16x32_bf16 v[44:47], a[204:207], a[188:191], v[44:47]
    s_waitcnt lgkmcnt(0)
    v_exp_f32 v39, v39
    s_nop 0
    v_cvt_pk_bf16_f32 v153, v38, v39
    v_mfma_f32_16x16x32_bf16 v[32:35], a[208:211], a[128:131], v[48:51]
    v_exp_f32 v40, v40
    v_mfma_f32_16x16x32_bf16 v[32:35], a[212:215], a[132:135], v[32:35]
    ds_read_b128 a[192:195], v8 offset:6144
    v_exp_f32 v41, v41
    v_mfma_f32_16x16x32_bf16 v[32:35], a[216:219], a[136:139], v[32:35]
    ds_read_b128 a[196:199], v9 offset:6144
    v_exp_f32 v42, v42
    v_cvt_pk_bf16_f32 v168, v40, v41
    v_mfma_f32_16x16x32_bf16 v[32:35], a[220:223], a[140:143], v[32:35]
    ds_read_b128 a[200:203], v10 offset:6144
    v_exp_f32 v43, v43
    v_mfma_f32_16x16x32_bf16 v[36:39], a[208:211], a[144:147], v[52:55]
    ds_read_b128 a[204:207], v11 offset:6144
    v_cvt_pk_bf16_f32 v169, v42, v43
    v_exp_f32 v44, v44
    v_mfma_f32_16x16x32_bf16 v[36:39], a[212:215], a[148:151], v[36:39]
    v_exp_f32 v45, v45
    v_mfma_f32_16x16x32_bf16 v[36:39], a[216:219], a[152:155], v[36:39]
    v_exp_f32 v46, v46
    v_cvt_pk_bf16_f32 v184, v44, v45
    v_mfma_f32_16x16x32_bf16 v[36:39], a[220:223], a[156:159], v[36:39]
    v_exp_f32 v47, v47
    v_mfma_f32_16x16x32_bf16 v[40:43], a[208:211], a[160:163], v[56:59]
    v_cvt_pk_bf16_f32 v185, v46, v47
    v_exp_f32 v32, v32
    v_mfma_f32_16x16x32_bf16 v[40:43], a[212:215], a[164:167], v[40:43]
    v_exp_f32 v33, v33
    v_mfma_f32_16x16x32_bf16 v[40:43], a[216:219], a[168:171], v[40:43]
    v_exp_f32 v34, v34
    v_cvt_pk_bf16_f32 v138, v32, v33
    v_mfma_f32_16x16x32_bf16 v[40:43], a[220:223], a[172:175], v[40:43]
    v_exp_f32 v35, v35
    v_mfma_f32_16x16x32_bf16 v[44:47], a[208:211], a[176:179], v[60:63]
    v_cvt_pk_bf16_f32 v139, v34, v35
    v_exp_f32 v36, v36
    v_mfma_f32_16x16x32_bf16 v[44:47], a[212:215], a[180:183], v[44:47]
    v_exp_f32 v37, v37
    v_mfma_f32_16x16x32_bf16 v[44:47], a[216:219], a[184:187], v[44:47]
    v_exp_f32 v38, v38
    v_cvt_pk_bf16_f32 v154, v36, v37
    v_mfma_f32_16x16x32_bf16 v[44:47], a[220:223], a[188:191], v[44:47]
    s_waitcnt lgkmcnt(0)
    v_exp_f32 v39, v39
    s_nop 0
    v_cvt_pk_bf16_f32 v155, v38, v39
    v_mfma_f32_16x16x32_bf16 v[32:35], a[192:195], a[128:131], v[48:51]
    v_exp_f32 v40, v40
    v_mfma_f32_16x16x32_bf16 v[32:35], a[196:199], a[132:135], v[32:35]
    ds_read_b128 a[208:211], v8 offset:7168
    v_exp_f32 v41, v41
    v_mfma_f32_16x16x32_bf16 v[32:35], a[200:203], a[136:139], v[32:35]
    ds_read_b128 a[212:215], v9 offset:7168
    v_exp_f32 v42, v42
    v_cvt_pk_bf16_f32 v170, v40, v41
    v_mfma_f32_16x16x32_bf16 v[32:35], a[204:207], a[140:143], v[32:35]
    ds_read_b128 a[216:219], v10 offset:7168
    v_exp_f32 v43, v43
    v_mfma_f32_16x16x32_bf16 v[36:39], a[192:195], a[144:147], v[52:55]
    ds_read_b128 a[220:223], v11 offset:7168
    v_cvt_pk_bf16_f32 v171, v42, v43
    v_exp_f32 v44, v44
    v_mfma_f32_16x16x32_bf16 v[36:39], a[196:199], a[148:151], v[36:39]
    v_exp_f32 v45, v45
    v_mfma_f32_16x16x32_bf16 v[36:39], a[200:203], a[152:155], v[36:39]
    v_exp_f32 v46, v46
    v_cvt_pk_bf16_f32 v186, v44, v45
    v_mfma_f32_16x16x32_bf16 v[36:39], a[204:207], a[156:159], v[36:39]
    v_exp_f32 v47, v47
    v_mfma_f32_16x16x32_bf16 v[40:43], a[192:195], a[160:163], v[56:59]
    v_cvt_pk_bf16_f32 v187, v46, v47
    v_exp_f32 v32, v32
    v_mfma_f32_16x16x32_bf16 v[40:43], a[196:199], a[164:167], v[40:43]
    v_exp_f32 v33, v33
    v_mfma_f32_16x16x32_bf16 v[40:43], a[200:203], a[168:171], v[40:43]
    v_exp_f32 v34, v34
    v_cvt_pk_bf16_f32 v140, v32, v33
    v_mfma_f32_16x16x32_bf16 v[40:43], a[204:207], a[172:175], v[40:43]
    v_exp_f32 v35, v35
    v_mfma_f32_16x16x32_bf16 v[44:47], a[192:195], a[176:179], v[60:63]
    v_cvt_pk_bf16_f32 v141, v34, v35
    v_exp_f32 v36, v36
    v_mfma_f32_16x16x32_bf16 v[44:47], a[196:199], a[180:183], v[44:47]
    v_exp_f32 v37, v37
    v_mfma_f32_16x16x32_bf16 v[44:47], a[200:203], a[184:187], v[44:47]
    v_exp_f32 v38, v38
    v_cvt_pk_bf16_f32 v156, v36, v37
    v_mfma_f32_16x16x32_bf16 v[44:47], a[204:207], a[188:191], v[44:47]
    s_waitcnt lgkmcnt(0)
    v_exp_f32 v39, v39
    s_nop 0
    v_cvt_pk_bf16_f32 v157, v38, v39
    v_mfma_f32_16x16x32_bf16 v[32:35], a[208:211], a[128:131], v[48:51]
    s_waitcnt vmcnt(3)
    s_barrier
    v_exp_f32 v40, v40
    v_mfma_f32_16x16x32_bf16 v[32:35], a[212:215], a[132:135], v[32:35]
    ds_read_b128 a[192:195], v8 offset:32768
    v_exp_f32 v41, v41
    v_mfma_f32_16x16x32_bf16 v[32:35], a[216:219], a[136:139], v[32:35]
    ds_read_b128 a[196:199], v9 offset:32768
    v_exp_f32 v42, v42
    v_cvt_pk_bf16_f32 v172, v40, v41
    v_mfma_f32_16x16x32_bf16 v[32:35], a[220:223], a[140:143], v[32:35]
    ds_read_b128 a[200:203], v10 offset:32768
    v_exp_f32 v43, v43
    v_mfma_f32_16x16x32_bf16 v[36:39], a[208:211], a[144:147], v[52:55]
    ds_read_b128 a[204:207], v11 offset:32768
    v_cvt_pk_bf16_f32 v173, v42, v43
    v_exp_f32 v44, v44
    v_mfma_f32_16x16x32_bf16 v[36:39], a[212:215], a[148:151], v[36:39]
    ds_read_b64_tr_b16 a[224:225], v12 offset:0
    v_exp_f32 v45, v45
    v_mfma_f32_16x16x32_bf16 v[36:39], a[216:219], a[152:155], v[36:39]
    ds_read_b64_tr_b16 a[226:227], v12 offset:1024
    v_exp_f32 v46, v46
    v_cvt_pk_bf16_f32 v188, v44, v45
    v_mfma_f32_16x16x32_bf16 v[36:39], a[220:223], a[156:159], v[36:39]
    ds_read_b64_tr_b16 a[228:229], v12 offset:2048
    v_exp_f32 v47, v47
    v_mfma_f32_16x16x32_bf16 v[40:43], a[208:211], a[160:163], v[56:59]
    ds_read_b64_tr_b16 a[230:231], v12 offset:3072
    v_cvt_pk_bf16_f32 v189, v46, v47
    v_exp_f32 v32, v32
    v_mfma_f32_16x16x32_bf16 v[40:43], a[212:215], a[164:167], v[40:43]
    ds_read_b64_tr_b16 a[232:233], v12 offset:4096
    v_exp_f32 v33, v33
    v_mfma_f32_16x16x32_bf16 v[40:43], a[216:219], a[168:171], v[40:43]
    ds_read_b64_tr_b16 a[234:235], v12 offset:5120
    v_exp_f32 v34, v34
    v_cvt_pk_bf16_f32 v142, v32, v33
    v_mfma_f32_16x16x32_bf16 v[40:43], a[220:223], a[172:175], v[40:43]
    ds_read_b64_tr_b16 a[236:237], v12 offset:6144
    v_exp_f32 v35, v35
    v_mfma_f32_16x16x32_bf16 v[44:47], a[208:211], a[176:179], v[60:63]
    ds_read_b64_tr_b16 a[238:239], v12 offset:7168
    v_cvt_pk_bf16_f32 v143, v34, v35
    v_exp_f32 v36, v36
    v_mfma_f32_16x16x32_bf16 v[44:47], a[212:215], a[180:183], v[44:47]
    v_exp_f32 v37, v37
    v_mfma_f32_16x16x32_bf16 v[44:47], a[216:219], a[184:187], v[44:47]
    v_exp_f32 v38, v38
    v_cvt_pk_bf16_f32 v158, v36, v37
    v_mfma_f32_16x16x32_bf16 v[44:47], a[220:223], a[188:191], v[44:47]
    s_waitcnt lgkmcnt(0)
    v_exp_f32 v39, v39
    s_nop 0
    v_cvt_pk_bf16_f32 v159, v38, v39
    s_add_u32 m0, s91, 98304
    v_exp_f32 v40, v40
    buffer_load_dwordx4 v21, s[8:11], s93 offen offset:0 nt lds
    v_mfma_f32_16x16x32_bf16 a[112:115], v[108:111], v[128:131], 0
    v_exp_f32 v41, v41
    buffer_load_dwordx4 v21, s[8:11], s93 offen offset:1024 nt lds
    v_mfma_f32_16x16x32_bf16 a[112:115], v[108:111], v[132:135], a[112:115]
    v_exp_f32 v42, v42
    buffer_load_dwordx4 v21, s[8:11], s93 offen offset:2048 nt lds
    v_mfma_f32_16x16x32_bf16 a[116:119], v[108:111], v[144:147], 0
    v_exp_f32 v43, v43
    buffer_load_dwordx4 v21, s[8:11], s93 offen offset:3072 nt lds
    s_add_u32 s93, s93, 4096
    v_mfma_f32_16x16x32_bf16 a[116:119], v[108:111], v[148:151], a[116:119]
    s_add_u32 m0, s91, 102400
    v_mfma_f32_16x16x32_bf16 a[120:123], v[108:111], v[160:163], 0
    buffer_load_dwordx4 v21, s[8:11], s93 offen offset:0 nt lds
    v_mfma_f32_16x16x32_bf16 a[120:123], v[108:111], v[164:167], a[120:123]
    v_mfma_f32_16x16x32_bf16 a[124:127], v[108:111], v[176:179], 0
    buffer_load_dwordx4 v21, s[8:11], s93 offen offset:1024 nt lds
    v_mfma_f32_16x16x32_bf16 a[124:127], v[108:111], v[180:183], a[124:127]
    s_nop 0
    v_cvt_pk_bf16_f32 v174, v40, v41
    v_cvt_pk_bf16_f32 v175, v42, v43
    v_mfma_f32_16x16x32_bf16 v[36:39], a[192:195], a[144:147], v[52:55]
    v_exp_f32 v44, v44
    v_mfma_f32_16x16x32_bf16 v[36:39], a[196:199], a[148:151], v[36:39]
    ds_read_b128 a[208:211], v8 offset:33792
    ds_read_b128 a[212:215], v9 offset:33792
    v_mfma_f32_16x16x32_bf16 v[32:35], a[196:199], a[132:135], v[48:51]
    v_exp_f32 v45, v45
    v_mfma_f32_16x16x32_bf16 v[32:35], a[192:195], a[128:131], v[32:35]
    ds_read_b128 a[216:219], v10 offset:33792
    v_cvt_pk_bf16_f32 v190, v44, v45
    v_mfma_f32_16x16x32_bf16 v[32:35], a[200:203], a[136:139], v[32:35]
    v_exp_f32 v46, v46
    v_mfma_f32_16x16x32_bf16 v[32:35], a[204:207], a[140:143], v[32:35]
    buffer_load_dwordx4 v21, s[8:11], s93 offen offset:2048 nt lds
    v_mfma_f32_16x16x32_bf16 v[36:39], a[204:207], a[156:159], v[36:39]
    v_exp_f32 v47, v47
    v_mfma_f32_16x16x32_bf16 v[36:39], a[200:203], a[152:155], v[36:39]
    ds_read_b128 a[220:223], v11 offset:33792
    v_cvt_pk_bf16_f32 v191, v46, v47
    v_mfma_f32_16x16x32_bf16 v[44:47], a[200:203], a[184:187], v[60:63]
    v_exp_f32 v32, v32
    v_mfma_f32_16x16x32_bf16 v[44:47], a[204:207], a[188:191], v[44:47]
    ds_read_b64_tr_b16 a[240:241], v13 offset:0
    ds_read_b64_tr_b16 a[242:243], v13 offset:1024
    v_mfma_f32_16x16x32_bf16 v[40:43], a[204:207], a[172:175], v[56:59]
    v_exp_f32 v33, v33
    v_mfma_f32_16x16x32_bf16 v[40:43], a[200:203], a[168:171], v[40:43]
    ds_read_b64_tr_b16 a[244:245], v13 offset:2048
    v_cvt_pk_bf16_f32 v192, v32, v33
    v_mfma_f32_16x16x32_bf16 v[40:43], a[192:195], a[160:163], v[40:43]
    v_exp_f32 v34, v34
    v_mfma_f32_16x16x32_bf16 v[40:43], a[196:199], a[164:167], v[40:43]
    buffer_load_dwordx4 v21, s[8:11], s93 offen offset:3072 nt lds
    v_mfma_f32_16x16x32_bf16 v[44:47], a[196:199], a[180:183], v[44:47]
    s_add_u32 s93, s93, 28672
    v_exp_f32 v35, v35
    v_mfma_f32_16x16x32_bf16 v[44:47], a[192:195], a[176:179], v[44:47]
    ds_read_b64_tr_b16 a[246:247], v13 offset:3072
    v_cvt_pk_bf16_f32 v193, v34, v35
    v_mfma_f32_16x16x32_bf16 a[0:3], a[224:227], v[128:131], a[112:115]
    v_exp_f32 v36, v36
    v_mfma_f32_16x16x32_bf16 a[0:3], a[228:231], v[132:135], a[0:3]
    ds_read_b64_tr_b16 a[248:249], v13 offset:4096
    ds_read_b64_tr_b16 a[250:251], v13 offset:5120
    v_mfma_f32_16x16x32_bf16 a[0:3], a[232:235], v[136:139], a[0:3]
    v_exp_f32 v37, v37
    v_mfma_f32_16x16x32_bf16 a[0:3], a[236:239], v[140:143], a[0:3]
    ds_read_b64_tr_b16 a[252:253], v13 offset:6144
    v_cvt_pk_bf16_f32 v208, v36, v37
    v_mfma_f32_16x16x32_bf16 a[4:7], a[236:239], v[156:159], a[116:119]
    s_add_u32 m0, s91, 0
    v_exp_f32 v38, v38
    v_mfma_f32_16x16x32_bf16 a[4:7], a[232:235], v[152:155], a[4:7]
    buffer_load_dwordx4 v20, s[4:7], s92 offen offset:0 nt lds
    v_mfma_f32_16x16x32_bf16 a[4:7], a[228:231], v[148:151], a[4:7]
    v_exp_f32 v39, v39
    v_mfma_f32_16x16x32_bf16 a[4:7], a[224:227], v[144:147], a[4:7]
    ds_read_b64_tr_b16 a[254:255], v13 offset:7168
    v_cvt_pk_bf16_f32 v209, v38, v39
    v_mfma_f32_16x16x32_bf16 a[8:11], a[224:227], v[160:163], a[120:123]
    v_exp_f32 v40, v40
    v_mfma_f32_16x16x32_bf16 a[8:11], a[228:231], v[164:167], a[8:11]
    buffer_load_dwordx4 v20, s[4:7], s92 offen offset:1024 nt lds
    v_mfma_f32_16x16x32_bf16 a[8:11], a[232:235], v[168:171], a[8:11]
    v_exp_f32 v41, v41
    v_mfma_f32_16x16x32_bf16 a[8:11], a[236:239], v[172:175], a[8:11]
    v_cvt_pk_bf16_f32 v224, v40, v41
    v_mfma_f32_16x16x32_bf16 a[12:15], a[236:239], v[188:191], a[124:127]
    v_exp_f32 v42, v42
    v_mfma_f32_16x16x32_bf16 a[12:15], a[232:235], v[184:187], a[12:15]
    buffer_load_dwordx4 v20, s[4:7], s92 offen offset:2048 nt lds
    v_mfma_f32_16x16x32_bf16 a[12:15], a[228:231], v[180:183], a[12:15]
    v_exp_f32 v43, v43
    v_mfma_f32_16x16x32_bf16 a[12:15], a[224:227], v[176:179], a[12:15]
    v_cvt_pk_bf16_f32 v225, v42, v43
    v_smfmac_f32_16x16x64_bf16 v[64:67], v[4:7], v[128:135], v22
    s_waitcnt lgkmcnt(0)
    buffer_load_dwordx4 v20, s[4:7], s92 offen offset:3072 nt lds
    s_add_u32 s92, s92, 4096
    v_mfma_f32_16x16x32_bf16 v[36:39], a[208:211], a[144:147], v[52:55]
    v_exp_f32 v44, v44
    v_mfma_f32_16x16x32_bf16 v[36:39], a[212:215], a[148:151], v[36:39]
    ds_read_b128 a[192:195], v8 offset:34816
    ds_read_b128 a[196:199], v9 offset:34816
    v_mfma_f32_16x16x32_bf16 v[32:35], a[212:215], a[132:135], v[48:51]
    v_exp_f32 v45, v45
    v_mfma_f32_16x16x32_bf16 v[32:35], a[208:211], a[128:131], v[32:35]
    ds_read_b128 a[200:203], v10 offset:34816
    v_cvt_pk_bf16_f32 v240, v44, v45
    v_mfma_f32_16x16x32_bf16 v[32:35], a[216:219], a[136:139], v[32:35]
    s_add_u32 m0, s91, 4096
    v_exp_f32 v46, v46
    v_mfma_f32_16x16x32_bf16 v[32:35], a[220:223], a[140:143], v[32:35]
    buffer_load_dwordx4 v20, s[4:7], s92 offen offset:0 nt lds
    v_mfma_f32_16x16x32_bf16 v[36:39], a[220:223], a[156:159], v[36:39]
    v_exp_f32 v47, v47
    v_mfma_f32_16x16x32_bf16 v[36:39], a[216:219], a[152:155], v[36:39]
    ds_read_b128 a[204:207], v11 offset:34816
    v_cvt_pk_bf16_f32 v241, v46, v47
    v_mfma_f32_16x16x32_bf16 v[44:47], a[216:219], a[184:187], v[60:63]
    v_exp_f32 v32, v32
    v_mfma_f32_16x16x32_bf16 v[44:47], a[220:223], a[188:191], v[44:47]
    ds_read_b64_tr_b16 a[224:225], v14 offset:0
    ds_read_b64_tr_b16 a[226:227], v14 offset:1024
    v_mfma_f32_16x16x32_bf16 v[40:43], a[220:223], a[172:175], v[56:59]
    v_exp_f32 v33, v33
    v_mfma_f32_16x16x32_bf16 v[40:43], a[216:219], a[168:171], v[40:43]
    ds_read_b64_tr_b16 a[228:229], v14 offset:2048
    v_cvt_pk_bf16_f32 v194, v32, v33
    v_mfma_f32_16x16x32_bf16 v[40:43], a[208:211], a[160:163], v[40:43]
    v_exp_f32 v34, v34
    v_mfma_f32_16x16x32_bf16 v[40:43], a[212:215], a[164:167], v[40:43]
    buffer_load_dwordx4 v20, s[4:7], s92 offen offset:1024 nt lds
    v_mfma_f32_16x16x32_bf16 v[44:47], a[212:215], a[180:183], v[44:47]
    v_exp_f32 v35, v35
    v_mfma_f32_16x16x32_bf16 v[44:47], a[208:211], a[176:179], v[44:47]
    ds_read_b64_tr_b16 a[230:231], v14 offset:3072
    v_cvt_pk_bf16_f32 v195, v34, v35
    v_mfma_f32_16x16x32_bf16 a[16:19], a[240:243], v[128:131], a[112:115]
    v_exp_f32 v36, v36
    v_mfma_f32_16x16x32_bf16 a[16:19], a[244:247], v[132:135], a[16:19]
    ds_read_b64_tr_b16 a[232:233], v14 offset:4096
    ds_read_b64_tr_b16 a[234:235], v14 offset:5120
    v_mfma_f32_16x16x32_bf16 a[16:19], a[248:251], v[136:139], a[16:19]
    v_exp_f32 v37, v37
    v_mfma_f32_16x16x32_bf16 a[16:19], a[252:255], v[140:143], a[16:19]
    ds_read_b64_tr_b16 a[236:237], v14 offset:6144
    v_cvt_pk_bf16_f32 v210, v36, v37
    v_mfma_f32_16x16x32_bf16 a[20:23], a[252:255], v[156:159], a[116:119]
    v_exp_f32 v38, v38
    v_mfma_f32_16x16x32_bf16 a[20:23], a[248:251], v[152:155], a[20:23]
    buffer_load_dwordx4 v20, s[4:7], s92 offen offset:2048 nt lds
    v_mfma_f32_16x16x32_bf16 a[20:23], a[244:247], v[148:151], a[20:23]
    v_exp_f32 v39, v39
    v_mfma_f32_16x16x32_bf16 a[20:23], a[240:243], v[144:147], a[20:23]
    ds_read_b64_tr_b16 a[238:239], v14 offset:7168
    v_cvt_pk_bf16_f32 v211, v38, v39
    v_mfma_f32_16x16x32_bf16 a[24:27], a[240:243], v[160:163], a[120:123]
    v_exp_f32 v40, v40
    v_mfma_f32_16x16x32_bf16 a[24:27], a[244:247], v[164:167], a[24:27]
    buffer_load_dwordx4 v20, s[4:7], s92 offen offset:3072 nt lds
    v_mfma_f32_16x16x32_bf16 a[24:27], a[248:251], v[168:171], a[24:27]
    s_add_u32 s92, s92, 28672
    s_and_b32 s94, s89, 1
    v_exp_f32 v41, v41
    v_mfma_f32_16x16x32_bf16 a[24:27], a[252:255], v[172:175], a[24:27]
    s_lshl1_add_u32 s94, s38, s94
    v_cvt_pk_bf16_f32 v226, v40, v41
    v_lshrrev_b32 v97, 3, v2
    v_mfma_f32_16x16x32_bf16 a[28:31], a[252:255], v[188:191], a[124:127]
    s_lshl_b32 s94, s94, 6
    v_exp_f32 v42, v42
    v_mfma_f32_16x16x32_bf16 a[28:31], a[248:251], v[184:187], a[28:31]
    s_mov_b32 s24, s54
    v_and_b32 v96, 7, v2
    v_lshlrev_b32 v96, 4, v96
    v_mfma_f32_16x16x32_bf16 a[28:31], a[244:247], v[180:183], a[28:31]
    s_mov_b32 s25, s55
    v_exp_f32 v43, v43
    v_mfma_f32_16x16x32_bf16 a[28:31], a[240:243], v[176:179], a[28:31]
    s_mov_b32 s26, 1024
    v_cvt_pk_bf16_f32 v227, v42, v43
    v_lshl_add_u32 v96, v97, 10, v96
    v_smfmac_f32_16x16x64_bf16 v[68:71], v[4:7], v[144:151], v22
    s_waitcnt lgkmcnt(0)
    v_lshlrev_b32 v98, 4, v1
    v_mfma_f32_16x16x32_bf16 v[36:39], a[192:195], a[144:147], v[52:55]
    v_exp_f32 v44, v44
    v_mfma_f32_16x16x32_bf16 v[36:39], a[196:199], a[148:151], v[36:39]
    ds_read_b128 a[208:211], v8 offset:35840
    ds_read_b128 a[212:215], v9 offset:35840
    v_mfma_f32_16x16x32_bf16 v[32:35], a[196:199], a[132:135], v[48:51]
    v_exp_f32 v45, v45
    v_mfma_f32_16x16x32_bf16 v[32:35], a[192:195], a[128:131], v[32:35]
    ds_read_b128 a[216:219], v10 offset:35840
    v_cvt_pk_bf16_f32 v242, v44, v45
    v_mfma_f32_16x16x32_bf16 v[32:35], a[200:203], a[136:139], v[32:35]
    v_exp_f32 v46, v46
    v_mfma_f32_16x16x32_bf16 v[32:35], a[204:207], a[140:143], v[32:35]
    buffer_atomic_add v25, v28, s[40:43], 0 offen
    v_mfma_f32_16x16x32_bf16 v[36:39], a[204:207], a[156:159], v[36:39]
    v_exp_f32 v47, v47
    v_mfma_f32_16x16x32_bf16 v[36:39], a[200:203], a[152:155], v[36:39]
    ds_read_b128 a[220:223], v11 offset:35840
    v_cvt_pk_bf16_f32 v243, v46, v47
    v_mfma_f32_16x16x32_bf16 v[44:47], a[200:203], a[184:187], v[60:63]
    v_exp_f32 v32, v32
    v_mfma_f32_16x16x32_bf16 v[44:47], a[204:207], a[188:191], v[44:47]
    ds_read_b64_tr_b16 a[240:241], v15 offset:0
    ds_read_b64_tr_b16 a[242:243], v15 offset:1024
    v_mfma_f32_16x16x32_bf16 v[40:43], a[204:207], a[172:175], v[56:59]
    v_exp_f32 v33, v33
    v_mfma_f32_16x16x32_bf16 v[40:43], a[200:203], a[168:171], v[40:43]
    s_add_u32 m0, s91, 131072
    ds_read_b64_tr_b16 a[244:245], v15 offset:2048
    v_cvt_pk_bf16_f32 v196, v32, v33
    v_mfma_f32_16x16x32_bf16 v[40:43], a[192:195], a[160:163], v[40:43]
    s_add_u32 s95, s46, 0
    v_exp_f32 v34, v34
    v_mfma_f32_16x16x32_bf16 v[40:43], a[196:199], a[164:167], v[40:43]
    buffer_load_dwordx4 v96, s[12:15], s95 offen lds
    v_mfma_f32_16x16x32_bf16 v[44:47], a[196:199], a[180:183], v[44:47]
    v_exp_f32 v35, v35
    v_mfma_f32_16x16x32_bf16 v[44:47], a[192:195], a[176:179], v[44:47]
    ds_read_b64_tr_b16 a[246:247], v15 offset:3072
    v_cvt_pk_bf16_f32 v197, v34, v35
    v_mfma_f32_16x16x32_bf16 a[32:35], a[224:227], v[128:131], a[112:115]
    v_exp_f32 v36, v36
    v_mfma_f32_16x16x32_bf16 a[32:35], a[228:231], v[132:135], a[32:35]
    ds_read_b64_tr_b16 a[248:249], v15 offset:4096
    ds_read_b64_tr_b16 a[250:251], v15 offset:5120
    v_mfma_f32_16x16x32_bf16 a[32:35], a[232:235], v[136:139], a[32:35]
    v_exp_f32 v37, v37
    v_mfma_f32_16x16x32_bf16 a[32:35], a[236:239], v[140:143], a[32:35]
    s_add_u32 m0, s91, 132096
    ds_read_b64_tr_b16 a[252:253], v15 offset:6144
    v_cvt_pk_bf16_f32 v212, v36, v37
    v_mfma_f32_16x16x32_bf16 a[36:39], a[236:239], v[156:159], a[116:119]
    s_add_u32 s95, s46, 8192
    v_exp_f32 v38, v38
    v_mfma_f32_16x16x32_bf16 a[36:39], a[232:235], v[152:155], a[36:39]
    buffer_load_dwordx4 v96, s[12:15], s95 offen lds
    v_mfma_f32_16x16x32_bf16 a[36:39], a[228:231], v[148:151], a[36:39]
    v_exp_f32 v39, v39
    v_mfma_f32_16x16x32_bf16 a[36:39], a[224:227], v[144:147], a[36:39]
    s_add_u32 m0, s91, 133120
    ds_read_b64_tr_b16 a[254:255], v15 offset:7168
    v_cvt_pk_bf16_f32 v213, v38, v39
    v_mfma_f32_16x16x32_bf16 a[40:43], a[224:227], v[160:163], a[120:123]
    s_add_u32 s95, s46, 16384
    v_exp_f32 v40, v40
    v_mfma_f32_16x16x32_bf16 a[40:43], a[228:231], v[164:167], a[40:43]
    buffer_load_dwordx4 v96, s[12:15], s95 offen lds
    v_mfma_f32_16x16x32_bf16 a[40:43], a[232:235], v[168:171], a[40:43]
    v_exp_f32 v41, v41
    v_mfma_f32_16x16x32_bf16 a[40:43], a[236:239], v[172:175], a[40:43]
    s_add_u32 m0, s91, 134144
    v_cvt_pk_bf16_f32 v228, v40, v41
    v_mfma_f32_16x16x32_bf16 a[44:47], a[236:239], v[188:191], a[124:127]
    s_add_u32 s95, s46, 24576
    v_exp_f32 v42, v42
    v_mfma_f32_16x16x32_bf16 a[44:47], a[232:235], v[184:187], a[44:47]
    buffer_load_dwordx4 v96, s[12:15], s95 offen lds
    v_mfma_f32_16x16x32_bf16 a[44:47], a[228:231], v[180:183], a[44:47]
    v_exp_f32 v43, v43
    v_mfma_f32_16x16x32_bf16 a[44:47], a[224:227], v[176:179], a[44:47]
    v_cvt_pk_bf16_f32 v229, v42, v43
    v_smfmac_f32_16x16x64_bf16 v[72:75], v[4:7], v[160:167], v22
    s_waitcnt lgkmcnt(0)
    buffer_load_dwordx4 v[100:103], v98, s[24:27], s94 offen
    v_mfma_f32_16x16x32_bf16 v[36:39], a[208:211], a[144:147], v[52:55]
    v_exp_f32 v44, v44
    v_mfma_f32_16x16x32_bf16 v[36:39], a[212:215], a[148:151], v[36:39]
    ds_read_b128 a[192:195], v8 offset:36864
    ds_read_b128 a[196:199], v9 offset:36864
    v_mfma_f32_16x16x32_bf16 v[32:35], a[212:215], a[132:135], v[48:51]
    v_exp_f32 v45, v45
    v_mfma_f32_16x16x32_bf16 v[32:35], a[208:211], a[128:131], v[32:35]
    ds_read_b128 a[200:203], v10 offset:36864
    v_cvt_pk_bf16_f32 v244, v44, v45
    v_mfma_f32_16x16x32_bf16 v[32:35], a[216:219], a[136:139], v[32:35]
    v_exp_f32 v46, v46
    v_mfma_f32_16x16x32_bf16 v[32:35], a[220:223], a[140:143], v[32:35]
    v_and_b32 v112, 3, v2
    v_lshrrev_b32 v97, 2, v2
    v_mfma_f32_16x16x32_bf16 v[36:39], a[220:223], a[156:159], v[36:39]
    v_exp_f32 v47, v47
    v_mfma_f32_16x16x32_bf16 v[36:39], a[216:219], a[152:155], v[36:39]
    ds_read_b128 a[204:207], v11 offset:36864
    v_cvt_pk_bf16_f32 v245, v46, v47
    v_mfma_f32_16x16x32_bf16 v[44:47], a[216:219], a[184:187], v[60:63]
    v_exp_f32 v32, v32
    v_mfma_f32_16x16x32_bf16 v[44:47], a[220:223], a[188:191], v[44:47]
    ds_read_b64_tr_b16 a[224:225], v16 offset:0
    ds_read_b64_tr_b16 a[226:227], v16 offset:1024
    v_mfma_f32_16x16x32_bf16 v[40:43], a[220:223], a[172:175], v[56:59]
    v_exp_f32 v33, v33
    v_mfma_f32_16x16x32_bf16 v[40:43], a[216:219], a[168:171], v[40:43]
    ds_read_b64_tr_b16 a[228:229], v16 offset:2048
    v_cvt_pk_bf16_f32 v198, v32, v33
    v_mfma_f32_16x16x32_bf16 v[40:43], a[208:211], a[160:163], v[40:43]
    v_exp_f32 v34, v34
    v_mfma_f32_16x16x32_bf16 v[40:43], a[212:215], a[164:167], v[40:43]
    v_lshlrev_b32 v112, 4, v112
    v_lshl_add_u32 v97, v97, 7, v112
    v_mfma_f32_16x16x32_bf16 v[44:47], a[212:215], a[180:183], v[44:47]
    v_exp_f32 v35, v35
    v_mfma_f32_16x16x32_bf16 v[44:47], a[208:211], a[176:179], v[44:47]
    ds_read_b64_tr_b16 a[230:231], v16 offset:3072
    v_cvt_pk_bf16_f32 v199, v34, v35
    v_mfma_f32_16x16x32_bf16 a[48:51], a[240:243], v[128:131], a[112:115]
    v_exp_f32 v36, v36
    v_mfma_f32_16x16x32_bf16 a[48:51], a[244:247], v[132:135], a[48:51]
    ds_read_b64_tr_b16 a[232:233], v16 offset:4096
    ds_read_b64_tr_b16 a[234:235], v16 offset:5120
    v_mfma_f32_16x16x32_bf16 a[48:51], a[248:251], v[136:139], a[48:51]
    v_exp_f32 v37, v37
    v_mfma_f32_16x16x32_bf16 a[48:51], a[252:255], v[140:143], a[48:51]
    ds_read_b64_tr_b16 a[236:237], v16 offset:6144
    v_cvt_pk_bf16_f32 v214, v36, v37
    v_mfma_f32_16x16x32_bf16 a[52:55], a[252:255], v[156:159], a[116:119]
    v_exp_f32 v38, v38
    v_mfma_f32_16x16x32_bf16 a[52:55], a[248:251], v[152:155], a[52:55]
    v_add_u32 v97, s91, v97
    v_add_u32 v97, 131072, v97
    v_mfma_f32_16x16x32_bf16 a[52:55], a[244:247], v[148:151], a[52:55]
    v_exp_f32 v39, v39
    v_mfma_f32_16x16x32_bf16 a[52:55], a[240:243], v[144:147], a[52:55]
    ds_read_b64_tr_b16 a[238:239], v16 offset:7168
    v_cvt_pk_bf16_f32 v215, v38, v39
    v_mfma_f32_16x16x32_bf16 a[56:59], a[240:243], v[160:163], a[120:123]
    v_exp_f32 v40, v40
    v_mfma_f32_16x16x32_bf16 a[56:59], a[244:247], v[164:167], a[56:59]
    v_mfma_f32_16x16x32_bf16 a[56:59], a[248:251], v[168:171], a[56:59]
    v_exp_f32 v41, v41
    v_mfma_f32_16x16x32_bf16 a[56:59], a[252:255], v[172:175], a[56:59]
    v_cvt_pk_bf16_f32 v230, v40, v41
    v_mfma_f32_16x16x32_bf16 a[60:63], a[252:255], v[188:191], a[124:127]
    v_exp_f32 v42, v42
    v_mfma_f32_16x16x32_bf16 a[60:63], a[248:251], v[184:187], a[60:63]
    v_mfma_f32_16x16x32_bf16 a[60:63], a[244:247], v[180:183], a[60:63]
    v_exp_f32 v43, v43
    v_mfma_f32_16x16x32_bf16 a[60:63], a[240:243], v[176:179], a[60:63]
    v_cvt_pk_bf16_f32 v231, v42, v43
    v_smfmac_f32_16x16x64_bf16 v[76:79], v[4:7], v[176:183], v22
    s_waitcnt lgkmcnt(0)
    v_mfma_f32_16x16x32_bf16 v[36:39], a[192:195], a[144:147], v[52:55]
    v_exp_f32 v44, v44
    v_mfma_f32_16x16x32_bf16 v[36:39], a[196:199], a[148:151], v[36:39]
    ds_read_b128 a[208:211], v8 offset:37888
    ds_read_b128 a[212:215], v9 offset:37888
    v_mfma_f32_16x16x32_bf16 v[32:35], a[196:199], a[132:135], v[48:51]
    v_exp_f32 v45, v45
    v_mfma_f32_16x16x32_bf16 v[32:35], a[192:195], a[128:131], v[32:35]
    ds_read_b128 a[216:219], v10 offset:37888
    v_cvt_pk_bf16_f32 v246, v44, v45
    v_mfma_f32_16x16x32_bf16 v[32:35], a[200:203], a[136:139], v[32:35]
    v_exp_f32 v46, v46
    v_mfma_f32_16x16x32_bf16 v[32:35], a[204:207], a[140:143], v[32:35]
    buffer_load_dword v0, v30, s[28:31], s44 offen sc1
    v_mfma_f32_16x16x32_bf16 v[36:39], a[204:207], a[156:159], v[36:39]
    s_add_u32 s44, s44, s45
    v_exp_f32 v47, v47
    v_mfma_f32_16x16x32_bf16 v[36:39], a[200:203], a[152:155], v[36:39]
    ds_read_b128 a[220:223], v11 offset:37888
    v_cvt_pk_bf16_f32 v247, v46, v47
    v_mfma_f32_16x16x32_bf16 v[44:47], a[200:203], a[184:187], v[60:63]
    v_exp_f32 v32, v32
    v_mfma_f32_16x16x32_bf16 v[44:47], a[204:207], a[188:191], v[44:47]
    ds_read_b64_tr_b16 a[240:241], v17 offset:0
    ds_read_b64_tr_b16 a[242:243], v17 offset:1024
    v_mfma_f32_16x16x32_bf16 v[40:43], a[204:207], a[172:175], v[56:59]
    v_exp_f32 v33, v33
    v_mfma_f32_16x16x32_bf16 v[40:43], a[200:203], a[168:171], v[40:43]
    ds_read_b64_tr_b16 a[244:245], v17 offset:2048
    v_cvt_pk_bf16_f32 v200, v32, v33
    v_mfma_f32_16x16x32_bf16 v[40:43], a[192:195], a[160:163], v[40:43]
    v_exp_f32 v34, v34
    v_mfma_f32_16x16x32_bf16 v[40:43], a[196:199], a[164:167], v[40:43]
    v_accvgpr_read_b32 v66, a112
    v_mfma_f32_16x16x32_bf16 v[44:47], a[196:199], a[180:183], v[44:47]
    v_exp_f32 v35, v35
    v_mfma_f32_16x16x32_bf16 v[44:47], a[192:195], a[176:179], v[44:47]
    ds_read_b64_tr_b16 a[246:247], v17 offset:3072
    v_cvt_pk_bf16_f32 v201, v34, v35
    v_mfma_f32_16x16x32_bf16 a[64:67], a[224:227], v[128:131], a[112:115]
    v_exp_f32 v36, v36
    v_mfma_f32_16x16x32_bf16 a[64:67], a[228:231], v[132:135], a[64:67]
    ds_read_b64_tr_b16 a[248:249], v17 offset:4096
    ds_read_b64_tr_b16 a[250:251], v17 offset:5120
    v_mfma_f32_16x16x32_bf16 a[64:67], a[232:235], v[136:139], a[64:67]
    v_exp_f32 v37, v37
    v_mfma_f32_16x16x32_bf16 a[64:67], a[236:239], v[140:143], a[64:67]
    ds_read_b64_tr_b16 a[252:253], v17 offset:6144
    v_cvt_pk_bf16_f32 v216, v36, v37
    v_mfma_f32_16x16x32_bf16 a[68:71], a[236:239], v[156:159], a[116:119]
    v_exp_f32 v38, v38
    v_mfma_f32_16x16x32_bf16 a[68:71], a[232:235], v[152:155], a[68:71]
    v_accvgpr_read_b32 v70, a116
    v_mfma_f32_16x16x32_bf16 a[68:71], a[228:231], v[148:151], a[68:71]
    v_exp_f32 v39, v39
    v_mfma_f32_16x16x32_bf16 a[68:71], a[224:227], v[144:147], a[68:71]
    ds_read_b64_tr_b16 a[254:255], v17 offset:7168
    v_cvt_pk_bf16_f32 v217, v38, v39
    v_mfma_f32_16x16x32_bf16 a[72:75], a[224:227], v[160:163], a[120:123]
    v_exp_f32 v40, v40
    v_mfma_f32_16x16x32_bf16 a[72:75], a[228:231], v[164:167], a[72:75]
    v_accvgpr_read_b32 v74, a120
    v_mfma_f32_16x16x32_bf16 a[72:75], a[232:235], v[168:171], a[72:75]
    v_exp_f32 v41, v41
    v_mfma_f32_16x16x32_bf16 a[72:75], a[236:239], v[172:175], a[72:75]
    v_cvt_pk_bf16_f32 v232, v40, v41
    v_accvgpr_read_b32 v78, a124
    v_mfma_f32_16x16x32_bf16 a[76:79], a[236:239], v[188:191], a[124:127]
    v_exp_f32 v42, v42
    v_mfma_f32_16x16x32_bf16 a[76:79], a[232:235], v[184:187], a[76:79]
    v_mfma_f32_16x16x32_bf16 a[76:79], a[228:231], v[180:183], a[76:79]
    v_exp_f32 v43, v43
    v_mfma_f32_16x16x32_bf16 a[76:79], a[224:227], v[176:179], a[76:79]
    v_cvt_pk_bf16_f32 v233, v42, v43
    v_smfmac_f32_16x16x64_bf16 v[64:67], v[4:7], v[136:143], v22
    s_waitcnt lgkmcnt(0)
    v_mfma_f32_16x16x32_bf16 v[36:39], a[208:211], a[144:147], v[52:55]
    v_exp_f32 v44, v44
    v_mfma_f32_16x16x32_bf16 v[36:39], a[212:215], a[148:151], v[36:39]
    ds_read_b128 a[192:195], v8 offset:38912
    ds_read_b128 a[196:199], v9 offset:38912
    v_mfma_f32_16x16x32_bf16 v[32:35], a[212:215], a[132:135], v[48:51]
    v_exp_f32 v45, v45
    v_mfma_f32_16x16x32_bf16 v[32:35], a[208:211], a[128:131], v[32:35]
    ds_read_b128 a[200:203], v10 offset:38912
    v_cvt_pk_bf16_f32 v248, v44, v45
    v_mfma_f32_16x16x32_bf16 v[32:35], a[216:219], a[136:139], v[32:35]
    v_exp_f32 v46, v46
    v_mfma_f32_16x16x32_bf16 v[32:35], a[220:223], a[140:143], v[32:35]
    v_mfma_f32_16x16x32_bf16 v[36:39], a[220:223], a[156:159], v[36:39]
    v_exp_f32 v47, v47
    v_mfma_f32_16x16x32_bf16 v[36:39], a[216:219], a[152:155], v[36:39]
    ds_read_b128 a[204:207], v11 offset:38912
    v_cvt_pk_bf16_f32 v249, v46, v47
    v_mfma_f32_16x16x32_bf16 v[44:47], a[216:219], a[184:187], v[60:63]
    v_exp_f32 v32, v32
    v_mfma_f32_16x16x32_bf16 v[44:47], a[220:223], a[188:191], v[44:47]
    ds_read_b64_tr_b16 a[224:225], v18 offset:0
    ds_read_b64_tr_b16 a[226:227], v18 offset:1024
    v_mfma_f32_16x16x32_bf16 v[40:43], a[220:223], a[172:175], v[56:59]
    v_exp_f32 v33, v33
    v_mfma_f32_16x16x32_bf16 v[40:43], a[216:219], a[168:171], v[40:43]
    ds_read_b64_tr_b16 a[228:229], v18 offset:2048
    v_cvt_pk_bf16_f32 v202, v32, v33
    v_mfma_f32_16x16x32_bf16 v[40:43], a[208:211], a[160:163], v[40:43]
    v_exp_f32 v34, v34
    v_mfma_f32_16x16x32_bf16 v[40:43], a[212:215], a[164:167], v[40:43]
    v_mfma_f32_16x16x32_bf16 v[44:47], a[212:215], a[180:183], v[44:47]
    v_exp_f32 v35, v35
    v_mfma_f32_16x16x32_bf16 v[44:47], a[208:211], a[176:179], v[44:47]
    ds_read_b64_tr_b16 a[230:231], v18 offset:3072
    v_cvt_pk_bf16_f32 v203, v34, v35
    v_mfma_f32_16x16x32_bf16 a[80:83], a[240:243], v[128:131], a[112:115]
    v_exp_f32 v36, v36
    v_mfma_f32_16x16x32_bf16 a[80:83], a[244:247], v[132:135], a[80:83]
    ds_read_b64_tr_b16 a[232:233], v18 offset:4096
    ds_read_b64_tr_b16 a[234:235], v18 offset:5120
    v_mfma_f32_16x16x32_bf16 a[80:83], a[248:251], v[136:139], a[80:83]
    v_exp_f32 v37, v37
    v_mfma_f32_16x16x32_bf16 a[80:83], a[252:255], v[140:143], a[80:83]
    ds_read_b64_tr_b16 a[236:237], v18 offset:6144
    v_cvt_pk_bf16_f32 v218, v36, v37
    v_mfma_f32_16x16x32_bf16 a[84:87], a[252:255], v[156:159], a[116:119]
    v_exp_f32 v38, v38
    v_mfma_f32_16x16x32_bf16 a[84:87], a[248:251], v[152:155], a[84:87]
    v_mfma_f32_16x16x32_bf16 a[84:87], a[244:247], v[148:151], a[84:87]
    v_exp_f32 v39, v39
    v_mfma_f32_16x16x32_bf16 a[84:87], a[240:243], v[144:147], a[84:87]
    ds_read_b64_tr_b16 a[238:239], v18 offset:7168
    v_cvt_pk_bf16_f32 v219, v38, v39
    v_mfma_f32_16x16x32_bf16 a[88:91], a[240:243], v[160:163], a[120:123]
    v_exp_f32 v40, v40
    v_mfma_f32_16x16x32_bf16 a[88:91], a[244:247], v[164:167], a[88:91]
    v_mfma_f32_16x16x32_bf16 a[88:91], a[248:251], v[168:171], a[88:91]
    v_exp_f32 v41, v41
    v_mfma_f32_16x16x32_bf16 a[88:91], a[252:255], v[172:175], a[88:91]
    v_cvt_pk_bf16_f32 v234, v40, v41
    v_mfma_f32_16x16x32_bf16 a[92:95], a[252:255], v[188:191], a[124:127]
    v_exp_f32 v42, v42
    v_mfma_f32_16x16x32_bf16 a[92:95], a[248:251], v[184:187], a[92:95]
    v_mfma_f32_16x16x32_bf16 a[92:95], a[244:247], v[180:183], a[92:95]
    v_exp_f32 v43, v43
    v_mfma_f32_16x16x32_bf16 a[92:95], a[240:243], v[176:179], a[92:95]
    v_cvt_pk_bf16_f32 v235, v42, v43
    v_smfmac_f32_16x16x64_bf16 v[68:71], v[4:7], v[152:159], v22
    s_waitcnt lgkmcnt(0)
    v_mfma_f32_16x16x32_bf16 v[36:39], a[192:195], a[144:147], v[52:55]
    v_exp_f32 v44, v44
    v_mfma_f32_16x16x32_bf16 v[36:39], a[196:199], a[148:151], v[36:39]
    ds_read_b128 a[208:211], v8 offset:39936
    ds_read_b128 a[212:215], v9 offset:39936
    v_mfma_f32_16x16x32_bf16 v[32:35], a[196:199], a[132:135], v[48:51]
    s_mov_b32 s40, s58
    v_exp_f32 v45, v45
    v_mfma_f32_16x16x32_bf16 v[32:35], a[192:195], a[128:131], v[32:35]
    ds_read_b128 a[216:219], v10 offset:39936
    v_cvt_pk_bf16_f32 v250, v44, v45
    v_mfma_f32_16x16x32_bf16 v[32:35], a[200:203], a[136:139], v[32:35]
    s_mov_b32 s41, s59
    v_exp_f32 v46, v46
    v_mfma_f32_16x16x32_bf16 v[32:35], a[204:207], a[140:143], v[32:35]
    v_mfma_f32_16x16x32_bf16 v[36:39], a[204:207], a[156:159], v[36:39]
    s_mov_b32 s42, 256
    v_exp_f32 v47, v47
    v_mfma_f32_16x16x32_bf16 v[36:39], a[200:203], a[152:155], v[36:39]
    ds_read_b128 a[220:223], v11 offset:39936
    v_cvt_pk_bf16_f32 v251, v46, v47
    v_mfma_f32_16x16x32_bf16 v[44:47], a[200:203], a[184:187], v[60:63]
    s_add_u32 s32, s20, s50
    s_addc_u32 s33, s21, 0
    v_exp_f32 v32, v32
    v_mfma_f32_16x16x32_bf16 v[44:47], a[204:207], a[188:191], v[44:47]
    ds_read_b64_tr_b16 a[240:241], v19 offset:0
    ds_read_b64_tr_b16 a[242:243], v19 offset:1024
    v_mfma_f32_16x16x32_bf16 v[40:43], a[204:207], a[172:175], v[56:59]
    s_cmp_eq_u32 s89, 0
    s_cselect_b32 s34, 256, 0
    v_exp_f32 v33, v33
    v_mfma_f32_16x16x32_bf16 v[40:43], a[200:203], a[168:171], v[40:43]
    ds_read_b64_tr_b16 a[244:245], v19 offset:2048
    v_cvt_pk_bf16_f32 v204, v32, v33
    v_mfma_f32_16x16x32_bf16 v[40:43], a[192:195], a[160:163], v[40:43]
    s_lshr_b32 s50, s38, 2
    v_exp_f32 v34, v34
    v_mfma_f32_16x16x32_bf16 v[40:43], a[196:199], a[164:167], v[40:43]
    v_mfma_f32_16x16x32_bf16 v[44:47], a[196:199], a[180:183], v[44:47]
    s_lshl_b32 s95, s89, 6
    v_exp_f32 v35, v35
    v_mfma_f32_16x16x32_bf16 v[44:47], a[192:195], a[176:179], v[44:47]
    ds_read_b64_tr_b16 a[246:247], v19 offset:3072
    v_cvt_pk_bf16_f32 v205, v34, v35
    v_mfma_f32_16x16x32_bf16 a[96:99], a[224:227], v[128:131], a[112:115]
    s_add_u32 s50, s50, s95
    v_exp_f32 v36, v36
    v_mfma_f32_16x16x32_bf16 a[96:99], a[228:231], v[132:135], a[96:99]
    ds_read_b64_tr_b16 a[248:249], v19 offset:4096
    ds_read_b64_tr_b16 a[250:251], v19 offset:5120
    v_mfma_f32_16x16x32_bf16 a[96:99], a[232:235], v[136:139], a[96:99]
    s_lshl_b32 s50, s50, 8
    v_exp_f32 v37, v37
    v_mfma_f32_16x16x32_bf16 a[96:99], a[236:239], v[140:143], a[96:99]
    ds_read_b64_tr_b16 a[252:253], v19 offset:6144
    v_cvt_pk_bf16_f32 v220, v36, v37
    v_mfma_f32_16x16x32_bf16 a[100:103], a[236:239], v[156:159], a[116:119]
    s_add_u32 s50, s50, 3145728
    v_exp_f32 v38, v38
    v_mfma_f32_16x16x32_bf16 a[100:103], a[232:235], v[152:155], a[100:103]
    v_mfma_f32_16x16x32_bf16 a[100:103], a[228:231], v[148:151], a[100:103]
    v_exp_f32 v39, v39
    v_mfma_f32_16x16x32_bf16 a[100:103], a[224:227], v[144:147], a[100:103]
    ds_read_b64_tr_b16 a[254:255], v19 offset:7168
    v_cvt_pk_bf16_f32 v221, v38, v39
    v_mfma_f32_16x16x32_bf16 a[104:107], a[224:227], v[160:163], a[120:123]
    v_exp_f32 v40, v40
    v_mfma_f32_16x16x32_bf16 a[104:107], a[228:231], v[164:167], a[104:107]
    v_mfma_f32_16x16x32_bf16 a[104:107], a[232:235], v[168:171], a[104:107]
    v_exp_f32 v41, v41
    v_mfma_f32_16x16x32_bf16 a[104:107], a[236:239], v[172:175], a[104:107]
    v_cvt_pk_bf16_f32 v236, v40, v41
    v_mfma_f32_16x16x32_bf16 a[108:111], a[236:239], v[188:191], a[124:127]
    v_exp_f32 v42, v42
    v_mfma_f32_16x16x32_bf16 a[108:111], a[232:235], v[184:187], a[108:111]
    v_mfma_f32_16x16x32_bf16 a[108:111], a[228:231], v[180:183], a[108:111]
    v_exp_f32 v43, v43
    v_mfma_f32_16x16x32_bf16 a[108:111], a[224:227], v[176:179], a[108:111]
    v_cvt_pk_bf16_f32 v237, v42, v43
    v_smfmac_f32_16x16x64_bf16 v[72:75], v[4:7], v[168:175], v22
    s_waitcnt lgkmcnt(0)
    v_mfma_f32_16x16x32_bf16 v[36:39], a[208:211], a[144:147], v[52:55]
    s_waitcnt vmcnt(7)
    s_barrier
    v_exp_f32 v44, v44
    v_mfma_f32_16x16x32_bf16 v[36:39], a[212:215], a[148:151], v[36:39]
    ds_read_b128 a[192:195], v8 offset:0
    ds_read_b128 a[196:199], v9 offset:0
    v_mfma_f32_16x16x32_bf16 v[32:35], a[212:215], a[132:135], v[48:51]
    v_exp_f32 v45, v45
    v_mfma_f32_16x16x32_bf16 v[32:35], a[208:211], a[128:131], v[32:35]
    ds_read_b128 a[200:203], v10 offset:0
    v_cvt_pk_bf16_f32 v252, v44, v45
    v_mfma_f32_16x16x32_bf16 v[32:35], a[216:219], a[136:139], v[32:35]
    s_add_u32 m0, s91, 65536
    v_exp_f32 v46, v46
    v_mfma_f32_16x16x32_bf16 v[32:35], a[220:223], a[140:143], v[32:35]
    buffer_load_dwordx4 v21, s[8:11], s93 offen offset:0 nt lds
    v_mfma_f32_16x16x32_bf16 v[36:39], a[220:223], a[156:159], v[36:39]
    v_exp_f32 v47, v47
    v_mfma_f32_16x16x32_bf16 v[36:39], a[216:219], a[152:155], v[36:39]
    ds_read_b128 a[204:207], v11 offset:0
    v_cvt_pk_bf16_f32 v253, v46, v47
    v_mfma_f32_16x16x32_bf16 v[44:47], a[216:219], a[184:187], v[60:63]
    v_exp_f32 v32, v32
    v_mfma_f32_16x16x32_bf16 v[44:47], a[220:223], a[188:191], v[44:47]
    ds_read_b64_tr_b16 a[224:225], v12 offset:32768
    ds_read_b64_tr_b16 a[226:227], v12 offset:33792
    v_mfma_f32_16x16x32_bf16 v[40:43], a[220:223], a[172:175], v[56:59]
    v_exp_f32 v33, v33
    v_mfma_f32_16x16x32_bf16 v[40:43], a[216:219], a[168:171], v[40:43]
    ds_read_b64_tr_b16 a[228:229], v12 offset:34816
    v_cvt_pk_bf16_f32 v206, v32, v33
    v_mfma_f32_16x16x32_bf16 v[40:43], a[208:211], a[160:163], v[40:43]
    v_exp_f32 v34, v34
    v_mfma_f32_16x16x32_bf16 v[40:43], a[212:215], a[164:167], v[40:43]
    buffer_load_dwordx4 v21, s[8:11], s93 offen offset:1024 nt lds
    v_mfma_f32_16x16x32_bf16 v[44:47], a[212:215], a[180:183], v[44:47]
    v_exp_f32 v35, v35
    v_mfma_f32_16x16x32_bf16 v[44:47], a[208:211], a[176:179], v[44:47]
    ds_read_b64_tr_b16 a[230:231], v12 offset:35840
    v_cvt_pk_bf16_f32 v207, v34, v35
    v_mfma_f32_16x16x32_bf16 a[112:115], a[240:243], v[128:131], a[112:115]
    v_exp_f32 v36, v36
    v_mfma_f32_16x16x32_bf16 a[112:115], a[244:247], v[132:135], a[112:115]
    ds_read_b64_tr_b16 a[232:233], v12 offset:36864
    ds_read_b64_tr_b16 a[234:235], v12 offset:37888
    v_mfma_f32_16x16x32_bf16 a[112:115], a[248:251], v[136:139], a[112:115]
    v_exp_f32 v37, v37
    v_mfma_f32_16x16x32_bf16 a[112:115], a[252:255], v[140:143], a[112:115]
    ds_read_b64_tr_b16 a[236:237], v12 offset:38912
    v_cvt_pk_bf16_f32 v222, v36, v37
    v_mfma_f32_16x16x32_bf16 a[116:119], a[252:255], v[156:159], a[116:119]
    v_exp_f32 v38, v38
    v_mfma_f32_16x16x32_bf16 a[116:119], a[248:251], v[152:155], a[116:119]
    buffer_load_dwordx4 v21, s[8:11], s93 offen offset:2048 nt lds
    v_mfma_f32_16x16x32_bf16 a[116:119], a[244:247], v[148:151], a[116:119]
    v_exp_f32 v39, v39
    v_mfma_f32_16x16x32_bf16 a[116:119], a[240:243], v[144:147], a[116:119]
    ds_read_b64_tr_b16 a[238:239], v12 offset:39936
    v_cvt_pk_bf16_f32 v223, v38, v39
    v_mfma_f32_16x16x32_bf16 a[120:123], a[240:243], v[160:163], a[120:123]
    v_exp_f32 v40, v40
    v_mfma_f32_16x16x32_bf16 a[120:123], a[244:247], v[164:167], a[120:123]
    buffer_load_dwordx4 v21, s[8:11], s93 offen offset:3072 nt lds
    v_mfma_f32_16x16x32_bf16 a[120:123], a[248:251], v[168:171], a[120:123]
    s_add_u32 s93, s93, 4096
    v_exp_f32 v41, v41
    v_mfma_f32_16x16x32_bf16 a[120:123], a[252:255], v[172:175], a[120:123]
    v_cvt_pk_bf16_f32 v238, v40, v41
    v_mfma_f32_16x16x32_bf16 a[124:127], a[252:255], v[188:191], a[124:127]
    s_add_u32 m0, s91, 69632
    v_exp_f32 v42, v42
    v_mfma_f32_16x16x32_bf16 a[124:127], a[248:251], v[184:187], a[124:127]
    buffer_load_dwordx4 v21, s[8:11], s93 offen offset:0 nt lds
    v_mfma_f32_16x16x32_bf16 a[124:127], a[244:247], v[180:183], a[124:127]
    v_exp_f32 v43, v43
    v_mfma_f32_16x16x32_bf16 a[124:127], a[240:243], v[176:179], a[124:127]
    v_cvt_pk_bf16_f32 v239, v42, v43
    v_smfmac_f32_16x16x64_bf16 v[76:79], v[4:7], v[184:191], v22
    s_waitcnt lgkmcnt(0)
    buffer_load_dwordx4 v21, s[8:11], s93 offen offset:1024 nt lds
    v_mfma_f32_16x16x32_bf16 v[36:39], a[192:195], a[144:147], v[52:55]
    v_exp_f32 v44, v44
    v_mfma_f32_16x16x32_bf16 v[36:39], a[196:199], a[148:151], v[36:39]
    ds_read_b128 a[208:211], v8 offset:1024
    ds_read_b128 a[212:215], v9 offset:1024
    v_mfma_f32_16x16x32_bf16 v[32:35], a[196:199], a[132:135], v[48:51]
    v_exp_f32 v45, v45
    v_mfma_f32_16x16x32_bf16 v[32:35], a[192:195], a[128:131], v[32:35]
    ds_read_b128 a[216:219], v10 offset:1024
    v_cvt_pk_bf16_f32 v254, v44, v45
    v_mfma_f32_16x16x32_bf16 v[32:35], a[200:203], a[136:139], v[32:35]
    s_waitcnt vmcnt(7)
    v_exp_f32 v46, v46
    v_mfma_f32_16x16x32_bf16 v[32:35], a[204:207], a[140:143], v[32:35]
    ds_read_b64_tr_b16 v[112:113], v97 offset:0
    ds_read_b64_tr_b16 v[114:115], v97 offset:2048
    v_mfma_f32_16x16x32_bf16 v[36:39], a[204:207], a[156:159], v[36:39]
    v_exp_f32 v47, v47
    v_mfma_f32_16x16x32_bf16 v[36:39], a[200:203], a[152:155], v[36:39]
    ds_read_b128 a[220:223], v11 offset:1024
    v_cvt_pk_bf16_f32 v255, v46, v47
    v_mfma_f32_16x16x32_bf16 v[44:47], a[200:203], a[184:187], v[60:63]
    v_exp_f32 v32, v32
    v_mfma_f32_16x16x32_bf16 v[44:47], a[204:207], a[188:191], v[44:47]
    ds_read_b64_tr_b16 a[240:241], v13 offset:32768
    ds_read_b64_tr_b16 a[242:243], v13 offset:33792
    v_mfma_f32_16x16x32_bf16 v[40:43], a[204:207], a[172:175], v[56:59]
    v_exp_f32 v33, v33
    v_mfma_f32_16x16x32_bf16 v[40:43], a[200:203], a[168:171], v[40:43]
    ds_read_b64_tr_b16 a[244:245], v13 offset:34816
    v_cvt_pk_bf16_f32 v128, v32, v33
    v_mfma_f32_16x16x32_bf16 v[40:43], a[192:195], a[160:163], v[40:43]
    v_exp_f32 v34, v34
    v_mfma_f32_16x16x32_bf16 v[40:43], a[196:199], a[164:167], v[40:43]
    ds_read_b64_tr_b16 v[116:117], v97 offset:8
    ds_read_b64_tr_b16 v[118:119], v97 offset:2056
    v_mfma_f32_16x16x32_bf16 v[44:47], a[196:199], a[180:183], v[44:47]
    v_exp_f32 v35, v35
    v_mfma_f32_16x16x32_bf16 v[44:47], a[192:195], a[176:179], v[44:47]
    ds_read_b64_tr_b16 a[246:247], v13 offset:35840
    v_cvt_pk_bf16_f32 v129, v34, v35
    v_mfma_f32_16x16x32_bf16 a[0:3], a[224:227], v[192:195], a[0:3]
    v_exp_f32 v36, v36
    v_mfma_f32_16x16x32_bf16 a[0:3], a[228:231], v[196:199], a[0:3]
    ds_read_b64_tr_b16 a[248:249], v13 offset:36864
    ds_read_b64_tr_b16 a[250:251], v13 offset:37888
    v_mfma_f32_16x16x32_bf16 a[0:3], a[232:235], v[200:203], a[0:3]
    v_exp_f32 v37, v37
    v_mfma_f32_16x16x32_bf16 a[0:3], a[236:239], v[204:207], a[0:3]
    ds_read_b64_tr_b16 a[252:253], v13 offset:38912
    v_cvt_pk_bf16_f32 v144, v36, v37
    v_mfma_f32_16x16x32_bf16 a[4:7], a[236:239], v[220:223], a[4:7]
    v_exp_f32 v38, v38
    v_mfma_f32_16x16x32_bf16 a[4:7], a[232:235], v[216:219], a[4:7]
    ds_read_b64_tr_b16 v[120:121], v97 offset:64
    ds_read_b64_tr_b16 v[122:123], v97 offset:2112
    v_mfma_f32_16x16x32_bf16 a[4:7], a[228:231], v[212:215], a[4:7]
    v_exp_f32 v39, v39
    v_mfma_f32_16x16x32_bf16 a[4:7], a[224:227], v[208:211], a[4:7]
    ds_read_b64_tr_b16 a[254:255], v13 offset:39936
    v_cvt_pk_bf16_f32 v145, v38, v39
    v_mfma_f32_16x16x32_bf16 a[8:11], a[224:227], v[224:227], a[8:11]
    v_exp_f32 v40, v40
    v_mfma_f32_16x16x32_bf16 a[8:11], a[228:231], v[228:231], a[8:11]
    ds_read_b64_tr_b16 v[124:125], v97 offset:72
    ds_read_b64_tr_b16 v[126:127], v97 offset:2120
    v_mfma_f32_16x16x32_bf16 a[8:11], a[232:235], v[232:235], a[8:11]
    v_exp_f32 v41, v41
    v_mfma_f32_16x16x32_bf16 a[8:11], a[236:239], v[236:239], a[8:11]
    v_cvt_pk_bf16_f32 v160, v40, v41
    v_mfma_f32_16x16x32_bf16 a[12:15], a[236:239], v[252:255], a[12:15]
    v_exp_f32 v42, v42
    v_mfma_f32_16x16x32_bf16 a[12:15], a[232:235], v[248:251], a[12:15]
    buffer_load_dwordx4 v21, s[8:11], s93 offen offset:2048 nt lds
    v_mfma_f32_16x16x32_bf16 a[12:15], a[228:231], v[244:247], a[12:15]
    v_exp_f32 v43, v43
    v_mfma_f32_16x16x32_bf16 a[12:15], a[224:227], v[240:243], a[12:15]
    v_cvt_pk_bf16_f32 v161, v42, v43
    v_smfmac_f32_16x16x64_bf16 v[64:67], v[4:7], v[192:199], v22
    s_waitcnt lgkmcnt(0)
    buffer_load_dwordx4 v21, s[8:11], s93 offen offset:3072 nt lds
    s_add_u32 s93, s93, 28672
    v_mfma_f32_16x16x32_bf16 v[36:39], a[208:211], a[144:147], v[52:55]
    v_exp_f32 v44, v44
    v_mfma_f32_16x16x32_bf16 v[36:39], a[212:215], a[148:151], v[36:39]
    ds_read_b128 a[192:195], v8 offset:2048
    ds_read_b128 a[196:199], v9 offset:2048
    v_mfma_f32_16x16x32_bf16 v[32:35], a[212:215], a[132:135], v[48:51]
    v_exp_f32 v45, v45
    v_mfma_f32_16x16x32_bf16 v[32:35], a[208:211], a[128:131], v[32:35]
    ds_read_b128 a[200:203], v10 offset:2048
    v_cvt_pk_bf16_f32 v176, v44, v45
    v_mfma_f32_16x16x32_bf16 v[32:35], a[216:219], a[136:139], v[32:35]
    v_exp_f32 v46, v46
    v_mfma_f32_16x16x32_bf16 v[32:35], a[220:223], a[140:143], v[32:35]
    buffer_store_dwordx4 v[112:115], v23, s[20:23], s47 offen offset:0 sc1
    v_mfma_f32_16x16x32_bf16 v[36:39], a[220:223], a[156:159], v[36:39]
    v_exp_f32 v47, v47
    v_mfma_f32_16x16x32_bf16 v[36:39], a[216:219], a[152:155], v[36:39]
    ds_read_b128 a[204:207], v11 offset:2048
    v_cvt_pk_bf16_f32 v177, v46, v47
    v_mfma_f32_16x16x32_bf16 v[44:47], a[216:219], a[184:187], v[60:63]
    v_exp_f32 v32, v32
    v_mfma_f32_16x16x32_bf16 v[44:47], a[220:223], a[188:191], v[44:47]
    ds_read_b64_tr_b16 a[224:225], v14 offset:32768
    ds_read_b64_tr_b16 a[226:227], v14 offset:33792
    v_mfma_f32_16x16x32_bf16 v[40:43], a[220:223], a[172:175], v[56:59]
    v_exp_f32 v33, v33
    v_mfma_f32_16x16x32_bf16 v[40:43], a[216:219], a[168:171], v[40:43]
    ds_read_b64_tr_b16 a[228:229], v14 offset:34816
    v_cvt_pk_bf16_f32 v130, v32, v33
    v_mfma_f32_16x16x32_bf16 v[40:43], a[208:211], a[160:163], v[40:43]
    v_exp_f32 v34, v34
    v_mfma_f32_16x16x32_bf16 v[40:43], a[212:215], a[164:167], v[40:43]
    buffer_store_dwordx4 v[116:119], v23, s[20:23], s47 offen offset:1024 sc1
    v_mfma_f32_16x16x32_bf16 v[44:47], a[212:215], a[180:183], v[44:47]
    v_exp_f32 v35, v35
    v_mfma_f32_16x16x32_bf16 v[44:47], a[208:211], a[176:179], v[44:47]
    ds_read_b64_tr_b16 a[230:231], v14 offset:35840
    v_cvt_pk_bf16_f32 v131, v34, v35
    v_mfma_f32_16x16x32_bf16 a[16:19], a[240:243], v[192:195], a[16:19]
    v_exp_f32 v36, v36
    v_mfma_f32_16x16x32_bf16 a[16:19], a[244:247], v[196:199], a[16:19]
    ds_read_b64_tr_b16 a[232:233], v14 offset:36864
    ds_read_b64_tr_b16 a[234:235], v14 offset:37888
    v_mfma_f32_16x16x32_bf16 a[16:19], a[248:251], v[200:203], a[16:19]
    v_exp_f32 v37, v37
    v_mfma_f32_16x16x32_bf16 a[16:19], a[252:255], v[204:207], a[16:19]
    ds_read_b64_tr_b16 a[236:237], v14 offset:38912
    v_cvt_pk_bf16_f32 v146, v36, v37
    v_mfma_f32_16x16x32_bf16 a[20:23], a[252:255], v[220:223], a[20:23]
    v_exp_f32 v38, v38
    v_mfma_f32_16x16x32_bf16 a[20:23], a[248:251], v[216:219], a[20:23]
    buffer_store_dwordx4 v[120:123], v23, s[20:23], s47 offen offset:2048 sc1
    v_mfma_f32_16x16x32_bf16 a[20:23], a[244:247], v[212:215], a[20:23]
    v_exp_f32 v39, v39
    v_mfma_f32_16x16x32_bf16 a[20:23], a[240:243], v[208:211], a[20:23]
    ds_read_b64_tr_b16 a[238:239], v14 offset:39936
    v_cvt_pk_bf16_f32 v147, v38, v39
    v_mfma_f32_16x16x32_bf16 a[24:27], a[240:243], v[224:227], a[24:27]
    v_exp_f32 v40, v40
    v_mfma_f32_16x16x32_bf16 a[24:27], a[244:247], v[228:231], a[24:27]
    buffer_store_dwordx4 v[124:127], v23, s[20:23], s47 offen offset:3072 sc1
    v_mfma_f32_16x16x32_bf16 a[24:27], a[248:251], v[232:235], a[24:27]
    v_exp_f32 v41, v41
    v_mfma_f32_16x16x32_bf16 a[24:27], a[252:255], v[236:239], a[24:27]
    v_cvt_pk_bf16_f32 v162, v40, v41
    v_mfma_f32_16x16x32_bf16 a[28:31], a[252:255], v[252:255], a[28:31]
    s_add_u32 m0, s91, 32768
    v_exp_f32 v42, v42
    v_mfma_f32_16x16x32_bf16 a[28:31], a[248:251], v[248:251], a[28:31]
    buffer_load_dwordx4 v20, s[4:7], s92 offen offset:0 nt lds
    v_mfma_f32_16x16x32_bf16 a[28:31], a[244:247], v[244:247], a[28:31]
    v_exp_f32 v43, v43
    v_mfma_f32_16x16x32_bf16 a[28:31], a[240:243], v[240:243], a[28:31]
    v_cvt_pk_bf16_f32 v163, v42, v43
    v_smfmac_f32_16x16x64_bf16 v[68:71], v[4:7], v[208:215], v22
    s_waitcnt lgkmcnt(0)
    buffer_load_dwordx4 v20, s[4:7], s92 offen offset:1024 nt lds
    v_mfma_f32_16x16x32_bf16 v[36:39], a[192:195], a[144:147], v[52:55]
    v_exp_f32 v44, v44
    v_mfma_f32_16x16x32_bf16 v[36:39], a[196:199], a[148:151], v[36:39]
    ds_read_b128 a[208:211], v8 offset:3072
    ds_read_b128 a[212:215], v9 offset:3072
    v_mfma_f32_16x16x32_bf16 v[32:35], a[196:199], a[132:135], v[48:51]
    v_exp_f32 v45, v45
    v_mfma_f32_16x16x32_bf16 v[32:35], a[192:195], a[128:131], v[32:35]
    ds_read_b128 a[216:219], v10 offset:3072
    v_cvt_pk_bf16_f32 v178, v44, v45
    v_mfma_f32_16x16x32_bf16 v[32:35], a[200:203], a[136:139], v[32:35]
    v_exp_f32 v46, v46
    v_mfma_f32_16x16x32_bf16 v[32:35], a[204:207], a[140:143], v[32:35]
    buffer_load_dwordx4 v20, s[4:7], s92 offen offset:2048 nt lds
    v_mfma_f32_16x16x32_bf16 v[36:39], a[204:207], a[156:159], v[36:39]
    v_exp_f32 v47, v47
    v_mfma_f32_16x16x32_bf16 v[36:39], a[200:203], a[152:155], v[36:39]
    ds_read_b128 a[220:223], v11 offset:3072
    v_cvt_pk_bf16_f32 v179, v46, v47
    v_mfma_f32_16x16x32_bf16 v[44:47], a[200:203], a[184:187], v[60:63]
    v_exp_f32 v32, v32
    v_mfma_f32_16x16x32_bf16 v[44:47], a[204:207], a[188:191], v[44:47]
    ds_read_b64_tr_b16 a[240:241], v15 offset:32768
    ds_read_b64_tr_b16 a[242:243], v15 offset:33792
    v_mfma_f32_16x16x32_bf16 v[40:43], a[204:207], a[172:175], v[56:59]
    v_exp_f32 v33, v33
    v_mfma_f32_16x16x32_bf16 v[40:43], a[200:203], a[168:171], v[40:43]
    ds_read_b64_tr_b16 a[244:245], v15 offset:34816
    v_cvt_pk_bf16_f32 v132, v32, v33
    v_mfma_f32_16x16x32_bf16 v[40:43], a[192:195], a[160:163], v[40:43]
    v_exp_f32 v34, v34
    v_mfma_f32_16x16x32_bf16 v[40:43], a[196:199], a[164:167], v[40:43]
    buffer_load_dwordx4 v20, s[4:7], s92 offen offset:3072 nt lds
    v_mfma_f32_16x16x32_bf16 v[44:47], a[196:199], a[180:183], v[44:47]
    s_add_u32 s92, s92, 4096
    v_exp_f32 v35, v35
    v_mfma_f32_16x16x32_bf16 v[44:47], a[192:195], a[176:179], v[44:47]
    ds_read_b64_tr_b16 a[246:247], v15 offset:35840
    v_cvt_pk_bf16_f32 v133, v34, v35
    v_mfma_f32_16x16x32_bf16 a[32:35], a[224:227], v[192:195], a[32:35]
    v_exp_f32 v36, v36
    v_mfma_f32_16x16x32_bf16 a[32:35], a[228:231], v[196:199], a[32:35]
    ds_read_b64_tr_b16 a[248:249], v15 offset:36864
    ds_read_b64_tr_b16 a[250:251], v15 offset:37888
    v_mfma_f32_16x16x32_bf16 a[32:35], a[232:235], v[200:203], a[32:35]
    v_exp_f32 v37, v37
    v_mfma_f32_16x16x32_bf16 a[32:35], a[236:239], v[204:207], a[32:35]
    ds_read_b64_tr_b16 a[252:253], v15 offset:38912
    v_cvt_pk_bf16_f32 v148, v36, v37
    v_mfma_f32_16x16x32_bf16 a[36:39], a[236:239], v[220:223], a[36:39]
    s_add_u32 m0, s91, 36864
    v_exp_f32 v38, v38
    v_mfma_f32_16x16x32_bf16 a[36:39], a[232:235], v[216:219], a[36:39]
    buffer_load_dwordx4 v20, s[4:7], s92 offen offset:0 nt lds
    v_mfma_f32_16x16x32_bf16 a[36:39], a[228:231], v[212:215], a[36:39]
    v_exp_f32 v39, v39
    v_mfma_f32_16x16x32_bf16 a[36:39], a[224:227], v[208:211], a[36:39]
    ds_read_b64_tr_b16 a[254:255], v15 offset:39936
    v_cvt_pk_bf16_f32 v149, v38, v39
    v_mfma_f32_16x16x32_bf16 a[40:43], a[224:227], v[224:227], a[40:43]
    v_exp_f32 v40, v40
    v_mfma_f32_16x16x32_bf16 a[40:43], a[228:231], v[228:231], a[40:43]
    buffer_load_dwordx4 v20, s[4:7], s92 offen offset:1024 nt lds
    v_mfma_f32_16x16x32_bf16 a[40:43], a[232:235], v[232:235], a[40:43]
    v_exp_f32 v41, v41
    v_mfma_f32_16x16x32_bf16 a[40:43], a[236:239], v[236:239], a[40:43]
    v_cvt_pk_bf16_f32 v164, v40, v41
    v_mfma_f32_16x16x32_bf16 a[44:47], a[236:239], v[252:255], a[44:47]
    v_exp_f32 v42, v42
    v_mfma_f32_16x16x32_bf16 a[44:47], a[232:235], v[248:251], a[44:47]
    buffer_load_dwordx4 v20, s[4:7], s92 offen offset:2048 nt lds
    v_mfma_f32_16x16x32_bf16 a[44:47], a[228:231], v[244:247], a[44:47]
    v_exp_f32 v43, v43
    v_mfma_f32_16x16x32_bf16 a[44:47], a[224:227], v[240:243], a[44:47]
    v_cvt_pk_bf16_f32 v165, v42, v43
    v_smfmac_f32_16x16x64_bf16 v[72:75], v[4:7], v[224:231], v22
    s_waitcnt lgkmcnt(0)
    buffer_load_dwordx4 v20, s[4:7], s92 offen offset:3072 nt lds
    s_add_u32 s92, s92, 28672
    v_mfma_f32_16x16x32_bf16 v[36:39], a[208:211], a[144:147], v[52:55]
    v_exp_f32 v44, v44
    v_mfma_f32_16x16x32_bf16 v[36:39], a[212:215], a[148:151], v[36:39]
    ds_read_b128 a[192:195], v8 offset:4096
    ds_read_b128 a[196:199], v9 offset:4096
    v_mfma_f32_16x16x32_bf16 v[32:35], a[212:215], a[132:135], v[48:51]
    v_exp_f32 v45, v45
    v_mfma_f32_16x16x32_bf16 v[32:35], a[208:211], a[128:131], v[32:35]
    ds_read_b128 a[200:203], v10 offset:4096
    v_cvt_pk_bf16_f32 v180, v44, v45
    v_mfma_f32_16x16x32_bf16 v[32:35], a[216:219], a[136:139], v[32:35]
    v_exp_f32 v46, v46
    v_mfma_f32_16x16x32_bf16 v[32:35], a[220:223], a[140:143], v[32:35]
    v_mfma_f32_16x16x32_bf16 v[36:39], a[220:223], a[156:159], v[36:39]
    v_exp_f32 v47, v47
    v_mfma_f32_16x16x32_bf16 v[36:39], a[216:219], a[152:155], v[36:39]
    ds_read_b128 a[204:207], v11 offset:4096
    v_cvt_pk_bf16_f32 v181, v46, v47
    v_mfma_f32_16x16x32_bf16 v[44:47], a[216:219], a[184:187], v[60:63]
    v_exp_f32 v32, v32
    v_mfma_f32_16x16x32_bf16 v[44:47], a[220:223], a[188:191], v[44:47]
    ds_read_b64_tr_b16 a[224:225], v16 offset:32768
    ds_read_b64_tr_b16 a[226:227], v16 offset:33792
    v_mfma_f32_16x16x32_bf16 v[40:43], a[220:223], a[172:175], v[56:59]
    v_exp_f32 v33, v33
    v_mfma_f32_16x16x32_bf16 v[40:43], a[216:219], a[168:171], v[40:43]
    ds_read_b64_tr_b16 a[228:229], v16 offset:34816
    v_cvt_pk_bf16_f32 v134, v32, v33
    v_mfma_f32_16x16x32_bf16 v[40:43], a[208:211], a[160:163], v[40:43]
    v_exp_f32 v34, v34
    v_mfma_f32_16x16x32_bf16 v[40:43], a[212:215], a[164:167], v[40:43]
    v_mfma_f32_16x16x32_bf16 v[44:47], a[212:215], a[180:183], v[44:47]
    v_exp_f32 v35, v35
    v_mfma_f32_16x16x32_bf16 v[44:47], a[208:211], a[176:179], v[44:47]
    ds_read_b64_tr_b16 a[230:231], v16 offset:35840
    v_cvt_pk_bf16_f32 v135, v34, v35
    v_mfma_f32_16x16x32_bf16 a[48:51], a[240:243], v[192:195], a[48:51]
    v_exp_f32 v36, v36
    v_mfma_f32_16x16x32_bf16 a[48:51], a[244:247], v[196:199], a[48:51]
    ds_read_b64_tr_b16 a[232:233], v16 offset:36864
    ds_read_b64_tr_b16 a[234:235], v16 offset:37888
    v_mfma_f32_16x16x32_bf16 a[48:51], a[248:251], v[200:203], a[48:51]
    v_exp_f32 v37, v37
    v_mfma_f32_16x16x32_bf16 a[48:51], a[252:255], v[204:207], a[48:51]
    ds_read_b64_tr_b16 a[236:237], v16 offset:38912
    v_cvt_pk_bf16_f32 v150, v36, v37
    v_mfma_f32_16x16x32_bf16 a[52:55], a[252:255], v[220:223], a[52:55]
    v_exp_f32 v38, v38
    v_mfma_f32_16x16x32_bf16 a[52:55], a[248:251], v[216:219], a[52:55]
    v_mfma_f32_16x16x32_bf16 a[52:55], a[244:247], v[212:215], a[52:55]
    v_exp_f32 v39, v39
    v_mfma_f32_16x16x32_bf16 a[52:55], a[240:243], v[208:211], a[52:55]
    ds_read_b64_tr_b16 a[238:239], v16 offset:39936
    v_cvt_pk_bf16_f32 v151, v38, v39
    v_mfma_f32_16x16x32_bf16 a[56:59], a[240:243], v[224:227], a[56:59]
    v_exp_f32 v40, v40
    v_mfma_f32_16x16x32_bf16 a[56:59], a[244:247], v[228:231], a[56:59]
    v_mfma_f32_16x16x32_bf16 a[56:59], a[248:251], v[232:235], a[56:59]
    v_exp_f32 v41, v41
    v_mfma_f32_16x16x32_bf16 a[56:59], a[252:255], v[236:239], a[56:59]
    v_cvt_pk_bf16_f32 v166, v40, v41
    v_mfma_f32_16x16x32_bf16 a[60:63], a[252:255], v[252:255], a[60:63]
    v_exp_f32 v42, v42
    v_mfma_f32_16x16x32_bf16 a[60:63], a[248:251], v[248:251], a[60:63]
    v_mfma_f32_16x16x32_bf16 a[60:63], a[244:247], v[244:247], a[60:63]
    v_exp_f32 v43, v43
    v_mfma_f32_16x16x32_bf16 a[60:63], a[240:243], v[240:243], a[60:63]
    v_cvt_pk_bf16_f32 v167, v42, v43
    v_smfmac_f32_16x16x64_bf16 v[76:79], v[4:7], v[240:247], v22
    s_waitcnt lgkmcnt(0)
    v_mfma_f32_16x16x32_bf16 v[36:39], a[192:195], a[144:147], v[52:55]
    v_exp_f32 v44, v44
    v_mfma_f32_16x16x32_bf16 v[36:39], a[196:199], a[148:151], v[36:39]
    ds_read_b128 a[208:211], v8 offset:5120
    ds_read_b128 a[212:215], v9 offset:5120
    v_mfma_f32_16x16x32_bf16 v[32:35], a[196:199], a[132:135], v[48:51]
    v_exp_f32 v45, v45
    v_mfma_f32_16x16x32_bf16 v[32:35], a[192:195], a[128:131], v[32:35]
    ds_read_b128 a[216:219], v10 offset:5120
    v_cvt_pk_bf16_f32 v182, v44, v45
    v_mfma_f32_16x16x32_bf16 v[32:35], a[200:203], a[136:139], v[32:35]
    v_exp_f32 v46, v46
    v_mfma_f32_16x16x32_bf16 v[32:35], a[204:207], a[140:143], v[32:35]
    buffer_load_dword v0, v30, s[28:31], s44 offen sc1
    v_mfma_f32_16x16x32_bf16 v[36:39], a[204:207], a[156:159], v[36:39]
    s_add_u32 s44, s44, s45
    v_exp_f32 v47, v47
    v_mfma_f32_16x16x32_bf16 v[36:39], a[200:203], a[152:155], v[36:39]
    ds_read_b128 a[220:223], v11 offset:5120
    v_cvt_pk_bf16_f32 v183, v46, v47
    v_mfma_f32_16x16x32_bf16 v[44:47], a[200:203], a[184:187], v[60:63]
    v_exp_f32 v32, v32
    v_mfma_f32_16x16x32_bf16 v[44:47], a[204:207], a[188:191], v[44:47]
    ds_read_b64_tr_b16 a[240:241], v17 offset:32768
    ds_read_b64_tr_b16 a[242:243], v17 offset:33792
    v_mfma_f32_16x16x32_bf16 v[40:43], a[204:207], a[172:175], v[56:59]
    v_exp_f32 v33, v33
    v_mfma_f32_16x16x32_bf16 v[40:43], a[200:203], a[168:171], v[40:43]
    ds_read_b64_tr_b16 a[244:245], v17 offset:34816
    v_cvt_pk_bf16_f32 v136, v32, v33
    v_mfma_f32_16x16x32_bf16 v[40:43], a[192:195], a[160:163], v[40:43]
    v_exp_f32 v34, v34
    v_mfma_f32_16x16x32_bf16 v[40:43], a[196:199], a[164:167], v[40:43]
    v_mfma_f32_16x16x32_bf16 v[44:47], a[196:199], a[180:183], v[44:47]
    v_exp_f32 v35, v35
    v_mfma_f32_16x16x32_bf16 v[44:47], a[192:195], a[176:179], v[44:47]
    ds_read_b64_tr_b16 a[246:247], v17 offset:35840
    v_cvt_pk_bf16_f32 v137, v34, v35
    v_mfma_f32_16x16x32_bf16 a[64:67], a[224:227], v[192:195], a[64:67]
    v_exp_f32 v36, v36
    v_mfma_f32_16x16x32_bf16 a[64:67], a[228:231], v[196:199], a[64:67]
    ds_read_b64_tr_b16 a[248:249], v17 offset:36864
    ds_read_b64_tr_b16 a[250:251], v17 offset:37888
    v_mfma_f32_16x16x32_bf16 a[64:67], a[232:235], v[200:203], a[64:67]
    v_exp_f32 v37, v37
    v_mfma_f32_16x16x32_bf16 a[64:67], a[236:239], v[204:207], a[64:67]
    ds_read_b64_tr_b16 a[252:253], v17 offset:38912
    v_cvt_pk_bf16_f32 v152, v36, v37
    v_mfma_f32_16x16x32_bf16 a[68:71], a[236:239], v[220:223], a[68:71]
    v_exp_f32 v38, v38
    v_mfma_f32_16x16x32_bf16 a[68:71], a[232:235], v[216:219], a[68:71]
    v_mfma_f32_16x16x32_bf16 a[68:71], a[228:231], v[212:215], a[68:71]
    v_exp_f32 v39, v39
    v_mfma_f32_16x16x32_bf16 a[68:71], a[224:227], v[208:211], a[68:71]
    ds_read_b64_tr_b16 a[254:255], v17 offset:39936
    v_cvt_pk_bf16_f32 v153, v38, v39
    v_mfma_f32_16x16x32_bf16 a[72:75], a[224:227], v[224:227], a[72:75]
    v_exp_f32 v40, v40
    v_mfma_f32_16x16x32_bf16 a[72:75], a[228:231], v[228:231], a[72:75]
    v_mfma_f32_16x16x32_bf16 a[72:75], a[232:235], v[232:235], a[72:75]
    v_exp_f32 v41, v41
    v_mfma_f32_16x16x32_bf16 a[72:75], a[236:239], v[236:239], a[72:75]
    v_cvt_pk_bf16_f32 v168, v40, v41
    v_mfma_f32_16x16x32_bf16 a[76:79], a[236:239], v[252:255], a[76:79]
    v_exp_f32 v42, v42
    v_mfma_f32_16x16x32_bf16 a[76:79], a[232:235], v[248:251], a[76:79]
    v_mfma_f32_16x16x32_bf16 a[76:79], a[228:231], v[244:247], a[76:79]
    v_exp_f32 v43, v43
    v_mfma_f32_16x16x32_bf16 a[76:79], a[224:227], v[240:243], a[76:79]
    v_cvt_pk_bf16_f32 v169, v42, v43
    v_smfmac_f32_16x16x64_bf16 v[64:67], v[4:7], v[200:207], v22
    s_waitcnt lgkmcnt(0)
    v_mfma_f32_16x16x32_bf16 v[36:39], a[208:211], a[144:147], v[52:55]
    v_exp_f32 v44, v44
    v_mfma_f32_16x16x32_bf16 v[36:39], a[212:215], a[148:151], v[36:39]
    ds_read_b128 a[192:195], v8 offset:6144
    ds_read_b128 a[196:199], v9 offset:6144
    v_mfma_f32_16x16x32_bf16 v[32:35], a[212:215], a[132:135], v[48:51]
    v_exp_f32 v45, v45
    v_mfma_f32_16x16x32_bf16 v[32:35], a[208:211], a[128:131], v[32:35]
    ds_read_b128 a[200:203], v10 offset:6144
    v_cvt_pk_bf16_f32 v184, v44, v45
    v_mfma_f32_16x16x32_bf16 v[32:35], a[216:219], a[136:139], v[32:35]
    v_exp_f32 v46, v46
    v_mfma_f32_16x16x32_bf16 v[32:35], a[220:223], a[140:143], v[32:35]
    v_lshlrev_b32 v80, 16, v100
    v_and_b32 v81, 0xffff0000, v100
    v_mfma_f32_16x16x32_bf16 v[36:39], a[220:223], a[156:159], v[36:39]
    v_exp_f32 v47, v47
    v_mfma_f32_16x16x32_bf16 v[36:39], a[216:219], a[152:155], v[36:39]
    ds_read_b128 a[204:207], v11 offset:6144
    v_cvt_pk_bf16_f32 v185, v46, v47
    v_mfma_f32_16x16x32_bf16 v[44:47], a[216:219], a[184:187], v[60:63]
    v_exp_f32 v32, v32
    v_mfma_f32_16x16x32_bf16 v[44:47], a[220:223], a[188:191], v[44:47]
    ds_read_b64_tr_b16 a[224:225], v18 offset:32768
    ds_read_b64_tr_b16 a[226:227], v18 offset:33792
    v_mfma_f32_16x16x32_bf16 v[40:43], a[220:223], a[172:175], v[56:59]
    v_exp_f32 v33, v33
    v_mfma_f32_16x16x32_bf16 v[40:43], a[216:219], a[168:171], v[40:43]
    ds_read_b64_tr_b16 a[228:229], v18 offset:34816
    v_cvt_pk_bf16_f32 v138, v32, v33
    v_mfma_f32_16x16x32_bf16 v[40:43], a[208:211], a[160:163], v[40:43]
    v_exp_f32 v34, v34
    v_mfma_f32_16x16x32_bf16 v[40:43], a[212:215], a[164:167], v[40:43]
    v_lshlrev_b32 v82, 16, v101
    v_and_b32 v83, 0xffff0000, v101
    v_mfma_f32_16x16x32_bf16 v[44:47], a[212:215], a[180:183], v[44:47]
    v_exp_f32 v35, v35
    v_mfma_f32_16x16x32_bf16 v[44:47], a[208:211], a[176:179], v[44:47]
    ds_read_b64_tr_b16 a[230:231], v18 offset:35840
    v_cvt_pk_bf16_f32 v139, v34, v35
    v_mfma_f32_16x16x32_bf16 a[80:83], a[240:243], v[192:195], a[80:83]
    v_exp_f32 v36, v36
    v_mfma_f32_16x16x32_bf16 a[80:83], a[244:247], v[196:199], a[80:83]
    ds_read_b64_tr_b16 a[232:233], v18 offset:36864
    ds_read_b64_tr_b16 a[234:235], v18 offset:37888
    v_mfma_f32_16x16x32_bf16 a[80:83], a[248:251], v[200:203], a[80:83]
    v_exp_f32 v37, v37
    v_mfma_f32_16x16x32_bf16 a[80:83], a[252:255], v[204:207], a[80:83]
    ds_read_b64_tr_b16 a[236:237], v18 offset:38912
    v_cvt_pk_bf16_f32 v154, v36, v37
    v_mfma_f32_16x16x32_bf16 a[84:87], a[252:255], v[220:223], a[84:87]
    v_exp_f32 v38, v38
    v_mfma_f32_16x16x32_bf16 a[84:87], a[248:251], v[216:219], a[84:87]
    v_lshlrev_b32 v84, 16, v100
    v_and_b32 v85, 0xffff0000, v100
    v_mfma_f32_16x16x32_bf16 a[84:87], a[244:247], v[212:215], a[84:87]
    v_exp_f32 v39, v39
    v_mfma_f32_16x16x32_bf16 a[84:87], a[240:243], v[208:211], a[84:87]
    ds_read_b64_tr_b16 a[238:239], v18 offset:39936
    v_cvt_pk_bf16_f32 v155, v38, v39
    v_mfma_f32_16x16x32_bf16 a[88:91], a[240:243], v[224:227], a[88:91]
    v_exp_f32 v40, v40
    v_mfma_f32_16x16x32_bf16 a[88:91], a[244:247], v[228:231], a[88:91]
    v_lshlrev_b32 v86, 16, v101
    v_and_b32 v87, 0xffff0000, v101
    v_mfma_f32_16x16x32_bf16 a[88:91], a[248:251], v[232:235], a[88:91]
    v_exp_f32 v41, v41
    v_mfma_f32_16x16x32_bf16 a[88:91], a[252:255], v[236:239], a[88:91]
    v_cvt_pk_bf16_f32 v170, v40, v41
    v_mfma_f32_16x16x32_bf16 a[92:95], a[252:255], v[252:255], a[92:95]
    v_exp_f32 v42, v42
    v_mfma_f32_16x16x32_bf16 a[92:95], a[248:251], v[248:251], a[92:95]
    v_mfma_f32_16x16x32_bf16 a[92:95], a[244:247], v[244:247], a[92:95]
    v_exp_f32 v43, v43
    v_mfma_f32_16x16x32_bf16 a[92:95], a[240:243], v[240:243], a[92:95]
    v_cvt_pk_bf16_f32 v171, v42, v43
    v_smfmac_f32_16x16x64_bf16 v[68:71], v[4:7], v[216:223], v22
    s_waitcnt lgkmcnt(0)
    v_mfma_f32_16x16x32_bf16 v[36:39], a[192:195], a[144:147], v[52:55]
    v_exp_f32 v44, v44
    v_mfma_f32_16x16x32_bf16 v[36:39], a[196:199], a[148:151], v[36:39]
    ds_read_b128 a[208:211], v8 offset:7168
    ds_read_b128 a[212:215], v9 offset:7168
    v_mfma_f32_16x16x32_bf16 v[32:35], a[196:199], a[132:135], v[48:51]
    v_exp_f32 v45, v45
    v_mfma_f32_16x16x32_bf16 v[32:35], a[192:195], a[128:131], v[32:35]
    ds_read_b128 a[216:219], v10 offset:7168
    v_cvt_pk_bf16_f32 v186, v44, v45
    v_mfma_f32_16x16x32_bf16 v[32:35], a[200:203], a[136:139], v[32:35]
    v_exp_f32 v46, v46
    v_mfma_f32_16x16x32_bf16 v[32:35], a[204:207], a[140:143], v[32:35]
    v_lshlrev_b32 v88, 16, v102
    v_and_b32 v89, 0xffff0000, v102
    v_mfma_f32_16x16x32_bf16 v[36:39], a[204:207], a[156:159], v[36:39]
    v_exp_f32 v47, v47
    v_mfma_f32_16x16x32_bf16 v[36:39], a[200:203], a[152:155], v[36:39]
    ds_read_b128 a[220:223], v11 offset:7168
    v_cvt_pk_bf16_f32 v187, v46, v47
    v_mfma_f32_16x16x32_bf16 v[44:47], a[200:203], a[184:187], v[60:63]
    v_exp_f32 v32, v32
    v_mfma_f32_16x16x32_bf16 v[44:47], a[204:207], a[188:191], v[44:47]
    ds_read_b64_tr_b16 a[240:241], v19 offset:32768
    ds_read_b64_tr_b16 a[242:243], v19 offset:33792
    v_mfma_f32_16x16x32_bf16 v[40:43], a[204:207], a[172:175], v[56:59]
    v_exp_f32 v33, v33
    v_mfma_f32_16x16x32_bf16 v[40:43], a[200:203], a[168:171], v[40:43]
    ds_read_b64_tr_b16 a[244:245], v19 offset:34816
    v_cvt_pk_bf16_f32 v140, v32, v33
    v_mfma_f32_16x16x32_bf16 v[40:43], a[192:195], a[160:163], v[40:43]
    v_exp_f32 v34, v34
    v_mfma_f32_16x16x32_bf16 v[40:43], a[196:199], a[164:167], v[40:43]
    v_lshlrev_b32 v90, 16, v103
    v_and_b32 v91, 0xffff0000, v103
    v_mfma_f32_16x16x32_bf16 v[44:47], a[196:199], a[180:183], v[44:47]
    v_exp_f32 v35, v35
    v_mfma_f32_16x16x32_bf16 v[44:47], a[192:195], a[176:179], v[44:47]
    ds_read_b64_tr_b16 a[246:247], v19 offset:35840
    v_cvt_pk_bf16_f32 v141, v34, v35
    v_mfma_f32_16x16x32_bf16 a[96:99], a[224:227], v[192:195], a[96:99]
    v_exp_f32 v36, v36
    v_mfma_f32_16x16x32_bf16 a[96:99], a[228:231], v[196:199], a[96:99]
    ds_read_b64_tr_b16 a[248:249], v19 offset:36864
    ds_read_b64_tr_b16 a[250:251], v19 offset:37888
    v_mfma_f32_16x16x32_bf16 a[96:99], a[232:235], v[200:203], a[96:99]
    v_exp_f32 v37, v37
    v_mfma_f32_16x16x32_bf16 a[96:99], a[236:239], v[204:207], a[96:99]
    ds_read_b64_tr_b16 a[252:253], v19 offset:38912
    v_cvt_pk_bf16_f32 v156, v36, v37
    v_mfma_f32_16x16x32_bf16 a[100:103], a[236:239], v[220:223], a[100:103]
    v_exp_f32 v38, v38
    v_mfma_f32_16x16x32_bf16 a[100:103], a[232:235], v[216:219], a[100:103]
    v_lshlrev_b32 v92, 16, v102
    v_and_b32 v93, 0xffff0000, v102
    v_mfma_f32_16x16x32_bf16 a[100:103], a[228:231], v[212:215], a[100:103]
    v_exp_f32 v39, v39
    v_mfma_f32_16x16x32_bf16 a[100:103], a[224:227], v[208:211], a[100:103]
    ds_read_b64_tr_b16 a[254:255], v19 offset:39936
    v_cvt_pk_bf16_f32 v157, v38, v39
    v_mfma_f32_16x16x32_bf16 a[104:107], a[224:227], v[224:227], a[104:107]
    v_exp_f32 v40, v40
    v_mfma_f32_16x16x32_bf16 a[104:107], a[228:231], v[228:231], a[104:107]
    v_lshlrev_b32 v94, 16, v103
    v_and_b32 v95, 0xffff0000, v103
    v_mfma_f32_16x16x32_bf16 a[104:107], a[232:235], v[232:235], a[104:107]
    v_exp_f32 v41, v41
    v_mfma_f32_16x16x32_bf16 a[104:107], a[236:239], v[236:239], a[104:107]
    v_cvt_pk_bf16_f32 v172, v40, v41
    v_mfma_f32_16x16x32_bf16 a[108:111], a[236:239], v[252:255], a[108:111]
    v_exp_f32 v42, v42
    v_mfma_f32_16x16x32_bf16 a[108:111], a[232:235], v[248:251], a[108:111]
    v_mfma_f32_16x16x32_bf16 a[108:111], a[228:231], v[244:247], a[108:111]
    v_exp_f32 v43, v43
    v_mfma_f32_16x16x32_bf16 a[108:111], a[224:227], v[240:243], a[108:111]
    v_cvt_pk_bf16_f32 v173, v42, v43
    v_smfmac_f32_16x16x64_bf16 v[72:75], v[4:7], v[232:239], v22
    s_waitcnt lgkmcnt(0)
    v_mfma_f32_16x16x32_bf16 v[36:39], a[208:211], a[144:147], v[52:55]
    s_waitcnt vmcnt(1)
    s_barrier
    v_exp_f32 v44, v44
    v_mfma_f32_16x16x32_bf16 v[36:39], a[212:215], a[148:151], v[36:39]
    ds_read_b128 a[192:195], v8 offset:32768
    ds_read_b128 a[196:199], v9 offset:32768
    v_mfma_f32_16x16x32_bf16 v[32:35], a[212:215], a[132:135], v[48:51]
    v_exp_f32 v45, v45
    v_mfma_f32_16x16x32_bf16 v[32:35], a[208:211], a[128:131], v[32:35]
    ds_read_b128 a[200:203], v10 offset:32768
    v_cvt_pk_bf16_f32 v188, v44, v45
    v_mfma_f32_16x16x32_bf16 v[32:35], a[216:219], a[136:139], v[32:35]
    s_add_u32 m0, s91, 98304
    v_exp_f32 v46, v46
    v_mfma_f32_16x16x32_bf16 v[32:35], a[220:223], a[140:143], v[32:35]
    buffer_load_dwordx4 v21, s[8:11], s93 offen offset:0 nt lds
    v_mfma_f32_16x16x32_bf16 v[36:39], a[220:223], a[156:159], v[36:39]
    v_exp_f32 v47, v47
    v_mfma_f32_16x16x32_bf16 v[36:39], a[216:219], a[152:155], v[36:39]
    ds_read_b128 a[204:207], v11 offset:32768
    v_cvt_pk_bf16_f32 v189, v46, v47
    v_mfma_f32_16x16x32_bf16 v[44:47], a[216:219], a[184:187], v[60:63]
    v_exp_f32 v32, v32
    v_mfma_f32_16x16x32_bf16 v[44:47], a[220:223], a[188:191], v[44:47]
    ds_read_b64_tr_b16 a[224:225], v12 offset:0
    ds_read_b64_tr_b16 a[226:227], v12 offset:1024
    v_mfma_f32_16x16x32_bf16 v[40:43], a[220:223], a[172:175], v[56:59]
    v_exp_f32 v33, v33
    v_mfma_f32_16x16x32_bf16 v[40:43], a[216:219], a[168:171], v[40:43]
    ds_read_b64_tr_b16 a[228:229], v12 offset:2048
    v_cvt_pk_bf16_f32 v142, v32, v33
    v_mfma_f32_16x16x32_bf16 v[40:43], a[208:211], a[160:163], v[40:43]
    v_exp_f32 v34, v34
    v_mfma_f32_16x16x32_bf16 v[40:43], a[212:215], a[164:167], v[40:43]
    buffer_load_dwordx4 v21, s[8:11], s93 offen offset:1024 nt lds
    v_mfma_f32_16x16x32_bf16 v[44:47], a[212:215], a[180:183], v[44:47]
    v_exp_f32 v35, v35
    v_mfma_f32_16x16x32_bf16 v[44:47], a[208:211], a[176:179], v[44:47]
    ds_read_b64_tr_b16 a[230:231], v12 offset:3072
    v_cvt_pk_bf16_f32 v143, v34, v35
    v_mfma_f32_16x16x32_bf16 a[112:115], a[240:243], v[192:195], a[112:115]
    v_exp_f32 v36, v36
    v_mfma_f32_16x16x32_bf16 a[112:115], a[244:247], v[196:199], a[112:115]
    ds_read_b64_tr_b16 a[232:233], v12 offset:4096
    ds_read_b64_tr_b16 a[234:235], v12 offset:5120
    v_mfma_f32_16x16x32_bf16 a[112:115], a[248:251], v[200:203], a[112:115]
    v_exp_f32 v37, v37
    v_mfma_f32_16x16x32_bf16 a[112:115], a[252:255], v[204:207], a[112:115]
    ds_read_b64_tr_b16 a[236:237], v12 offset:6144
    v_cvt_pk_bf16_f32 v158, v36, v37
    v_mfma_f32_16x16x32_bf16 a[116:119], a[252:255], v[220:223], a[116:119]
    v_exp_f32 v38, v38
    v_mfma_f32_16x16x32_bf16 a[116:119], a[248:251], v[216:219], a[116:119]
    buffer_load_dwordx4 v21, s[8:11], s93 offen offset:2048 nt lds
    v_mfma_f32_16x16x32_bf16 a[116:119], a[244:247], v[212:215], a[116:119]
    v_exp_f32 v39, v39
    v_mfma_f32_16x16x32_bf16 a[116:119], a[240:243], v[208:211], a[116:119]
    ds_read_b64_tr_b16 a[238:239], v12 offset:7168
    v_cvt_pk_bf16_f32 v159, v38, v39
    v_mfma_f32_16x16x32_bf16 a[120:123], a[240:243], v[224:227], a[120:123]
    v_exp_f32 v40, v40
    v_mfma_f32_16x16x32_bf16 a[120:123], a[244:247], v[228:231], a[120:123]
    buffer_load_dwordx4 v21, s[8:11], s93 offen offset:3072 nt lds
    v_mfma_f32_16x16x32_bf16 a[120:123], a[248:251], v[232:235], a[120:123]
    s_add_u32 s93, s93, 4096
    v_exp_f32 v41, v41
    v_mfma_f32_16x16x32_bf16 a[120:123], a[252:255], v[236:239], a[120:123]
    v_cvt_pk_bf16_f32 v174, v40, v41
    v_mfma_f32_16x16x32_bf16 a[124:127], a[252:255], v[252:255], a[124:127]
    s_add_u32 m0, s91, 102400
    v_exp_f32 v42, v42
    v_mfma_f32_16x16x32_bf16 a[124:127], a[248:251], v[248:251], a[124:127]
    buffer_load_dwordx4 v21, s[8:11], s93 offen offset:0 nt lds
    v_mfma_f32_16x16x32_bf16 a[124:127], a[244:247], v[244:247], a[124:127]
    v_exp_f32 v43, v43
    v_mfma_f32_16x16x32_bf16 a[124:127], a[240:243], v[240:243], a[124:127]
    v_cvt_pk_bf16_f32 v175, v42, v43
    v_smfmac_f32_16x16x64_bf16 v[76:79], v[4:7], v[248:255], v22
    s_waitcnt lgkmcnt(0)
    buffer_load_dwordx4 v21, s[8:11], s93 offen offset:1024 nt lds
    v_mfma_f32_16x16x32_bf16 v[36:39], a[192:195], a[144:147], v[52:55]
    v_exp_f32 v44, v44
    v_mfma_f32_16x16x32_bf16 v[36:39], a[196:199], a[148:151], v[36:39]
    ds_read_b128 a[208:211], v8 offset:33792
    ds_read_b128 a[212:215], v9 offset:33792
    v_mfma_f32_16x16x32_bf16 v[32:35], a[196:199], a[132:135], v[48:51]
    v_exp_f32 v45, v45
    v_mfma_f32_16x16x32_bf16 v[32:35], a[192:195], a[128:131], v[32:35]
    ds_read_b128 a[216:219], v10 offset:33792
    v_cvt_pk_bf16_f32 v190, v44, v45
    v_mfma_f32_16x16x32_bf16 v[32:35], a[200:203], a[136:139], v[32:35]
    v_exp_f32 v46, v46
    v_mfma_f32_16x16x32_bf16 v[32:35], a[204:207], a[140:143], v[32:35]
    buffer_load_dwordx4 v21, s[8:11], s93 offen offset:2048 nt lds
    v_mfma_f32_16x16x32_bf16 v[36:39], a[204:207], a[156:159], v[36:39]
    v_exp_f32 v47, v47
    v_mfma_f32_16x16x32_bf16 v[36:39], a[200:203], a[152:155], v[36:39]
    ds_read_b128 a[220:223], v11 offset:33792
    v_cvt_pk_bf16_f32 v191, v46, v47
    v_mfma_f32_16x16x32_bf16 v[44:47], a[200:203], a[184:187], v[60:63]
    v_exp_f32 v32, v32
    v_mfma_f32_16x16x32_bf16 v[44:47], a[204:207], a[188:191], v[44:47]
    ds_read_b64_tr_b16 a[240:241], v13 offset:0
    ds_read_b64_tr_b16 a[242:243], v13 offset:1024
    v_mfma_f32_16x16x32_bf16 v[40:43], a[204:207], a[172:175], v[56:59]
    v_exp_f32 v33, v33
    v_mfma_f32_16x16x32_bf16 v[40:43], a[200:203], a[168:171], v[40:43]
    ds_read_b64_tr_b16 a[244:245], v13 offset:2048
    v_cvt_pk_bf16_f32 v192, v32, v33
    v_mfma_f32_16x16x32_bf16 v[40:43], a[192:195], a[160:163], v[40:43]
    v_exp_f32 v34, v34
    v_mfma_f32_16x16x32_bf16 v[40:43], a[196:199], a[164:167], v[40:43]
    buffer_load_dwordx4 v21, s[8:11], s93 offen offset:3072 nt lds
    v_mfma_f32_16x16x32_bf16 v[44:47], a[196:199], a[180:183], v[44:47]
    s_add_u32 s93, s93, 28672
    v_exp_f32 v35, v35
    v_mfma_f32_16x16x32_bf16 v[44:47], a[192:195], a[176:179], v[44:47]
    ds_read_b64_tr_b16 a[246:247], v13 offset:3072
    v_cvt_pk_bf16_f32 v193, v34, v35
    v_mfma_f32_16x16x32_bf16 a[0:3], a[224:227], v[128:131], a[0:3]
    v_exp_f32 v36, v36
    v_mfma_f32_16x16x32_bf16 a[0:3], a[228:231], v[132:135], a[0:3]
    ds_read_b64_tr_b16 a[248:249], v13 offset:4096
    ds_read_b64_tr_b16 a[250:251], v13 offset:5120
    v_mfma_f32_16x16x32_bf16 a[0:3], a[232:235], v[136:139], a[0:3]
    v_exp_f32 v37, v37
    v_mfma_f32_16x16x32_bf16 a[0:3], a[236:239], v[140:143], a[0:3]
    ds_read_b64_tr_b16 a[252:253], v13 offset:6144
    v_cvt_pk_bf16_f32 v208, v36, v37
    v_mfma_f32_16x16x32_bf16 a[4:7], a[236:239], v[156:159], a[4:7]
    s_add_u32 m0, s91, 0
    v_exp_f32 v38, v38
    v_mfma_f32_16x16x32_bf16 a[4:7], a[232:235], v[152:155], a[4:7]
    buffer_load_dwordx4 v20, s[4:7], s92 offen offset:0 nt lds
    v_mfma_f32_16x16x32_bf16 a[4:7], a[228:231], v[148:151], a[4:7]
    v_exp_f32 v39, v39
    v_mfma_f32_16x16x32_bf16 a[4:7], a[224:227], v[144:147], a[4:7]
    ds_read_b64_tr_b16 a[254:255], v13 offset:7168
    v_cvt_pk_bf16_f32 v209, v38, v39
    v_mfma_f32_16x16x32_bf16 a[8:11], a[224:227], v[160:163], a[8:11]
    v_exp_f32 v40, v40
    v_mfma_f32_16x16x32_bf16 a[8:11], a[228:231], v[164:167], a[8:11]
    buffer_load_dwordx4 v20, s[4:7], s92 offen offset:1024 nt lds
    v_mfma_f32_16x16x32_bf16 a[8:11], a[232:235], v[168:171], a[8:11]
    v_exp_f32 v41, v41
    v_mfma_f32_16x16x32_bf16 a[8:11], a[236:239], v[172:175], a[8:11]
    v_cvt_pk_bf16_f32 v224, v40, v41
    v_mfma_f32_16x16x32_bf16 a[12:15], a[236:239], v[188:191], a[12:15]
    v_exp_f32 v42, v42
    v_mfma_f32_16x16x32_bf16 a[12:15], a[232:235], v[184:187], a[12:15]
    buffer_load_dwordx4 v20, s[4:7], s92 offen offset:2048 nt lds
    v_mfma_f32_16x16x32_bf16 a[12:15], a[228:231], v[180:183], a[12:15]
    v_exp_f32 v43, v43
    v_mfma_f32_16x16x32_bf16 a[12:15], a[224:227], v[176:179], a[12:15]
    v_cvt_pk_bf16_f32 v225, v42, v43
    v_smfmac_f32_16x16x64_bf16 v[64:67], v[4:7], v[128:135], v22
    s_waitcnt lgkmcnt(0)
    buffer_load_dwordx4 v20, s[4:7], s92 offen offset:3072 nt lds
    s_add_u32 s92, s92, 4096
    v_mfma_f32_16x16x32_bf16 v[36:39], a[208:211], a[144:147], v[52:55]
    v_exp_f32 v44, v44
    v_mfma_f32_16x16x32_bf16 v[36:39], a[212:215], a[148:151], v[36:39]
    ds_read_b128 a[192:195], v8 offset:34816
    ds_read_b128 a[196:199], v9 offset:34816
    v_mfma_f32_16x16x32_bf16 v[32:35], a[212:215], a[132:135], v[48:51]
    v_exp_f32 v45, v45
    v_mfma_f32_16x16x32_bf16 v[32:35], a[208:211], a[128:131], v[32:35]
    ds_read_b128 a[200:203], v10 offset:34816
    v_cvt_pk_bf16_f32 v240, v44, v45
    v_mfma_f32_16x16x32_bf16 v[32:35], a[216:219], a[136:139], v[32:35]
    s_add_u32 m0, s91, 4096
    v_exp_f32 v46, v46
    v_mfma_f32_16x16x32_bf16 v[32:35], a[220:223], a[140:143], v[32:35]
    buffer_load_dwordx4 v20, s[4:7], s92 offen offset:0 nt lds
    v_mfma_f32_16x16x32_bf16 v[36:39], a[220:223], a[156:159], v[36:39]
    v_exp_f32 v47, v47
    v_mfma_f32_16x16x32_bf16 v[36:39], a[216:219], a[152:155], v[36:39]
    ds_read_b128 a[204:207], v11 offset:34816
    v_cvt_pk_bf16_f32 v241, v46, v47
    v_mfma_f32_16x16x32_bf16 v[44:47], a[216:219], a[184:187], v[60:63]
    v_exp_f32 v32, v32
    v_mfma_f32_16x16x32_bf16 v[44:47], a[220:223], a[188:191], v[44:47]
    ds_read_b64_tr_b16 a[224:225], v14 offset:0
    ds_read_b64_tr_b16 a[226:227], v14 offset:1024
    v_mfma_f32_16x16x32_bf16 v[40:43], a[220:223], a[172:175], v[56:59]
    v_exp_f32 v33, v33
    v_mfma_f32_16x16x32_bf16 v[40:43], a[216:219], a[168:171], v[40:43]
    ds_read_b64_tr_b16 a[228:229], v14 offset:2048
    v_cvt_pk_bf16_f32 v194, v32, v33
    v_mfma_f32_16x16x32_bf16 v[40:43], a[208:211], a[160:163], v[40:43]
    v_exp_f32 v34, v34
    v_mfma_f32_16x16x32_bf16 v[40:43], a[212:215], a[164:167], v[40:43]
    buffer_load_dwordx4 v20, s[4:7], s92 offen offset:1024 nt lds
    v_mfma_f32_16x16x32_bf16 v[44:47], a[212:215], a[180:183], v[44:47]
    v_exp_f32 v35, v35
    v_mfma_f32_16x16x32_bf16 v[44:47], a[208:211], a[176:179], v[44:47]
    ds_read_b64_tr_b16 a[230:231], v14 offset:3072
    v_cvt_pk_bf16_f32 v195, v34, v35
    v_mfma_f32_16x16x32_bf16 a[16:19], a[240:243], v[128:131], a[16:19]
    v_exp_f32 v36, v36
    v_mfma_f32_16x16x32_bf16 a[16:19], a[244:247], v[132:135], a[16:19]
    ds_read_b64_tr_b16 a[232:233], v14 offset:4096
    ds_read_b64_tr_b16 a[234:235], v14 offset:5120
    v_mfma_f32_16x16x32_bf16 a[16:19], a[248:251], v[136:139], a[16:19]
    v_exp_f32 v37, v37
    v_mfma_f32_16x16x32_bf16 a[16:19], a[252:255], v[140:143], a[16:19]
    ds_read_b64_tr_b16 a[236:237], v14 offset:6144
    v_cvt_pk_bf16_f32 v210, v36, v37
    v_mfma_f32_16x16x32_bf16 a[20:23], a[252:255], v[156:159], a[20:23]
    v_exp_f32 v38, v38
    v_mfma_f32_16x16x32_bf16 a[20:23], a[248:251], v[152:155], a[20:23]
    buffer_load_dwordx4 v20, s[4:7], s92 offen offset:2048 nt lds
    v_mfma_f32_16x16x32_bf16 a[20:23], a[244:247], v[148:151], a[20:23]
    v_exp_f32 v39, v39
    v_mfma_f32_16x16x32_bf16 a[20:23], a[240:243], v[144:147], a[20:23]
    ds_read_b64_tr_b16 a[238:239], v14 offset:7168
    v_cvt_pk_bf16_f32 v211, v38, v39
    v_mfma_f32_16x16x32_bf16 a[24:27], a[240:243], v[160:163], a[24:27]
    v_exp_f32 v40, v40
    v_mfma_f32_16x16x32_bf16 a[24:27], a[244:247], v[164:167], a[24:27]
    buffer_load_dwordx4 v20, s[4:7], s92 offen offset:3072 nt lds
    v_mfma_f32_16x16x32_bf16 a[24:27], a[248:251], v[168:171], a[24:27]
    s_add_u32 s92, s92, 28672
    v_exp_f32 v41, v41
    v_mfma_f32_16x16x32_bf16 a[24:27], a[252:255], v[172:175], a[24:27]
    v_cvt_pk_bf16_f32 v226, v40, v41
    v_mfma_f32_16x16x32_bf16 a[28:31], a[252:255], v[188:191], a[28:31]
    v_exp_f32 v42, v42
    v_mfma_f32_16x16x32_bf16 a[28:31], a[248:251], v[184:187], a[28:31]
    v_mfma_f32_16x16x32_bf16 a[28:31], a[244:247], v[180:183], a[28:31]
    v_exp_f32 v43, v43
    v_mfma_f32_16x16x32_bf16 a[28:31], a[240:243], v[176:179], a[28:31]
    v_cvt_pk_bf16_f32 v227, v42, v43
    v_smfmac_f32_16x16x64_bf16 v[68:71], v[4:7], v[144:151], v22
    s_waitcnt lgkmcnt(0)
    v_mfma_f32_16x16x32_bf16 v[36:39], a[192:195], a[144:147], v[52:55]
    v_exp_f32 v44, v44
    v_mfma_f32_16x16x32_bf16 v[36:39], a[196:199], a[148:151], v[36:39]
    ds_read_b128 a[208:211], v8 offset:35840
    ds_read_b128 a[212:215], v9 offset:35840
    v_mfma_f32_16x16x32_bf16 v[32:35], a[196:199], a[132:135], v[48:51]
    v_exp_f32 v45, v45
    v_mfma_f32_16x16x32_bf16 v[32:35], a[192:195], a[128:131], v[32:35]
    ds_read_b128 a[216:219], v10 offset:35840
    v_cvt_pk_bf16_f32 v242, v44, v45
    v_mfma_f32_16x16x32_bf16 v[32:35], a[200:203], a[136:139], v[32:35]
    v_exp_f32 v46, v46
    v_mfma_f32_16x16x32_bf16 v[32:35], a[204:207], a[140:143], v[32:35]
    buffer_load_dword v29, v24, s[40:43], 0 offen sc1
    v_mfma_f32_16x16x32_bf16 v[36:39], a[204:207], a[156:159], v[36:39]
    v_exp_f32 v47, v47
    v_mfma_f32_16x16x32_bf16 v[36:39], a[200:203], a[152:155], v[36:39]
    ds_read_b128 a[220:223], v11 offset:35840
    v_cvt_pk_bf16_f32 v243, v46, v47
    v_mfma_f32_16x16x32_bf16 v[44:47], a[200:203], a[184:187], v[60:63]
    v_exp_f32 v32, v32
    v_mfma_f32_16x16x32_bf16 v[44:47], a[204:207], a[188:191], v[44:47]
    ds_read_b64_tr_b16 a[240:241], v15 offset:0
    ds_read_b64_tr_b16 a[242:243], v15 offset:1024
    v_mfma_f32_16x16x32_bf16 v[40:43], a[204:207], a[172:175], v[56:59]
    v_exp_f32 v33, v33
    v_mfma_f32_16x16x32_bf16 v[40:43], a[200:203], a[168:171], v[40:43]
    ds_read_b64_tr_b16 a[244:245], v15 offset:2048
    v_cvt_pk_bf16_f32 v196, v32, v33
    v_mfma_f32_16x16x32_bf16 v[40:43], a[192:195], a[160:163], v[40:43]
    v_exp_f32 v34, v34
    v_mfma_f32_16x16x32_bf16 v[40:43], a[196:199], a[164:167], v[40:43]
    buffer_store_dword v25, v28, s[32:35], 0 offen offset:128 sc1
    v_mfma_f32_16x16x32_bf16 v[44:47], a[196:199], a[180:183], v[44:47]
    v_exp_f32 v35, v35
    v_mfma_f32_16x16x32_bf16 v[44:47], a[192:195], a[176:179], v[44:47]
    ds_read_b64_tr_b16 a[246:247], v15 offset:3072
    v_cvt_pk_bf16_f32 v197, v34, v35
    v_mfma_f32_16x16x32_bf16 a[32:35], a[224:227], v[128:131], a[32:35]
    v_exp_f32 v36, v36
    v_mfma_f32_16x16x32_bf16 a[32:35], a[228:231], v[132:135], a[32:35]
    ds_read_b64_tr_b16 a[248:249], v15 offset:4096
    ds_read_b64_tr_b16 a[250:251], v15 offset:5120
    v_mfma_f32_16x16x32_bf16 a[32:35], a[232:235], v[136:139], a[32:35]
    v_exp_f32 v37, v37
    v_mfma_f32_16x16x32_bf16 a[32:35], a[236:239], v[140:143], a[32:35]
    ds_read_b64_tr_b16 a[252:253], v15 offset:6144
    v_cvt_pk_bf16_f32 v212, v36, v37
    v_mfma_f32_16x16x32_bf16 a[36:39], a[236:239], v[156:159], a[36:39]
    v_exp_f32 v38, v38
    v_mfma_f32_16x16x32_bf16 a[36:39], a[232:235], v[152:155], a[36:39]
    v_mfma_f32_16x16x32_bf16 a[36:39], a[228:231], v[148:151], a[36:39]
    v_exp_f32 v39, v39
    v_mfma_f32_16x16x32_bf16 a[36:39], a[224:227], v[144:147], a[36:39]
    ds_read_b64_tr_b16 a[254:255], v15 offset:7168
    v_cvt_pk_bf16_f32 v213, v38, v39
    v_mfma_f32_16x16x32_bf16 a[40:43], a[224:227], v[160:163], a[40:43]
    v_exp_f32 v40, v40
    v_mfma_f32_16x16x32_bf16 a[40:43], a[228:231], v[164:167], a[40:43]
    v_mfma_f32_16x16x32_bf16 a[40:43], a[232:235], v[168:171], a[40:43]
    v_exp_f32 v41, v41
    v_mfma_f32_16x16x32_bf16 a[40:43], a[236:239], v[172:175], a[40:43]
    v_cvt_pk_bf16_f32 v228, v40, v41
    v_mfma_f32_16x16x32_bf16 a[44:47], a[236:239], v[188:191], a[44:47]
    v_exp_f32 v42, v42
    v_mfma_f32_16x16x32_bf16 a[44:47], a[232:235], v[184:187], a[44:47]
    v_mfma_f32_16x16x32_bf16 a[44:47], a[228:231], v[180:183], a[44:47]
    v_exp_f32 v43, v43
    v_mfma_f32_16x16x32_bf16 a[44:47], a[224:227], v[176:179], a[44:47]
    v_cvt_pk_bf16_f32 v229, v42, v43
    v_smfmac_f32_16x16x64_bf16 v[72:75], v[4:7], v[160:167], v22
    s_waitcnt lgkmcnt(0)
    v_mfma_f32_16x16x32_bf16 v[36:39], a[208:211], a[144:147], v[52:55]
    v_exp_f32 v44, v44
    v_mfma_f32_16x16x32_bf16 v[36:39], a[212:215], a[148:151], v[36:39]
    ds_read_b128 a[192:195], v8 offset:36864
    ds_read_b128 a[196:199], v9 offset:36864
    v_mfma_f32_16x16x32_bf16 v[32:35], a[212:215], a[132:135], v[48:51]
    v_exp_f32 v45, v45
    v_mfma_f32_16x16x32_bf16 v[32:35], a[208:211], a[128:131], v[32:35]
    ds_read_b128 a[200:203], v10 offset:36864
    v_cvt_pk_bf16_f32 v244, v44, v45
    v_mfma_f32_16x16x32_bf16 v[32:35], a[216:219], a[136:139], v[32:35]
    v_exp_f32 v46, v46
    v_mfma_f32_16x16x32_bf16 v[32:35], a[220:223], a[140:143], v[32:35]
    v_mfma_f32_16x16x32_bf16 v[36:39], a[220:223], a[156:159], v[36:39]
    v_exp_f32 v47, v47
    v_mfma_f32_16x16x32_bf16 v[36:39], a[216:219], a[152:155], v[36:39]
    ds_read_b128 a[204:207], v11 offset:36864
    v_cvt_pk_bf16_f32 v245, v46, v47
    v_mfma_f32_16x16x32_bf16 v[44:47], a[216:219], a[184:187], v[60:63]
    v_exp_f32 v32, v32
    v_mfma_f32_16x16x32_bf16 v[44:47], a[220:223], a[188:191], v[44:47]
    ds_read_b64_tr_b16 a[224:225], v16 offset:0
    ds_read_b64_tr_b16 a[226:227], v16 offset:1024
    v_mfma_f32_16x16x32_bf16 v[40:43], a[220:223], a[172:175], v[56:59]
    v_exp_f32 v33, v33
    v_mfma_f32_16x16x32_bf16 v[40:43], a[216:219], a[168:171], v[40:43]
    ds_read_b64_tr_b16 a[228:229], v16 offset:2048
    v_cvt_pk_bf16_f32 v198, v32, v33
    v_mfma_f32_16x16x32_bf16 v[40:43], a[208:211], a[160:163], v[40:43]
    v_exp_f32 v34, v34
    v_mfma_f32_16x16x32_bf16 v[40:43], a[212:215], a[164:167], v[40:43]
    v_mfma_f32_16x16x32_bf16 v[44:47], a[212:215], a[180:183], v[44:47]
    v_exp_f32 v35, v35
    v_mfma_f32_16x16x32_bf16 v[44:47], a[208:211], a[176:179], v[44:47]
    ds_read_b64_tr_b16 a[230:231], v16 offset:3072
    v_cvt_pk_bf16_f32 v199, v34, v35
    v_mfma_f32_16x16x32_bf16 a[48:51], a[240:243], v[128:131], a[48:51]
    v_exp_f32 v36, v36
    v_mfma_f32_16x16x32_bf16 a[48:51], a[244:247], v[132:135], a[48:51]
    ds_read_b64_tr_b16 a[232:233], v16 offset:4096
    ds_read_b64_tr_b16 a[234:235], v16 offset:5120
    v_mfma_f32_16x16x32_bf16 a[48:51], a[248:251], v[136:139], a[48:51]
    v_exp_f32 v37, v37
    v_mfma_f32_16x16x32_bf16 a[48:51], a[252:255], v[140:143], a[48:51]
    ds_read_b64_tr_b16 a[236:237], v16 offset:6144
    v_cvt_pk_bf16_f32 v214, v36, v37
    v_mfma_f32_16x16x32_bf16 a[52:55], a[252:255], v[156:159], a[52:55]
    v_exp_f32 v38, v38
    v_mfma_f32_16x16x32_bf16 a[52:55], a[248:251], v[152:155], a[52:55]
    v_mfma_f32_16x16x32_bf16 a[52:55], a[244:247], v[148:151], a[52:55]
    v_exp_f32 v39, v39
    v_mfma_f32_16x16x32_bf16 a[52:55], a[240:243], v[144:147], a[52:55]
    ds_read_b64_tr_b16 a[238:239], v16 offset:7168
    v_cvt_pk_bf16_f32 v215, v38, v39
    v_mfma_f32_16x16x32_bf16 a[56:59], a[240:243], v[160:163], a[56:59]
    s_waitcnt vmcnt(1)
    v_exp_f32 v40, v40
    v_mfma_f32_16x16x32_bf16 a[56:59], a[244:247], v[164:167], a[56:59]
    v_cmp_gt_u32 vcc, 64, v29
    v_mfma_f32_16x16x32_bf16 a[56:59], a[248:251], v[168:171], a[56:59]
    v_exp_f32 v41, v41
    v_mfma_f32_16x16x32_bf16 a[56:59], a[252:255], v[172:175], a[56:59]
    v_cvt_pk_bf16_f32 v230, v40, v41
    v_mfma_f32_16x16x32_bf16 a[60:63], a[252:255], v[188:191], a[60:63]
    s_cbranch_vccnz K2_SPIN0
K2_BACK0:
    v_exp_f32 v42, v42
    v_mfma_f32_16x16x32_bf16 a[60:63], a[248:251], v[184:187], a[60:63]
    v_mfma_f32_16x16x32_bf16 a[60:63], a[244:247], v[180:183], a[60:63]
    s_mov_b32 s30, s51
    v_exp_f32 v43, v43
    v_mfma_f32_16x16x32_bf16 a[60:63], a[240:243], v[176:179], a[60:63]
    v_cvt_pk_bf16_f32 v231, v42, v43
    v_smfmac_f32_16x16x64_bf16 v[76:79], v[4:7], v[176:183], v22
    s_waitcnt lgkmcnt(0)
    v_mfma_f32_16x16x32_bf16 v[36:39], a[192:195], a[144:147], v[52:55]
    v_exp_f32 v44, v44
    v_mfma_f32_16x16x32_bf16 v[36:39], a[196:199], a[148:151], v[36:39]
    ds_read_b128 a[208:211], v8 offset:37888
    ds_read_b128 a[212:215], v9 offset:37888
    v_mfma_f32_16x16x32_bf16 v[32:35], a[196:199], a[132:135], v[48:51]
    v_exp_f32 v45, v45
    v_mfma_f32_16x16x32_bf16 v[32:35], a[192:195], a[128:131], v[32:35]
    ds_read_b128 a[216:219], v10 offset:37888
    v_cvt_pk_bf16_f32 v246, v44, v45
    v_mfma_f32_16x16x32_bf16 v[32:35], a[200:203], a[136:139], v[32:35]
    v_exp_f32 v46, v46
    v_mfma_f32_16x16x32_bf16 v[32:35], a[204:207], a[140:143], v[32:35]
    buffer_load_dword v0, v30, s[28:31], s44 offen sc1
    v_mfma_f32_16x16x32_bf16 v[36:39], a[204:207], a[156:159], v[36:39]
    s_add_u32 s44, s44, s45
    v_exp_f32 v47, v47
    v_mfma_f32_16x16x32_bf16 v[36:39], a[200:203], a[152:155], v[36:39]
    ds_read_b128 a[220:223], v11 offset:37888
    v_cvt_pk_bf16_f32 v247, v46, v47
    v_mfma_f32_16x16x32_bf16 v[44:47], a[200:203], a[184:187], v[60:63]
    v_exp_f32 v32, v32
    v_mfma_f32_16x16x32_bf16 v[44:47], a[204:207], a[188:191], v[44:47]
    ds_read_b64_tr_b16 a[240:241], v17 offset:0
    ds_read_b64_tr_b16 a[242:243], v17 offset:1024
    v_mfma_f32_16x16x32_bf16 v[40:43], a[204:207], a[172:175], v[56:59]
    v_exp_f32 v33, v33
    v_mfma_f32_16x16x32_bf16 v[40:43], a[200:203], a[168:171], v[40:43]
    ds_read_b64_tr_b16 a[244:245], v17 offset:2048
    v_cvt_pk_bf16_f32 v200, v32, v33
    v_mfma_f32_16x16x32_bf16 v[40:43], a[192:195], a[160:163], v[40:43]
    v_exp_f32 v34, v34
    v_mfma_f32_16x16x32_bf16 v[40:43], a[196:199], a[164:167], v[40:43]
    v_mfma_f32_16x16x32_bf16 v[44:47], a[196:199], a[180:183], v[44:47]
    v_exp_f32 v35, v35
    v_mfma_f32_16x16x32_bf16 v[44:47], a[192:195], a[176:179], v[44:47]
    ds_read_b64_tr_b16 a[246:247], v17 offset:3072
    v_cvt_pk_bf16_f32 v201, v34, v35
    v_mfma_f32_16x16x32_bf16 a[64:67], a[224:227], v[128:131], a[64:67]
    v_exp_f32 v36, v36
    v_mfma_f32_16x16x32_bf16 a[64:67], a[228:231], v[132:135], a[64:67]
    ds_read_b64_tr_b16 a[248:249], v17 offset:4096
    ds_read_b64_tr_b16 a[250:251], v17 offset:5120
    v_mfma_f32_16x16x32_bf16 a[64:67], a[232:235], v[136:139], a[64:67]
    v_exp_f32 v37, v37
    v_mfma_f32_16x16x32_bf16 a[64:67], a[236:239], v[140:143], a[64:67]
    ds_read_b64_tr_b16 a[252:253], v17 offset:6144
    v_cvt_pk_bf16_f32 v216, v36, v37
    v_mfma_f32_16x16x32_bf16 a[68:71], a[236:239], v[156:159], a[68:71]
    v_exp_f32 v38, v38
    v_mfma_f32_16x16x32_bf16 a[68:71], a[232:235], v[152:155], a[68:71]
    v_mfma_f32_16x16x32_bf16 a[68:71], a[228:231], v[148:151], a[68:71]
    v_exp_f32 v39, v39
    v_mfma_f32_16x16x32_bf16 a[68:71], a[224:227], v[144:147], a[68:71]
    ds_read_b64_tr_b16 a[254:255], v17 offset:7168
    v_cvt_pk_bf16_f32 v217, v38, v39
    v_mfma_f32_16x16x32_bf16 a[72:75], a[224:227], v[160:163], a[72:75]
    v_exp_f32 v40, v40
    v_mfma_f32_16x16x32_bf16 a[72:75], a[228:231], v[164:167], a[72:75]
    v_mfma_f32_16x16x32_bf16 a[72:75], a[232:235], v[168:171], a[72:75]
    v_exp_f32 v41, v41
    v_mfma_f32_16x16x32_bf16 a[72:75], a[236:239], v[172:175], a[72:75]
    v_cvt_pk_bf16_f32 v232, v40, v41
    v_mfma_f32_16x16x32_bf16 a[76:79], a[236:239], v[188:191], a[76:79]
    v_exp_f32 v42, v42
    v_mfma_f32_16x16x32_bf16 a[76:79], a[232:235], v[184:187], a[76:79]
    v_mfma_f32_16x16x32_bf16 a[76:79], a[228:231], v[180:183], a[76:79]
    v_exp_f32 v43, v43
    v_mfma_f32_16x16x32_bf16 a[76:79], a[224:227], v[176:179], a[76:79]
    v_cvt_pk_bf16_f32 v233, v42, v43
    v_smfmac_f32_16x16x64_bf16 v[64:67], v[4:7], v[136:143], v22
    s_waitcnt lgkmcnt(0)
    v_mfma_f32_16x16x32_bf16 v[36:39], a[208:211], a[144:147], v[52:55]
    v_exp_f32 v44, v44
    v_mfma_f32_16x16x32_bf16 v[36:39], a[212:215], a[148:151], v[36:39]
    ds_read_b128 a[192:195], v8 offset:38912
    ds_read_b128 a[196:199], v9 offset:38912
    v_mfma_f32_16x16x32_bf16 v[32:35], a[212:215], a[132:135], v[48:51]
    s_mov_b32 s16, s20
    v_exp_f32 v45, v45
    v_mfma_f32_16x16x32_bf16 v[32:35], a[208:211], a[128:131], v[32:35]
    ds_read_b128 a[200:203], v10 offset:38912
    v_cvt_pk_bf16_f32 v248, v44, v45
    v_mfma_f32_16x16x32_bf16 v[32:35], a[216:219], a[136:139], v[32:35]
    s_mov_b32 s17, s21
    v_exp_f32 v46, v46
    v_mfma_f32_16x16x32_bf16 v[32:35], a[220:223], a[140:143], v[32:35]
    v_mfma_f32_16x16x32_bf16 v[36:39], a[220:223], a[156:159], v[36:39]
    s_mov_b32 s18, 0
    v_exp_f32 v47, v47
    v_mfma_f32_16x16x32_bf16 v[36:39], a[216:219], a[152:155], v[36:39]
    ds_read_b128 a[204:207], v11 offset:38912
    v_cvt_pk_bf16_f32 v249, v46, v47
    v_mfma_f32_16x16x32_bf16 v[44:47], a[216:219], a[184:187], v[60:63]
    s_mov_b32 s46, -294912
    v_exp_f32 v32, v32
    v_mfma_f32_16x16x32_bf16 v[44:47], a[220:223], a[188:191], v[44:47]
    ds_read_b64_tr_b16 a[224:225], v18 offset:0
    ds_read_b64_tr_b16 a[226:227], v18 offset:1024
    v_mfma_f32_16x16x32_bf16 v[40:43], a[220:223], a[172:175], v[56:59]
    s_andn2_b32 s47, s48, 32767
    v_exp_f32 v33, v33
    v_mfma_f32_16x16x32_bf16 v[40:43], a[216:219], a[168:171], v[40:43]
    ds_read_b64_tr_b16 a[228:229], v18 offset:2048
    v_cvt_pk_bf16_f32 v202, v32, v33
    v_mfma_f32_16x16x32_bf16 v[40:43], a[208:211], a[160:163], v[40:43]
    v_exp_f32 v34, v34
    v_mfma_f32_16x16x32_bf16 v[40:43], a[212:215], a[164:167], v[40:43]
    v_and_b32 v24, 31, v2
    v_mfma_f32_16x16x32_bf16 v[44:47], a[212:215], a[180:183], v[44:47]
    s_add_u32 s40, s20, s50
    s_addc_u32 s41, s21, 0
    v_exp_f32 v35, v35
    v_mfma_f32_16x16x32_bf16 v[44:47], a[208:211], a[176:179], v[44:47]
    ds_read_b64_tr_b16 a[230:231], v18 offset:3072
    v_cvt_pk_bf16_f32 v203, v34, v35
    v_mfma_f32_16x16x32_bf16 a[80:83], a[240:243], v[128:131], a[80:83]
    v_exp_f32 v36, v36
    v_mfma_f32_16x16x32_bf16 a[80:83], a[244:247], v[132:135], a[80:83]
    ds_read_b64_tr_b16 a[232:233], v18 offset:4096
    ds_read_b64_tr_b16 a[234:235], v18 offset:5120
    v_mfma_f32_16x16x32_bf16 a[80:83], a[248:251], v[136:139], a[80:83]
    v_exp_f32 v37, v37
    v_mfma_f32_16x16x32_bf16 a[80:83], a[252:255], v[140:143], a[80:83]
    ds_read_b64_tr_b16 a[236:237], v18 offset:6144
    v_cvt_pk_bf16_f32 v218, v36, v37
    v_mfma_f32_16x16x32_bf16 a[84:87], a[252:255], v[156:159], a[84:87]
    v_exp_f32 v38, v38
    v_mfma_f32_16x16x32_bf16 a[84:87], a[248:251], v[152:155], a[84:87]
    v_lshlrev_b32 v24, 9, v24
    v_mfma_f32_16x16x32_bf16 a[84:87], a[244:247], v[148:151], a[84:87]
    v_exp_f32 v39, v39
    v_mfma_f32_16x16x32_bf16 a[84:87], a[240:243], v[144:147], a[84:87]
    ds_read_b64_tr_b16 a[238:239], v18 offset:7168
    v_cvt_pk_bf16_f32 v219, v38, v39
    v_mfma_f32_16x16x32_bf16 a[88:91], a[240:243], v[160:163], a[88:91]
    v_exp_f32 v40, v40
    v_mfma_f32_16x16x32_bf16 a[88:91], a[244:247], v[164:167], a[88:91]
    v_mfma_f32_16x16x32_bf16 a[88:91], a[248:251], v[168:171], a[88:91]
    v_exp_f32 v41, v41
    v_mfma_f32_16x16x32_bf16 a[88:91], a[252:255], v[172:175], a[88:91]
    v_cvt_pk_bf16_f32 v234, v40, v41
    v_mfma_f32_16x16x32_bf16 a[92:95], a[252:255], v[188:191], a[92:95]
    v_exp_f32 v42, v42
    v_mfma_f32_16x16x32_bf16 a[92:95], a[248:251], v[184:187], a[92:95]
    v_mfma_f32_16x16x32_bf16 a[92:95], a[244:247], v[180:183], a[92:95]
    v_exp_f32 v43, v43
    v_mfma_f32_16x16x32_bf16 a[92:95], a[240:243], v[176:179], a[92:95]
    v_cvt_pk_bf16_f32 v235, v42, v43
    v_smfmac_f32_16x16x64_bf16 v[68:71], v[4:7], v[152:159], v22
    s_waitcnt lgkmcnt(0)
    v_mfma_f32_16x16x32_bf16 v[36:39], a[192:195], a[144:147], v[52:55]
    v_exp_f32 v44, v44
    v_mfma_f32_16x16x32_bf16 v[36:39], a[196:199], a[148:151], v[36:39]
    ds_read_b128 a[208:211], v8 offset:39936
    buffer_load_dwordx4 v[96:99], v23, s[20:23], s99 offen
    v_mfma_f32_16x16x32_bf16 v[32:35], a[196:199], a[132:135], v[48:51]
    v_exp_f32 v45, v45
    v_mfma_f32_16x16x32_bf16 v[32:35], a[192:195], a[128:131], v[32:35]
    ds_read_b128 a[212:215], v9 offset:39936
    v_cvt_pk_bf16_f32 v250, v44, v45
    v_mfma_f32_16x16x32_bf16 v[32:35], a[200:203], a[136:139], v[32:35]
    v_exp_f32 v46, v46
    v_mfma_f32_16x16x32_bf16 v[32:35], a[204:207], a[140:143], v[32:35]
    ds_read_b128 a[216:219], v10 offset:39936
    buffer_load_dwordx4 v[104:107], v23, s[20:23], s100 offen
    v_mfma_f32_16x16x32_bf16 v[36:39], a[204:207], a[156:159], v[36:39]
    v_exp_f32 v47, v47
    v_mfma_f32_16x16x32_bf16 v[36:39], a[200:203], a[152:155], v[36:39]
    ds_read_b128 a[220:223], v11 offset:39936
    v_cvt_pk_bf16_f32 v251, v46, v47
    v_mfma_f32_16x16x32_bf16 v[44:47], a[200:203], a[184:187], v[60:63]
    v_exp_f32 v32, v32
    v_mfma_f32_16x16x32_bf16 v[44:47], a[204:207], a[188:191], v[44:47]
    ds_read_b64_tr_b16 a[240:241], v19 offset:0
    buffer_load_dwordx4 v[100:103], v23, s[20:23], s99 offen offset:1024
    v_mfma_f32_16x16x32_bf16 v[40:43], a[204:207], a[172:175], v[56:59]
    v_exp_f32 v33, v33
    v_mfma_f32_16x16x32_bf16 v[40:43], a[200:203], a[168:171], v[40:43]
    ds_read_b64_tr_b16 a[242:243], v19 offset:1024
    v_cvt_pk_bf16_f32 v204, v32, v33
    v_mfma_f32_16x16x32_bf16 v[40:43], a[192:195], a[160:163], v[40:43]
    v_exp_f32 v34, v34
    v_mfma_f32_16x16x32_bf16 v[40:43], a[196:199], a[164:167], v[40:43]
    ds_read_b64_tr_b16 a[244:245], v19 offset:2048
    buffer_load_dwordx4 v[108:111], v23, s[20:23], s100 offen offset:1024
    v_mfma_f32_16x16x32_bf16 v[44:47], a[196:199], a[180:183], v[44:47]
    s_add_u32 s99, s99, 4096
    v_exp_f32 v35, v35
    v_mfma_f32_16x16x32_bf16 v[44:47], a[192:195], a[176:179], v[44:47]
    s_add_u32 s100, s100, 2048
    ds_read_b64_tr_b16 a[246:247], v19 offset:3072
    v_cvt_pk_bf16_f32 v205, v34, v35
    v_mfma_f32_16x16x32_bf16 a[96:99], a[224:227], v[128:131], a[96:99]
    v_exp_f32 v36, v36
    v_mfma_f32_16x16x32_bf16 a[96:99], a[228:231], v[132:135], a[96:99]
    ds_read_b64_tr_b16 a[248:249], v19 offset:4096
    ds_read_b64_tr_b16 a[250:251], v19 offset:5120
    v_mfma_f32_16x16x32_bf16 a[96:99], a[232:235], v[136:139], a[96:99]
    v_exp_f32 v37, v37
    v_mfma_f32_16x16x32_bf16 a[96:99], a[236:239], v[140:143], a[96:99]
    ds_read_b64_tr_b16 a[252:253], v19 offset:6144
    v_cvt_pk_bf16_f32 v220, v36, v37
    v_mfma_f32_16x16x32_bf16 a[100:103], a[236:239], v[156:159], a[100:103]
    v_exp_f32 v38, v38
    v_mfma_f32_16x16x32_bf16 a[100:103], a[232:235], v[152:155], a[100:103]
    v_mfma_f32_16x16x32_bf16 a[100:103], a[228:231], v[148:151], a[100:103]
    v_exp_f32 v39, v39
    v_mfma_f32_16x16x32_bf16 a[100:103], a[224:227], v[144:147], a[100:103]
    ds_read_b64_tr_b16 a[254:255], v19 offset:7168
    v_cvt_pk_bf16_f32 v221, v38, v39
    v_mfma_f32_16x16x32_bf16 a[104:107], a[224:227], v[160:163], a[104:107]
    v_exp_f32 v40, v40
    v_mfma_f32_16x16x32_bf16 a[104:107], a[228:231], v[164:167], a[104:107]
    v_mfma_f32_16x16x32_bf16 a[104:107], a[232:235], v[168:171], a[104:107]
    v_exp_f32 v41, v41
    v_mfma_f32_16x16x32_bf16 a[104:107], a[236:239], v[172:175], a[104:107]
    v_cvt_pk_bf16_f32 v236, v40, v41
    v_mfma_f32_16x16x32_bf16 a[108:111], a[236:239], v[188:191], a[108:111]
    v_exp_f32 v42, v42
    v_mfma_f32_16x16x32_bf16 a[108:111], a[232:235], v[184:187], a[108:111]
    v_mfma_f32_16x16x32_bf16 a[108:111], a[228:231], v[180:183], a[108:111]
    v_exp_f32 v43, v43
    v_mfma_f32_16x16x32_bf16 a[108:111], a[224:227], v[176:179], a[108:111]
    v_cvt_pk_bf16_f32 v237, v42, v43
    v_smfmac_f32_16x16x64_bf16 v[72:75], v[4:7], v[168:175], v22
    s_waitcnt lgkmcnt(0)
    v_mfma_f32_16x16x32_bf16 v[36:39], a[208:211], a[144:147], v[52:55]
    s_waitcnt vmcnt(7)
    s_barrier
    v_exp_f32 v44, v44
    v_mfma_f32_16x16x32_bf16 v[36:39], a[212:215], a[148:151], v[36:39]
    ds_read_b128 a[192:195], v8 offset:0
    ds_read_b128 a[196:199], v9 offset:0
    v_mfma_f32_16x16x32_bf16 v[32:35], a[212:215], a[132:135], v[48:51]
    v_exp_f32 v45, v45
    v_mfma_f32_16x16x32_bf16 v[32:35], a[208:211], a[128:131], v[32:35]
    ds_read_b128 a[200:203], v10 offset:0
    v_cvt_pk_bf16_f32 v252, v44, v45
    v_mfma_f32_16x16x32_bf16 v[32:35], a[216:219], a[136:139], v[32:35]
    s_add_u32 m0, s91, 65536
    v_exp_f32 v46, v46
    v_mfma_f32_16x16x32_bf16 v[32:35], a[220:223], a[140:143], v[32:35]
    buffer_load_dwordx4 v21, s[8:11], s93 offen offset:0 nt lds
    v_mfma_f32_16x16x32_bf16 v[36:39], a[220:223], a[156:159], v[36:39]
    v_exp_f32 v47, v47
    v_mfma_f32_16x16x32_bf16 v[36:39], a[216:219], a[152:155], v[36:39]
    ds_read_b128 a[204:207], v11 offset:0
    v_cvt_pk_bf16_f32 v253, v46, v47
    v_mfma_f32_16x16x32_bf16 v[44:47], a[216:219], a[184:187], v[60:63]
    v_exp_f32 v32, v32
    v_mfma_f32_16x16x32_bf16 v[44:47], a[220:223], a[188:191], v[44:47]
    ds_read_b64_tr_b16 a[224:225], v12 offset:32768
    ds_read_b64_tr_b16 a[226:227], v12 offset:33792
    v_mfma_f32_16x16x32_bf16 v[40:43], a[220:223], a[172:175], v[56:59]
    v_exp_f32 v33, v33
    v_mfma_f32_16x16x32_bf16 v[40:43], a[216:219], a[168:171], v[40:43]
    ds_read_b64_tr_b16 a[228:229], v12 offset:34816
    v_cvt_pk_bf16_f32 v206, v32, v33
    v_mfma_f32_16x16x32_bf16 v[40:43], a[208:211], a[160:163], v[40:43]
    v_exp_f32 v34, v34
    v_mfma_f32_16x16x32_bf16 v[40:43], a[212:215], a[164:167], v[40:43]
    buffer_load_dwordx4 v21, s[8:11], s93 offen offset:1024 nt lds
    v_mfma_f32_16x16x32_bf16 v[44:47], a[212:215], a[180:183], v[44:47]
    v_exp_f32 v35, v35
    v_mfma_f32_16x16x32_bf16 v[44:47], a[208:211], a[176:179], v[44:47]
    ds_read_b64_tr_b16 a[230:231], v12 offset:35840
    v_cvt_pk_bf16_f32 v207, v34, v35
    v_mfma_f32_16x16x32_bf16 a[112:115], a[240:243], v[128:131], a[112:115]
    v_exp_f32 v36, v36
    v_mfma_f32_16x16x32_bf16 a[112:115], a[244:247], v[132:135], a[112:115]
    ds_read_b64_tr_b16 a[232:233], v12 offset:36864
    ds_read_b64_tr_b16 a[234:235], v12 offset:37888
    v_mfma_f32_16x16x32_bf16 a[112:115], a[248:251], v[136:139], a[112:115]
    v_exp_f32 v37, v37
    v_mfma_f32_16x16x32_bf16 a[112:115], a[252:255], v[140:143], a[112:115]
    ds_read_b64_tr_b16 a[236:237], v12 offset:38912
    v_cvt_pk_bf16_f32 v222, v36, v37
    v_mfma_f32_16x16x32_bf16 a[116:119], a[252:255], v[156:159], a[116:119]
    v_exp_f32 v38, v38
    v_mfma_f32_16x16x32_bf16 a[116:119], a[248:251], v[152:155], a[116:119]
    buffer_load_dwordx4 v21, s[8:11], s93 offen offset:2048 nt lds
    v_mfma_f32_16x16x32_bf16 a[116:119], a[244:247], v[148:151], a[116:119]
    v_exp_f32 v39, v39
    v_mfma_f32_16x16x32_bf16 a[116:119], a[240:243], v[144:147], a[116:119]
    ds_read_b64_tr_b16 a[238:239], v12 offset:39936
    v_cvt_pk_bf16_f32 v223, v38, v39
    v_mfma_f32_16x16x32_bf16 a[120:123], a[240:243], v[160:163], a[120:123]
    v_exp_f32 v40, v40
    v_mfma_f32_16x16x32_bf16 a[120:123], a[244:247], v[164:167], a[120:123]
    buffer_load_dwordx4 v21, s[8:11], s93 offen offset:3072 nt lds
    v_mfma_f32_16x16x32_bf16 a[120:123], a[248:251], v[168:171], a[120:123]
    s_add_u32 s93, s93, 4096
    v_exp_f32 v41, v41
    v_mfma_f32_16x16x32_bf16 a[120:123], a[252:255], v[172:175], a[120:123]
    v_cvt_pk_bf16_f32 v238, v40, v41
    v_mfma_f32_16x16x32_bf16 a[124:127], a[252:255], v[188:191], a[124:127]
    s_add_u32 m0, s91, 69632
    v_exp_f32 v42, v42
    v_mfma_f32_16x16x32_bf16 a[124:127], a[248:251], v[184:187], a[124:127]
    buffer_load_dwordx4 v21, s[8:11], s93 offen offset:0 nt lds
    v_mfma_f32_16x16x32_bf16 a[124:127], a[244:247], v[180:183], a[124:127]
    v_exp_f32 v43, v43
    v_mfma_f32_16x16x32_bf16 a[124:127], a[240:243], v[176:179], a[124:127]
    s_mov_b32 s94, 5
    v_cvt_pk_bf16_f32 v239, v42, v43
    v_smfmac_f32_16x16x64_bf16 v[76:79], v[4:7], v[184:191], v22
    s_waitcnt lgkmcnt(0)
    buffer_load_dwordx4 v21, s[8:11], s93 offen offset:1024 nt lds
.p2align 6
K2_LOOP:
    v_mfma_f32_16x16x32_bf16 v[36:39], a[192:195], a[144:147], v[52:55]
    v_exp_f32 v44, v44
    v_mfma_f32_16x16x32_bf16 v[36:39], a[196:199], a[148:151], v[36:39]
    ds_read_b128 a[208:211], v8 offset:1024
    buffer_load_dwordx4 v[112:115], v23, s[20:23], s99 offen
    v_mfma_f32_16x16x32_bf16 v[32:35], a[196:199], a[132:135], v[48:51]
    v_exp_f32 v45, v45
    v_mfma_f32_16x16x32_bf16 v[32:35], a[192:195], a[128:131], v[32:35]
    ds_read_b128 a[212:215], v9 offset:1024
    v_cvt_pk_bf16_f32 v254, v44, v45
    v_mfma_f32_16x16x32_bf16 v[32:35], a[200:203], a[136:139], v[32:35]
    v_exp_f32 v46, v46
    v_mfma_f32_16x16x32_bf16 v[32:35], a[204:207], a[140:143], v[32:35]
    ds_read_b128 a[216:219], v10 offset:1024
    buffer_load_dwordx4 v[120:123], v23, s[20:23], s100 offen
    v_mfma_f32_16x16x32_bf16 v[36:39], a[204:207], a[156:159], v[36:39]
    v_exp_f32 v47, v47
    v_mfma_f32_16x16x32_bf16 v[36:39], a[200:203], a[152:155], v[36:39]
    ds_read_b128 a[220:223], v11 offset:1024
    v_cvt_pk_bf16_f32 v255, v46, v47
    v_mfma_f32_16x16x32_bf16 v[44:47], a[200:203], a[184:187], v[60:63]
    v_exp_f32 v32, v32
    v_mfma_f32_16x16x32_bf16 v[44:47], a[204:207], a[188:191], v[44:47]
    ds_read_b64_tr_b16 a[240:241], v13 offset:32768
    buffer_load_dwordx4 v[116:119], v23, s[20:23], s99 offen offset:1024
    v_mfma_f32_16x16x32_bf16 v[40:43], a[204:207], a[172:175], v[56:59]
    v_exp_f32 v33, v33
    v_mfma_f32_16x16x32_bf16 v[40:43], a[200:203], a[168:171], v[40:43]
    ds_read_b64_tr_b16 a[242:243], v13 offset:33792
    v_cvt_pk_bf16_f32 v128, v32, v33
    v_mfma_f32_16x16x32_bf16 v[40:43], a[192:195], a[160:163], v[40:43]
    v_exp_f32 v34, v34
    v_mfma_f32_16x16x32_bf16 v[40:43], a[196:199], a[164:167], v[40:43]
    ds_read_b64_tr_b16 a[244:245], v13 offset:34816
    buffer_load_dwordx4 v[124:127], v23, s[20:23], s100 offen offset:1024
    v_mfma_f32_16x16x32_bf16 v[44:47], a[196:199], a[180:183], v[44:47]
    s_add_u32 s99, s99, 4096
    v_exp_f32 v35, v35
    v_mfma_f32_16x16x32_bf16 v[44:47], a[192:195], a[176:179], v[44:47]
    s_add_u32 s100, s100, 2048
    ds_read_b64_tr_b16 a[246:247], v13 offset:35840
    v_cvt_pk_bf16_f32 v129, v34, v35
    v_mfma_f32_16x16x32_bf16 a[0:3], a[224:227], v[192:195], a[0:3]
    v_exp_f32 v36, v36
    v_mfma_f32_16x16x32_bf16 a[0:3], a[228:231], v[196:199], a[0:3]
    ds_read_b64_tr_b16 a[248:249], v13 offset:36864
    ds_read_b64_tr_b16 a[250:251], v13 offset:37888
    v_mfma_f32_16x16x32_bf16 a[0:3], a[232:235], v[200:203], a[0:3]
    v_exp_f32 v37, v37
    v_mfma_f32_16x16x32_bf16 a[0:3], a[236:239], v[204:207], a[0:3]
    ds_read_b64_tr_b16 a[252:253], v13 offset:38912
    v_cvt_pk_bf16_f32 v144, v36, v37
    v_mfma_f32_16x16x32_bf16 a[4:7], a[236:239], v[220:223], a[4:7]
    v_exp_f32 v38, v38
    v_mfma_f32_16x16x32_bf16 a[4:7], a[232:235], v[216:219], a[4:7]
    buffer_load_dwordx4 v21, s[8:11], s93 offen offset:2048 nt lds
    v_mfma_f32_16x16x32_bf16 a[4:7], a[228:231], v[212:215], a[4:7]
    v_exp_f32 v39, v39
    v_mfma_f32_16x16x32_bf16 a[4:7], a[224:227], v[208:211], a[4:7]
    ds_read_b64_tr_b16 a[254:255], v13 offset:39936
    v_cvt_pk_bf16_f32 v145, v38, v39
    v_mfma_f32_16x16x32_bf16 a[8:11], a[224:227], v[224:227], a[8:11]
    v_exp_f32 v40, v40
    v_mfma_f32_16x16x32_bf16 a[8:11], a[228:231], v[228:231], a[8:11]
    buffer_load_dwordx4 v21, s[8:11], s93 offen offset:3072 nt lds
    v_mfma_f32_16x16x32_bf16 a[8:11], a[232:235], v[232:235], a[8:11]
    s_add_u32 s93, s93, 28672
    v_exp_f32 v41, v41
    v_mfma_f32_16x16x32_bf16 a[8:11], a[236:239], v[236:239], a[8:11]
    v_cvt_pk_bf16_f32 v160, v40, v41
    v_mfma_f32_16x16x32_bf16 a[12:15], a[236:239], v[252:255], a[12:15]
    s_add_u32 m0, s91, 32768
    v_exp_f32 v42, v42
    v_mfma_f32_16x16x32_bf16 a[12:15], a[232:235], v[248:251], a[12:15]
    buffer_load_dwordx4 v20, s[4:7], s92 offen offset:0 nt lds
    v_mfma_f32_16x16x32_bf16 a[12:15], a[228:231], v[244:247], a[12:15]
    v_exp_f32 v43, v43
    v_mfma_f32_16x16x32_bf16 a[12:15], a[224:227], v[240:243], a[12:15]
    s_waitcnt vmcnt(13)
    v_cvt_pk_bf16_f32 v161, v42, v43
    v_mfma_f32_16x16x32_bf16 v[80:83], v[96:99], v[104:107], v[80:83]
    v_mfma_f32_16x16x32_bf16 v[84:87], v[96:99], v[108:111], v[84:87]
    v_mfma_f32_16x16x32_bf16 v[92:95], v[100:103], v[108:111], v[92:95]
    v_mfma_f32_16x16x32_bf16 v[88:91], v[100:103], v[104:107], v[88:91]
    v_smfmac_f32_16x16x64_bf16 v[64:67], v[4:7], v[192:199], v22
    s_waitcnt lgkmcnt(0)
    v_mfma_f32_16x16x32_bf16 v[36:39], a[208:211], a[144:147], v[52:55]
    v_exp_f32 v44, v44
    v_mfma_f32_16x16x32_bf16 v[36:39], a[212:215], a[148:151], v[36:39]
    ds_read_b128 a[192:195], v8 offset:2048
    buffer_load_dwordx4 v[96:99], v23, s[20:23], s99 offen
    v_mfma_f32_16x16x32_bf16 v[32:35], a[212:215], a[132:135], v[48:51]
    v_exp_f32 v45, v45
    v_mfma_f32_16x16x32_bf16 v[32:35], a[208:211], a[128:131], v[32:35]
    ds_read_b128 a[196:199], v9 offset:2048
    v_cvt_pk_bf16_f32 v176, v44, v45
    v_mfma_f32_16x16x32_bf16 v[32:35], a[216:219], a[136:139], v[32:35]
    v_exp_f32 v46, v46
    v_mfma_f32_16x16x32_bf16 v[32:35], a[220:223], a[140:143], v[32:35]
    ds_read_b128 a[200:203], v10 offset:2048
    buffer_load_dwordx4 v[104:107], v23, s[20:23], s100 offen
    v_mfma_f32_16x16x32_bf16 v[36:39], a[220:223], a[156:159], v[36:39]
    v_exp_f32 v47, v47
    v_mfma_f32_16x16x32_bf16 v[36:39], a[216:219], a[152:155], v[36:39]
    ds_read_b128 a[204:207], v11 offset:2048
    v_cvt_pk_bf16_f32 v177, v46, v47
    v_mfma_f32_16x16x32_bf16 v[44:47], a[216:219], a[184:187], v[60:63]
    v_exp_f32 v32, v32
    v_mfma_f32_16x16x32_bf16 v[44:47], a[220:223], a[188:191], v[44:47]
    ds_read_b64_tr_b16 a[224:225], v14 offset:32768
    buffer_load_dwordx4 v[100:103], v23, s[20:23], s99 offen offset:1024
    v_mfma_f32_16x16x32_bf16 v[40:43], a[220:223], a[172:175], v[56:59]
    v_exp_f32 v33, v33
    v_mfma_f32_16x16x32_bf16 v[40:43], a[216:219], a[168:171], v[40:43]
    ds_read_b64_tr_b16 a[226:227], v14 offset:33792
    v_cvt_pk_bf16_f32 v130, v32, v33
    v_mfma_f32_16x16x32_bf16 v[40:43], a[208:211], a[160:163], v[40:43]
    v_exp_f32 v34, v34
    v_mfma_f32_16x16x32_bf16 v[40:43], a[212:215], a[164:167], v[40:43]
    ds_read_b64_tr_b16 a[228:229], v14 offset:34816
    buffer_load_dwordx4 v[108:111], v23, s[20:23], s100 offen offset:1024
    v_mfma_f32_16x16x32_bf16 v[44:47], a[212:215], a[180:183], v[44:47]
    s_add_u32 s99, s99, 4096
    v_exp_f32 v35, v35
    v_mfma_f32_16x16x32_bf16 v[44:47], a[208:211], a[176:179], v[44:47]
    s_add_u32 s100, s100, 2048
    ds_read_b64_tr_b16 a[230:231], v14 offset:35840
    v_cvt_pk_bf16_f32 v131, v34, v35
    v_mfma_f32_16x16x32_bf16 a[16:19], a[240:243], v[192:195], a[16:19]
    v_exp_f32 v36, v36
    v_mfma_f32_16x16x32_bf16 a[16:19], a[244:247], v[196:199], a[16:19]
    ds_read_b64_tr_b16 a[232:233], v14 offset:36864
    ds_read_b64_tr_b16 a[234:235], v14 offset:37888
    v_mfma_f32_16x16x32_bf16 a[16:19], a[248:251], v[200:203], a[16:19]
    v_exp_f32 v37, v37
    v_mfma_f32_16x16x32_bf16 a[16:19], a[252:255], v[204:207], a[16:19]
    ds_read_b64_tr_b16 a[236:237], v14 offset:38912
    v_cvt_pk_bf16_f32 v146, v36, v37
    v_mfma_f32_16x16x32_bf16 a[20:23], a[252:255], v[220:223], a[20:23]
    v_exp_f32 v38, v38
    v_mfma_f32_16x16x32_bf16 a[20:23], a[248:251], v[216:219], a[20:23]
    buffer_load_dwordx4 v20, s[4:7], s92 offen offset:1024 nt lds
    v_mfma_f32_16x16x32_bf16 a[20:23], a[244:247], v[212:215], a[20:23]
    v_exp_f32 v39, v39
    v_mfma_f32_16x16x32_bf16 a[20:23], a[240:243], v[208:211], a[20:23]
    ds_read_b64_tr_b16 a[238:239], v14 offset:39936
    v_cvt_pk_bf16_f32 v147, v38, v39
    v_mfma_f32_16x16x32_bf16 a[24:27], a[240:243], v[224:227], a[24:27]
    v_exp_f32 v40, v40
    v_mfma_f32_16x16x32_bf16 a[24:27], a[244:247], v[228:231], a[24:27]
    buffer_load_dwordx4 v20, s[4:7], s92 offen offset:2048 nt lds
    v_mfma_f32_16x16x32_bf16 a[24:27], a[248:251], v[232:235], a[24:27]
    v_exp_f32 v41, v41
    v_mfma_f32_16x16x32_bf16 a[24:27], a[252:255], v[236:239], a[24:27]
    v_cvt_pk_bf16_f32 v162, v40, v41
    v_mfma_f32_16x16x32_bf16 a[28:31], a[252:255], v[252:255], a[28:31]
    v_exp_f32 v42, v42
    v_mfma_f32_16x16x32_bf16 a[28:31], a[248:251], v[248:251], a[28:31]
    buffer_load_dwordx4 v20, s[4:7], s92 offen offset:3072 nt lds
    v_mfma_f32_16x16x32_bf16 a[28:31], a[244:247], v[244:247], a[28:31]
    s_add_u32 s92, s92, 4096
    v_exp_f32 v43, v43
    v_mfma_f32_16x16x32_bf16 a[28:31], a[240:243], v[240:243], a[28:31]
    v_cvt_pk_bf16_f32 v163, v42, v43
    v_smfmac_f32_16x16x64_bf16 v[68:71], v[4:7], v[208:215], v22
    s_waitcnt lgkmcnt(0)
    v_mfma_f32_16x16x32_bf16 v[36:39], a[192:195], a[144:147], v[52:55]
    v_exp_f32 v44, v44
    v_mfma_f32_16x16x32_bf16 v[36:39], a[196:199], a[148:151], v[36:39]
    ds_read_b128 a[208:211], v8 offset:3072
    ds_read_b128 a[212:215], v9 offset:3072
    v_mfma_f32_16x16x32_bf16 v[32:35], a[196:199], a[132:135], v[48:51]
    v_exp_f32 v45, v45
    v_mfma_f32_16x16x32_bf16 v[32:35], a[192:195], a[128:131], v[32:35]
    ds_read_b128 a[216:219], v10 offset:3072
    v_cvt_pk_bf16_f32 v178, v44, v45
    v_mfma_f32_16x16x32_bf16 v[32:35], a[200:203], a[136:139], v[32:35]
    s_add_u32 m0, s91, 36864
    v_exp_f32 v46, v46
    v_mfma_f32_16x16x32_bf16 v[32:35], a[204:207], a[140:143], v[32:35]
    buffer_load_dwordx4 v20, s[4:7], s92 offen offset:0 nt lds
    v_mfma_f32_16x16x32_bf16 v[36:39], a[204:207], a[156:159], v[36:39]
    v_exp_f32 v47, v47
    v_mfma_f32_16x16x32_bf16 v[36:39], a[200:203], a[152:155], v[36:39]
    ds_read_b128 a[220:223], v11 offset:3072
    v_cvt_pk_bf16_f32 v179, v46, v47
    v_mfma_f32_16x16x32_bf16 v[44:47], a[200:203], a[184:187], v[60:63]
    v_exp_f32 v32, v32
    v_mfma_f32_16x16x32_bf16 v[44:47], a[204:207], a[188:191], v[44:47]
    ds_read_b64_tr_b16 a[240:241], v15 offset:32768
    ds_read_b64_tr_b16 a[242:243], v15 offset:33792
    v_mfma_f32_16x16x32_bf16 v[40:43], a[204:207], a[172:175], v[56:59]
    v_exp_f32 v33, v33
    v_mfma_f32_16x16x32_bf16 v[40:43], a[200:203], a[168:171], v[40:43]
    ds_read_b64_tr_b16 a[244:245], v15 offset:34816
    v_cvt_pk_bf16_f32 v132, v32, v33
    v_mfma_f32_16x16x32_bf16 v[40:43], a[192:195], a[160:163], v[40:43]
    v_exp_f32 v34, v34
    v_mfma_f32_16x16x32_bf16 v[40:43], a[196:199], a[164:167], v[40:43]
    buffer_load_dwordx4 v20, s[4:7], s92 offen offset:1024 nt lds
    v_mfma_f32_16x16x32_bf16 v[44:47], a[196:199], a[180:183], v[44:47]
    v_exp_f32 v35, v35
    v_mfma_f32_16x16x32_bf16 v[44:47], a[192:195], a[176:179], v[44:47]
    ds_read_b64_tr_b16 a[246:247], v15 offset:35840
    v_cvt_pk_bf16_f32 v133, v34, v35
    v_mfma_f32_16x16x32_bf16 a[32:35], a[224:227], v[192:195], a[32:35]
    v_exp_f32 v36, v36
    v_mfma_f32_16x16x32_bf16 a[32:35], a[228:231], v[196:199], a[32:35]
    ds_read_b64_tr_b16 a[248:249], v15 offset:36864
    ds_read_b64_tr_b16 a[250:251], v15 offset:37888
    v_mfma_f32_16x16x32_bf16 a[32:35], a[232:235], v[200:203], a[32:35]
    v_exp_f32 v37, v37
    v_mfma_f32_16x16x32_bf16 a[32:35], a[236:239], v[204:207], a[32:35]
    ds_read_b64_tr_b16 a[252:253], v15 offset:38912
    v_cvt_pk_bf16_f32 v148, v36, v37
    v_mfma_f32_16x16x32_bf16 a[36:39], a[236:239], v[220:223], a[36:39]
    v_exp_f32 v38, v38
    v_mfma_f32_16x16x32_bf16 a[36:39], a[232:235], v[216:219], a[36:39]
    buffer_load_dwordx4 v20, s[4:7], s92 offen offset:2048 nt lds
    v_mfma_f32_16x16x32_bf16 a[36:39], a[228:231], v[212:215], a[36:39]
    v_exp_f32 v39, v39
    v_mfma_f32_16x16x32_bf16 a[36:39], a[224:227], v[208:211], a[36:39]
    ds_read_b64_tr_b16 a[254:255], v15 offset:39936
    v_cvt_pk_bf16_f32 v149, v38, v39
    v_mfma_f32_16x16x32_bf16 a[40:43], a[224:227], v[224:227], a[40:43]
    v_exp_f32 v40, v40
    v_mfma_f32_16x16x32_bf16 a[40:43], a[228:231], v[228:231], a[40:43]
    buffer_load_dwordx4 v20, s[4:7], s92 offen offset:3072 nt lds
    v_mfma_f32_16x16x32_bf16 a[40:43], a[232:235], v[232:235], a[40:43]
    s_add_u32 s92, s92, 28672
    v_exp_f32 v41, v41
    v_mfma_f32_16x16x32_bf16 a[40:43], a[236:239], v[236:239], a[40:43]
    v_cvt_pk_bf16_f32 v164, v40, v41
    v_mfma_f32_16x16x32_bf16 a[44:47], a[236:239], v[252:255], a[44:47]
    v_exp_f32 v42, v42
    v_mfma_f32_16x16x32_bf16 a[44:47], a[232:235], v[248:251], a[44:47]
    v_mfma_f32_16x16x32_bf16 a[44:47], a[228:231], v[244:247], a[44:47]
    v_exp_f32 v43, v43
    v_mfma_f32_16x16x32_bf16 a[44:47], a[224:227], v[240:243], a[44:47]
    s_waitcnt vmcnt(14)
    v_cvt_pk_bf16_f32 v165, v42, v43
    v_mfma_f32_16x16x32_bf16 v[80:83], v[112:115], v[120:123], v[80:83]
    v_mfma_f32_16x16x32_bf16 v[84:87], v[112:115], v[124:127], v[84:87]
    v_mfma_f32_16x16x32_bf16 v[92:95], v[116:119], v[124:127], v[92:95]
    v_mfma_f32_16x16x32_bf16 v[88:91], v[116:119], v[120:123], v[88:91]
    v_smfmac_f32_16x16x64_bf16 v[72:75], v[4:7], v[224:231], v22
    s_waitcnt lgkmcnt(0)
    v_mfma_f32_16x16x32_bf16 v[36:39], a[208:211], a[144:147], v[52:55]
    v_exp_f32 v44, v44
    v_mfma_f32_16x16x32_bf16 v[36:39], a[212:215], a[148:151], v[36:39]
    ds_read_b128 a[192:195], v8 offset:4096
    buffer_load_dwordx4 v[112:115], v23, s[20:23], s99 offen
    v_mfma_f32_16x16x32_bf16 v[32:35], a[212:215], a[132:135], v[48:51]
    v_exp_f32 v45, v45
    v_mfma_f32_16x16x32_bf16 v[32:35], a[208:211], a[128:131], v[32:35]
    ds_read_b128 a[196:199], v9 offset:4096
    v_cvt_pk_bf16_f32 v180, v44, v45
    v_mfma_f32_16x16x32_bf16 v[32:35], a[216:219], a[136:139], v[32:35]
    v_exp_f32 v46, v46
    v_mfma_f32_16x16x32_bf16 v[32:35], a[220:223], a[140:143], v[32:35]
    ds_read_b128 a[200:203], v10 offset:4096
    buffer_load_dwordx4 v[120:123], v23, s[20:23], s100 offen
    v_mfma_f32_16x16x32_bf16 v[36:39], a[220:223], a[156:159], v[36:39]
    v_exp_f32 v47, v47
    v_mfma_f32_16x16x32_bf16 v[36:39], a[216:219], a[152:155], v[36:39]
    ds_read_b128 a[204:207], v11 offset:4096
    v_cvt_pk_bf16_f32 v181, v46, v47
    v_mfma_f32_16x16x32_bf16 v[44:47], a[216:219], a[184:187], v[60:63]
    v_exp_f32 v32, v32
    v_mfma_f32_16x16x32_bf16 v[44:47], a[220:223], a[188:191], v[44:47]
    ds_read_b64_tr_b16 a[224:225], v16 offset:32768
    buffer_load_dwordx4 v[116:119], v23, s[20:23], s99 offen offset:1024
    v_mfma_f32_16x16x32_bf16 v[40:43], a[220:223], a[172:175], v[56:59]
    v_exp_f32 v33, v33
    v_mfma_f32_16x16x32_bf16 v[40:43], a[216:219], a[168:171], v[40:43]
    ds_read_b64_tr_b16 a[226:227], v16 offset:33792
    v_cvt_pk_bf16_f32 v134, v32, v33
    v_mfma_f32_16x16x32_bf16 v[40:43], a[208:211], a[160:163], v[40:43]
    v_exp_f32 v34, v34
    v_mfma_f32_16x16x32_bf16 v[40:43], a[212:215], a[164:167], v[40:43]
    ds_read_b64_tr_b16 a[228:229], v16 offset:34816
    buffer_load_dwordx4 v[124:127], v23, s[20:23], s100 offen offset:1024
    v_mfma_f32_16x16x32_bf16 v[44:47], a[212:215], a[180:183], v[44:47]
    s_add_u32 s99, s99, 4096
    v_exp_f32 v35, v35
    v_mfma_f32_16x16x32_bf16 v[44:47], a[208:211], a[176:179], v[44:47]
    s_add_u32 s100, s100, 2048
    ds_read_b64_tr_b16 a[230:231], v16 offset:35840
    v_cvt_pk_bf16_f32 v135, v34, v35
    v_mfma_f32_16x16x32_bf16 a[48:51], a[240:243], v[192:195], a[48:51]
    v_exp_f32 v36, v36
    v_mfma_f32_16x16x32_bf16 a[48:51], a[244:247], v[196:199], a[48:51]
    ds_read_b64_tr_b16 a[232:233], v16 offset:36864
    ds_read_b64_tr_b16 a[234:235], v16 offset:37888
    v_mfma_f32_16x16x32_bf16 a[48:51], a[248:251], v[200:203], a[48:51]
    v_exp_f32 v37, v37
    v_mfma_f32_16x16x32_bf16 a[48:51], a[252:255], v[204:207], a[48:51]
    ds_read_b64_tr_b16 a[236:237], v16 offset:38912
    v_cvt_pk_bf16_f32 v150, v36, v37
    v_mfma_f32_16x16x32_bf16 a[52:55], a[252:255], v[220:223], a[52:55]
    v_exp_f32 v38, v38
    v_mfma_f32_16x16x32_bf16 a[52:55], a[248:251], v[216:219], a[52:55]
    v_mfma_f32_16x16x32_bf16 a[52:55], a[244:247], v[212:215], a[52:55]
    v_exp_f32 v39, v39
    v_mfma_f32_16x16x32_bf16 a[52:55], a[240:243], v[208:211], a[52:55]
    ds_read_b64_tr_b16 a[238:239], v16 offset:39936
    v_cvt_pk_bf16_f32 v151, v38, v39
    v_mfma_f32_16x16x32_bf16 a[56:59], a[240:243], v[224:227], a[56:59]
    v_exp_f32 v40, v40
    v_mfma_f32_16x16x32_bf16 a[56:59], a[244:247], v[228:231], a[56:59]
    v_mfma_f32_16x16x32_bf16 a[56:59], a[248:251], v[232:235], a[56:59]
    v_exp_f32 v41, v41
    v_mfma_f32_16x16x32_bf16 a[56:59], a[252:255], v[236:239], a[56:59]
    v_cvt_pk_bf16_f32 v166, v40, v41
    v_mfma_f32_16x16x32_bf16 a[60:63], a[252:255], v[252:255], a[60:63]
    v_exp_f32 v42, v42
    v_mfma_f32_16x16x32_bf16 a[60:63], a[248:251], v[248:251], a[60:63]
    v_mfma_f32_16x16x32_bf16 a[60:63], a[244:247], v[244:247], a[60:63]
    v_exp_f32 v43, v43
    v_mfma_f32_16x16x32_bf16 a[60:63], a[240:243], v[240:243], a[60:63]
    s_waitcnt vmcnt(11)
    v_cvt_pk_bf16_f32 v167, v42, v43
    v_mfma_f32_16x16x32_bf16 v[80:83], v[96:99], v[104:107], v[80:83]
    v_mfma_f32_16x16x32_bf16 v[84:87], v[96:99], v[108:111], v[84:87]
    v_mfma_f32_16x16x32_bf16 v[92:95], v[100:103], v[108:111], v[92:95]
    v_mfma_f32_16x16x32_bf16 v[88:91], v[100:103], v[104:107], v[88:91]
    v_smfmac_f32_16x16x64_bf16 v[76:79], v[4:7], v[240:247], v22
    s_waitcnt lgkmcnt(0)
    v_mfma_f32_16x16x32_bf16 v[36:39], a[192:195], a[144:147], v[52:55]
    v_exp_f32 v44, v44
    v_mfma_f32_16x16x32_bf16 v[36:39], a[196:199], a[148:151], v[36:39]
    ds_read_b128 a[208:211], v8 offset:5120
    buffer_load_dwordx4 v[96:99], v23, s[20:23], s99 offen
    v_mfma_f32_16x16x32_bf16 v[32:35], a[196:199], a[132:135], v[48:51]
    v_exp_f32 v45, v45
    v_mfma_f32_16x16x32_bf16 v[32:35], a[192:195], a[128:131], v[32:35]
    ds_read_b128 a[212:215], v9 offset:5120
    v_cvt_pk_bf16_f32 v182, v44, v45
    v_mfma_f32_16x16x32_bf16 v[32:35], a[200:203], a[136:139], v[32:35]
    v_exp_f32 v46, v46
    v_mfma_f32_16x16x32_bf16 v[32:35], a[204:207], a[140:143], v[32:35]
    ds_read_b128 a[216:219], v10 offset:5120
    buffer_load_dwordx4 v[104:107], v23, s[20:23], s100 offen
    v_mfma_f32_16x16x32_bf16 v[36:39], a[204:207], a[156:159], v[36:39]
    v_exp_f32 v47, v47
    v_mfma_f32_16x16x32_bf16 v[36:39], a[200:203], a[152:155], v[36:39]
    ds_read_b128 a[220:223], v11 offset:5120
    v_cvt_pk_bf16_f32 v183, v46, v47
    v_mfma_f32_16x16x32_bf16 v[44:47], a[200:203], a[184:187], v[60:63]
    v_exp_f32 v32, v32
    v_mfma_f32_16x16x32_bf16 v[44:47], a[204:207], a[188:191], v[44:47]
    ds_read_b64_tr_b16 a[240:241], v17 offset:32768
    buffer_load_dwordx4 v[100:103], v23, s[20:23], s99 offen offset:1024
    v_mfma_f32_16x16x32_bf16 v[40:43], a[204:207], a[172:175], v[56:59]
    v_exp_f32 v33, v33
    v_mfma_f32_16x16x32_bf16 v[40:43], a[200:203], a[168:171], v[40:43]
    ds_read_b64_tr_b16 a[242:243], v17 offset:33792
    v_cvt_pk_bf16_f32 v136, v32, v33
    v_mfma_f32_16x16x32_bf16 v[40:43], a[192:195], a[160:163], v[40:43]
    v_exp_f32 v34, v34
    v_mfma_f32_16x16x32_bf16 v[40:43], a[196:199], a[164:167], v[40:43]
    ds_read_b64_tr_b16 a[244:245], v17 offset:34816
    buffer_load_dwordx4 v[108:111], v23, s[20:23], s100 offen offset:1024
    v_mfma_f32_16x16x32_bf16 v[44:47], a[196:199], a[180:183], v[44:47]
    s_add_u32 s99, s99, 4096
    v_exp_f32 v35, v35
    v_mfma_f32_16x16x32_bf16 v[44:47], a[192:195], a[176:179], v[44:47]
    s_add_u32 s100, s100, 2048
    ds_read_b64_tr_b16 a[246:247], v17 offset:35840
    v_cvt_pk_bf16_f32 v137, v34, v35
    v_mfma_f32_16x16x32_bf16 a[64:67], a[224:227], v[192:195], a[64:67]
    v_exp_f32 v36, v36
    v_mfma_f32_16x16x32_bf16 a[64:67], a[228:231], v[196:199], a[64:67]
    ds_read_b64_tr_b16 a[248:249], v17 offset:36864
    ds_read_b64_tr_b16 a[250:251], v17 offset:37888
    v_mfma_f32_16x16x32_bf16 a[64:67], a[232:235], v[200:203], a[64:67]
    v_exp_f32 v37, v37
    v_mfma_f32_16x16x32_bf16 a[64:67], a[236:239], v[204:207], a[64:67]
    ds_read_b64_tr_b16 a[252:253], v17 offset:38912
    v_cvt_pk_bf16_f32 v152, v36, v37
    v_mfma_f32_16x16x32_bf16 a[68:71], a[236:239], v[220:223], a[68:71]
    v_exp_f32 v38, v38
    v_mfma_f32_16x16x32_bf16 a[68:71], a[232:235], v[216:219], a[68:71]
    buffer_load_dword v0, v30, s[28:31], s44 offen sc1
    v_mfma_f32_16x16x32_bf16 a[68:71], a[228:231], v[212:215], a[68:71]
    s_add_u32 s44, s44, s45
    v_exp_f32 v39, v39
    v_mfma_f32_16x16x32_bf16 a[68:71], a[224:227], v[208:211], a[68:71]
    s_xor_b32 s95, s46, 32768
    ds_read_b64_tr_b16 a[254:255], v17 offset:39936
    v_cvt_pk_bf16_f32 v153, v38, v39
    v_mfma_f32_16x16x32_bf16 a[72:75], a[224:227], v[224:227], a[72:75]
    s_xor_b32 s95, s95, s47
    v_exp_f32 v40, v40
    v_mfma_f32_16x16x32_bf16 a[72:75], a[228:231], v[228:231], a[72:75]
    buffer_load_dword v0, v31, s[16:19], s95 offen sc1
    v_mfma_f32_16x16x32_bf16 a[72:75], a[232:235], v[232:235], a[72:75]
    s_add_u32 s46, s46, 32768
    v_exp_f32 v41, v41
    v_mfma_f32_16x16x32_bf16 a[72:75], a[236:239], v[236:239], a[72:75]
    v_cvt_pk_bf16_f32 v168, v40, v41
    v_mfma_f32_16x16x32_bf16 a[76:79], a[236:239], v[252:255], a[76:79]
    s_cmp_le_u32 s94, 1
    s_cselect_b32 s42, 16384, 0
    v_exp_f32 v42, v42
    v_mfma_f32_16x16x32_bf16 a[76:79], a[232:235], v[248:251], a[76:79]
    buffer_load_dword v29, v24, s[40:43], 0 offen offset:128 sc1
    v_mfma_f32_16x16x32_bf16 a[76:79], a[228:231], v[244:247], a[76:79]
    v_exp_f32 v43, v43
    v_mfma_f32_16x16x32_bf16 a[76:79], a[224:227], v[240:243], a[76:79]
    v_cvt_pk_bf16_f32 v169, v42, v43
    v_smfmac_f32_16x16x64_bf16 v[64:67], v[4:7], v[200:207], v22
    s_waitcnt lgkmcnt(0)
    v_mfma_f32_16x16x32_bf16 v[36:39], a[208:211], a[144:147], v[52:55]
    v_exp_f32 v44, v44
    v_mfma_f32_16x16x32_bf16 v[36:39], a[212:215], a[148:151], v[36:39]
    ds_read_b128 a[192:195], v8 offset:6144
    ds_read_b128 a[196:199], v9 offset:6144
    v_mfma_f32_16x16x32_bf16 v[32:35], a[212:215], a[132:135], v[48:51]
    v_exp_f32 v45, v45
    v_mfma_f32_16x16x32_bf16 v[32:35], a[208:211], a[128:131], v[32:35]
    ds_read_b128 a[200:203], v10 offset:6144
    v_cvt_pk_bf16_f32 v184, v44, v45
    v_mfma_f32_16x16x32_bf16 v[32:35], a[216:219], a[136:139], v[32:35]
    v_exp_f32 v46, v46
    v_mfma_f32_16x16x32_bf16 v[32:35], a[220:223], a[140:143], v[32:35]
    v_mfma_f32_16x16x32_bf16 v[36:39], a[220:223], a[156:159], v[36:39]
    v_exp_f32 v47, v47
    v_mfma_f32_16x16x32_bf16 v[36:39], a[216:219], a[152:155], v[36:39]
    ds_read_b128 a[204:207], v11 offset:6144
    v_cvt_pk_bf16_f32 v185, v46, v47
    v_mfma_f32_16x16x32_bf16 v[44:47], a[216:219], a[184:187], v[60:63]
    v_exp_f32 v32, v32
    v_mfma_f32_16x16x32_bf16 v[44:47], a[220:223], a[188:191], v[44:47]
    ds_read_b64_tr_b16 a[224:225], v18 offset:32768
    ds_read_b64_tr_b16 a[226:227], v18 offset:33792
    v_mfma_f32_16x16x32_bf16 v[40:43], a[220:223], a[172:175], v[56:59]
    v_exp_f32 v33, v33
    v_mfma_f32_16x16x32_bf16 v[40:43], a[216:219], a[168:171], v[40:43]
    ds_read_b64_tr_b16 a[228:229], v18 offset:34816
    v_cvt_pk_bf16_f32 v138, v32, v33
    v_mfma_f32_16x16x32_bf16 v[40:43], a[208:211], a[160:163], v[40:43]
    v_exp_f32 v34, v34
    v_mfma_f32_16x16x32_bf16 v[40:43], a[212:215], a[164:167], v[40:43]
    v_mfma_f32_16x16x32_bf16 v[44:47], a[212:215], a[180:183], v[44:47]
    v_exp_f32 v35, v35
    v_mfma_f32_16x16x32_bf16 v[44:47], a[208:211], a[176:179], v[44:47]
    ds_read_b64_tr_b16 a[230:231], v18 offset:35840
    v_cvt_pk_bf16_f32 v139, v34, v35
    v_mfma_f32_16x16x32_bf16 a[80:83], a[240:243], v[192:195], a[80:83]
    v_exp_f32 v36, v36
    v_mfma_f32_16x16x32_bf16 a[80:83], a[244:247], v[196:199], a[80:83]
    ds_read_b64_tr_b16 a[232:233], v18 offset:36864
    ds_read_b64_tr_b16 a[234:235], v18 offset:37888
    v_mfma_f32_16x16x32_bf16 a[80:83], a[248:251], v[200:203], a[80:83]
    v_exp_f32 v37, v37
    v_mfma_f32_16x16x32_bf16 a[80:83], a[252:255], v[204:207], a[80:83]
    ds_read_b64_tr_b16 a[236:237], v18 offset:38912
    v_cvt_pk_bf16_f32 v154, v36, v37
    v_mfma_f32_16x16x32_bf16 a[84:87], a[252:255], v[220:223], a[84:87]
    v_exp_f32 v38, v38
    v_mfma_f32_16x16x32_bf16 a[84:87], a[248:251], v[216:219], a[84:87]
    v_mfma_f32_16x16x32_bf16 a[84:87], a[244:247], v[212:215], a[84:87]
    v_exp_f32 v39, v39
    v_mfma_f32_16x16x32_bf16 a[84:87], a[240:243], v[208:211], a[84:87]
    ds_read_b64_tr_b16 a[238:239], v18 offset:39936
    v_cvt_pk_bf16_f32 v155, v38, v39
    v_mfma_f32_16x16x32_bf16 a[88:91], a[240:243], v[224:227], a[88:91]
    v_exp_f32 v40, v40
    v_mfma_f32_16x16x32_bf16 a[88:91], a[244:247], v[228:231], a[88:91]
    v_mfma_f32_16x16x32_bf16 a[88:91], a[248:251], v[232:235], a[88:91]
    v_exp_f32 v41, v41
    v_mfma_f32_16x16x32_bf16 a[88:91], a[252:255], v[236:239], a[88:91]
    v_cvt_pk_bf16_f32 v170, v40, v41
    v_mfma_f32_16x16x32_bf16 a[92:95], a[252:255], v[252:255], a[92:95]
    v_exp_f32 v42, v42
    v_mfma_f32_16x16x32_bf16 a[92:95], a[248:251], v[248:251], a[92:95]
    v_mfma_f32_16x16x32_bf16 a[92:95], a[244:247], v[244:247], a[92:95]
    v_exp_f32 v43, v43
    v_mfma_f32_16x16x32_bf16 a[92:95], a[240:243], v[240:243], a[92:95]
    s_waitcnt vmcnt(7)
    v_cvt_pk_bf16_f32 v171, v42, v43
    v_mfma_f32_16x16x32_bf16 v[80:83], v[112:115], v[120:123], v[80:83]
    v_mfma_f32_16x16x32_bf16 v[84:87], v[112:115], v[124:127], v[84:87]
    v_mfma_f32_16x16x32_bf16 v[92:95], v[116:119], v[124:127], v[92:95]
    v_mfma_f32_16x16x32_bf16 v[88:91], v[116:119], v[120:123], v[88:91]
    v_smfmac_f32_16x16x64_bf16 v[68:71], v[4:7], v[216:223], v22
    s_waitcnt lgkmcnt(0)
    v_mfma_f32_16x16x32_bf16 v[36:39], a[192:195], a[144:147], v[52:55]
    v_exp_f32 v44, v44
    v_mfma_f32_16x16x32_bf16 v[36:39], a[196:199], a[148:151], v[36:39]
    ds_read_b128 a[208:211], v8 offset:7168
    buffer_load_dwordx4 v[112:115], v23, s[20:23], s99 offen
    v_mfma_f32_16x16x32_bf16 v[32:35], a[196:199], a[132:135], v[48:51]
    v_exp_f32 v45, v45
    v_mfma_f32_16x16x32_bf16 v[32:35], a[192:195], a[128:131], v[32:35]
    ds_read_b128 a[212:215], v9 offset:7168
    v_cvt_pk_bf16_f32 v186, v44, v45
    v_mfma_f32_16x16x32_bf16 v[32:35], a[200:203], a[136:139], v[32:35]
    v_exp_f32 v46, v46
    v_mfma_f32_16x16x32_bf16 v[32:35], a[204:207], a[140:143], v[32:35]
    ds_read_b128 a[216:219], v10 offset:7168
    buffer_load_dwordx4 v[120:123], v23, s[20:23], s100 offen
    v_mfma_f32_16x16x32_bf16 v[36:39], a[204:207], a[156:159], v[36:39]
    v_exp_f32 v47, v47
    v_mfma_f32_16x16x32_bf16 v[36:39], a[200:203], a[152:155], v[36:39]
    ds_read_b128 a[220:223], v11 offset:7168
    v_cvt_pk_bf16_f32 v187, v46, v47
    v_mfma_f32_16x16x32_bf16 v[44:47], a[200:203], a[184:187], v[60:63]
    v_exp_f32 v32, v32
    v_mfma_f32_16x16x32_bf16 v[44:47], a[204:207], a[188:191], v[44:47]
    ds_read_b64_tr_b16 a[240:241], v19 offset:32768
    buffer_load_dwordx4 v[116:119], v23, s[20:23], s99 offen offset:1024
    v_mfma_f32_16x16x32_bf16 v[40:43], a[204:207], a[172:175], v[56:59]
    v_exp_f32 v33, v33
    v_mfma_f32_16x16x32_bf16 v[40:43], a[200:203], a[168:171], v[40:43]
    ds_read_b64_tr_b16 a[242:243], v19 offset:33792
    v_cvt_pk_bf16_f32 v140, v32, v33
    v_mfma_f32_16x16x32_bf16 v[40:43], a[192:195], a[160:163], v[40:43]
    v_exp_f32 v34, v34
    v_mfma_f32_16x16x32_bf16 v[40:43], a[196:199], a[164:167], v[40:43]
    ds_read_b64_tr_b16 a[244:245], v19 offset:34816
    buffer_load_dwordx4 v[124:127], v23, s[20:23], s100 offen offset:1024
    v_mfma_f32_16x16x32_bf16 v[44:47], a[196:199], a[180:183], v[44:47]
    s_add_u32 s99, s99, 4096
    v_exp_f32 v35, v35
    v_mfma_f32_16x16x32_bf16 v[44:47], a[192:195], a[176:179], v[44:47]
    s_add_u32 s100, s100, 2048
    ds_read_b64_tr_b16 a[246:247], v19 offset:35840
    v_cvt_pk_bf16_f32 v141, v34, v35
    v_mfma_f32_16x16x32_bf16 a[96:99], a[224:227], v[192:195], a[96:99]
    v_exp_f32 v36, v36
    v_mfma_f32_16x16x32_bf16 a[96:99], a[228:231], v[196:199], a[96:99]
    ds_read_b64_tr_b16 a[248:249], v19 offset:36864
    ds_read_b64_tr_b16 a[250:251], v19 offset:37888
    v_mfma_f32_16x16x32_bf16 a[96:99], a[232:235], v[200:203], a[96:99]
    v_exp_f32 v37, v37
    v_mfma_f32_16x16x32_bf16 a[96:99], a[236:239], v[204:207], a[96:99]
    ds_read_b64_tr_b16 a[252:253], v19 offset:38912
    v_cvt_pk_bf16_f32 v156, v36, v37
    v_mfma_f32_16x16x32_bf16 a[100:103], a[236:239], v[220:223], a[100:103]
    v_exp_f32 v38, v38
    v_mfma_f32_16x16x32_bf16 a[100:103], a[232:235], v[216:219], a[100:103]
    v_mfma_f32_16x16x32_bf16 a[100:103], a[228:231], v[212:215], a[100:103]
    v_exp_f32 v39, v39
    v_mfma_f32_16x16x32_bf16 a[100:103], a[224:227], v[208:211], a[100:103]
    ds_read_b64_tr_b16 a[254:255], v19 offset:39936
    v_cvt_pk_bf16_f32 v157, v38, v39
    v_mfma_f32_16x16x32_bf16 a[104:107], a[224:227], v[224:227], a[104:107]
    v_exp_f32 v40, v40
    v_mfma_f32_16x16x32_bf16 a[104:107], a[228:231], v[228:231], a[104:107]
    v_mfma_f32_16x16x32_bf16 a[104:107], a[232:235], v[232:235], a[104:107]
    v_exp_f32 v41, v41
    v_mfma_f32_16x16x32_bf16 a[104:107], a[236:239], v[236:239], a[104:107]
    v_cvt_pk_bf16_f32 v172, v40, v41
    v_mfma_f32_16x16x32_bf16 a[108:111], a[236:239], v[252:255], a[108:111]
    v_exp_f32 v42, v42
    v_mfma_f32_16x16x32_bf16 a[108:111], a[232:235], v[248:251], a[108:111]
    v_mfma_f32_16x16x32_bf16 a[108:111], a[228:231], v[244:247], a[108:111]
    v_exp_f32 v43, v43
    v_mfma_f32_16x16x32_bf16 a[108:111], a[224:227], v[240:243], a[108:111]
    v_cvt_pk_bf16_f32 v173, v42, v43
    v_smfmac_f32_16x16x64_bf16 v[72:75], v[4:7], v[232:239], v22
    s_waitcnt lgkmcnt(0)
    v_mfma_f32_16x16x32_bf16 v[36:39], a[208:211], a[144:147], v[52:55]
    s_waitcnt vmcnt(15)
    s_barrier
    v_exp_f32 v44, v44
    v_mfma_f32_16x16x32_bf16 v[36:39], a[212:215], a[148:151], v[36:39]
    ds_read_b128 a[192:195], v8 offset:32768
    ds_read_b128 a[196:199], v9 offset:32768
    v_mfma_f32_16x16x32_bf16 v[32:35], a[212:215], a[132:135], v[48:51]
    v_exp_f32 v45, v45
    v_mfma_f32_16x16x32_bf16 v[32:35], a[208:211], a[128:131], v[32:35]
    ds_read_b128 a[200:203], v10 offset:32768
    v_cvt_pk_bf16_f32 v188, v44, v45
    v_mfma_f32_16x16x32_bf16 v[32:35], a[216:219], a[136:139], v[32:35]
    s_add_u32 m0, s91, 98304
    v_exp_f32 v46, v46
    v_mfma_f32_16x16x32_bf16 v[32:35], a[220:223], a[140:143], v[32:35]
    buffer_load_dwordx4 v21, s[8:11], s93 offen offset:0 nt lds
    v_mfma_f32_16x16x32_bf16 v[36:39], a[220:223], a[156:159], v[36:39]
    v_exp_f32 v47, v47
    v_mfma_f32_16x16x32_bf16 v[36:39], a[216:219], a[152:155], v[36:39]
    ds_read_b128 a[204:207], v11 offset:32768
    v_cvt_pk_bf16_f32 v189, v46, v47
    v_mfma_f32_16x16x32_bf16 v[44:47], a[216:219], a[184:187], v[60:63]
    v_exp_f32 v32, v32
    v_mfma_f32_16x16x32_bf16 v[44:47], a[220:223], a[188:191], v[44:47]
    ds_read_b64_tr_b16 a[224:225], v12 offset:0
    ds_read_b64_tr_b16 a[226:227], v12 offset:1024
    v_mfma_f32_16x16x32_bf16 v[40:43], a[220:223], a[172:175], v[56:59]
    v_exp_f32 v33, v33
    v_mfma_f32_16x16x32_bf16 v[40:43], a[216:219], a[168:171], v[40:43]
    ds_read_b64_tr_b16 a[228:229], v12 offset:2048
    v_cvt_pk_bf16_f32 v142, v32, v33
    v_mfma_f32_16x16x32_bf16 v[40:43], a[208:211], a[160:163], v[40:43]
    v_exp_f32 v34, v34
    v_mfma_f32_16x16x32_bf16 v[40:43], a[212:215], a[164:167], v[40:43]
    buffer_load_dwordx4 v21, s[8:11], s93 offen offset:1024 nt lds
    v_mfma_f32_16x16x32_bf16 v[44:47], a[212:215], a[180:183], v[44:47]
    v_exp_f32 v35, v35
    v_mfma_f32_16x16x32_bf16 v[44:47], a[208:211], a[176:179], v[44:47]
    ds_read_b64_tr_b16 a[230:231], v12 offset:3072
    v_cvt_pk_bf16_f32 v143, v34, v35
    v_mfma_f32_16x16x32_bf16 a[112:115], a[240:243], v[192:195], a[112:115]
    v_exp_f32 v36, v36
    v_mfma_f32_16x16x32_bf16 a[112:115], a[244:247], v[196:199], a[112:115]
    ds_read_b64_tr_b16 a[232:233], v12 offset:4096
    ds_read_b64_tr_b16 a[234:235], v12 offset:5120
    v_mfma_f32_16x16x32_bf16 a[112:115], a[248:251], v[200:203], a[112:115]
    v_exp_f32 v37, v37
    v_mfma_f32_16x16x32_bf16 a[112:115], a[252:255], v[204:207], a[112:115]
    ds_read_b64_tr_b16 a[236:237], v12 offset:6144
    v_cvt_pk_bf16_f32 v158, v36, v37
    v_mfma_f32_16x16x32_bf16 a[116:119], a[252:255], v[220:223], a[116:119]
    v_exp_f32 v38, v38
    v_mfma_f32_16x16x32_bf16 a[116:119], a[248:251], v[216:219], a[116:119]
    buffer_load_dwordx4 v21, s[8:11], s93 offen offset:2048 nt lds
    v_mfma_f32_16x16x32_bf16 a[116:119], a[244:247], v[212:215], a[116:119]
    v_exp_f32 v39, v39
    v_mfma_f32_16x16x32_bf16 a[116:119], a[240:243], v[208:211], a[116:119]
    ds_read_b64_tr_b16 a[238:239], v12 offset:7168
    v_cvt_pk_bf16_f32 v159, v38, v39
    v_mfma_f32_16x16x32_bf16 a[120:123], a[240:243], v[224:227], a[120:123]
    v_exp_f32 v40, v40
    v_mfma_f32_16x16x32_bf16 a[120:123], a[244:247], v[228:231], a[120:123]
    buffer_load_dwordx4 v21, s[8:11], s93 offen offset:3072 nt lds
    v_mfma_f32_16x16x32_bf16 a[120:123], a[248:251], v[232:235], a[120:123]
    s_add_u32 s93, s93, 4096
    v_exp_f32 v41, v41
    v_mfma_f32_16x16x32_bf16 a[120:123], a[252:255], v[236:239], a[120:123]
    v_cvt_pk_bf16_f32 v174, v40, v41
    v_mfma_f32_16x16x32_bf16 a[124:127], a[252:255], v[252:255], a[124:127]
    s_add_u32 m0, s91, 102400
    v_exp_f32 v42, v42
    v_mfma_f32_16x16x32_bf16 a[124:127], a[248:251], v[248:251], a[124:127]
    buffer_load_dwordx4 v21, s[8:11], s93 offen offset:0 nt lds
    v_mfma_f32_16x16x32_bf16 a[124:127], a[244:247], v[244:247], a[124:127]
    v_exp_f32 v43, v43
    v_mfma_f32_16x16x32_bf16 a[124:127], a[240:243], v[240:243], a[124:127]
    s_waitcnt vmcnt(12)
    v_cvt_pk_bf16_f32 v175, v42, v43
    v_mfma_f32_16x16x32_bf16 v[80:83], v[96:99], v[104:107], v[80:83]
    v_mfma_f32_16x16x32_bf16 v[84:87], v[96:99], v[108:111], v[84:87]
    buffer_load_dwordx4 v21, s[8:11], s93 offen offset:1024 nt lds
    v_mfma_f32_16x16x32_bf16 v[92:95], v[100:103], v[108:111], v[92:95]
    v_mfma_f32_16x16x32_bf16 v[88:91], v[100:103], v[104:107], v[88:91]
    s_cmp_eq_u32 s94, 0
    v_smfmac_f32_16x16x64_bf16 v[76:79], v[4:7], v[248:255], v22
    s_waitcnt lgkmcnt(0)
    s_cbranch_scc1 K2_FIN
    v_mfma_f32_16x16x32_bf16 v[36:39], a[192:195], a[144:147], v[52:55]
    v_exp_f32 v44, v44
    v_mfma_f32_16x16x32_bf16 v[36:39], a[196:199], a[148:151], v[36:39]
    ds_read_b128 a[208:211], v8 offset:33792
    buffer_load_dwordx4 v[96:99], v23, s[20:23], s99 offen
    v_mfma_f32_16x16x32_bf16 v[32:35], a[196:199], a[132:135], v[48:51]
    v_exp_f32 v45, v45
    v_mfma_f32_16x16x32_bf16 v[32:35], a[192:195], a[128:131], v[32:35]
    ds_read_b128 a[212:215], v9 offset:33792
    v_cvt_pk_bf16_f32 v190, v44, v45
    v_mfma_f32_16x16x32_bf16 v[32:35], a[200:203], a[136:139], v[32:35]
    v_exp_f32 v46, v46
    v_mfma_f32_16x16x32_bf16 v[32:35], a[204:207], a[140:143], v[32:35]
    ds_read_b128 a[216:219], v10 offset:33792
    buffer_load_dwordx4 v[104:107], v23, s[20:23], s100 offen
    v_mfma_f32_16x16x32_bf16 v[36:39], a[204:207], a[156:159], v[36:39]
    v_exp_f32 v47, v47
    v_mfma_f32_16x16x32_bf16 v[36:39], a[200:203], a[152:155], v[36:39]
    ds_read_b128 a[220:223], v11 offset:33792
    v_cvt_pk_bf16_f32 v191, v46, v47
    v_mfma_f32_16x16x32_bf16 v[44:47], a[200:203], a[184:187], v[60:63]
    v_exp_f32 v32, v32
    v_mfma_f32_16x16x32_bf16 v[44:47], a[204:207], a[188:191], v[44:47]
    ds_read_b64_tr_b16 a[240:241], v13 offset:0
    buffer_load_dwordx4 v[100:103], v23, s[20:23], s99 offen offset:1024
    v_mfma_f32_16x16x32_bf16 v[40:43], a[204:207], a[172:175], v[56:59]
    v_exp_f32 v33, v33
    v_mfma_f32_16x16x32_bf16 v[40:43], a[200:203], a[168:171], v[40:43]
    ds_read_b64_tr_b16 a[242:243], v13 offset:1024
    v_cvt_pk_bf16_f32 v192, v32, v33
    v_mfma_f32_16x16x32_bf16 v[40:43], a[192:195], a[160:163], v[40:43]
    v_exp_f32 v34, v34
    v_mfma_f32_16x16x32_bf16 v[40:43], a[196:199], a[164:167], v[40:43]
    ds_read_b64_tr_b16 a[244:245], v13 offset:2048
    buffer_load_dwordx4 v[108:111], v23, s[20:23], s100 offen offset:1024
    v_mfma_f32_16x16x32_bf16 v[44:47], a[196:199], a[180:183], v[44:47]
    s_add_u32 s99, s99, 4096
    v_exp_f32 v35, v35
    v_mfma_f32_16x16x32_bf16 v[44:47], a[192:195], a[176:179], v[44:47]
    s_add_u32 s100, s100, 2048
    ds_read_b64_tr_b16 a[246:247], v13 offset:3072
    v_cvt_pk_bf16_f32 v193, v34, v35
    v_mfma_f32_16x16x32_bf16 a[0:3], a[224:227], v[128:131], a[0:3]
    v_exp_f32 v36, v36
    v_mfma_f32_16x16x32_bf16 a[0:3], a[228:231], v[132:135], a[0:3]
    ds_read_b64_tr_b16 a[248:249], v13 offset:4096
    ds_read_b64_tr_b16 a[250:251], v13 offset:5120
    v_mfma_f32_16x16x32_bf16 a[0:3], a[232:235], v[136:139], a[0:3]
    v_exp_f32 v37, v37
    v_mfma_f32_16x16x32_bf16 a[0:3], a[236:239], v[140:143], a[0:3]
    ds_read_b64_tr_b16 a[252:253], v13 offset:6144
    v_cvt_pk_bf16_f32 v208, v36, v37
    v_mfma_f32_16x16x32_bf16 a[4:7], a[236:239], v[156:159], a[4:7]
    v_exp_f32 v38, v38
    v_mfma_f32_16x16x32_bf16 a[4:7], a[232:235], v[152:155], a[4:7]
    buffer_load_dwordx4 v21, s[8:11], s93 offen offset:2048 nt lds
    v_mfma_f32_16x16x32_bf16 a[4:7], a[228:231], v[148:151], a[4:7]
    v_exp_f32 v39, v39
    v_mfma_f32_16x16x32_bf16 a[4:7], a[224:227], v[144:147], a[4:7]
    ds_read_b64_tr_b16 a[254:255], v13 offset:7168
    v_cvt_pk_bf16_f32 v209, v38, v39
    v_mfma_f32_16x16x32_bf16 a[8:11], a[224:227], v[160:163], a[8:11]
    v_exp_f32 v40, v40
    v_mfma_f32_16x16x32_bf16 a[8:11], a[228:231], v[164:167], a[8:11]
    buffer_load_dwordx4 v21, s[8:11], s93 offen offset:3072 nt lds
    v_mfma_f32_16x16x32_bf16 a[8:11], a[232:235], v[168:171], a[8:11]
    s_add_u32 s93, s93, 28672
    v_exp_f32 v41, v41
    v_mfma_f32_16x16x32_bf16 a[8:11], a[236:239], v[172:175], a[8:11]
    v_cvt_pk_bf16_f32 v224, v40, v41
    v_mfma_f32_16x16x32_bf16 a[12:15], a[236:239], v[188:191], a[12:15]
    s_add_u32 m0, s91, 0
    v_exp_f32 v42, v42
    v_mfma_f32_16x16x32_bf16 a[12:15], a[232:235], v[184:187], a[12:15]
    buffer_load_dwordx4 v20, s[4:7], s92 offen offset:0 nt lds
    v_mfma_f32_16x16x32_bf16 a[12:15], a[228:231], v[180:183], a[12:15]
    v_exp_f32 v43, v43
    v_mfma_f32_16x16x32_bf16 a[12:15], a[224:227], v[176:179], a[12:15]
    s_waitcnt vmcnt(13)
    v_cvt_pk_bf16_f32 v225, v42, v43
    v_mfma_f32_16x16x32_bf16 v[80:83], v[112:115], v[120:123], v[80:83]
    v_mfma_f32_16x16x32_bf16 v[84:87], v[112:115], v[124:127], v[84:87]
    v_mfma_f32_16x16x32_bf16 v[92:95], v[116:119], v[124:127], v[92:95]
    v_mfma_f32_16x16x32_bf16 v[88:91], v[116:119], v[120:123], v[88:91]
    v_smfmac_f32_16x16x64_bf16 v[64:67], v[4:7], v[128:135], v22
    s_waitcnt lgkmcnt(0)
    v_mfma_f32_16x16x32_bf16 v[36:39], a[208:211], a[144:147], v[52:55]
    v_exp_f32 v44, v44
    v_mfma_f32_16x16x32_bf16 v[36:39], a[212:215], a[148:151], v[36:39]
    ds_read_b128 a[192:195], v8 offset:34816
    buffer_load_dwordx4 v[112:115], v23, s[20:23], s99 offen
    v_mfma_f32_16x16x32_bf16 v[32:35], a[212:215], a[132:135], v[48:51]
    v_exp_f32 v45, v45
    v_mfma_f32_16x16x32_bf16 v[32:35], a[208:211], a[128:131], v[32:35]
    ds_read_b128 a[196:199], v9 offset:34816
    v_cvt_pk_bf16_f32 v240, v44, v45
    v_mfma_f32_16x16x32_bf16 v[32:35], a[216:219], a[136:139], v[32:35]
    v_exp_f32 v46, v46
    v_mfma_f32_16x16x32_bf16 v[32:35], a[220:223], a[140:143], v[32:35]
    ds_read_b128 a[200:203], v10 offset:34816
    buffer_load_dwordx4 v[120:123], v23, s[20:23], s100 offen
    v_mfma_f32_16x16x32_bf16 v[36:39], a[220:223], a[156:159], v[36:39]
    v_exp_f32 v47, v47
    v_mfma_f32_16x16x32_bf16 v[36:39], a[216:219], a[152:155], v[36:39]
    ds_read_b128 a[204:207], v11 offset:34816
    v_cvt_pk_bf16_f32 v241, v46, v47
    v_mfma_f32_16x16x32_bf16 v[44:47], a[216:219], a[184:187], v[60:63]
    v_exp_f32 v32, v32
    v_mfma_f32_16x16x32_bf16 v[44:47], a[220:223], a[188:191], v[44:47]
    ds_read_b64_tr_b16 a[224:225], v14 offset:0
    buffer_load_dwordx4 v[116:119], v23, s[20:23], s99 offen offset:1024
    v_mfma_f32_16x16x32_bf16 v[40:43], a[220:223], a[172:175], v[56:59]
    v_exp_f32 v33, v33
    v_mfma_f32_16x16x32_bf16 v[40:43], a[216:219], a[168:171], v[40:43]
    ds_read_b64_tr_b16 a[226:227], v14 offset:1024
    v_cvt_pk_bf16_f32 v194, v32, v33
    v_mfma_f32_16x16x32_bf16 v[40:43], a[208:211], a[160:163], v[40:43]
    v_exp_f32 v34, v34
    v_mfma_f32_16x16x32_bf16 v[40:43], a[212:215], a[164:167], v[40:43]
    ds_read_b64_tr_b16 a[228:229], v14 offset:2048
    buffer_load_dwordx4 v[124:127], v23, s[20:23], s100 offen offset:1024
    v_mfma_f32_16x16x32_bf16 v[44:47], a[212:215], a[180:183], v[44:47]
    s_add_u32 s99, s99, 4096
    v_exp_f32 v35, v35
    v_mfma_f32_16x16x32_bf16 v[44:47], a[208:211], a[176:179], v[44:47]
    s_add_u32 s100, s100, 2048
    ds_read_b64_tr_b16 a[230:231], v14 offset:3072
    v_cvt_pk_bf16_f32 v195, v34, v35
    v_mfma_f32_16x16x32_bf16 a[16:19], a[240:243], v[128:131], a[16:19]
    v_exp_f32 v36, v36
    v_mfma_f32_16x16x32_bf16 a[16:19], a[244:247], v[132:135], a[16:19]
    ds_read_b64_tr_b16 a[232:233], v14 offset:4096
    ds_read_b64_tr_b16 a[234:235], v14 offset:5120
    v_mfma_f32_16x16x32_bf16 a[16:19], a[248:251], v[136:139], a[16:19]
    v_exp_f32 v37, v37
    v_mfma_f32_16x16x32_bf16 a[16:19], a[252:255], v[140:143], a[16:19]
    ds_read_b64_tr_b16 a[236:237], v14 offset:6144
    v_cvt_pk_bf16_f32 v210, v36, v37
    v_mfma_f32_16x16x32_bf16 a[20:23], a[252:255], v[156:159], a[20:23]
    v_exp_f32 v38, v38
    v_mfma_f32_16x16x32_bf16 a[20:23], a[248:251], v[152:155], a[20:23]
    buffer_load_dwordx4 v20, s[4:7], s92 offen offset:1024 nt lds
    v_mfma_f32_16x16x32_bf16 a[20:23], a[244:247], v[148:151], a[20:23]
    v_exp_f32 v39, v39
    v_mfma_f32_16x16x32_bf16 a[20:23], a[240:243], v[144:147], a[20:23]
    ds_read_b64_tr_b16 a[238:239], v14 offset:7168
    v_cvt_pk_bf16_f32 v211, v38, v39
    v_mfma_f32_16x16x32_bf16 a[24:27], a[240:243], v[160:163], a[24:27]
    v_exp_f32 v40, v40
    v_mfma_f32_16x16x32_bf16 a[24:27], a[244:247], v[164:167], a[24:27]
    buffer_load_dwordx4 v20, s[4:7], s92 offen offset:2048 nt lds
    v_mfma_f32_16x16x32_bf16 a[24:27], a[248:251], v[168:171], a[24:27]
    v_exp_f32 v41, v41
    v_mfma_f32_16x16x32_bf16 a[24:27], a[252:255], v[172:175], a[24:27]
    v_cvt_pk_bf16_f32 v226, v40, v41
    v_mfma_f32_16x16x32_bf16 a[28:31], a[252:255], v[188:191], a[28:31]
    v_exp_f32 v42, v42
    v_mfma_f32_16x16x32_bf16 a[28:31], a[248:251], v[184:187], a[28:31]
    buffer_load_dwordx4 v20, s[4:7], s92 offen offset:3072 nt lds
    v_mfma_f32_16x16x32_bf16 a[28:31], a[244:247], v[180:183], a[28:31]
    s_add_u32 s92, s92, 4096
    v_exp_f32 v43, v43
    v_mfma_f32_16x16x32_bf16 a[28:31], a[240:243], v[176:179], a[28:31]
    v_cvt_pk_bf16_f32 v227, v42, v43
    v_smfmac_f32_16x16x64_bf16 v[68:71], v[4:7], v[144:151], v22
    s_waitcnt lgkmcnt(0)
    v_mfma_f32_16x16x32_bf16 v[36:39], a[192:195], a[144:147], v[52:55]
    v_exp_f32 v44, v44
    v_mfma_f32_16x16x32_bf16 v[36:39], a[196:199], a[148:151], v[36:39]
    ds_read_b128 a[208:211], v8 offset:35840
    ds_read_b128 a[212:215], v9 offset:35840
    v_mfma_f32_16x16x32_bf16 v[32:35], a[196:199], a[132:135], v[48:51]
    v_exp_f32 v45, v45
    v_mfma_f32_16x16x32_bf16 v[32:35], a[192:195], a[128:131], v[32:35]
    ds_read_b128 a[216:219], v10 offset:35840
    v_cvt_pk_bf16_f32 v242, v44, v45
    v_mfma_f32_16x16x32_bf16 v[32:35], a[200:203], a[136:139], v[32:35]
    s_add_u32 m0, s91, 4096
    v_exp_f32 v46, v46
    v_mfma_f32_16x16x32_bf16 v[32:35], a[204:207], a[140:143], v[32:35]
    buffer_load_dwordx4 v20, s[4:7], s92 offen offset:0 nt lds
    v_mfma_f32_16x16x32_bf16 v[36:39], a[204:207], a[156:159], v[36:39]
    v_exp_f32 v47, v47
    v_mfma_f32_16x16x32_bf16 v[36:39], a[200:203], a[152:155], v[36:39]
    ds_read_b128 a[220:223], v11 offset:35840
    v_cvt_pk_bf16_f32 v243, v46, v47
    v_mfma_f32_16x16x32_bf16 v[44:47], a[200:203], a[184:187], v[60:63]
    v_exp_f32 v32, v32
    v_mfma_f32_16x16x32_bf16 v[44:47], a[204:207], a[188:191], v[44:47]
    ds_read_b64_tr_b16 a[240:241], v15 offset:0
    ds_read_b64_tr_b16 a[242:243], v15 offset:1024
    v_mfma_f32_16x16x32_bf16 v[40:43], a[204:207], a[172:175], v[56:59]
    v_exp_f32 v33, v33
    v_mfma_f32_16x16x32_bf16 v[40:43], a[200:203], a[168:171], v[40:43]
    ds_read_b64_tr_b16 a[244:245], v15 offset:2048
    v_cvt_pk_bf16_f32 v196, v32, v33
    v_mfma_f32_16x16x32_bf16 v[40:43], a[192:195], a[160:163], v[40:43]
    v_exp_f32 v34, v34
    v_mfma_f32_16x16x32_bf16 v[40:43], a[196:199], a[164:167], v[40:43]
    buffer_load_dwordx4 v20, s[4:7], s92 offen offset:1024 nt lds
    v_mfma_f32_16x16x32_bf16 v[44:47], a[196:199], a[180:183], v[44:47]
    v_exp_f32 v35, v35
    v_mfma_f32_16x16x32_bf16 v[44:47], a[192:195], a[176:179], v[44:47]
    ds_read_b64_tr_b16 a[246:247], v15 offset:3072
    v_cvt_pk_bf16_f32 v197, v34, v35
    v_mfma_f32_16x16x32_bf16 a[32:35], a[224:227], v[128:131], a[32:35]
    v_exp_f32 v36, v36
    v_mfma_f32_16x16x32_bf16 a[32:35], a[228:231], v[132:135], a[32:35]
    ds_read_b64_tr_b16 a[248:249], v15 offset:4096
    ds_read_b64_tr_b16 a[250:251], v15 offset:5120
    v_mfma_f32_16x16x32_bf16 a[32:35], a[232:235], v[136:139], a[32:35]
    v_exp_f32 v37, v37
    v_mfma_f32_16x16x32_bf16 a[32:35], a[236:239], v[140:143], a[32:35]
    ds_read_b64_tr_b16 a[252:253], v15 offset:6144
    v_cvt_pk_bf16_f32 v212, v36, v37
    v_mfma_f32_16x16x32_bf16 a[36:39], a[236:239], v[156:159], a[36:39]
    v_exp_f32 v38, v38
    v_mfma_f32_16x16x32_bf16 a[36:39], a[232:235], v[152:155], a[36:39]
    buffer_load_dwordx4 v20, s[4:7], s92 offen offset:2048 nt lds
    v_mfma_f32_16x16x32_bf16 a[36:39], a[228:231], v[148:151], a[36:39]
    v_exp_f32 v39, v39
    v_mfma_f32_16x16x32_bf16 a[36:39], a[224:227], v[144:147], a[36:39]
    ds_read_b64_tr_b16 a[254:255], v15 offset:7168
    v_cvt_pk_bf16_f32 v213, v38, v39
    v_mfma_f32_16x16x32_bf16 a[40:43], a[224:227], v[160:163], a[40:43]
    v_exp_f32 v40, v40
    v_mfma_f32_16x16x32_bf16 a[40:43], a[228:231], v[164:167], a[40:43]
    buffer_load_dwordx4 v20, s[4:7], s92 offen offset:3072 nt lds
    v_mfma_f32_16x16x32_bf16 a[40:43], a[232:235], v[168:171], a[40:43]
    s_add_u32 s92, s92, 28672
    v_exp_f32 v41, v41
    v_mfma_f32_16x16x32_bf16 a[40:43], a[236:239], v[172:175], a[40:43]
    v_cvt_pk_bf16_f32 v228, v40, v41
    v_mfma_f32_16x16x32_bf16 a[44:47], a[236:239], v[188:191], a[44:47]
    v_exp_f32 v42, v42
    v_mfma_f32_16x16x32_bf16 a[44:47], a[232:235], v[184:187], a[44:47]
    v_mfma_f32_16x16x32_bf16 a[44:47], a[228:231], v[180:183], a[44:47]
    v_exp_f32 v43, v43
    v_mfma_f32_16x16x32_bf16 a[44:47], a[224:227], v[176:179], a[44:47]
    s_waitcnt vmcnt(14)
    v_cvt_pk_bf16_f32 v229, v42, v43
    v_mfma_f32_16x16x32_bf16 v[80:83], v[96:99], v[104:107], v[80:83]
    v_mfma_f32_16x16x32_bf16 v[84:87], v[96:99], v[108:111], v[84:87]
    v_mfma_f32_16x16x32_bf16 v[92:95], v[100:103], v[108:111], v[92:95]
    v_mfma_f32_16x16x32_bf16 v[88:91], v[100:103], v[104:107], v[88:91]
    v_smfmac_f32_16x16x64_bf16 v[72:75], v[4:7], v[160:167], v22
    s_waitcnt lgkmcnt(0)
    v_mfma_f32_16x16x32_bf16 v[36:39], a[208:211], a[144:147], v[52:55]
    v_exp_f32 v44, v44
    v_mfma_f32_16x16x32_bf16 v[36:39], a[212:215], a[148:151], v[36:39]
    ds_read_b128 a[192:195], v8 offset:36864
    buffer_load_dwordx4 v[96:99], v23, s[20:23], s99 offen
    v_mfma_f32_16x16x32_bf16 v[32:35], a[212:215], a[132:135], v[48:51]
    v_exp_f32 v45, v45
    v_mfma_f32_16x16x32_bf16 v[32:35], a[208:211], a[128:131], v[32:35]
    ds_read_b128 a[196:199], v9 offset:36864
    v_cvt_pk_bf16_f32 v244, v44, v45
    v_mfma_f32_16x16x32_bf16 v[32:35], a[216:219], a[136:139], v[32:35]
    v_exp_f32 v46, v46
    v_mfma_f32_16x16x32_bf16 v[32:35], a[220:223], a[140:143], v[32:35]
    ds_read_b128 a[200:203], v10 offset:36864
    buffer_load_dwordx4 v[104:107], v23, s[20:23], s100 offen
    v_mfma_f32_16x16x32_bf16 v[36:39], a[220:223], a[156:159], v[36:39]
    v_exp_f32 v47, v47
    v_mfma_f32_16x16x32_bf16 v[36:39], a[216:219], a[152:155], v[36:39]
    ds_read_b128 a[204:207], v11 offset:36864
    v_cvt_pk_bf16_f32 v245, v46, v47
    v_mfma_f32_16x16x32_bf16 v[44:47], a[216:219], a[184:187], v[60:63]
    v_exp_f32 v32, v32
    v_mfma_f32_16x16x32_bf16 v[44:47], a[220:223], a[188:191], v[44:47]
    ds_read_b64_tr_b16 a[224:225], v16 offset:0
    buffer_load_dwordx4 v[100:103], v23, s[20:23], s99 offen offset:1024
    v_mfma_f32_16x16x32_bf16 v[40:43], a[220:223], a[172:175], v[56:59]
    v_exp_f32 v33, v33
    v_mfma_f32_16x16x32_bf16 v[40:43], a[216:219], a[168:171], v[40:43]
    ds_read_b64_tr_b16 a[226:227], v16 offset:1024
    v_cvt_pk_bf16_f32 v198, v32, v33
    v_mfma_f32_16x16x32_bf16 v[40:43], a[208:211], a[160:163], v[40:43]
    v_exp_f32 v34, v34
    v_mfma_f32_16x16x32_bf16 v[40:43], a[212:215], a[164:167], v[40:43]
    ds_read_b64_tr_b16 a[228:229], v16 offset:2048
    buffer_load_dwordx4 v[108:111], v23, s[20:23], s100 offen offset:1024
    v_mfma_f32_16x16x32_bf16 v[44:47], a[212:215], a[180:183], v[44:47]
    s_add_u32 s99, s99, 4096
    v_exp_f32 v35, v35
    v_mfma_f32_16x16x32_bf16 v[44:47], a[208:211], a[176:179], v[44:47]
    s_add_u32 s100, s100, 2048
    ds_read_b64_tr_b16 a[230:231], v16 offset:3072
    v_cvt_pk_bf16_f32 v199, v34, v35
    v_mfma_f32_16x16x32_bf16 a[48:51], a[240:243], v[128:131], a[48:51]
    v_exp_f32 v36, v36
    v_mfma_f32_16x16x32_bf16 a[48:51], a[244:247], v[132:135], a[48:51]
    ds_read_b64_tr_b16 a[232:233], v16 offset:4096
    ds_read_b64_tr_b16 a[234:235], v16 offset:5120
    v_mfma_f32_16x16x32_bf16 a[48:51], a[248:251], v[136:139], a[48:51]
    v_exp_f32 v37, v37
    v_mfma_f32_16x16x32_bf16 a[48:51], a[252:255], v[140:143], a[48:51]
    ds_read_b64_tr_b16 a[236:237], v16 offset:6144
    v_cvt_pk_bf16_f32 v214, v36, v37
    v_mfma_f32_16x16x32_bf16 a[52:55], a[252:255], v[156:159], a[52:55]
    v_exp_f32 v38, v38
    v_mfma_f32_16x16x32_bf16 a[52:55], a[248:251], v[152:155], a[52:55]
    s_waitcnt vmcnt(32)
    v_cmp_ne_u32 vcc, 1, v29
    v_mfma_f32_16x16x32_bf16 a[52:55], a[244:247], v[148:151], a[52:55]
    v_exp_f32 v39, v39
    v_mfma_f32_16x16x32_bf16 a[52:55], a[240:243], v[144:147], a[52:55]
    ds_read_b64_tr_b16 a[238:239], v16 offset:7168
    v_cvt_pk_bf16_f32 v215, v38, v39
    v_mfma_f32_16x16x32_bf16 a[56:59], a[240:243], v[160:163], a[56:59]
    s_cmp_eq_u64 vcc, 0
    s_cselect_b32 s18, 37748736, 0
    v_exp_f32 v40, v40
    v_mfma_f32_16x16x32_bf16 a[56:59], a[244:247], v[164:167], a[56:59]
    v_mfma_f32_16x16x32_bf16 a[56:59], a[248:251], v[168:171], a[56:59]
    s_cmp_le_u32 s94, 1
    s_cselect_b32 s18, s18, 0
    v_exp_f32 v41, v41
    v_mfma_f32_16x16x32_bf16 a[56:59], a[252:255], v[172:175], a[56:59]
    v_cvt_pk_bf16_f32 v230, v40, v41
    v_mfma_f32_16x16x32_bf16 a[60:63], a[252:255], v[188:191], a[60:63]
    v_exp_f32 v42, v42
    v_mfma_f32_16x16x32_bf16 a[60:63], a[248:251], v[184:187], a[60:63]
    v_mfma_f32_16x16x32_bf16 a[60:63], a[244:247], v[180:183], a[60:63]
    v_exp_f32 v43, v43
    v_mfma_f32_16x16x32_bf16 a[60:63], a[240:243], v[176:179], a[60:63]
    s_waitcnt vmcnt(11)
    v_cvt_pk_bf16_f32 v231, v42, v43
    v_mfma_f32_16x16x32_bf16 v[80:83], v[112:115], v[120:123], v[80:83]
    v_mfma_f32_16x16x32_bf16 v[84:87], v[112:115], v[124:127], v[84:87]
    v_mfma_f32_16x16x32_bf16 v[92:95], v[116:119], v[124:127], v[92:95]
    v_mfma_f32_16x16x32_bf16 v[88:91], v[116:119], v[120:123], v[88:91]
    v_smfmac_f32_16x16x64_bf16 v[76:79], v[4:7], v[176:183], v22
    s_waitcnt lgkmcnt(0)
    v_mfma_f32_16x16x32_bf16 v[36:39], a[192:195], a[144:147], v[52:55]
    v_exp_f32 v44, v44
    v_mfma_f32_16x16x32_bf16 v[36:39], a[196:199], a[148:151], v[36:39]
    ds_read_b128 a[208:211], v8 offset:37888
    buffer_load_dwordx4 v[112:115], v23, s[20:23], s99 offen
    v_mfma_f32_16x16x32_bf16 v[32:35], a[196:199], a[132:135], v[48:51]
    v_exp_f32 v45, v45
    v_mfma_f32_16x16x32_bf16 v[32:35], a[192:195], a[128:131], v[32:35]
    ds_read_b128 a[212:215], v9 offset:37888
    v_cvt_pk_bf16_f32 v246, v44, v45
    v_mfma_f32_16x16x32_bf16 v[32:35], a[200:203], a[136:139], v[32:35]
    v_exp_f32 v46, v46
    v_mfma_f32_16x16x32_bf16 v[32:35], a[204:207], a[140:143], v[32:35]
    ds_read_b128 a[216:219], v10 offset:37888
    buffer_load_dwordx4 v[120:123], v23, s[20:23], s100 offen
    v_mfma_f32_16x16x32_bf16 v[36:39], a[204:207], a[156:159], v[36:39]
    v_exp_f32 v47, v47
    v_mfma_f32_16x16x32_bf16 v[36:39], a[200:203], a[152:155], v[36:39]
    ds_read_b128 a[220:223], v11 offset:37888
    v_cvt_pk_bf16_f32 v247, v46, v47
    v_mfma_f32_16x16x32_bf16 v[44:47], a[200:203], a[184:187], v[60:63]
    v_exp_f32 v32, v32
    v_mfma_f32_16x16x32_bf16 v[44:47], a[204:207], a[188:191], v[44:47]
    ds_read_b64_tr_b16 a[240:241], v17 offset:0
    buffer_load_dwordx4 v[116:119], v23, s[20:23], s99 offen offset:1024
    v_mfma_f32_16x16x32_bf16 v[40:43], a[204:207], a[172:175], v[56:59]
    v_exp_f32 v33, v33
    v_mfma_f32_16x16x32_bf16 v[40:43], a[200:203], a[168:171], v[40:43]
    ds_read_b64_tr_b16 a[242:243], v17 offset:1024
    v_cvt_pk_bf16_f32 v200, v32, v33
    v_mfma_f32_16x16x32_bf16 v[40:43], a[192:195], a[160:163], v[40:43]
    v_exp_f32 v34, v34
    v_mfma_f32_16x16x32_bf16 v[40:43], a[196:199], a[164:167], v[40:43]
    ds_read_b64_tr_b16 a[244:245], v17 offset:2048
    buffer_load_dwordx4 v[124:127], v23, s[20:23], s100 offen offset:1024
    v_mfma_f32_16x16x32_bf16 v[44:47], a[196:199], a[180:183], v[44:47]
    s_add_u32 s99, s99, 4096
    v_exp_f32 v35, v35
    v_mfma_f32_16x16x32_bf16 v[44:47], a[192:195], a[176:179], v[44:47]
    s_add_u32 s100, s100, 2048
    ds_read_b64_tr_b16 a[246:247], v17 offset:3072
    v_cvt_pk_bf16_f32 v201, v34, v35
    v_mfma_f32_16x16x32_bf16 a[64:67], a[224:227], v[128:131], a[64:67]
    v_exp_f32 v36, v36
    v_mfma_f32_16x16x32_bf16 a[64:67], a[228:231], v[132:135], a[64:67]
    ds_read_b64_tr_b16 a[248:249], v17 offset:4096
    ds_read_b64_tr_b16 a[250:251], v17 offset:5120
    v_mfma_f32_16x16x32_bf16 a[64:67], a[232:235], v[136:139], a[64:67]
    v_exp_f32 v37, v37
    v_mfma_f32_16x16x32_bf16 a[64:67], a[236:239], v[140:143], a[64:67]
    ds_read_b64_tr_b16 a[252:253], v17 offset:6144
    v_cvt_pk_bf16_f32 v216, v36, v37
    v_mfma_f32_16x16x32_bf16 a[68:71], a[236:239], v[156:159], a[68:71]
    v_exp_f32 v38, v38
    v_mfma_f32_16x16x32_bf16 a[68:71], a[232:235], v[152:155], a[68:71]
    buffer_load_dword v0, v30, s[28:31], s44 offen sc1
    v_mfma_f32_16x16x32_bf16 a[68:71], a[228:231], v[148:151], a[68:71]
    s_add_u32 s44, s44, s45
    v_exp_f32 v39, v39
    v_mfma_f32_16x16x32_bf16 a[68:71], a[224:227], v[144:147], a[68:71]
    s_xor_b32 s95, s46, 32768
    ds_read_b64_tr_b16 a[254:255], v17 offset:7168
    v_cvt_pk_bf16_f32 v217, v38, v39
    v_mfma_f32_16x16x32_bf16 a[72:75], a[224:227], v[160:163], a[72:75]
    s_xor_b32 s95, s95, s47
    v_exp_f32 v40, v40
    v_mfma_f32_16x16x32_bf16 a[72:75], a[228:231], v[164:167], a[72:75]
    buffer_load_dword v0, v31, s[16:19], s95 offen sc1
    v_mfma_f32_16x16x32_bf16 a[72:75], a[232:235], v[168:171], a[72:75]
    s_add_u32 s46, s46, 32768
    v_exp_f32 v41, v41
    v_mfma_f32_16x16x32_bf16 a[72:75], a[236:239], v[172:175], a[72:75]
    v_cvt_pk_bf16_f32 v232, v40, v41
    v_mfma_f32_16x16x32_bf16 a[76:79], a[236:239], v[188:191], a[76:79]
    v_exp_f32 v42, v42
    v_mfma_f32_16x16x32_bf16 a[76:79], a[232:235], v[184:187], a[76:79]
    global_load_dword v0, v[26:27], off
    v_mfma_f32_16x16x32_bf16 a[76:79], a[228:231], v[180:183], a[76:79]
    v_exp_f32 v43, v43
    v_mfma_f32_16x16x32_bf16 a[76:79], a[224:227], v[176:179], a[76:79]
    v_cvt_pk_bf16_f32 v233, v42, v43
    v_smfmac_f32_16x16x64_bf16 v[64:67], v[4:7], v[136:143], v22
    s_waitcnt lgkmcnt(0)
    v_mfma_f32_16x16x32_bf16 v[36:39], a[208:211], a[144:147], v[52:55]
    v_exp_f32 v44, v44
    v_mfma_f32_16x16x32_bf16 v[36:39], a[212:215], a[148:151], v[36:39]
    ds_read_b128 a[192:195], v8 offset:38912
    ds_read_b128 a[196:199], v9 offset:38912
    v_mfma_f32_16x16x32_bf16 v[32:35], a[212:215], a[132:135], v[48:51]
    v_exp_f32 v45, v45
    v_mfma_f32_16x16x32_bf16 v[32:35], a[208:211], a[128:131], v[32:35]
    ds_read_b128 a[200:203], v10 offset:38912
    v_cvt_pk_bf16_f32 v248, v44, v45
    v_mfma_f32_16x16x32_bf16 v[32:35], a[216:219], a[136:139], v[32:35]
    v_exp_f32 v46, v46
    v_mfma_f32_16x16x32_bf16 v[32:35], a[220:223], a[140:143], v[32:35]
    v_mfma_f32_16x16x32_bf16 v[36:39], a[220:223], a[156:159], v[36:39]
    v_exp_f32 v47, v47
    v_mfma_f32_16x16x32_bf16 v[36:39], a[216:219], a[152:155], v[36:39]
    ds_read_b128 a[204:207], v11 offset:38912
    v_cvt_pk_bf16_f32 v249, v46, v47
    v_mfma_f32_16x16x32_bf16 v[44:47], a[216:219], a[184:187], v[60:63]
    v_exp_f32 v32, v32
    v_mfma_f32_16x16x32_bf16 v[44:47], a[220:223], a[188:191], v[44:47]
    ds_read_b64_tr_b16 a[224:225], v18 offset:0
    ds_read_b64_tr_b16 a[226:227], v18 offset:1024
    v_mfma_f32_16x16x32_bf16 v[40:43], a[220:223], a[172:175], v[56:59]
    v_exp_f32 v33, v33
    v_mfma_f32_16x16x32_bf16 v[40:43], a[216:219], a[168:171], v[40:43]
    ds_read_b64_tr_b16 a[228:229], v18 offset:2048
    v_cvt_pk_bf16_f32 v202, v32, v33
    v_mfma_f32_16x16x32_bf16 v[40:43], a[208:211], a[160:163], v[40:43]
    v_exp_f32 v34, v34
    v_mfma_f32_16x16x32_bf16 v[40:43], a[212:215], a[164:167], v[40:43]
    v_mfma_f32_16x16x32_bf16 v[44:47], a[212:215], a[180:183], v[44:47]
    v_exp_f32 v35, v35
    v_mfma_f32_16x16x32_bf16 v[44:47], a[208:211], a[176:179], v[44:47]
    ds_read_b64_tr_b16 a[230:231], v18 offset:3072
    v_cvt_pk_bf16_f32 v203, v34, v35
    v_mfma_f32_16x16x32_bf16 a[80:83], a[240:243], v[128:131], a[80:83]
    v_exp_f32 v36, v36
    v_mfma_f32_16x16x32_bf16 a[80:83], a[244:247], v[132:135], a[80:83]
    ds_read_b64_tr_b16 a[232:233], v18 offset:4096
    ds_read_b64_tr_b16 a[234:235], v18 offset:5120
    v_mfma_f32_16x16x32_bf16 a[80:83], a[248:251], v[136:139], a[80:83]
    v_exp_f32 v37, v37
    v_mfma_f32_16x16x32_bf16 a[80:83], a[252:255], v[140:143], a[80:83]
    ds_read_b64_tr_b16 a[236:237], v18 offset:6144
    v_cvt_pk_bf16_f32 v218, v36, v37
    v_mfma_f32_16x16x32_bf16 a[84:87], a[252:255], v[156:159], a[84:87]
    v_exp_f32 v38, v38
    v_mfma_f32_16x16x32_bf16 a[84:87], a[248:251], v[152:155], a[84:87]
    v_mfma_f32_16x16x32_bf16 a[84:87], a[244:247], v[148:151], a[84:87]
    v_exp_f32 v39, v39
    v_mfma_f32_16x16x32_bf16 a[84:87], a[240:243], v[144:147], a[84:87]
    ds_read_b64_tr_b16 a[238:239], v18 offset:7168
    v_cvt_pk_bf16_f32 v219, v38, v39
    v_mfma_f32_16x16x32_bf16 a[88:91], a[240:243], v[160:163], a[88:91]
    v_exp_f32 v40, v40
    v_mfma_f32_16x16x32_bf16 a[88:91], a[244:247], v[164:167], a[88:91]
    v_mfma_f32_16x16x32_bf16 a[88:91], a[248:251], v[168:171], a[88:91]
    v_exp_f32 v41, v41
    v_mfma_f32_16x16x32_bf16 a[88:91], a[252:255], v[172:175], a[88:91]
    v_cvt_pk_bf16_f32 v234, v40, v41
    v_mfma_f32_16x16x32_bf16 a[92:95], a[252:255], v[188:191], a[92:95]
    v_exp_f32 v42, v42
    v_mfma_f32_16x16x32_bf16 a[92:95], a[248:251], v[184:187], a[92:95]
    v_mfma_f32_16x16x32_bf16 a[92:95], a[244:247], v[180:183], a[92:95]
    v_exp_f32 v43, v43
    v_mfma_f32_16x16x32_bf16 a[92:95], a[240:243], v[176:179], a[92:95]
    s_waitcnt vmcnt(7)
    v_cvt_pk_bf16_f32 v235, v42, v43
    v_mfma_f32_16x16x32_bf16 v[80:83], v[96:99], v[104:107], v[80:83]
    v_mfma_f32_16x16x32_bf16 v[84:87], v[96:99], v[108:111], v[84:87]
    v_mfma_f32_16x16x32_bf16 v[92:95], v[100:103], v[108:111], v[92:95]
    v_mfma_f32_16x16x32_bf16 v[88:91], v[100:103], v[104:107], v[88:91]
    v_smfmac_f32_16x16x64_bf16 v[68:71], v[4:7], v[152:159], v22
    s_waitcnt lgkmcnt(0)
    v_mfma_f32_16x16x32_bf16 v[36:39], a[192:195], a[144:147], v[52:55]
    v_exp_f32 v44, v44
    v_mfma_f32_16x16x32_bf16 v[36:39], a[196:199], a[148:151], v[36:39]
    ds_read_b128 a[208:211], v8 offset:39936
    buffer_load_dwordx4 v[96:99], v23, s[20:23], s99 offen
    v_mfma_f32_16x16x32_bf16 v[32:35], a[196:199], a[132:135], v[48:51]
    v_exp_f32 v45, v45
    v_mfma_f32_16x16x32_bf16 v[32:35], a[192:195], a[128:131], v[32:35]
    ds_read_b128 a[212:215], v9 offset:39936
    v_cvt_pk_bf16_f32 v250, v44, v45
    v_mfma_f32_16x16x32_bf16 v[32:35], a[200:203], a[136:139], v[32:35]
    v_exp_f32 v46, v46
    v_mfma_f32_16x16x32_bf16 v[32:35], a[204:207], a[140:143], v[32:35]
    ds_read_b128 a[216:219], v10 offset:39936
    buffer_load_dwordx4 v[104:107], v23, s[20:23], s100 offen
    v_mfma_f32_16x16x32_bf16 v[36:39], a[204:207], a[156:159], v[36:39]
    v_exp_f32 v47, v47
    v_mfma_f32_16x16x32_bf16 v[36:39], a[200:203], a[152:155], v[36:39]
    ds_read_b128 a[220:223], v11 offset:39936
    v_cvt_pk_bf16_f32 v251, v46, v47
    v_mfma_f32_16x16x32_bf16 v[44:47], a[200:203], a[184:187], v[60:63]
    v_exp_f32 v32, v32
    v_mfma_f32_16x16x32_bf16 v[44:47], a[204:207], a[188:191], v[44:47]
    ds_read_b64_tr_b16 a[240:241], v19 offset:0
    buffer_load_dwordx4 v[100:103], v23, s[20:23], s99 offen offset:1024
    v_mfma_f32_16x16x32_bf16 v[40:43], a[204:207], a[172:175], v[56:59]
    v_exp_f32 v33, v33
    v_mfma_f32_16x16x32_bf16 v[40:43], a[200:203], a[168:171], v[40:43]
    ds_read_b64_tr_b16 a[242:243], v19 offset:1024
    v_cvt_pk_bf16_f32 v204, v32, v33
    v_mfma_f32_16x16x32_bf16 v[40:43], a[192:195], a[160:163], v[40:43]
    v_exp_f32 v34, v34
    v_mfma_f32_16x16x32_bf16 v[40:43], a[196:199], a[164:167], v[40:43]
    ds_read_b64_tr_b16 a[244:245], v19 offset:2048
    buffer_load_dwordx4 v[108:111], v23, s[20:23], s100 offen offset:1024
    v_mfma_f32_16x16x32_bf16 v[44:47], a[196:199], a[180:183], v[44:47]
    s_add_u32 s99, s99, 4096
    v_exp_f32 v35, v35
    v_mfma_f32_16x16x32_bf16 v[44:47], a[192:195], a[176:179], v[44:47]
    s_add_u32 s100, s100, 2048
    ds_read_b64_tr_b16 a[246:247], v19 offset:3072
    v_cvt_pk_bf16_f32 v205, v34, v35
    v_mfma_f32_16x16x32_bf16 a[96:99], a[224:227], v[128:131], a[96:99]
    v_exp_f32 v36, v36
    v_mfma_f32_16x16x32_bf16 a[96:99], a[228:231], v[132:135], a[96:99]
    ds_read_b64_tr_b16 a[248:249], v19 offset:4096
    ds_read_b64_tr_b16 a[250:251], v19 offset:5120
    v_mfma_f32_16x16x32_bf16 a[96:99], a[232:235], v[136:139], a[96:99]
    v_exp_f32 v37, v37
    v_mfma_f32_16x16x32_bf16 a[96:99], a[236:239], v[140:143], a[96:99]
    ds_read_b64_tr_b16 a[252:253], v19 offset:6144
    v_cvt_pk_bf16_f32 v220, v36, v37
    v_mfma_f32_16x16x32_bf16 a[100:103], a[236:239], v[156:159], a[100:103]
    v_exp_f32 v38, v38
    v_mfma_f32_16x16x32_bf16 a[100:103], a[232:235], v[152:155], a[100:103]
    v_mfma_f32_16x16x32_bf16 a[100:103], a[228:231], v[148:151], a[100:103]
    v_exp_f32 v39, v39
    v_mfma_f32_16x16x32_bf16 a[100:103], a[224:227], v[144:147], a[100:103]
    ds_read_b64_tr_b16 a[254:255], v19 offset:7168
    v_cvt_pk_bf16_f32 v221, v38, v39
    v_mfma_f32_16x16x32_bf16 a[104:107], a[224:227], v[160:163], a[104:107]
    v_exp_f32 v40, v40
    v_mfma_f32_16x16x32_bf16 a[104:107], a[228:231], v[164:167], a[104:107]
    v_mfma_f32_16x16x32_bf16 a[104:107], a[232:235], v[168:171], a[104:107]
    v_exp_f32 v41, v41
    v_mfma_f32_16x16x32_bf16 a[104:107], a[236:239], v[172:175], a[104:107]
    v_cvt_pk_bf16_f32 v236, v40, v41
    v_mfma_f32_16x16x32_bf16 a[108:111], a[236:239], v[188:191], a[108:111]
    v_exp_f32 v42, v42
    v_mfma_f32_16x16x32_bf16 a[108:111], a[232:235], v[184:187], a[108:111]
    v_mfma_f32_16x16x32_bf16 a[108:111], a[228:231], v[180:183], a[108:111]
    v_exp_f32 v43, v43
    v_mfma_f32_16x16x32_bf16 a[108:111], a[224:227], v[176:179], a[108:111]
    v_cvt_pk_bf16_f32 v237, v42, v43
    v_smfmac_f32_16x16x64_bf16 v[72:75], v[4:7], v[168:175], v22
    s_waitcnt lgkmcnt(0)
    v_mfma_f32_16x16x32_bf16 v[36:39], a[208:211], a[144:147], v[52:55]
    s_waitcnt vmcnt(15)
    s_barrier
    v_exp_f32 v44, v44
    v_mfma_f32_16x16x32_bf16 v[36:39], a[212:215], a[148:151], v[36:39]
    ds_read_b128 a[192:195], v8 offset:0
    ds_read_b128 a[196:199], v9 offset:0
    v_mfma_f32_16x16x32_bf16 v[32:35], a[212:215], a[132:135], v[48:51]
    v_exp_f32 v45, v45
    v_mfma_f32_16x16x32_bf16 v[32:35], a[208:211], a[128:131], v[32:35]
    ds_read_b128 a[200:203], v10 offset:0
    v_cvt_pk_bf16_f32 v252, v44, v45
    v_mfma_f32_16x16x32_bf16 v[32:35], a[216:219], a[136:139], v[32:35]
    s_add_u32 m0, s91, 65536
    v_exp_f32 v46, v46
    v_mfma_f32_16x16x32_bf16 v[32:35], a[220:223], a[140:143], v[32:35]
    buffer_load_dwordx4 v21, s[8:11], s93 offen offset:0 nt lds
    v_mfma_f32_16x16x32_bf16 v[36:39], a[220:223], a[156:159], v[36:39]
    v_exp_f32 v47, v47
    v_mfma_f32_16x16x32_bf16 v[36:39], a[216:219], a[152:155], v[36:39]
    ds_read_b128 a[204:207], v11 offset:0
    v_cvt_pk_bf16_f32 v253, v46, v47
    v_mfma_f32_16x16x32_bf16 v[44:47], a[216:219], a[184:187], v[60:63]
    v_exp_f32 v32, v32
    v_mfma_f32_16x16x32_bf16 v[44:47], a[220:223], a[188:191], v[44:47]
    ds_read_b64_tr_b16 a[224:225], v12 offset:32768
    ds_read_b64_tr_b16 a[226:227], v12 offset:33792
    v_mfma_f32_16x16x32_bf16 v[40:43], a[220:223], a[172:175], v[56:59]
    v_exp_f32 v33, v33
    v_mfma_f32_16x16x32_bf16 v[40:43], a[216:219], a[168:171], v[40:43]
    ds_read_b64_tr_b16 a[228:229], v12 offset:34816
    v_cvt_pk_bf16_f32 v206, v32, v33
    v_mfma_f32_16x16x32_bf16 v[40:43], a[208:211], a[160:163], v[40:43]
    v_exp_f32 v34, v34
    v_mfma_f32_16x16x32_bf16 v[40:43], a[212:215], a[164:167], v[40:43]
    buffer_load_dwordx4 v21, s[8:11], s93 offen offset:1024 nt lds
    v_mfma_f32_16x16x32_bf16 v[44:47], a[212:215], a[180:183], v[44:47]
    v_exp_f32 v35, v35
    v_mfma_f32_16x16x32_bf16 v[44:47], a[208:211], a[176:179], v[44:47]
    ds_read_b64_tr_b16 a[230:231], v12 offset:35840
    v_cvt_pk_bf16_f32 v207, v34, v35
    v_mfma_f32_16x16x32_bf16 a[112:115], a[240:243], v[128:131], a[112:115]
    v_exp_f32 v36, v36
    v_mfma_f32_16x16x32_bf16 a[112:115], a[244:247], v[132:135], a[112:115]
    ds_read_b64_tr_b16 a[232:233], v12 offset:36864
    ds_read_b64_tr_b16 a[234:235], v12 offset:37888
    v_mfma_f32_16x16x32_bf16 a[112:115], a[248:251], v[136:139], a[112:115]
    v_exp_f32 v37, v37
    v_mfma_f32_16x16x32_bf16 a[112:115], a[252:255], v[140:143], a[112:115]
    ds_read_b64_tr_b16 a[236:237], v12 offset:38912
    v_cvt_pk_bf16_f32 v222, v36, v37
    v_mfma_f32_16x16x32_bf16 a[116:119], a[252:255], v[156:159], a[116:119]
    v_exp_f32 v38, v38
    v_mfma_f32_16x16x32_bf16 a[116:119], a[248:251], v[152:155], a[116:119]
    buffer_load_dwordx4 v21, s[8:11], s93 offen offset:2048 nt lds
    v_mfma_f32_16x16x32_bf16 a[116:119], a[244:247], v[148:151], a[116:119]
    v_exp_f32 v39, v39
    v_mfma_f32_16x16x32_bf16 a[116:119], a[240:243], v[144:147], a[116:119]
    ds_read_b64_tr_b16 a[238:239], v12 offset:39936
    v_cvt_pk_bf16_f32 v223, v38, v39
    v_mfma_f32_16x16x32_bf16 a[120:123], a[240:243], v[160:163], a[120:123]
    v_exp_f32 v40, v40
    v_mfma_f32_16x16x32_bf16 a[120:123], a[244:247], v[164:167], a[120:123]
    buffer_load_dwordx4 v21, s[8:11], s93 offen offset:3072 nt lds
    v_mfma_f32_16x16x32_bf16 a[120:123], a[248:251], v[168:171], a[120:123]
    s_add_u32 s93, s93, 4096
    v_exp_f32 v41, v41
    v_mfma_f32_16x16x32_bf16 a[120:123], a[252:255], v[172:175], a[120:123]
    v_cvt_pk_bf16_f32 v238, v40, v41
    v_mfma_f32_16x16x32_bf16 a[124:127], a[252:255], v[188:191], a[124:127]
    s_add_u32 m0, s91, 69632
    v_exp_f32 v42, v42
    v_mfma_f32_16x16x32_bf16 a[124:127], a[248:251], v[184:187], a[124:127]
    buffer_load_dwordx4 v21, s[8:11], s93 offen offset:0 nt lds
    v_mfma_f32_16x16x32_bf16 a[124:127], a[244:247], v[180:183], a[124:127]
    v_exp_f32 v43, v43
    v_mfma_f32_16x16x32_bf16 a[124:127], a[240:243], v[176:179], a[124:127]
    s_waitcnt vmcnt(12)
    v_cvt_pk_bf16_f32 v239, v42, v43
    v_mfma_f32_16x16x32_bf16 v[80:83], v[112:115], v[120:123], v[80:83]
    v_mfma_f32_16x16x32_bf16 v[84:87], v[112:115], v[124:127], v[84:87]
    buffer_load_dwordx4 v21, s[8:11], s93 offen offset:1024 nt lds
    v_mfma_f32_16x16x32_bf16 v[92:95], v[116:119], v[124:127], v[92:95]
    v_mfma_f32_16x16x32_bf16 v[88:91], v[116:119], v[120:123], v[88:91]
    s_sub_u32 s94, s94, 1
    v_smfmac_f32_16x16x64_bf16 v[76:79], v[4:7], v[184:191], v22
    s_waitcnt lgkmcnt(0)
    s_branch K2_LOOP
K2_FIN:
    v_mfma_f32_16x16x32_bf16 v[32:35], a[192:195], a[128:131], v[48:51]
    v_exp_f32 v44, v44
    v_mfma_f32_16x16x32_bf16 v[32:35], a[196:199], a[132:135], v[32:35]
    ds_read_b128 a[208:211], v8 offset:33792
    v_exp_f32 v45, v45
    v_mfma_f32_16x16x32_bf16 v[32:35], a[200:203], a[136:139], v[32:35]
    ds_read_b128 a[212:215], v9 offset:33792
    v_exp_f32 v46, v46
    v_cvt_pk_bf16_f32 v190, v44, v45
    v_mfma_f32_16x16x32_bf16 v[32:35], a[204:207], a[140:143], v[32:35]
    ds_read_b128 a[216:219], v10 offset:33792
    v_exp_f32 v47, v47
    v_mfma_f32_16x16x32_bf16 a[0:3], a[224:227], v[128:131], a[0:3]
    s_waitcnt vmcnt(10)
    v_cvt_pk_bf16_f32 v191, v46, v47
    v_mfma_f32_16x16x32_bf16 v[36:39], a[192:195], a[144:147], v[52:55]
    ds_read_b128 a[220:223], v11 offset:33792
    v_cmp_ne_u32 vcc, 1, v29
    v_mfma_f32_16x16x32_bf16 v[36:39], a[196:199], a[148:151], v[36:39]
    ds_read_b64_tr_b16 a[240:241], v13 offset:0
    v_mfma_f32_16x16x32_bf16 v[36:39], a[200:203], a[152:155], v[36:39]
    s_nop 0
    v_mfma_f32_16x16x32_bf16 v[36:39], a[204:207], a[156:159], v[36:39]
    s_cbranch_vccnz K2_SPIN1
K2_BACK1:
    ds_read_b64_tr_b16 a[242:243], v13 offset:1024
    v_mfma_f32_16x16x32_bf16 a[0:3], a[228:231], v[132:135], a[0:3]
    v_mfma_f32_16x16x32_bf16 v[40:43], a[192:195], a[160:163], v[56:59]
    ds_read_b64_tr_b16 a[244:245], v13 offset:2048
    v_exp_f32 v32, v32
    v_mfma_f32_16x16x32_bf16 v[40:43], a[196:199], a[164:167], v[40:43]
    ds_read_b64_tr_b16 a[246:247], v13 offset:3072
    v_exp_f32 v33, v33
    v_mfma_f32_16x16x32_bf16 v[40:43], a[200:203], a[168:171], v[40:43]
    v_exp_f32 v34, v34
    v_cvt_pk_bf16_f32 v192, v32, v33
    v_mfma_f32_16x16x32_bf16 v[40:43], a[204:207], a[172:175], v[40:43]
    ds_read_b64_tr_b16 a[248:249], v13 offset:4096
    v_exp_f32 v35, v35
    v_mfma_f32_16x16x32_bf16 a[0:3], a[232:235], v[136:139], a[0:3]
    v_cvt_pk_bf16_f32 v193, v34, v35
    v_mfma_f32_16x16x32_bf16 v[44:47], a[192:195], a[176:179], v[60:63]
    ds_read_b64_tr_b16 a[250:251], v13 offset:5120
    v_exp_f32 v36, v36
    v_mfma_f32_16x16x32_bf16 v[44:47], a[196:199], a[180:183], v[44:47]
    ds_read_b64_tr_b16 a[252:253], v13 offset:6144
    v_exp_f32 v37, v37
    v_mfma_f32_16x16x32_bf16 v[44:47], a[200:203], a[184:187], v[44:47]
    v_exp_f32 v38, v38
    v_cvt_pk_bf16_f32 v208, v36, v37
    v_mfma_f32_16x16x32_bf16 v[44:47], a[204:207], a[188:191], v[44:47]
    ds_read_b64_tr_b16 a[254:255], v13 offset:7168
    v_exp_f32 v39, v39
    v_mfma_f32_16x16x32_bf16 a[0:3], a[236:239], v[140:143], a[0:3]
    s_waitcnt vmcnt(6)
    v_cvt_pk_bf16_f32 v209, v38, v39
    v_mfma_f32_16x16x32_bf16 v[80:83], v[112:115], v[120:123], v[80:83]
    buffer_load_dwordx4 v21, s[8:11], s93 offen offset:2048 nt lds
    v_mfma_f32_16x16x32_bf16 v[84:87], v[112:115], v[124:127], v[84:87]
    v_mfma_f32_16x16x32_bf16 v[92:95], v[116:119], v[124:127], v[92:95]
    buffer_load_dwordx4 v21, s[8:11], s93 offen offset:3072 nt lds
    v_mfma_f32_16x16x32_bf16 v[88:91], v[116:119], v[120:123], v[88:91]
    s_add_u32 s93, s93, 28672
    v_smfmac_f32_16x16x64_bf16 v[64:67], v[4:7], v[128:135], v22
    s_waitcnt lgkmcnt(0)
    v_mfma_f32_16x16x32_bf16 v[32:35], a[208:211], a[128:131], v[48:51]
    v_exp_f32 v40, v40
    v_mfma_f32_16x16x32_bf16 v[32:35], a[212:215], a[132:135], v[32:35]
    ds_read_b128 a[192:195], v8 offset:34816
    v_exp_f32 v41, v41
    v_mfma_f32_16x16x32_bf16 v[32:35], a[216:219], a[136:139], v[32:35]
    s_add_u32 m0, s91, 131072
    v_exp_f32 v42, v42
    v_cvt_pk_bf16_f32 v224, v40, v41
    v_mfma_f32_16x16x32_bf16 v[32:35], a[220:223], a[140:143], v[32:35]
    s_xor_b32 s92, s48, 94208
    ds_read_b128 a[196:199], v9 offset:34816
    v_exp_f32 v43, v43
    v_mfma_f32_16x16x32_bf16 a[4:7], a[224:227], v[144:147], a[4:7]
    v_cvt_pk_bf16_f32 v225, v42, v43
    buffer_load_dwordx4 v23, s[20:23], s92 offen offset:0 sc1 lds
    v_mfma_f32_16x16x32_bf16 v[36:39], a[208:211], a[144:147], v[52:55]
    ds_read_b128 a[200:203], v10 offset:34816
    v_exp_f32 v44, v44
    v_mfma_f32_16x16x32_bf16 v[36:39], a[212:215], a[148:151], v[36:39]
    ds_read_b128 a[204:207], v11 offset:34816
    v_exp_f32 v45, v45
    v_mfma_f32_16x16x32_bf16 v[36:39], a[216:219], a[152:155], v[36:39]
    v_exp_f32 v46, v46
    v_cvt_pk_bf16_f32 v240, v44, v45
    v_mfma_f32_16x16x32_bf16 v[36:39], a[220:223], a[156:159], v[36:39]
    v_exp_f32 v47, v47
    v_mfma_f32_16x16x32_bf16 a[4:7], a[228:231], v[148:151], a[4:7]
    v_cvt_pk_bf16_f32 v241, v46, v47
    buffer_load_dwordx4 v23, s[20:23], s92 offen offset:1024 sc1 lds
    v_mfma_f32_16x16x32_bf16 v[40:43], a[208:211], a[160:163], v[56:59]
    v_exp_f32 v32, v32
    v_mfma_f32_16x16x32_bf16 v[40:43], a[212:215], a[164:167], v[40:43]
    v_exp_f32 v33, v33
    v_mfma_f32_16x16x32_bf16 v[40:43], a[216:219], a[168:171], v[40:43]
    v_exp_f32 v34, v34
    v_cvt_pk_bf16_f32 v194, v32, v33
    v_mfma_f32_16x16x32_bf16 v[40:43], a[220:223], a[172:175], v[40:43]
    v_exp_f32 v35, v35
    v_mfma_f32_16x16x32_bf16 a[4:7], a[232:235], v[152:155], a[4:7]
    v_cvt_pk_bf16_f32 v195, v34, v35
    buffer_load_dwordx4 v23, s[20:23], s92 offen offset:2048 sc1 lds
    v_mfma_f32_16x16x32_bf16 v[44:47], a[208:211], a[176:179], v[60:63]
    v_exp_f32 v36, v36
    v_mfma_f32_16x16x32_bf16 v[44:47], a[212:215], a[180:183], v[44:47]
    v_exp_f32 v37, v37
    v_mfma_f32_16x16x32_bf16 v[44:47], a[216:219], a[184:187], v[44:47]
    v_exp_f32 v38, v38
    v_cvt_pk_bf16_f32 v210, v36, v37
    v_mfma_f32_16x16x32_bf16 v[44:47], a[220:223], a[188:191], v[44:47]
    v_exp_f32 v39, v39
    v_mfma_f32_16x16x32_bf16 a[4:7], a[236:239], v[156:159], a[4:7]
    v_cvt_pk_bf16_f32 v211, v38, v39
    buffer_load_dwordx4 v23, s[20:23], s92 offen offset:3072 sc1 lds
    v_smfmac_f32_16x16x64_bf16 v[68:71], v[4:7], v[144:151], v22
    s_waitcnt lgkmcnt(0)
    v_mfma_f32_16x16x32_bf16 v[32:35], a[192:195], a[128:131], v[48:51]
    v_exp_f32 v40, v40
    v_mfma_f32_16x16x32_bf16 v[32:35], a[196:199], a[132:135], v[32:35]
    ds_read_b128 a[208:211], v8 offset:35840
    v_exp_f32 v41, v41
    v_mfma_f32_16x16x32_bf16 v[32:35], a[200:203], a[136:139], v[32:35]
    s_add_u32 m0, s91, 135168
    v_exp_f32 v42, v42
    v_cvt_pk_bf16_f32 v226, v40, v41
    v_mfma_f32_16x16x32_bf16 v[32:35], a[204:207], a[140:143], v[32:35]
    s_xor_b32 s92, s48, 98304
    ds_read_b128 a[212:215], v9 offset:35840
    v_exp_f32 v43, v43
    v_mfma_f32_16x16x32_bf16 a[8:11], a[224:227], v[160:163], a[8:11]
    v_cvt_pk_bf16_f32 v227, v42, v43
    buffer_load_dwordx4 v23, s[20:23], s92 offen offset:0 sc1 lds
    v_mfma_f32_16x16x32_bf16 v[36:39], a[192:195], a[144:147], v[52:55]
    ds_read_b128 a[216:219], v10 offset:35840
    v_exp_f32 v44, v44
    v_mfma_f32_16x16x32_bf16 v[36:39], a[196:199], a[148:151], v[36:39]
    ds_read_b128 a[220:223], v11 offset:35840
    v_exp_f32 v45, v45
    v_mfma_f32_16x16x32_bf16 v[36:39], a[200:203], a[152:155], v[36:39]
    v_exp_f32 v46, v46
    v_cvt_pk_bf16_f32 v242, v44, v45
    v_mfma_f32_16x16x32_bf16 v[36:39], a[204:207], a[156:159], v[36:39]
    v_exp_f32 v47, v47
    v_mfma_f32_16x16x32_bf16 a[8:11], a[228:231], v[164:167], a[8:11]
    v_cvt_pk_bf16_f32 v243, v46, v47
    buffer_load_dwordx4 v23, s[20:23], s92 offen offset:1024 sc1 lds
    v_mfma_f32_16x16x32_bf16 v[40:43], a[192:195], a[160:163], v[56:59]
    v_exp_f32 v32, v32
    v_mfma_f32_16x16x32_bf16 v[40:43], a[196:199], a[164:167], v[40:43]
    v_exp_f32 v33, v33
    v_mfma_f32_16x16x32_bf16 v[40:43], a[200:203], a[168:171], v[40:43]
    v_exp_f32 v34, v34
    v_cvt_pk_bf16_f32 v196, v32, v33
    v_mfma_f32_16x16x32_bf16 v[40:43], a[204:207], a[172:175], v[40:43]
    v_exp_f32 v35, v35
    v_mfma_f32_16x16x32_bf16 a[8:11], a[232:235], v[168:171], a[8:11]
    v_cvt_pk_bf16_f32 v197, v34, v35
    buffer_load_dwordx4 v23, s[20:23], s92 offen offset:2048 sc1 lds
    v_mfma_f32_16x16x32_bf16 v[44:47], a[192:195], a[176:179], v[60:63]
    v_exp_f32 v36, v36
    v_mfma_f32_16x16x32_bf16 v[44:47], a[196:199], a[180:183], v[44:47]
    v_exp_f32 v37, v37
    v_mfma_f32_16x16x32_bf16 v[44:47], a[200:203], a[184:187], v[44:47]
    v_exp_f32 v38, v38
    v_cvt_pk_bf16_f32 v212, v36, v37
    v_mfma_f32_16x16x32_bf16 v[44:47], a[204:207], a[188:191], v[44:47]
    v_exp_f32 v39, v39
    v_mfma_f32_16x16x32_bf16 a[8:11], a[236:239], v[172:175], a[8:11]
    v_cvt_pk_bf16_f32 v213, v38, v39
    buffer_load_dwordx4 v23, s[20:23], s92 offen offset:3072 sc1 lds
    v_smfmac_f32_16x16x64_bf16 v[72:75], v[4:7], v[160:167], v22
    s_waitcnt lgkmcnt(0)
    v_mfma_f32_16x16x32_bf16 v[32:35], a[208:211], a[128:131], v[48:51]
    v_exp_f32 v40, v40
    v_mfma_f32_16x16x32_bf16 v[32:35], a[212:215], a[132:135], v[32:35]
    ds_read_b128 a[192:195], v8 offset:36864
    v_exp_f32 v41, v41
    v_mfma_f32_16x16x32_bf16 v[32:35], a[216:219], a[136:139], v[32:35]
    s_add_u32 m0, s91, 0
    v_exp_f32 v42, v42
    v_cvt_pk_bf16_f32 v228, v40, v41
    v_mfma_f32_16x16x32_bf16 v[32:35], a[220:223], a[140:143], v[32:35]
    s_xor_b32 s92, s48, 102400
    ds_read_b128 a[196:199], v9 offset:36864
    v_exp_f32 v43, v43
    v_mfma_f32_16x16x32_bf16 a[12:15], a[224:227], v[176:179], a[12:15]
    v_cvt_pk_bf16_f32 v229, v42, v43
    buffer_load_dwordx4 v23, s[20:23], s92 offen offset:0 sc1 lds
    v_mfma_f32_16x16x32_bf16 v[36:39], a[208:211], a[144:147], v[52:55]
    ds_read_b128 a[200:203], v10 offset:36864
    v_exp_f32 v44, v44
    v_mfma_f32_16x16x32_bf16 v[36:39], a[212:215], a[148:151], v[36:39]
    ds_read_b128 a[204:207], v11 offset:36864
    v_exp_f32 v45, v45
    v_mfma_f32_16x16x32_bf16 v[36:39], a[216:219], a[152:155], v[36:39]
    v_exp_f32 v46, v46
    v_cvt_pk_bf16_f32 v244, v44, v45
    v_mfma_f32_16x16x32_bf16 v[36:39], a[220:223], a[156:159], v[36:39]
    v_exp_f32 v47, v47
    v_mfma_f32_16x16x32_bf16 a[12:15], a[228:231], v[180:183], a[12:15]
    v_cvt_pk_bf16_f32 v245, v46, v47
    buffer_load_dwordx4 v23, s[20:23], s92 offen offset:1024 sc1 lds
    v_mfma_f32_16x16x32_bf16 v[40:43], a[208:211], a[160:163], v[56:59]
    v_exp_f32 v32, v32
    v_mfma_f32_16x16x32_bf16 v[40:43], a[212:215], a[164:167], v[40:43]
    v_exp_f32 v33, v33
    v_mfma_f32_16x16x32_bf16 v[40:43], a[216:219], a[168:171], v[40:43]
    v_exp_f32 v34, v34
    v_cvt_pk_bf16_f32 v198, v32, v33
    v_mfma_f32_16x16x32_bf16 v[40:43], a[220:223], a[172:175], v[40:43]
    v_exp_f32 v35, v35
    v_mfma_f32_16x16x32_bf16 a[12:15], a[232:235], v[184:187], a[12:15]
    v_cvt_pk_bf16_f32 v199, v34, v35
    buffer_load_dwordx4 v23, s[20:23], s92 offen offset:2048 sc1 lds
    v_mfma_f32_16x16x32_bf16 v[44:47], a[208:211], a[176:179], v[60:63]
    v_exp_f32 v36, v36
    v_mfma_f32_16x16x32_bf16 v[44:47], a[212:215], a[180:183], v[44:47]
    v_exp_f32 v37, v37
    v_mfma_f32_16x16x32_bf16 v[44:47], a[216:219], a[184:187], v[44:47]
    v_exp_f32 v38, v38
    v_cvt_pk_bf16_f32 v214, v36, v37
    v_mfma_f32_16x16x32_bf16 v[44:47], a[220:223], a[188:191], v[44:47]
    v_exp_f32 v39, v39
    v_mfma_f32_16x16x32_bf16 a[12:15], a[236:239], v[188:191], a[12:15]
    v_cvt_pk_bf16_f32 v215, v38, v39
    buffer_load_dwordx4 v23, s[20:23], s92 offen offset:3072 sc1 lds
    v_smfmac_f32_16x16x64_bf16 v[76:79], v[4:7], v[176:183], v22
    s_waitcnt lgkmcnt(0)
    v_mfma_f32_16x16x32_bf16 v[32:35], a[192:195], a[128:131], v[48:51]
    v_exp_f32 v40, v40
    v_mfma_f32_16x16x32_bf16 v[32:35], a[196:199], a[132:135], v[32:35]
    ds_read_b128 a[208:211], v8 offset:37888
    v_exp_f32 v41, v41
    v_mfma_f32_16x16x32_bf16 v[32:35], a[200:203], a[136:139], v[32:35]
    s_add_u32 m0, s91, 4096
    v_exp_f32 v42, v42
    v_cvt_pk_bf16_f32 v230, v40, v41
    v_mfma_f32_16x16x32_bf16 v[32:35], a[204:207], a[140:143], v[32:35]
    s_xor_b32 s92, s48, 106496
    ds_read_b128 a[212:215], v9 offset:37888
    v_exp_f32 v43, v43
    v_mfma_f32_16x16x32_bf16 a[16:19], a[240:243], v[128:131], a[16:19]
    v_cvt_pk_bf16_f32 v231, v42, v43
    buffer_load_dwordx4 v23, s[20:23], s92 offen offset:0 sc1 lds
    v_mfma_f32_16x16x32_bf16 v[36:39], a[192:195], a[144:147], v[52:55]
    ds_read_b128 a[216:219], v10 offset:37888
    v_exp_f32 v44, v44
    v_mfma_f32_16x16x32_bf16 v[36:39], a[196:199], a[148:151], v[36:39]
    ds_read_b128 a[220:223], v11 offset:37888
    v_exp_f32 v45, v45
    v_mfma_f32_16x16x32_bf16 v[36:39], a[200:203], a[152:155], v[36:39]
    v_exp_f32 v46, v46
    v_cvt_pk_bf16_f32 v246, v44, v45
    v_mfma_f32_16x16x32_bf16 v[36:39], a[204:207], a[156:159], v[36:39]
    v_exp_f32 v47, v47
    v_mfma_f32_16x16x32_bf16 a[16:19], a[244:247], v[132:135], a[16:19]
    v_cvt_pk_bf16_f32 v247, v46, v47
    buffer_load_dwordx4 v23, s[20:23], s92 offen offset:1024 sc1 lds
    v_mfma_f32_16x16x32_bf16 v[40:43], a[192:195], a[160:163], v[56:59]
    v_exp_f32 v32, v32
    v_mfma_f32_16x16x32_bf16 v[40:43], a[196:199], a[164:167], v[40:43]
    v_exp_f32 v33, v33
    v_mfma_f32_16x16x32_bf16 v[40:43], a[200:203], a[168:171], v[40:43]
    v_exp_f32 v34, v34
    v_cvt_pk_bf16_f32 v200, v32, v33
    v_mfma_f32_16x16x32_bf16 v[40:43], a[204:207], a[172:175], v[40:43]
    v_exp_f32 v35, v35
    v_mfma_f32_16x16x32_bf16 a[16:19], a[248:251], v[136:139], a[16:19]
    v_cvt_pk_bf16_f32 v201, v34, v35
    buffer_load_dwordx4 v23, s[20:23], s92 offen offset:2048 sc1 lds
    v_mfma_f32_16x16x32_bf16 v[44:47], a[192:195], a[176:179], v[60:63]
    v_exp_f32 v36, v36
    v_mfma_f32_16x16x32_bf16 v[44:47], a[196:199], a[180:183], v[44:47]
    v_exp_f32 v37, v37
    v_mfma_f32_16x16x32_bf16 v[44:47], a[200:203], a[184:187], v[44:47]
    v_exp_f32 v38, v38
    v_cvt_pk_bf16_f32 v216, v36, v37
    v_mfma_f32_16x16x32_bf16 v[44:47], a[204:207], a[188:191], v[44:47]
    v_exp_f32 v39, v39
    v_mfma_f32_16x16x32_bf16 a[16:19], a[252:255], v[140:143], a[16:19]
    v_cvt_pk_bf16_f32 v217, v38, v39
    buffer_load_dwordx4 v23, s[20:23], s92 offen offset:3072 sc1 lds
    v_smfmac_f32_16x16x64_bf16 v[64:67], v[4:7], v[136:143], v22
    s_waitcnt lgkmcnt(0)
    v_mfma_f32_16x16x32_bf16 v[32:35], a[208:211], a[128:131], v[48:51]
    v_exp_f32 v40, v40
    v_mfma_f32_16x16x32_bf16 v[32:35], a[212:215], a[132:135], v[32:35]
    ds_read_b128 a[192:195], v8 offset:38912
    v_exp_f32 v41, v41
    v_mfma_f32_16x16x32_bf16 v[32:35], a[216:219], a[136:139], v[32:35]
    v_exp_f32 v42, v42
    v_cvt_pk_bf16_f32 v232, v40, v41
    v_mfma_f32_16x16x32_bf16 v[32:35], a[220:223], a[140:143], v[32:35]
    s_xor_b32 s92, s48, 0
    ds_read_b128 a[196:199], v9 offset:38912
    v_exp_f32 v43, v43
    v_mfma_f32_16x16x32_bf16 a[20:23], a[240:243], v[144:147], a[20:23]
    v_cvt_pk_bf16_f32 v233, v42, v43
    buffer_load_dwordx4 v[96:99], v23, s[20:23], s92 offen offset:0 sc1
    v_mfma_f32_16x16x32_bf16 v[36:39], a[208:211], a[144:147], v[52:55]
    ds_read_b128 a[200:203], v10 offset:38912
    v_exp_f32 v44, v44
    v_mfma_f32_16x16x32_bf16 v[36:39], a[212:215], a[148:151], v[36:39]
    ds_read_b128 a[204:207], v11 offset:38912
    v_exp_f32 v45, v45
    v_mfma_f32_16x16x32_bf16 v[36:39], a[216:219], a[152:155], v[36:39]
    v_exp_f32 v46, v46
    v_cvt_pk_bf16_f32 v248, v44, v45
    v_mfma_f32_16x16x32_bf16 v[36:39], a[220:223], a[156:159], v[36:39]
    v_exp_f32 v47, v47
    v_mfma_f32_16x16x32_bf16 a[20:23], a[244:247], v[148:151], a[20:23]
    v_cvt_pk_bf16_f32 v249, v46, v47
    buffer_load_dwordx4 v[100:103], v23, s[20:23], s92 offen offset:1024 sc1
    v_mfma_f32_16x16x32_bf16 v[40:43], a[208:211], a[160:163], v[56:59]
    v_exp_f32 v32, v32
    v_mfma_f32_16x16x32_bf16 v[40:43], a[212:215], a[164:167], v[40:43]
    v_exp_f32 v33, v33
    v_mfma_f32_16x16x32_bf16 v[40:43], a[216:219], a[168:171], v[40:43]
    v_exp_f32 v34, v34
    v_cvt_pk_bf16_f32 v202, v32, v33
    v_mfma_f32_16x16x32_bf16 v[40:43], a[220:223], a[172:175], v[40:43]
    v_exp_f32 v35, v35
    v_mfma_f32_16x16x32_bf16 a[20:23], a[248:251], v[152:155], a[20:23]
    v_cvt_pk_bf16_f32 v203, v34, v35
    buffer_load_dwordx4 v[104:107], v23, s[20:23], s92 offen offset:2048 sc1
    v_mfma_f32_16x16x32_bf16 v[44:47], a[208:211], a[176:179], v[60:63]
    v_exp_f32 v36, v36
    v_mfma_f32_16x16x32_bf16 v[44:47], a[212:215], a[180:183], v[44:47]
    v_exp_f32 v37, v37
    v_mfma_f32_16x16x32_bf16 v[44:47], a[216:219], a[184:187], v[44:47]
    v_exp_f32 v38, v38
    v_cvt_pk_bf16_f32 v218, v36, v37
    v_mfma_f32_16x16x32_bf16 v[44:47], a[220:223], a[188:191], v[44:47]
    v_exp_f32 v39, v39
    v_mfma_f32_16x16x32_bf16 a[20:23], a[252:255], v[156:159], a[20:23]
    v_cvt_pk_bf16_f32 v219, v38, v39
    buffer_load_dwordx4 v[108:111], v23, s[20:23], s92 offen offset:3072 sc1
    v_smfmac_f32_16x16x64_bf16 v[68:71], v[4:7], v[152:159], v22
    s_waitcnt lgkmcnt(0)
    v_mfma_f32_16x16x32_bf16 v[32:35], a[192:195], a[128:131], v[48:51]
    v_exp_f32 v40, v40
    v_mfma_f32_16x16x32_bf16 v[32:35], a[196:199], a[132:135], v[32:35]
    ds_read_b128 a[208:211], v8 offset:39936
    v_exp_f32 v41, v41
    v_mfma_f32_16x16x32_bf16 v[32:35], a[200:203], a[136:139], v[32:35]
    v_exp_f32 v42, v42
    v_cvt_pk_bf16_f32 v234, v40, v41
    v_mfma_f32_16x16x32_bf16 v[32:35], a[204:207], a[140:143], v[32:35]
    s_xor_b32 s92, s48, 4096
    ds_read_b128 a[212:215], v9 offset:39936
    v_exp_f32 v43, v43
    v_mfma_f32_16x16x32_bf16 a[24:27], a[240:243], v[160:163], a[24:27]
    v_cvt_pk_bf16_f32 v235, v42, v43
    buffer_load_dwordx4 v[112:115], v23, s[20:23], s92 offen offset:0 sc1
    v_mfma_f32_16x16x32_bf16 v[36:39], a[192:195], a[144:147], v[52:55]
    ds_read_b128 a[216:219], v10 offset:39936
    v_exp_f32 v44, v44
    v_mfma_f32_16x16x32_bf16 v[36:39], a[196:199], a[148:151], v[36:39]
    ds_read_b128 a[220:223], v11 offset:39936
    v_exp_f32 v45, v45
    v_mfma_f32_16x16x32_bf16 v[36:39], a[200:203], a[152:155], v[36:39]
    v_exp_f32 v46, v46
    v_cvt_pk_bf16_f32 v250, v44, v45
    v_mfma_f32_16x16x32_bf16 v[36:39], a[204:207], a[156:159], v[36:39]
    v_exp_f32 v47, v47
    v_mfma_f32_16x16x32_bf16 a[24:27], a[244:247], v[164:167], a[24:27]
    v_cvt_pk_bf16_f32 v251, v46, v47
    buffer_load_dwordx4 v[116:119], v23, s[20:23], s92 offen offset:1024 sc1
    v_mfma_f32_16x16x32_bf16 v[40:43], a[192:195], a[160:163], v[56:59]
    v_exp_f32 v32, v32
    v_mfma_f32_16x16x32_bf16 v[40:43], a[196:199], a[164:167], v[40:43]
    v_exp_f32 v33, v33
    v_mfma_f32_16x16x32_bf16 v[40:43], a[200:203], a[168:171], v[40:43]
    v_exp_f32 v34, v34
    v_cvt_pk_bf16_f32 v204, v32, v33
    v_mfma_f32_16x16x32_bf16 v[40:43], a[204:207], a[172:175], v[40:43]
    v_exp_f32 v35, v35
    v_mfma_f32_16x16x32_bf16 a[24:27], a[248:251], v[168:171], a[24:27]
    v_cvt_pk_bf16_f32 v205, v34, v35
    buffer_load_dwordx4 v[120:123], v23, s[20:23], s92 offen offset:2048 sc1
    v_mfma_f32_16x16x32_bf16 v[44:47], a[192:195], a[176:179], v[60:63]
    v_exp_f32 v36, v36
    v_mfma_f32_16x16x32_bf16 v[44:47], a[196:199], a[180:183], v[44:47]
    v_exp_f32 v37, v37
    v_mfma_f32_16x16x32_bf16 v[44:47], a[200:203], a[184:187], v[44:47]
    v_exp_f32 v38, v38
    v_cvt_pk_bf16_f32 v220, v36, v37
    v_mfma_f32_16x16x32_bf16 v[44:47], a[204:207], a[188:191], v[44:47]
    v_exp_f32 v39, v39
    v_mfma_f32_16x16x32_bf16 a[24:27], a[252:255], v[172:175], a[24:27]
    v_cvt_pk_bf16_f32 v221, v38, v39
    buffer_load_dwordx4 v[124:127], v23, s[20:23], s92 offen offset:3072 sc1
    v_smfmac_f32_16x16x64_bf16 v[72:75], v[4:7], v[168:175], v22
    s_waitcnt lgkmcnt(0)
    v_mfma_f32_16x16x32_bf16 v[32:35], a[208:211], a[128:131], v[48:51]
    s_waitcnt vmcnt(24)
    s_barrier
    v_exp_f32 v40, v40
    v_mfma_f32_16x16x32_bf16 v[32:35], a[212:215], a[132:135], v[32:35]
    ds_read_b64_tr_b16 a[224:225], v12 offset:32768
    v_exp_f32 v41, v41
    v_mfma_f32_16x16x32_bf16 v[32:35], a[216:219], a[136:139], v[32:35]
    s_add_u32 m0, s91, 36864
    v_exp_f32 v42, v42
    v_cvt_pk_bf16_f32 v236, v40, v41
    v_mfma_f32_16x16x32_bf16 v[32:35], a[220:223], a[140:143], v[32:35]
    s_xor_b32 s92, s48, 77824
    ds_read_b64_tr_b16 a[226:227], v12 offset:33792
    v_exp_f32 v43, v43
    v_mfma_f32_16x16x32_bf16 a[28:31], a[240:243], v[176:179], a[28:31]
    v_cvt_pk_bf16_f32 v237, v42, v43
    buffer_load_dwordx4 v23, s[20:23], s92 offen offset:0 sc1 lds
    v_mfma_f32_16x16x32_bf16 v[36:39], a[208:211], a[144:147], v[52:55]
    ds_read_b64_tr_b16 a[228:229], v12 offset:34816
    v_exp_f32 v44, v44
    v_mfma_f32_16x16x32_bf16 v[36:39], a[212:215], a[148:151], v[36:39]
    ds_read_b64_tr_b16 a[230:231], v12 offset:35840
    v_exp_f32 v45, v45
    v_mfma_f32_16x16x32_bf16 v[36:39], a[216:219], a[152:155], v[36:39]
    v_exp_f32 v46, v46
    v_cvt_pk_bf16_f32 v252, v44, v45
    v_mfma_f32_16x16x32_bf16 v[36:39], a[220:223], a[156:159], v[36:39]
    ds_read_b64_tr_b16 a[232:233], v12 offset:36864
    v_exp_f32 v47, v47
    v_mfma_f32_16x16x32_bf16 a[28:31], a[244:247], v[180:183], a[28:31]
    v_cvt_pk_bf16_f32 v253, v46, v47
    buffer_load_dwordx4 v23, s[20:23], s92 offen offset:1024 sc1 lds
    v_mfma_f32_16x16x32_bf16 v[40:43], a[208:211], a[160:163], v[56:59]
    ds_read_b64_tr_b16 a[234:235], v12 offset:37888
    v_exp_f32 v32, v32
    v_mfma_f32_16x16x32_bf16 v[40:43], a[212:215], a[164:167], v[40:43]
    ds_read_b64_tr_b16 a[236:237], v12 offset:38912
    v_exp_f32 v33, v33
    v_mfma_f32_16x16x32_bf16 v[40:43], a[216:219], a[168:171], v[40:43]
    v_exp_f32 v34, v34
    v_cvt_pk_bf16_f32 v206, v32, v33
    v_mfma_f32_16x16x32_bf16 v[40:43], a[220:223], a[172:175], v[40:43]
    ds_read_b64_tr_b16 a[238:239], v12 offset:39936
    v_exp_f32 v35, v35
    v_mfma_f32_16x16x32_bf16 a[28:31], a[248:251], v[184:187], a[28:31]
    v_cvt_pk_bf16_f32 v207, v34, v35
    buffer_load_dwordx4 v23, s[20:23], s92 offen offset:2048 sc1 lds
    v_mfma_f32_16x16x32_bf16 v[44:47], a[208:211], a[176:179], v[60:63]
    v_exp_f32 v36, v36
    v_mfma_f32_16x16x32_bf16 v[44:47], a[212:215], a[180:183], v[44:47]
    v_exp_f32 v37, v37
    v_mfma_f32_16x16x32_bf16 v[44:47], a[216:219], a[184:187], v[44:47]
    v_exp_f32 v38, v38
    v_cvt_pk_bf16_f32 v222, v36, v37
    v_mfma_f32_16x16x32_bf16 v[44:47], a[220:223], a[188:191], v[44:47]
    v_exp_f32 v39, v39
    v_mfma_f32_16x16x32_bf16 a[28:31], a[252:255], v[188:191], a[28:31]
    v_cvt_pk_bf16_f32 v223, v38, v39
    buffer_load_dwordx4 v23, s[20:23], s92 offen offset:3072 sc1 lds
    v_smfmac_f32_16x16x64_bf16 v[76:79], v[4:7], v[184:191], v22
    s_waitcnt lgkmcnt(0)
    s_mov_b32 s47, 0x5d800000
    s_lshl_b32 s97, s98, 17
    s_lshl_b32 s95, s88, 14
    s_add_u32 s97, s97, s95
    s_add_u32 s97, s97, 16777216
    v_mfma_f32_16x16x32_bf16 a[0:3], a[224:227], v[192:195], a[0:3]
    v_exp_f32 v40, v40
    v_mfma_f32_16x16x32_bf16 a[0:3], a[228:231], v[196:199], a[0:3]
    v_exp_f32 v41, v41
    v_mfma_f32_16x16x32_bf16 a[0:3], a[232:235], v[200:203], a[0:3]
    v_exp_f32 v42, v42
    v_mfma_f32_16x16x32_bf16 a[0:3], a[236:239], v[204:207], a[0:3]
    v_exp_f32 v43, v43
    v_mfma_f32_16x16x32_bf16 a[4:7], a[224:227], v[208:211], a[4:7]
    v_cvt_pk_bf16_f32 v238, v40, v41
    v_cvt_pk_bf16_f32 v239, v42, v43
    v_mfma_f32_16x16x32_bf16 a[4:7], a[228:231], v[212:215], a[4:7]
    v_exp_f32 v44, v44
    s_mov_b32 s12, s36
    v_mfma_f32_16x16x32_bf16 a[4:7], a[232:235], v[216:219], a[4:7]
    v_exp_f32 v45, v45
    s_mov_b32 s13, s37
    v_mfma_f32_16x16x32_bf16 a[4:7], a[236:239], v[220:223], a[4:7]
    v_exp_f32 v46, v46
    s_mov_b32 s14, 2097152
    v_mfma_f32_16x16x32_bf16 a[8:11], a[224:227], v[224:227], a[8:11]
    v_exp_f32 v47, v47
    s_mov_b32 s15, 0x20000
    v_mfma_f32_16x16x32_bf16 a[8:11], a[228:231], v[228:231], a[8:11]
    v_cvt_pk_bf16_f32 v254, v44, v45
    v_cvt_pk_bf16_f32 v255, v46, v47
    s_mov_b32 s16, s56
    v_mfma_f32_16x16x32_bf16 a[8:11], a[232:235], v[232:235], a[8:11]
    s_mov_b32 s17, s57
    ds_read_b64_tr_b16 a[240:241], v13 offset:32768
    s_xor_b32 s92, s48, 8192
    buffer_load_dwordx4 a[128:131], v23, s[20:23], s92 offen offset:0 sc1
    v_mfma_f32_16x16x32_bf16 a[8:11], a[236:239], v[236:239], a[8:11]
    s_mov_b32 s18, 2097152
    ds_read_b64_tr_b16 a[242:243], v13 offset:33792
    v_mfma_f32_16x16x32_bf16 a[12:15], a[224:227], v[240:243], a[12:15]
    s_mov_b32 s19, 0x20000
    ds_read_b64_tr_b16 a[244:245], v13 offset:34816
    v_mfma_f32_16x16x32_bf16 a[12:15], a[228:231], v[244:247], a[12:15]
    ds_read_b64_tr_b16 a[246:247], v13 offset:35840
    v_mfma_f32_16x16x32_bf16 a[12:15], a[232:235], v[248:251], a[12:15]
    ds_read_b64_tr_b16 a[248:249], v13 offset:36864
    v_mfma_f32_16x16x32_bf16 a[12:15], a[236:239], v[252:255], a[12:15]
    ds_read_b64_tr_b16 a[250:251], v13 offset:37888
    v_smfmac_f32_16x16x64_bf16 v[64:67], v[4:7], v[192:199], v22
    ds_read_b64_tr_b16 a[252:253], v13 offset:38912
    buffer_load_dwordx4 a[132:135], v23, s[20:23], s92 offen offset:1024 sc1
    v_smfmac_f32_16x16x64_bf16 v[68:71], v[4:7], v[208:215], v22
    ds_read_b64_tr_b16 a[254:255], v13 offset:39936
    v_smfmac_f32_16x16x64_bf16 v[72:75], v[4:7], v[224:231], v22
    v_smfmac_f32_16x16x64_bf16 v[76:79], v[4:7], v[240:247], v22
    v_smfmac_f32_16x16x64_bf16 v[64:67], v[4:7], v[200:207], v22
    v_smfmac_f32_16x16x64_bf16 v[68:71], v[4:7], v[216:223], v22
    v_smfmac_f32_16x16x64_bf16 v[72:75], v[4:7], v[232:239], v22
    buffer_load_dwordx4 a[136:139], v23, s[20:23], s92 offen offset:2048 sc1
    v_smfmac_f32_16x16x64_bf16 v[76:79], v[4:7], v[248:255], v22
    s_waitcnt lgkmcnt(0)
    v_mfma_f32_16x16x32_bf16 a[28:31], a[240:243], v[240:243], a[28:31]
    ds_read_b64_tr_b16 a[224:225], v14 offset:32768
    v_mfma_f32_16x16x32_bf16 a[28:31], a[244:247], v[244:247], a[28:31]
    ds_read_b64_tr_b16 a[226:227], v14 offset:33792
    v_mfma_f32_16x16x32_bf16 a[28:31], a[248:251], v[248:251], a[28:31]
    ds_read_b64_tr_b16 a[228:229], v14 offset:34816
    v_mfma_f32_16x16x32_bf16 a[28:31], a[252:255], v[252:255], a[28:31]
    ds_read_b64_tr_b16 a[230:231], v14 offset:35840
    v_add_f32 v64, v64, v65
    v_mfma_f32_16x16x32_bf16 a[24:27], a[252:255], v[236:239], a[24:27]
    ds_read_b64_tr_b16 a[232:233], v14 offset:36864
    buffer_load_dwordx4 a[140:143], v23, s[20:23], s92 offen offset:3072 sc1
    v_mfma_f32_16x16x32_bf16 a[24:27], a[248:251], v[232:235], a[24:27]
    ds_read_b64_tr_b16 a[234:235], v14 offset:37888
    v_add_f32 v68, v68, v69
    v_mfma_f32_16x16x32_bf16 a[24:27], a[244:247], v[228:231], a[24:27]
    ds_read_b64_tr_b16 a[236:237], v14 offset:38912
    v_add_f32 v72, v72, v73
    v_mfma_f32_16x16x32_bf16 a[24:27], a[240:243], v[224:227], a[24:27]
    ds_read_b64_tr_b16 a[238:239], v14 offset:39936
    v_add_f32 v76, v76, v77
    v_mfma_f32_16x16x32_bf16 a[20:23], a[240:243], v[208:211], a[20:23]
    v_rcp_f32 v67, v64
    v_mfma_f32_16x16x32_bf16 a[20:23], a[244:247], v[212:215], a[20:23]
    v_rcp_f32 v71, v68
    v_mfma_f32_16x16x32_bf16 a[20:23], a[248:251], v[216:219], a[20:23]
    s_xor_b32 s92, s48, 12288
    buffer_load_dwordx4 a[144:147], v23, s[20:23], s92 offen offset:0 sc1
    v_mfma_f32_16x16x32_bf16 a[20:23], a[252:255], v[220:223], a[20:23]
    v_rcp_f32 v75, v72
    v_mfma_f32_16x16x32_bf16 a[16:19], a[252:255], v[204:207], a[16:19]
    v_rcp_f32 v79, v76
    v_mfma_f32_16x16x32_bf16 a[16:19], a[248:251], v[200:203], a[16:19]
    v_mul_f32 v65, -v66, v67
    v_mul_f32 v69, -v70, v71
    v_mfma_f32_16x16x32_bf16 a[16:19], a[244:247], v[196:199], a[16:19]
    v_mul_f32 v73, -v74, v75
    v_mul_f32 v77, -v78, v79
    v_mfma_f32_16x16x32_bf16 a[16:19], a[240:243], v[192:195], a[16:19]
    s_waitcnt lgkmcnt(0)
    v_add_f32 v27, v64, v68
    v_add_f32 v26, v72, v76
    v_mfma_f32_16x16x32_bf16 a[32:35], a[224:227], v[192:195], a[32:35]
    ds_read_b64_tr_b16 a[240:241], v14 offset:0
    buffer_load_dwordx4 a[148:151], v23, s[20:23], s92 offen offset:1024 sc1
    v_mfma_f32_16x16x32_bf16 a[32:35], a[228:231], v[196:199], a[32:35]
    ds_read_b64_tr_b16 a[242:243], v14 offset:1024
    v_and_b32 v24, 3, v2
    v_mfma_f32_16x16x32_bf16 a[32:35], a[232:235], v[200:203], a[32:35]
    ds_read_b64_tr_b16 a[244:245], v14 offset:2048
    v_add_f32 v27, v27, v26
    v_mfma_f32_16x16x32_bf16 a[32:35], a[236:239], v[204:207], a[32:35]
    ds_read_b64_tr_b16 a[246:247], v14 offset:3072
    v_lshlrev_b32 v24, 13, v24
    v_mfma_f32_16x16x32_bf16 a[36:39], a[236:239], v[220:223], a[36:39]
    ds_read_b64_tr_b16 a[248:249], v14 offset:4096
    v_cmp_ngt_f32 vcc, s47, v27
    v_mfma_f32_16x16x32_bf16 a[36:39], a[232:235], v[216:219], a[36:39]
    ds_read_b64_tr_b16 a[250:251], v14 offset:5120
    s_lshl_b32 s95, s89, 2
    v_add_u32 v24, s95, v24
    v_mfma_f32_16x16x32_bf16 a[36:39], a[228:231], v[212:215], a[36:39]
    ds_read_b64_tr_b16 a[252:253], v14 offset:6144
    buffer_load_dwordx4 a[152:155], v23, s[20:23], s92 offen offset:2048 sc1
    v_mfma_f32_16x16x32_bf16 a[36:39], a[224:227], v[208:211], a[36:39]
    ds_read_b64_tr_b16 a[254:255], v14 offset:7168
    s_cmp_lg_u64 vcc, 0
    s_cselect_b32 s46, 1, 0
    v_mov_b32 v27, s46
    v_mfma_f32_16x16x32_bf16 a[40:43], a[224:227], v[224:227], a[40:43]
    ds_write_b32 v24, v27 offset:32768
    v_mov_b32 v25, s91
    v_mfma_f32_16x16x32_bf16 a[40:43], a[228:231], v[228:231], a[40:43]
    v_accvgpr_read_b32 v32, a0
    v_accvgpr_read_b32 v33, a1
    v_mfma_f32_16x16x32_bf16 a[40:43], a[232:235], v[232:235], a[40:43]
    v_accvgpr_read_b32 v34, a2
    v_accvgpr_read_b32 v35, a3
    v_mfma_f32_16x16x32_bf16 a[40:43], a[236:239], v[236:239], a[40:43]
    v_accvgpr_read_b32 v36, a16
    v_accvgpr_read_b32 v37, a17
    v_mfma_f32_16x16x32_bf16 a[44:47], a[236:239], v[252:255], a[44:47]
    buffer_load_dwordx4 a[156:159], v23, s[20:23], s92 offen offset:3072 sc1
    v_accvgpr_read_b32 v38, a18
    v_mfma_f32_16x16x32_bf16 a[44:47], a[232:235], v[248:251], a[44:47]
    v_accvgpr_read_b32 v39, a19
    v_fma_f32 v32, v32, v67, v65
    v_mfma_f32_16x16x32_bf16 a[44:47], a[228:231], v[244:247], a[44:47]
    v_fma_f32 v33, v33, v67, v65
    v_fma_f32 v34, v34, v67, v65
    v_mfma_f32_16x16x32_bf16 a[44:47], a[224:227], v[240:243], a[44:47]
    s_waitcnt lgkmcnt(0)
    v_fma_f32 v35, v35, v67, v65
    v_fma_f32 v36, v36, v67, v65
    v_mfma_f32_16x16x32_bf16 a[44:47], a[240:243], v[176:179], a[44:47]
    s_barrier
    ds_read_b128 v[24:27], v25 offset:32768
    v_fma_f32 v37, v37, v67, v65
    v_mfma_f32_16x16x32_bf16 a[44:47], a[244:247], v[180:183], a[44:47]
    ds_read_b64_tr_b16 a[224:225], v15 offset:0
    v_fma_f32 v38, v38, v67, v65
    v_mfma_f32_16x16x32_bf16 a[44:47], a[248:251], v[184:187], a[44:47]
    ds_read_b64_tr_b16 a[226:227], v15 offset:1024
    s_xor_b32 s92, s48, 16384
    buffer_load_dwordx4 a[160:163], v23, s[20:23], s92 offen offset:0 sc1
    v_mfma_f32_16x16x32_bf16 a[44:47], a[252:255], v[188:191], a[44:47]
    ds_read_b64_tr_b16 a[228:229], v15 offset:2048
    v_fma_f32 v39, v39, v67, v65
    v_mfma_f32_16x16x32_bf16 a[40:43], a[252:255], v[172:175], a[40:43]
    ds_read_b64_tr_b16 a[230:231], v15 offset:3072
    v_cvt_pk_bf16_f32 v32, v32, v33
    v_mfma_f32_16x16x32_bf16 a[40:43], a[248:251], v[168:171], a[40:43]
    ds_read_b64_tr_b16 a[232:233], v15 offset:4096
    v_cvt_pk_bf16_f32 v33, v34, v35
    v_mfma_f32_16x16x32_bf16 a[40:43], a[244:247], v[164:167], a[40:43]
    ds_read_b64_tr_b16 a[234:235], v15 offset:5120
    v_cvt_pk_bf16_f32 v34, v36, v37
    v_mfma_f32_16x16x32_bf16 a[40:43], a[240:243], v[160:163], a[40:43]
    ds_read_b64_tr_b16 a[236:237], v15 offset:6144
    v_cvt_pk_bf16_f32 v35, v38, v39
    v_mfma_f32_16x16x32_bf16 a[36:39], a[240:243], v[144:147], a[36:39]
    ds_read_b64_tr_b16 a[238:239], v15 offset:7168
    buffer_load_dwordx4 a[164:167], v23, s[20:23], s92 offen offset:1024 sc1
    v_mfma_f32_16x16x32_bf16 a[36:39], a[244:247], v[148:151], a[36:39]
    s_add_u32 s93, s97, 0
    buffer_store_dwordx4 v[32:35], v23, s[20:23], s93 offen offset:0 sc1
    v_accvgpr_read_b32 v40, a4
    v_mfma_f32_16x16x32_bf16 a[36:39], a[248:251], v[152:155], a[36:39]
    v_accvgpr_read_b32 v41, a5
    v_accvgpr_read_b32 v42, a6
    v_mfma_f32_16x16x32_bf16 a[36:39], a[252:255], v[156:159], a[36:39]
    v_accvgpr_read_b32 v43, a7
    v_accvgpr_read_b32 v44, a20
    v_mfma_f32_16x16x32_bf16 a[32:35], a[252:255], v[140:143], a[32:35]
    v_accvgpr_read_b32 v45, a21
    v_accvgpr_read_b32 v46, a22
    v_mfma_f32_16x16x32_bf16 a[32:35], a[248:251], v[136:139], a[32:35]
    v_accvgpr_read_b32 v47, a23
    v_fma_f32 v40, v40, v71, v69
    v_mfma_f32_16x16x32_bf16 a[32:35], a[244:247], v[132:135], a[32:35]
    v_fma_f32 v41, v41, v71, v69
    v_fma_f32 v42, v42, v71, v69
    v_mfma_f32_16x16x32_bf16 a[32:35], a[240:243], v[128:131], a[32:35]
    s_waitcnt lgkmcnt(0)
    buffer_load_dwordx4 a[168:171], v23, s[20:23], s92 offen offset:2048 sc1
    v_fma_f32 v43, v43, v71, v69
    v_mfma_f32_16x16x32_bf16 a[48:51], a[224:227], v[128:131], a[48:51]
    ds_read_b64_tr_b16 a[240:241], v15 offset:32768
    v_or_b32 v24, v24, v25
    v_mfma_f32_16x16x32_bf16 a[48:51], a[228:231], v[132:135], a[48:51]
    ds_read_b64_tr_b16 a[242:243], v15 offset:33792
    v_or3_b32 v24, v24, v26, v27
    v_mfma_f32_16x16x32_bf16 a[48:51], a[232:235], v[136:139], a[48:51]
    ds_read_b64_tr_b16 a[244:245], v15 offset:34816
    v_readfirstlane_b32 s46, v24
    v_mfma_f32_16x16x32_bf16 a[48:51], a[236:239], v[140:143], a[48:51]
    ds_read_b64_tr_b16 a[246:247], v15 offset:35840
    v_fma_f32 v44, v44, v71, v69
    v_mfma_f32_16x16x32_bf16 a[52:55], a[236:239], v[156:159], a[52:55]
    s_andn2_b32 s46, s46, s96
    s_cbranch_scc1 K2_SLOW
    ds_read_b64_tr_b16 a[248:249], v15 offset:36864
    v_fma_f32 v45, v45, v71, v69
    v_mfma_f32_16x16x32_bf16 a[52:55], a[232:235], v[152:155], a[52:55]
    s_waitcnt vmcnt(30)
    ds_read_b64_tr_b16 a[250:251], v15 offset:37888
    buffer_load_dwordx4 a[172:175], v23, s[20:23], s92 offen offset:3072 sc1
    v_mfma_f32_16x16x32_bf16 a[52:55], a[228:231], v[148:151], a[52:55]
    ds_read_b64_tr_b16 a[252:253], v15 offset:38912
    v_fma_f32 v46, v46, v71, v69
    v_mfma_f32_16x16x32_bf16 a[52:55], a[224:227], v[144:147], a[52:55]
    ds_read_b64_tr_b16 a[254:255], v15 offset:39936
    v_fma_f32 v47, v47, v71, v69
    v_mfma_f32_16x16x32_bf16 a[56:59], a[224:227], v[160:163], a[56:59]
    v_cvt_pk_bf16_f32 v40, v40, v41
    v_cvt_pk_bf16_f32 v41, v42, v43
    v_mfma_f32_16x16x32_bf16 a[56:59], a[228:231], v[164:167], a[56:59]
    v_cvt_pk_bf16_f32 v42, v44, v45
    v_cvt_pk_bf16_f32 v43, v46, v47
    v_mfma_f32_16x16x32_bf16 a[56:59], a[232:235], v[168:171], a[56:59]
    buffer_store_dwordx4 v[40:43], v23, s[20:23], s93 offen offset:1024 sc1
    v_accvgpr_read_b32 v48, a8
    v_mfma_f32_16x16x32_bf16 a[56:59], a[236:239], v[172:175], a[56:59]
    v_accvgpr_read_b32 v49, a9
    v_accvgpr_read_b32 v50, a10
    v_mfma_f32_16x16x32_bf16 a[60:63], a[236:239], v[188:191], a[60:63]
    v_accvgpr_read_b32 v51, a11
    v_accvgpr_read_b32 v52, a24
    v_mfma_f32_16x16x32_bf16 a[60:63], a[232:235], v[184:187], a[60:63]
    v_accvgpr_read_b32 v53, a25
    v_accvgpr_read_b32 v54, a26
    v_mfma_f32_16x16x32_bf16 a[60:63], a[228:231], v[180:183], a[60:63]
    v_accvgpr_read_b32 v55, a27
    v_fma_f32 v48, v48, v75, v73
    v_mfma_f32_16x16x32_bf16 a[60:63], a[224:227], v[176:179], a[60:63]
    s_waitcnt lgkmcnt(0)
    v_fma_f32 v49, v49, v75, v73
    v_fma_f32 v50, v50, v75, v73
    v_mfma_f32_16x16x32_bf16 a[60:63], a[240:243], v[240:243], a[60:63]
    ds_read_b64_tr_b16 a[224:225], v16 offset:32768
    s_xor_b32 s92, s48, 20480
    buffer_load_dwordx4 a[176:179], v23, s[20:23], s92 offen offset:0 sc1
    v_mfma_f32_16x16x32_bf16 a[60:63], a[244:247], v[244:247], a[60:63]
    ds_read_b64_tr_b16 a[226:227], v16 offset:33792
    v_fma_f32 v51, v51, v75, v73
    v_mfma_f32_16x16x32_bf16 a[60:63], a[248:251], v[248:251], a[60:63]
    ds_read_b64_tr_b16 a[228:229], v16 offset:34816
    v_fma_f32 v52, v52, v75, v73
    v_mfma_f32_16x16x32_bf16 a[60:63], a[252:255], v[252:255], a[60:63]
    ds_read_b64_tr_b16 a[230:231], v16 offset:35840
    v_fma_f32 v53, v53, v75, v73
    v_mfma_f32_16x16x32_bf16 a[56:59], a[252:255], v[236:239], a[56:59]
    ds_read_b64_tr_b16 a[232:233], v16 offset:36864
    v_fma_f32 v54, v54, v75, v73
    v_mfma_f32_16x16x32_bf16 a[56:59], a[248:251], v[232:235], a[56:59]
    ds_read_b64_tr_b16 a[234:235], v16 offset:37888
    v_fma_f32 v55, v55, v75, v73
    v_mfma_f32_16x16x32_bf16 a[56:59], a[244:247], v[228:231], a[56:59]
    ds_read_b64_tr_b16 a[236:237], v16 offset:38912
    buffer_load_dwordx4 a[180:183], v23, s[20:23], s92 offen offset:1024 sc1
    v_mfma_f32_16x16x32_bf16 a[56:59], a[240:243], v[224:227], a[56:59]
    ds_read_b64_tr_b16 a[238:239], v16 offset:39936
    v_cvt_pk_bf16_f32 v48, v48, v49
    v_mfma_f32_16x16x32_bf16 a[52:55], a[240:243], v[208:211], a[52:55]
    v_cvt_pk_bf16_f32 v49, v50, v51
    v_cvt_pk_bf16_f32 v50, v52, v53
    v_mfma_f32_16x16x32_bf16 a[52:55], a[244:247], v[212:215], a[52:55]
    v_cvt_pk_bf16_f32 v51, v54, v55
    buffer_store_dwordx4 v[48:51], v23, s[20:23], s93 offen offset:2048 sc1
    v_mfma_f32_16x16x32_bf16 a[52:55], a[248:251], v[216:219], a[52:55]
    v_accvgpr_read_b32 v56, a12
    v_accvgpr_read_b32 v57, a13
    v_mfma_f32_16x16x32_bf16 a[52:55], a[252:255], v[220:223], a[52:55]
    v_accvgpr_read_b32 v58, a14
    v_accvgpr_read_b32 v59, a15
    v_mfma_f32_16x16x32_bf16 a[48:51], a[252:255], v[204:207], a[48:51]
    v_accvgpr_read_b32 v60, a28
    v_accvgpr_read_b32 v61, a29
    v_mfma_f32_16x16x32_bf16 a[48:51], a[248:251], v[200:203], a[48:51]
    v_accvgpr_read_b32 v62, a30
    v_accvgpr_read_b32 v63, a31
    v_mfma_f32_16x16x32_bf16 a[48:51], a[244:247], v[196:199], a[48:51]
    v_fma_f32 v56, v56, v79, v77
    v_fma_f32 v57, v57, v79, v77
    v_mfma_f32_16x16x32_bf16 a[48:51], a[240:243], v[192:195], a[48:51]
    s_waitcnt lgkmcnt(0)
    buffer_load_dwordx4 a[184:187], v23, s[20:23], s92 offen offset:2048 sc1
    v_fma_f32 v58, v58, v79, v77
    v_mfma_f32_16x16x32_bf16 a[64:67], a[224:227], v[192:195], a[64:67]
    ds_read_b64_tr_b16 a[240:241], v16 offset:0
    v_fma_f32 v59, v59, v79, v77
    v_mfma_f32_16x16x32_bf16 a[64:67], a[228:231], v[196:199], a[64:67]
    ds_read_b64_tr_b16 a[242:243], v16 offset:1024
    v_fma_f32 v60, v60, v79, v77
    v_mfma_f32_16x16x32_bf16 a[64:67], a[232:235], v[200:203], a[64:67]
    ds_read_b64_tr_b16 a[244:245], v16 offset:2048
    v_fma_f32 v61, v61, v79, v77
    v_mfma_f32_16x16x32_bf16 a[64:67], a[236:239], v[204:207], a[64:67]
    ds_read_b64_tr_b16 a[246:247], v16 offset:3072
    v_fma_f32 v62, v62, v79, v77
    v_mfma_f32_16x16x32_bf16 a[68:71], a[236:239], v[220:223], a[68:71]
    ds_read_b64_tr_b16 a[248:249], v16 offset:4096
    v_fma_f32 v63, v63, v79, v77
    v_mfma_f32_16x16x32_bf16 a[68:71], a[232:235], v[216:219], a[68:71]
    ds_read_b64_tr_b16 a[250:251], v16 offset:5120
    buffer_load_dwordx4 a[188:191], v23, s[20:23], s92 offen offset:3072 sc1
    v_mfma_f32_16x16x32_bf16 a[68:71], a[228:231], v[212:215], a[68:71]
    ds_read_b64_tr_b16 a[252:253], v16 offset:6144
    v_cvt_pk_bf16_f32 v56, v56, v57
    v_mfma_f32_16x16x32_bf16 a[68:71], a[224:227], v[208:211], a[68:71]
    ds_read_b64_tr_b16 a[254:255], v16 offset:7168
    v_cvt_pk_bf16_f32 v57, v58, v59
    v_mfma_f32_16x16x32_bf16 a[72:75], a[224:227], v[224:227], a[72:75]
    v_cvt_pk_bf16_f32 v58, v60, v61
    v_cvt_pk_bf16_f32 v59, v62, v63
    v_mfma_f32_16x16x32_bf16 a[72:75], a[228:231], v[228:231], a[72:75]
    buffer_store_dwordx4 v[56:59], v23, s[20:23], s93 offen offset:3072 sc1
    v_accvgpr_read_b32 v32, a32
    v_mfma_f32_16x16x32_bf16 a[72:75], a[232:235], v[232:235], a[72:75]
    v_accvgpr_read_b32 v33, a33
    v_accvgpr_read_b32 v34, a34
    v_mfma_f32_16x16x32_bf16 a[72:75], a[236:239], v[236:239], a[72:75]
    v_accvgpr_read_b32 v35, a35
    v_accvgpr_read_b32 v36, a48
    v_mfma_f32_16x16x32_bf16 a[76:79], a[236:239], v[252:255], a[76:79]
    v_accvgpr_read_b32 v37, a49
    v_accvgpr_read_b32 v38, a50
    v_mfma_f32_16x16x32_bf16 a[76:79], a[232:235], v[248:251], a[76:79]
    v_accvgpr_read_b32 v39, a51
    v_fma_f32 v32, v32, v67, v65
    v_mfma_f32_16x16x32_bf16 a[76:79], a[228:231], v[244:247], a[76:79]
    v_fma_f32 v33, v33, v67, v65
    v_fma_f32 v34, v34, v67, v65
    v_mfma_f32_16x16x32_bf16 a[76:79], a[224:227], v[240:243], a[76:79]
    s_waitcnt lgkmcnt(0)
    v_fma_f32 v35, v35, v67, v65
    v_fma_f32 v36, v36, v67, v65
    v_mfma_f32_16x16x32_bf16 a[76:79], a[240:243], v[176:179], a[76:79]
    ds_read_b64_tr_b16 a[224:225], v17 offset:0
    v_fma_f32 v37, v37, v67, v65
    v_mfma_f32_16x16x32_bf16 a[76:79], a[244:247], v[180:183], a[76:79]
    ds_read_b64_tr_b16 a[226:227], v17 offset:1024
    v_fma_f32 v38, v38, v67, v65
    v_mfma_f32_16x16x32_bf16 a[76:79], a[248:251], v[184:187], a[76:79]
    ds_read_b64_tr_b16 a[228:229], v17 offset:2048
    v_fma_f32 v39, v39, v67, v65
    v_mfma_f32_16x16x32_bf16 a[76:79], a[252:255], v[188:191], a[76:79]
    ds_read_b64_tr_b16 a[230:231], v17 offset:3072
    v_cvt_pk_bf16_f32 v32, v32, v33
    v_mfma_f32_16x16x32_bf16 a[72:75], a[252:255], v[172:175], a[72:75]
    ds_read_b64_tr_b16 a[232:233], v17 offset:4096
    v_cvt_pk_bf16_f32 v33, v34, v35
    v_mfma_f32_16x16x32_bf16 a[72:75], a[248:251], v[168:171], a[72:75]
    ds_read_b64_tr_b16 a[234:235], v17 offset:5120
    v_cvt_pk_bf16_f32 v34, v36, v37
    v_mfma_f32_16x16x32_bf16 a[72:75], a[244:247], v[164:167], a[72:75]
    ds_read_b64_tr_b16 a[236:237], v17 offset:6144
    v_cvt_pk_bf16_f32 v35, v38, v39
    v_mfma_f32_16x16x32_bf16 a[72:75], a[240:243], v[160:163], a[72:75]
    ds_read_b64_tr_b16 a[238:239], v17 offset:7168
    s_add_u32 s93, s97, 4096
    buffer_store_dwordx4 v[32:35], v23, s[20:23], s93 offen offset:0 sc1
    v_mfma_f32_16x16x32_bf16 a[68:71], a[240:243], v[144:147], a[68:71]
    v_accvgpr_read_b32 v40, a36
    v_accvgpr_read_b32 v41, a37
    v_mfma_f32_16x16x32_bf16 a[68:71], a[244:247], v[148:151], a[68:71]
    v_accvgpr_read_b32 v42, a38
    v_accvgpr_read_b32 v43, a39
    v_mfma_f32_16x16x32_bf16 a[68:71], a[248:251], v[152:155], a[68:71]
    v_accvgpr_read_b32 v44, a52
    v_accvgpr_read_b32 v45, a53
    v_mfma_f32_16x16x32_bf16 a[68:71], a[252:255], v[156:159], a[68:71]
    v_accvgpr_read_b32 v46, a54
    v_accvgpr_read_b32 v47, a55
    v_mfma_f32_16x16x32_bf16 a[64:67], a[252:255], v[140:143], a[64:67]
    v_fma_f32 v40, v40, v71, v69
    v_fma_f32 v41, v41, v71, v69
    v_mfma_f32_16x16x32_bf16 a[64:67], a[248:251], v[136:139], a[64:67]
    v_fma_f32 v42, v42, v71, v69
    v_fma_f32 v43, v43, v71, v69
    v_mfma_f32_16x16x32_bf16 a[64:67], a[244:247], v[132:135], a[64:67]
    v_fma_f32 v44, v44, v71, v69
    v_fma_f32 v45, v45, v71, v69
    v_mfma_f32_16x16x32_bf16 a[64:67], a[240:243], v[128:131], a[64:67]
    s_waitcnt lgkmcnt(0)
    v_fma_f32 v46, v46, v71, v69
    v_fma_f32 v47, v47, v71, v69
    v_mfma_f32_16x16x32_bf16 a[80:83], a[224:227], v[128:131], a[80:83]
    ds_read_b64_tr_b16 a[240:241], v17 offset:32768
    v_cvt_pk_bf16_f32 v40, v40, v41
    v_mfma_f32_16x16x32_bf16 a[80:83], a[228:231], v[132:135], a[80:83]
    ds_read_b64_tr_b16 a[242:243], v17 offset:33792
    v_cvt_pk_bf16_f32 v41, v42, v43
    v_mfma_f32_16x16x32_bf16 a[80:83], a[232:235], v[136:139], a[80:83]
    ds_read_b64_tr_b16 a[244:245], v17 offset:34816
    v_cvt_pk_bf16_f32 v42, v44, v45
    v_mfma_f32_16x16x32_bf16 a[80:83], a[236:239], v[140:143], a[80:83]
    ds_read_b64_tr_b16 a[246:247], v17 offset:35840
    v_cvt_pk_bf16_f32 v43, v46, v47
    v_mfma_f32_16x16x32_bf16 a[84:87], a[236:239], v[156:159], a[84:87]
    ds_read_b64_tr_b16 a[248:249], v17 offset:36864
    buffer_store_dwordx4 v[40:43], v23, s[20:23], s93 offen offset:1024 sc1
    v_mfma_f32_16x16x32_bf16 a[84:87], a[232:235], v[152:155], a[84:87]
    ds_read_b64_tr_b16 a[250:251], v17 offset:37888
    v_accvgpr_read_b32 v48, a40
    v_mfma_f32_16x16x32_bf16 a[84:87], a[228:231], v[148:151], a[84:87]
    ds_read_b64_tr_b16 a[252:253], v17 offset:38912
    v_accvgpr_read_b32 v49, a41
    v_mfma_f32_16x16x32_bf16 a[84:87], a[224:227], v[144:147], a[84:87]
    ds_read_b64_tr_b16 a[254:255], v17 offset:39936
    v_accvgpr_read_b32 v50, a42
    v_mfma_f32_16x16x32_bf16 a[88:91], a[224:227], v[160:163], a[88:91]
    v_accvgpr_read_b32 v51, a43
    v_accvgpr_read_b32 v52, a56
    v_mfma_f32_16x16x32_bf16 a[88:91], a[228:231], v[164:167], a[88:91]
    v_accvgpr_read_b32 v53, a57
    v_accvgpr_read_b32 v54, a58
    v_mfma_f32_16x16x32_bf16 a[88:91], a[232:235], v[168:171], a[88:91]
    v_accvgpr_read_b32 v55, a59
    v_fma_f32 v48, v48, v75, v73
    v_mfma_f32_16x16x32_bf16 a[88:91], a[236:239], v[172:175], a[88:91]
    v_fma_f32 v49, v49, v75, v73
    v_fma_f32 v50, v50, v75, v73
    v_mfma_f32_16x16x32_bf16 a[92:95], a[236:239], v[188:191], a[92:95]
    v_fma_f32 v51, v51, v75, v73
    v_fma_f32 v52, v52, v75, v73
    v_mfma_f32_16x16x32_bf16 a[92:95], a[232:235], v[184:187], a[92:95]
    v_fma_f32 v53, v53, v75, v73
    v_fma_f32 v54, v54, v75, v73
    v_mfma_f32_16x16x32_bf16 a[92:95], a[228:231], v[180:183], a[92:95]
    v_fma_f32 v55, v55, v75, v73
    v_cvt_pk_bf16_f32 v48, v48, v49
    v_mfma_f32_16x16x32_bf16 a[92:95], a[224:227], v[176:179], a[92:95]
    s_waitcnt lgkmcnt(0)
    v_cvt_pk_bf16_f32 v49, v50, v51
    v_cvt_pk_bf16_f32 v50, v52, v53
    v_mfma_f32_16x16x32_bf16 a[92:95], a[240:243], v[240:243], a[92:95]
    ds_read_b64_tr_b16 a[224:225], v18 offset:32768
    v_cvt_pk_bf16_f32 v51, v54, v55
    v_mfma_f32_16x16x32_bf16 a[92:95], a[244:247], v[244:247], a[92:95]
    ds_read_b64_tr_b16 a[226:227], v18 offset:33792
    buffer_store_dwordx4 v[48:51], v23, s[20:23], s93 offen offset:2048 sc1
    v_mfma_f32_16x16x32_bf16 a[92:95], a[248:251], v[248:251], a[92:95]
    ds_read_b64_tr_b16 a[228:229], v18 offset:34816
    v_accvgpr_read_b32 v56, a44
    v_mfma_f32_16x16x32_bf16 a[92:95], a[252:255], v[252:255], a[92:95]
    ds_read_b64_tr_b16 a[230:231], v18 offset:35840
    v_accvgpr_read_b32 v57, a45
    v_mfma_f32_16x16x32_bf16 a[88:91], a[252:255], v[236:239], a[88:91]
    ds_read_b64_tr_b16 a[232:233], v18 offset:36864
    v_accvgpr_read_b32 v58, a46
    v_mfma_f32_16x16x32_bf16 a[88:91], a[248:251], v[232:235], a[88:91]
    s_waitcnt vmcnt(36)
    ds_read_b64_tr_b16 a[234:235], v18 offset:37888
    v_accvgpr_read_b32 v59, a47
    v_mfma_f32_16x16x32_bf16 a[88:91], a[244:247], v[228:231], a[88:91]
    ds_read_b64_tr_b16 a[236:237], v18 offset:38912
    v_accvgpr_read_b32 v60, a60
    v_mfma_f32_16x16x32_bf16 a[88:91], a[240:243], v[224:227], a[88:91]
    ds_read_b64_tr_b16 a[238:239], v18 offset:39936
    v_accvgpr_read_b32 v61, a61
    v_mfma_f32_16x16x32_bf16 a[84:87], a[240:243], v[208:211], a[84:87]
    v_accvgpr_read_b32 v62, a62
    v_accvgpr_read_b32 v63, a63
    v_mfma_f32_16x16x32_bf16 a[84:87], a[244:247], v[212:215], a[84:87]
    v_fma_f32 v56, v56, v79, v77
    v_fma_f32 v57, v57, v79, v77
    v_mfma_f32_16x16x32_bf16 a[84:87], a[248:251], v[216:219], a[84:87]
    v_fma_f32 v58, v58, v79, v77
    v_fma_f32 v59, v59, v79, v77
    v_mfma_f32_16x16x32_bf16 a[84:87], a[252:255], v[220:223], a[84:87]
    v_fma_f32 v60, v60, v79, v77
    v_fma_f32 v61, v61, v79, v77
    v_mfma_f32_16x16x32_bf16 a[80:83], a[252:255], v[204:207], a[80:83]
    v_fma_f32 v62, v62, v79, v77
    v_fma_f32 v63, v63, v79, v77
    v_mfma_f32_16x16x32_bf16 a[80:83], a[248:251], v[200:203], a[80:83]
    v_cvt_pk_bf16_f32 v56, v56, v57
    v_cvt_pk_bf16_f32 v57, v58, v59
    v_mfma_f32_16x16x32_bf16 a[80:83], a[244:247], v[196:199], a[80:83]
    v_cvt_pk_bf16_f32 v58, v60, v61
    v_cvt_pk_bf16_f32 v59, v62, v63
    v_mfma_f32_16x16x32_bf16 a[80:83], a[240:243], v[192:195], a[80:83]
    s_waitcnt lgkmcnt(0)
    buffer_store_dwordx4 v[56:59], v23, s[20:23], s93 offen offset:3072 sc1
    v_mfma_f32_16x16x32_bf16 a[96:99], a[224:227], v[192:195], a[96:99]
    ds_read_b64_tr_b16 a[240:241], v18 offset:0
    v_mfma_f32_16x16x32_bf16 a[96:99], a[228:231], v[196:199], a[96:99]
    ds_read_b64_tr_b16 a[242:243], v18 offset:1024
    v_mfma_f32_16x16x32_bf16 a[96:99], a[232:235], v[200:203], a[96:99]
    ds_read_b64_tr_b16 a[244:245], v18 offset:2048
    v_accvgpr_read_b32 v32, a64
    v_mfma_f32_16x16x32_bf16 a[96:99], a[236:239], v[204:207], a[96:99]
    ds_read_b64_tr_b16 a[246:247], v18 offset:3072
    v_accvgpr_read_b32 v33, a65
    v_mfma_f32_16x16x32_bf16 a[100:103], a[236:239], v[220:223], a[100:103]
    ds_read_b64_tr_b16 a[248:249], v18 offset:4096
    v_accvgpr_read_b32 v34, a66
    v_mfma_f32_16x16x32_bf16 a[100:103], a[232:235], v[216:219], a[100:103]
    ds_read_b64_tr_b16 a[250:251], v18 offset:5120
    v_accvgpr_read_b32 v35, a67
    v_mfma_f32_16x16x32_bf16 a[100:103], a[228:231], v[212:215], a[100:103]
    ds_read_b64_tr_b16 a[252:253], v18 offset:6144
    v_accvgpr_read_b32 v36, a80
    v_mfma_f32_16x16x32_bf16 a[100:103], a[224:227], v[208:211], a[100:103]
    ds_read_b64_tr_b16 a[254:255], v18 offset:7168
    v_accvgpr_read_b32 v37, a81
    v_mfma_f32_16x16x32_bf16 a[104:107], a[224:227], v[224:227], a[104:107]
    v_accvgpr_read_b32 v38, a82
    v_accvgpr_read_b32 v39, a83
    v_mfma_f32_16x16x32_bf16 a[104:107], a[228:231], v[228:231], a[104:107]
    v_fma_f32 v32, v32, v67, v65
    v_fma_f32 v33, v33, v67, v65
    v_mfma_f32_16x16x32_bf16 a[104:107], a[232:235], v[232:235], a[104:107]
    v_fma_f32 v34, v34, v67, v65
    v_fma_f32 v35, v35, v67, v65
    v_mfma_f32_16x16x32_bf16 a[104:107], a[236:239], v[236:239], a[104:107]
    v_fma_f32 v36, v36, v67, v65
    v_fma_f32 v37, v37, v67, v65
    v_mfma_f32_16x16x32_bf16 a[108:111], a[236:239], v[252:255], a[108:111]
    v_fma_f32 v38, v38, v67, v65
    v_fma_f32 v39, v39, v67, v65
    v_mfma_f32_16x16x32_bf16 a[108:111], a[232:235], v[248:251], a[108:111]
    v_cvt_pk_bf16_f32 v32, v32, v33
    v_cvt_pk_bf16_f32 v33, v34, v35
    v_mfma_f32_16x16x32_bf16 a[108:111], a[228:231], v[244:247], a[108:111]
    v_cvt_pk_bf16_f32 v34, v36, v37
    v_cvt_pk_bf16_f32 v35, v38, v39
    v_mfma_f32_16x16x32_bf16 a[108:111], a[224:227], v[240:243], a[108:111]
    s_waitcnt lgkmcnt(0)
    s_add_u32 s93, s97, 8192
    buffer_store_dwordx4 v[32:35], v23, s[20:23], s93 offen offset:0 sc1
    v_accvgpr_read_b32 v40, a68
    v_mfma_f32_16x16x32_bf16 a[108:111], a[240:243], v[176:179], a[108:111]
    ds_read_b64_tr_b16 a[224:225], v19 offset:0
    v_accvgpr_read_b32 v41, a69
    v_mfma_f32_16x16x32_bf16 a[108:111], a[244:247], v[180:183], a[108:111]
    ds_read_b64_tr_b16 a[226:227], v19 offset:1024
    v_accvgpr_read_b32 v42, a70
    v_mfma_f32_16x16x32_bf16 a[108:111], a[248:251], v[184:187], a[108:111]
    ds_read_b64_tr_b16 a[228:229], v19 offset:2048
    v_accvgpr_read_b32 v43, a71
    v_mfma_f32_16x16x32_bf16 a[108:111], a[252:255], v[188:191], a[108:111]
    ds_read_b64_tr_b16 a[230:231], v19 offset:3072
    v_accvgpr_read_b32 v44, a84
    v_mfma_f32_16x16x32_bf16 a[104:107], a[252:255], v[172:175], a[104:107]
    ds_read_b64_tr_b16 a[232:233], v19 offset:4096
    v_accvgpr_read_b32 v45, a85
    v_mfma_f32_16x16x32_bf16 a[104:107], a[248:251], v[168:171], a[104:107]
    ds_read_b64_tr_b16 a[234:235], v19 offset:5120
    v_accvgpr_read_b32 v46, a86
    v_mfma_f32_16x16x32_bf16 a[104:107], a[244:247], v[164:167], a[104:107]
    ds_read_b64_tr_b16 a[236:237], v19 offset:6144
    v_accvgpr_read_b32 v47, a87
    v_mfma_f32_16x16x32_bf16 a[104:107], a[240:243], v[160:163], a[104:107]
    ds_read_b64_tr_b16 a[238:239], v19 offset:7168
    v_fma_f32 v40, v40, v71, v69
    v_mfma_f32_16x16x32_bf16 a[100:103], a[240:243], v[144:147], a[100:103]
    v_fma_f32 v41, v41, v71, v69
    v_fma_f32 v42, v42, v71, v69
    v_mfma_f32_16x16x32_bf16 a[100:103], a[244:247], v[148:151], a[100:103]
    v_fma_f32 v43, v43, v71, v69
    v_fma_f32 v44, v44, v71, v69
    v_mfma_f32_16x16x32_bf16 a[100:103], a[248:251], v[152:155], a[100:103]
    v_fma_f32 v45, v45, v71, v69
    v_fma_f32 v46, v46, v71, v69
    v_mfma_f32_16x16x32_bf16 a[100:103], a[252:255], v[156:159], a[100:103]
    v_fma_f32 v47, v47, v71, v69
    v_cvt_pk_bf16_f32 v40, v40, v41
    v_mfma_f32_16x16x32_bf16 a[96:99], a[252:255], v[140:143], a[96:99]
    v_cvt_pk_bf16_f32 v41, v42, v43
    v_cvt_pk_bf16_f32 v42, v44, v45
    v_mfma_f32_16x16x32_bf16 a[96:99], a[248:251], v[136:139], a[96:99]
    v_cvt_pk_bf16_f32 v43, v46, v47
    buffer_store_dwordx4 v[40:43], v23, s[20:23], s93 offen offset:1024 sc1
    v_mfma_f32_16x16x32_bf16 a[96:99], a[244:247], v[132:135], a[96:99]
    v_accvgpr_read_b32 v48, a72
    v_accvgpr_read_b32 v49, a73
    v_mfma_f32_16x16x32_bf16 a[96:99], a[240:243], v[128:131], a[96:99]
    s_waitcnt lgkmcnt(0)
    v_accvgpr_read_b32 v50, a74
    v_accvgpr_read_b32 v51, a75
    v_mfma_f32_16x16x32_bf16 a[112:115], a[224:227], v[128:131], a[112:115]
    ds_read_b64_tr_b16 a[240:241], v19 offset:32768
    v_accvgpr_read_b32 v52, a88
    v_mfma_f32_16x16x32_bf16 a[112:115], a[228:231], v[132:135], a[112:115]
    ds_read_b64_tr_b16 a[242:243], v19 offset:33792
    v_accvgpr_read_b32 v53, a89
    v_mfma_f32_16x16x32_bf16 a[112:115], a[232:235], v[136:139], a[112:115]
    ds_read_b64_tr_b16 a[244:245], v19 offset:34816
    v_accvgpr_read_b32 v54, a90
    v_mfma_f32_16x16x32_bf16 a[112:115], a[236:239], v[140:143], a[112:115]
    ds_read_b64_tr_b16 a[246:247], v19 offset:35840
    v_accvgpr_read_b32 v55, a91
    v_mfma_f32_16x16x32_bf16 a[116:119], a[236:239], v[156:159], a[116:119]
    ds_read_b64_tr_b16 a[248:249], v19 offset:36864
    v_fma_f32 v48, v48, v75, v73
    v_mfma_f32_16x16x32_bf16 a[116:119], a[232:235], v[152:155], a[116:119]
    ds_read_b64_tr_b16 a[250:251], v19 offset:37888
    v_fma_f32 v49, v49, v75, v73
    v_mfma_f32_16x16x32_bf16 a[116:119], a[228:231], v[148:151], a[116:119]
    ds_read_b64_tr_b16 a[252:253], v19 offset:38912
    v_fma_f32 v50, v50, v75, v73
    v_mfma_f32_16x16x32_bf16 a[116:119], a[224:227], v[144:147], a[116:119]
    ds_read_b64_tr_b16 a[254:255], v19 offset:39936
    v_fma_f32 v51, v51, v75, v73
    v_mfma_f32_16x16x32_bf16 a[120:123], a[224:227], v[160:163], a[120:123]
    v_fma_f32 v52, v52, v75, v73
    v_fma_f32 v53, v53, v75, v73
    v_mfma_f32_16x16x32_bf16 a[120:123], a[228:231], v[164:167], a[120:123]
    v_fma_f32 v54, v54, v75, v73
    v_fma_f32 v55, v55, v75, v73
    v_mfma_f32_16x16x32_bf16 a[120:123], a[232:235], v[168:171], a[120:123]
    v_cvt_pk_bf16_f32 v48, v48, v49
    v_cvt_pk_bf16_f32 v49, v50, v51
    v_mfma_f32_16x16x32_bf16 a[120:123], a[236:239], v[172:175], a[120:123]
    v_cvt_pk_bf16_f32 v50, v52, v53
    v_cvt_pk_bf16_f32 v51, v54, v55
    v_mfma_f32_16x16x32_bf16 a[124:127], a[236:239], v[188:191], a[124:127]
    buffer_store_dwordx4 v[48:51], v23, s[20:23], s93 offen offset:2048 sc1
    v_accvgpr_read_b32 v56, a76
    v_mfma_f32_16x16x32_bf16 a[124:127], a[232:235], v[184:187], a[124:127]
    v_accvgpr_read_b32 v57, a77
    v_accvgpr_read_b32 v58, a78
    v_mfma_f32_16x16x32_bf16 a[124:127], a[228:231], v[180:183], a[124:127]
    v_accvgpr_read_b32 v59, a79
    v_accvgpr_read_b32 v60, a92
    v_mfma_f32_16x16x32_bf16 a[124:127], a[224:227], v[176:179], a[124:127]
    s_waitcnt lgkmcnt(0)
    v_accvgpr_read_b32 v61, a93
    v_accvgpr_read_b32 v62, a94
    v_mfma_f32_16x16x32_bf16 a[124:127], a[240:243], v[240:243], a[124:127]
    v_accvgpr_read_b32 v63, a95
    v_fma_f32 v56, v56, v79, v77
    v_mfma_f32_16x16x32_bf16 a[124:127], a[244:247], v[244:247], a[124:127]
    v_fma_f32 v57, v57, v79, v77
    v_fma_f32 v58, v58, v79, v77
    v_mfma_f32_16x16x32_bf16 a[124:127], a[248:251], v[248:251], a[124:127]
    v_fma_f32 v59, v59, v79, v77
    v_fma_f32 v60, v60, v79, v77
    v_mfma_f32_16x16x32_bf16 a[124:127], a[252:255], v[252:255], a[124:127]
    v_fma_f32 v61, v61, v79, v77
    v_fma_f32 v62, v62, v79, v77
    v_mfma_f32_16x16x32_bf16 a[120:123], a[252:255], v[236:239], a[120:123]
    v_fma_f32 v63, v63, v79, v77
    v_cvt_pk_bf16_f32 v56, v56, v57
    v_mfma_f32_16x16x32_bf16 a[120:123], a[248:251], v[232:235], a[120:123]
    v_cvt_pk_bf16_f32 v57, v58, v59
    v_cvt_pk_bf16_f32 v58, v60, v61
    v_mfma_f32_16x16x32_bf16 a[120:123], a[244:247], v[228:231], a[120:123]
    v_cvt_pk_bf16_f32 v59, v62, v63
    buffer_store_dwordx4 v[56:59], v23, s[20:23], s93 offen offset:3072 sc1
    v_mfma_f32_16x16x32_bf16 a[120:123], a[240:243], v[224:227], a[120:123]
    v_mfma_f32_16x16x32_bf16 a[116:119], a[240:243], v[208:211], a[116:119]
    v_mfma_f32_16x16x32_bf16 a[116:119], a[244:247], v[212:215], a[116:119]
    v_mfma_f32_16x16x32_bf16 a[116:119], a[248:251], v[216:219], a[116:119]
    v_mfma_f32_16x16x32_bf16 a[116:119], a[252:255], v[220:223], a[116:119]
    v_mfma_f32_16x16x32_bf16 a[112:115], a[252:255], v[204:207], a[112:115]
    v_mfma_f32_16x16x32_bf16 a[112:115], a[248:251], v[200:203], a[112:115]
    v_mfma_f32_16x16x32_bf16 a[112:115], a[244:247], v[196:199], a[112:115]
    v_mfma_f32_16x16x32_bf16 a[112:115], a[240:243], v[192:195], a[112:115]
    s_nop 4
    v_accvgpr_read_b32 v32, a96
    v_accvgpr_read_b32 v33, a97
    v_accvgpr_read_b32 v34, a98
    v_accvgpr_read_b32 v35, a99
    v_accvgpr_read_b32 v36, a112
    v_accvgpr_read_b32 v37, a113
    v_accvgpr_read_b32 v38, a114
    v_accvgpr_read_b32 v39, a115
    v_pk_fma_f32 v[32:33], v[32:33], v[66:67], v[64:65] op_sel:[0,1,1]
    v_pk_fma_f32 v[34:35], v[34:35], v[66:67], v[64:65] op_sel:[0,1,1]
    v_pk_fma_f32 v[36:37], v[36:37], v[66:67], v[64:65] op_sel:[0,1,1]
    v_pk_fma_f32 v[38:39], v[38:39], v[66:67], v[64:65] op_sel:[0,1,1]
    v_cvt_pk_bf16_f32 v32, v32, v33
    v_cvt_pk_bf16_f32 v33, v34, v35
    v_cvt_pk_bf16_f32 v34, v36, v37
    v_cvt_pk_bf16_f32 v35, v38, v39
    s_add_u32 s93, s97, 12288
    buffer_store_dwordx4 v[32:35], v23, s[20:23], s93 offen offset:0 sc1
    v_accvgpr_read_b32 v40, a100
    v_accvgpr_read_b32 v41, a101
    v_accvgpr_read_b32 v42, a102
    v_accvgpr_read_b32 v43, a103
    v_accvgpr_read_b32 v44, a116
    v_accvgpr_read_b32 v45, a117
    v_accvgpr_read_b32 v46, a118
    v_accvgpr_read_b32 v47, a119
    v_pk_fma_f32 v[40:41], v[40:41], v[70:71], v[68:69] op_sel:[0,1,1]
    v_pk_fma_f32 v[42:43], v[42:43], v[70:71], v[68:69] op_sel:[0,1,1]
    v_pk_fma_f32 v[44:45], v[44:45], v[70:71], v[68:69] op_sel:[0,1,1]
    v_pk_fma_f32 v[46:47], v[46:47], v[70:71], v[68:69] op_sel:[0,1,1]
    v_cvt_pk_bf16_f32 v40, v40, v41
    v_cvt_pk_bf16_f32 v41, v42, v43
    v_cvt_pk_bf16_f32 v42, v44, v45
    v_cvt_pk_bf16_f32 v43, v46, v47
    buffer_store_dwordx4 v[40:43], v23, s[20:23], s93 offen offset:1024 sc1
    v_accvgpr_read_b32 v48, a104
    v_accvgpr_read_b32 v49, a105
    v_accvgpr_read_b32 v50, a106
    v_accvgpr_read_b32 v51, a107
    v_accvgpr_read_b32 v52, a120
    v_accvgpr_read_b32 v53, a121
    v_accvgpr_read_b32 v54, a122
    v_accvgpr_read_b32 v55, a123
    v_pk_fma_f32 v[48:49], v[48:49], v[74:75], v[72:73] op_sel:[0,1,1]
    v_pk_fma_f32 v[50:51], v[50:51], v[74:75], v[72:73] op_sel:[0,1,1]
    v_pk_fma_f32 v[52:53], v[52:53], v[74:75], v[72:73] op_sel:[0,1,1]
    v_pk_fma_f32 v[54:55], v[54:55], v[74:75], v[72:73] op_sel:[0,1,1]
    v_cvt_pk_bf16_f32 v48, v48, v49
    v_cvt_pk_bf16_f32 v49, v50, v51
    v_cvt_pk_bf16_f32 v50, v52, v53
    v_cvt_pk_bf16_f32 v51, v54, v55
    buffer_store_dwordx4 v[48:51], v23, s[20:23], s93 offen offset:2048 sc1
    v_accvgpr_read_b32 v56, a108
    v_accvgpr_read_b32 v57, a109
    v_accvgpr_read_b32 v58, a110
    v_accvgpr_read_b32 v59, a111
    v_accvgpr_read_b32 v60, a124
    v_accvgpr_read_b32 v61, a125
    v_accvgpr_read_b32 v62, a126
    v_accvgpr_read_b32 v63, a127
    v_pk_fma_f32 v[56:57], v[56:57], v[78:79], v[76:77] op_sel:[0,1,1]
    v_pk_fma_f32 v[58:59], v[58:59], v[78:79], v[76:77] op_sel:[0,1,1]
    v_pk_fma_f32 v[60:61], v[60:61], v[78:79], v[76:77] op_sel:[0,1,1]
    v_pk_fma_f32 v[62:63], v[62:63], v[78:79], v[76:77] op_sel:[0,1,1]
    v_cvt_pk_bf16_f32 v56, v56, v57
    v_cvt_pk_bf16_f32 v57, v58, v59
    v_cvt_pk_bf16_f32 v58, v60, v61
    v_cvt_pk_bf16_f32 v59, v62, v63
    buffer_store_dwordx4 v[56:59], v23, s[20:23], s93 offen offset:3072 sc1
    s_waitcnt vmcnt(50)
    s_xor_b32 s92, s48, 24576
    buffer_load_dwordx4 a[192:195], v23, s[20:23], s92 offen offset:0 sc1
    buffer_load_dwordx4 a[196:199], v23, s[20:23], s92 offen offset:1024 sc1
    buffer_load_dwordx4 a[200:203], v23, s[20:23], s92 offen offset:2048 sc1
    buffer_load_dwordx4 a[204:207], v23, s[20:23], s92 offen offset:3072 sc1
    s_xor_b32 s92, s48, 28672
    buffer_load_dwordx4 a[208:211], v23, s[20:23], s92 offen offset:0 sc1
    buffer_load_dwordx4 a[212:215], v23, s[20:23], s92 offen offset:1024 sc1
    buffer_load_dwordx4 a[216:219], v23, s[20:23], s92 offen offset:2048 sc1
    buffer_load_dwordx4 a[220:223], v23, s[20:23], s92 offen offset:3072 sc1
    s_xor_b32 s92, s48, 32768
    buffer_load_dwordx4 v[128:131], v23, s[20:23], s92 offen offset:0 sc1
    buffer_load_dwordx4 v[132:135], v23, s[20:23], s92 offen offset:1024 sc1
    s_lshr_b32 s95, s89, 1
    s_lshl_b32 s46, s101, 1
    s_add_u32 s46, s46, s95
    s_lshl_b32 s46, s46, 15
    s_and_b32 s95, s89, 1
    s_lshl_b32 s47, s38, 1
    s_add_u32 s47, s47, s95
    s_lshl_b32 s47, s47, 6
    v_lshl_add_u32 v8, v1, 4, s47
    v_lshl_add_u32 v9, v3, 10, v8
    v_add_u32 v9, s46, v9
    v_add_u32 v10, 0x4000, v9
    v_add_u32 v12, s91, v23
    v_add_u32 v13, 0x10000, v12
    v_add_u32 v14, 0x20000, v12
    s_lshl_b32 s95, s95, 15
    s_lshr_b32 s46, s89, 1
    s_lshl_b32 s46, s46, 11
    s_add_u32 s95, s95, s46
    v_add_u32 v15, s95, v23
    v_mov_b32 v25, 1
    v_and_b32 v24, 3, v2
    v_bfe_u32 v26, v2, 2, 1
    v_lshl_add_u32 v24, v24, 3, v26
    v_lshlrev_b32 v24, 8, v24
    s_lshr_b32 s50, s101, 2
    s_lshl_b32 s50, s50, 4
    s_add_u32 s50, s50, s89
    s_lshl_b32 s50, s50, 9
    s_add_u32 s50, s50, 3145728
    s_lshl_b32 s95, s89, 31
    s_xor_b32 s95, s95, s87
    v_mov_b32 v16, s95
    v_mov_b32 v17, s95
    v_mov_b32 v18, s95
    v_mov_b32 v19, s95
    s_waitcnt vmcnt(10)
    s_barrier
    buffer_store_dword v25, v28, s[32:35], 0 offen sc1
    buffer_load_dwordx4 v[136:139], v23, s[20:23], s92 offen offset:2048 sc1
    buffer_load_dwordx4 v[140:143], v23, s[20:23], s92 offen offset:3072 sc1
    s_xor_b32 s92, s48, 36864
    buffer_load_dwordx4 v[144:147], v23, s[20:23], s92 offen offset:0 sc1
    buffer_load_dwordx4 v[148:151], v23, s[20:23], s92 offen offset:1024 sc1
    buffer_load_dwordx4 v[152:155], v23, s[20:23], s92 offen offset:2048 sc1
    buffer_load_dwordx4 v[156:159], v23, s[20:23], s92 offen offset:3072 sc1
    s_xor_b32 s92, s48, 40960
    buffer_load_dwordx4 v[160:163], v23, s[20:23], s92 offen offset:0 sc1
    buffer_load_dwordx4 v[164:167], v23, s[20:23], s92 offen offset:1024 sc1
    buffer_load_dwordx4 v[168:171], v23, s[20:23], s92 offen offset:2048 sc1
    buffer_load_dwordx4 v[172:175], v23, s[20:23], s92 offen offset:3072 sc1
    s_xor_b32 s92, s48, 45056
    buffer_load_dwordx4 v[176:179], v23, s[20:23], s92 offen offset:0 sc1
    buffer_load_dwordx4 v[180:183], v23, s[20:23], s92 offen offset:1024 sc1
    buffer_load_dwordx4 v[184:187], v23, s[20:23], s92 offen offset:2048 sc1
    buffer_load_dwordx4 v[188:191], v23, s[20:23], s92 offen offset:3072 sc1
    s_xor_b32 s92, s48, 49152
    buffer_load_dwordx4 a[0:3], v23, s[20:23], s92 offen offset:0 sc1
    s_waitcnt vmcnt(40)
    buffer_load_dwordx4 a[4:7], v23, s[20:23], s92 offen offset:1024 sc1
    buffer_load_dwordx4 a[8:11], v23, s[20:23], s92 offen offset:2048 sc1
    buffer_load_dwordx4 a[12:15], v23, s[20:23], s92 offen offset:3072 sc1
    s_xor_b32 s92, s48, 53248
    buffer_load_dwordx4 a[16:19], v23, s[20:23], s92 offen offset:0 sc1
    buffer_load_dwordx4 a[20:23], v23, s[20:23], s92 offen offset:1024 sc1
    buffer_load_dwordx4 a[24:27], v23, s[20:23], s92 offen offset:2048 sc1
    buffer_load_dwordx4 a[28:31], v23, s[20:23], s92 offen offset:3072 sc1
    s_xor_b32 s92, s48, 57344
    buffer_load_dwordx4 a[32:35], v23, s[20:23], s92 offen offset:0 sc1
    buffer_load_dwordx4 a[36:39], v23, s[20:23], s92 offen offset:1024 sc1
    buffer_load_dwordx4 a[40:43], v23, s[20:23], s92 offen offset:2048 sc1
    buffer_load_dwordx4 a[44:47], v23, s[20:23], s92 offen offset:3072 sc1
    s_xor_b32 s92, s48, 61440
    buffer_load_dwordx4 a[48:51], v23, s[20:23], s92 offen offset:0 sc1
    buffer_load_dwordx4 a[52:55], v23, s[20:23], s92 offen offset:1024 sc1
    buffer_load_dwordx4 a[56:59], v23, s[20:23], s92 offen offset:2048 sc1
    buffer_load_dwordx4 a[60:63], v23, s[20:23], s92 offen offset:3072 sc1
    s_xor_b32 s92, s48, 65536
    buffer_load_dwordx4 a[64:67], v23, s[20:23], s92 offen offset:0 sc1
    s_waitcnt vmcnt(40)
    buffer_load_dwordx4 a[68:71], v23, s[20:23], s92 offen offset:1024 sc1
    buffer_load_dwordx4 a[72:75], v23, s[20:23], s92 offen offset:2048 sc1
    buffer_load_dwordx4 a[76:79], v23, s[20:23], s92 offen offset:3072 sc1
    s_xor_b32 s92, s48, 69632
    buffer_load_dwordx4 a[80:83], v23, s[20:23], s92 offen offset:0 sc1
    buffer_load_dwordx4 a[84:87], v23, s[20:23], s92 offen offset:1024 sc1
    buffer_load_dwordx4 a[88:91], v23, s[20:23], s92 offen offset:2048 sc1
    buffer_load_dwordx4 a[92:95], v23, s[20:23], s92 offen offset:3072 sc1
    s_xor_b32 s92, s48, 73728
    buffer_load_dwordx4 a[96:99], v23, s[20:23], s92 offen offset:0 sc1
    buffer_load_dwordx4 a[100:103], v23, s[20:23], s92 offen offset:1024 sc1
    buffer_load_dwordx4 a[104:107], v23, s[20:23], s92 offen offset:2048 sc1
    buffer_load_dwordx4 a[108:111], v23, s[20:23], s92 offen offset:3072 sc1
    s_add_u32 m0, s91, 32768
    s_xor_b32 s92, s48, 81920
    buffer_load_dwordx4 v23, s[20:23], s92 offen offset:0 sc1 lds
    buffer_load_dwordx4 v23, s[20:23], s92 offen offset:1024 sc1 lds
    buffer_load_dwordx4 v23, s[20:23], s92 offen offset:2048 sc1 lds
    buffer_load_dwordx4 v23, s[20:23], s92 offen offset:3072 sc1 lds
    buffer_load_dword v27, v24, s[20:23], s50 offen sc1
    s_add_u32 m0, s91, 98304
    s_xor_b32 s92, s48, 86016
    buffer_load_dwordx4 v23, s[20:23], s92 offen offset:0 sc1 lds
    s_waitcnt vmcnt(40)
    buffer_load_dwordx4 v23, s[20:23], s92 offen offset:1024 sc1 lds
    buffer_load_dwordx4 v23, s[20:23], s92 offen offset:2048 sc1 lds
    buffer_load_dwordx4 v23, s[20:23], s92 offen offset:3072 sc1 lds
    s_add_u32 m0, s91, 102400
    s_xor_b32 s92, s48, 90112
    buffer_load_dwordx4 v23, s[20:23], s92 offen offset:0 sc1 lds
    buffer_load_dwordx4 v23, s[20:23], s92 offen offset:1024 sc1 lds
    buffer_load_dwordx4 v23, s[20:23], s92 offen offset:2048 sc1 lds
    buffer_load_dwordx4 v23, s[20:23], s92 offen offset:3072 sc1 lds
    s_add_u32 m0, s91, 65536
    s_xor_b32 s92, s48, 110592
    buffer_load_dwordx4 v23, s[20:23], s92 offen offset:0 sc1 lds
    buffer_load_dwordx4 v23, s[20:23], s92 offen offset:1024 sc1 lds
    buffer_load_dwordx4 v23, s[20:23], s92 offen offset:2048 sc1 lds
    buffer_load_dwordx4 v23, s[20:23], s92 offen offset:3072 sc1 lds
    s_add_u32 m0, s91, 69632
    s_xor_b32 s92, s48, 114688
    buffer_load_dwordx4 v23, s[20:23], s92 offen offset:0 sc1 lds
    buffer_load_dwordx4 v23, s[20:23], s92 offen offset:1024 sc1 lds
    buffer_load_dwordx4 v23, s[20:23], s92 offen offset:2048 sc1 lds
    buffer_load_dwordx4 v23, s[20:23], s92 offen offset:3072 sc1 lds
    s_waitcnt vmcnt(16)
    v_cmp_ne_u32 vcc, 1, v27
    s_mov_b32 s94, 200000
    s_nop 3
    s_cbranch_vccz K2_RDY
K2_POLL2:
    buffer_load_dword v27, v24, s[20:23], s50 offen sc1
    s_waitcnt vmcnt(0)
    v_cmp_ne_u32 vcc, 1, v27
    s_sub_u32 s94, s94, 1
    s_cbranch_scc1 K2_RDY
    s_nop 2
    s_cbranch_vccnz K2_POLL2
K2_RDY:
    s_xor_b32 s93, s49, 0
    buffer_load_dwordx4 a[112:115], v23, s[20:23], s93 offen offset:0 sc1
    buffer_load_dwordx4 a[116:119], v23, s[20:23], s93 offen offset:1024 sc1
    buffer_load_dwordx4 a[120:123], v23, s[20:23], s93 offen offset:2048 sc1
    buffer_load_dwordx4 a[124:127], v23, s[20:23], s93 offen offset:3072 sc1
    s_xor_b32 s93, s49, 4096
    buffer_load_dwordx4 a[224:227], v23, s[20:23], s93 offen offset:0 sc1
    buffer_load_dwordx4 a[228:231], v23, s[20:23], s93 offen offset:1024 sc1
    buffer_load_dwordx4 a[232:235], v23, s[20:23], s93 offen offset:2048 sc1
    buffer_load_dwordx4 a[236:239], v23, s[20:23], s93 offen offset:3072 sc1
    s_xor_b32 s93, s49, 8192
    buffer_load_dwordx4 a[240:243], v23, s[20:23], s93 offen offset:0 sc1
    buffer_load_dwordx4 a[244:247], v23, s[20:23], s93 offen offset:1024 sc1
    buffer_load_dwordx4 a[248:251], v23, s[20:23], s93 offen offset:2048 sc1
    buffer_load_dwordx4 a[252:255], v23, s[20:23], s93 offen offset:3072 sc1
    s_xor_b32 s93, s49, 12288
    buffer_load_dwordx4 v[32:35], v23, s[20:23], s93 offen offset:0 sc1
    buffer_load_dwordx4 v[36:39], v23, s[20:23], s93 offen offset:1024 sc1
    buffer_load_dwordx4 v[40:43], v23, s[20:23], s93 offen offset:2048 sc1
    buffer_load_dwordx4 v[44:47], v23, s[20:23], s93 offen offset:3072 sc1
    s_waitcnt vmcnt(12)
    v_mfma_f32_16x16x32_bf16 v[192:195], v[96:99], a[112:115], v[16:19]
    s_xor_b32 s93, s49, 16384
    buffer_load_dwordx4 v[48:51], v23, s[20:23], s93 offen offset:0 sc1
    v_mfma_f32_16x16x32_bf16 v[196:199], v[96:99], a[116:119], v[16:19]
    v_mfma_f32_16x16x32_bf16 v[200:203], v[96:99], a[120:123], v[16:19]
    v_mfma_f32_16x16x32_bf16 v[204:207], v[96:99], a[124:127], v[16:19]
    v_mfma_f32_16x16x32_bf16 v[220:223], v[100:103], a[124:127], v[16:19]
    buffer_load_dwordx4 v[52:55], v23, s[20:23], s93 offen offset:1024 sc1
    v_mfma_f32_16x16x32_bf16 v[216:219], v[100:103], a[120:123], v[16:19]
    v_mfma_f32_16x16x32_bf16 v[212:215], v[100:103], a[116:119], v[16:19]
    v_mfma_f32_16x16x32_bf16 v[208:211], v[100:103], a[112:115], v[16:19]
    v_mfma_f32_16x16x32_bf16 v[224:227], v[104:107], a[112:115], v[16:19]
    buffer_load_dwordx4 v[56:59], v23, s[20:23], s93 offen offset:2048 sc1
    v_mfma_f32_16x16x32_bf16 v[228:231], v[104:107], a[116:119], v[16:19]
    v_mfma_f32_16x16x32_bf16 v[232:235], v[104:107], a[120:123], v[16:19]
    v_mfma_f32_16x16x32_bf16 v[236:239], v[104:107], a[124:127], v[16:19]
    v_mfma_f32_16x16x32_bf16 v[252:255], v[108:111], a[124:127], v[16:19]
    buffer_load_dwordx4 v[60:63], v23, s[20:23], s93 offen offset:3072 sc1
    v_mfma_f32_16x16x32_bf16 v[248:251], v[108:111], a[120:123], v[16:19]
    v_mfma_f32_16x16x32_bf16 v[244:247], v[108:111], a[116:119], v[16:19]
    v_mfma_f32_16x16x32_bf16 v[240:243], v[108:111], a[112:115], v[16:19]
    s_waitcnt vmcnt(12)
    v_mfma_f32_16x16x32_bf16 v[240:243], v[124:127], a[224:227], v[240:243]
    s_xor_b32 s93, s49, 20480
    buffer_load_dwordx4 v[96:99], v23, s[20:23], s93 offen offset:0 sc1
    s_mov_b32 s95, 0xbfb8aa3b
    v_mul_f32 v24, s95, v80
    v_mfma_f32_16x16x32_bf16 v[244:247], v[124:127], a[228:231], v[244:247]
    v_mul_f32 v25, s95, v81
    v_mul_f32 v26, s95, v82
    v_mfma_f32_16x16x32_bf16 v[248:251], v[124:127], a[232:235], v[248:251]
    buffer_load_dwordx4 v[100:103], v23, s[20:23], s93 offen offset:1024 sc1
    v_mul_f32 v27, s95, v83
    v_mfma_f32_16x16x32_bf16 v[252:255], v[124:127], a[236:239], v[252:255]
    v_mul_f32 v28, s95, v84
    v_mul_f32 v29, s95, v85
    v_mfma_f32_16x16x32_bf16 v[236:239], v[120:123], a[236:239], v[236:239]
    buffer_load_dwordx4 v[104:107], v23, s[20:23], s93 offen offset:2048 sc1
    v_mul_f32 v30, s95, v86
    v_mfma_f32_16x16x32_bf16 v[232:235], v[120:123], a[232:235], v[232:235]
    v_mul_f32 v31, s95, v87
    v_mfma_f32_16x16x32_bf16 v[228:231], v[120:123], a[228:231], v[228:231]
    buffer_load_dwordx4 v[108:111], v23, s[20:23], s93 offen offset:3072 sc1
    v_mfma_f32_16x16x32_bf16 v[224:227], v[120:123], a[224:227], v[224:227]
    v_exp_f32 v24, v24
    v_mfma_f32_16x16x32_bf16 v[208:211], v[116:119], a[224:227], v[208:211]
    s_xor_b32 s93, s49, 24576
    buffer_load_dwordx4 a[112:115], v23, s[20:23], s93 offen offset:0 sc1
    v_mfma_f32_16x16x32_bf16 v[212:215], v[116:119], a[228:231], v[212:215]
    v_exp_f32 v25, v25
    v_mfma_f32_16x16x32_bf16 v[216:219], v[116:119], a[232:235], v[216:219]
    buffer_load_dwordx4 a[116:119], v23, s[20:23], s93 offen offset:1024 sc1
    v_mfma_f32_16x16x32_bf16 v[220:223], v[116:119], a[236:239], v[220:223]
    v_exp_f32 v26, v26
    v_mfma_f32_16x16x32_bf16 v[204:207], v[112:115], a[236:239], v[204:207]
    buffer_load_dwordx4 a[120:123], v23, s[20:23], s93 offen offset:2048 sc1
    v_mfma_f32_16x16x32_bf16 v[200:203], v[112:115], a[232:235], v[200:203]
    v_exp_f32 v27, v27
    v_mfma_f32_16x16x32_bf16 v[196:199], v[112:115], a[228:231], v[196:199]
    buffer_load_dwordx4 a[124:127], v23, s[20:23], s93 offen offset:3072 sc1
    v_mfma_f32_16x16x32_bf16 v[192:195], v[112:115], a[224:227], v[192:195]
    v_exp_f32 v28, v28
    s_waitcnt vmcnt(12)
    v_mfma_f32_16x16x32_bf16 v[192:195], a[128:131], a[240:243], v[192:195]
    s_xor_b32 s93, s49, 28672
    buffer_load_dwordx4 v[112:115], v23, s[20:23], s93 offen offset:0 sc1
    v_mfma_f32_16x16x32_bf16 v[192:195], a[144:147], v[32:35], v[192:195]
    v_exp_f32 v29, v29
    v_mfma_f32_16x16x32_bf16 v[196:199], a[144:147], v[36:39], v[196:199]
    v_exp_f32 v30, v30
    v_mfma_f32_16x16x32_bf16 v[196:199], a[128:131], a[244:247], v[196:199]
    v_exp_f32 v31, v31
    v_mfma_f32_16x16x32_bf16 v[200:203], a[128:131], a[248:251], v[200:203]
    buffer_load_dwordx4 v[116:119], v23, s[20:23], s93 offen offset:1024 sc1
    v_add_f32 v24, 1.0, v24
    v_mfma_f32_16x16x32_bf16 v[200:203], a[144:147], v[40:43], v[200:203]
    v_add_f32 v25, 1.0, v25
    v_add_f32 v26, 1.0, v26
    v_mfma_f32_16x16x32_bf16 v[204:207], a[144:147], v[44:47], v[204:207]
    v_add_f32 v27, 1.0, v27
    v_add_f32 v28, 1.0, v28
    v_mfma_f32_16x16x32_bf16 v[204:207], a[128:131], a[252:255], v[204:207]
    v_add_f32 v29, 1.0, v29
    v_add_f32 v30, 1.0, v30
    v_mfma_f32_16x16x32_bf16 v[220:223], a[132:135], a[252:255], v[220:223]
    buffer_load_dwordx4 v[120:123], v23, s[20:23], s93 offen offset:2048 sc1
    v_add_f32 v31, 1.0, v31
    v_mfma_f32_16x16x32_bf16 v[220:223], a[148:151], v[44:47], v[220:223]
    v_rcp_f32 v24, v24
    v_mfma_f32_16x16x32_bf16 v[216:219], a[148:151], v[40:43], v[216:219]
    v_rcp_f32 v25, v25
    v_mfma_f32_16x16x32_bf16 v[216:219], a[132:135], a[248:251], v[216:219]
    v_rcp_f32 v26, v26
    v_mfma_f32_16x16x32_bf16 v[212:215], a[132:135], a[244:247], v[212:215]
    buffer_load_dwordx4 v[124:127], v23, s[20:23], s93 offen offset:3072 sc1
    v_mfma_f32_16x16x32_bf16 v[212:215], a[148:151], v[36:39], v[212:215]
    v_rcp_f32 v27, v27
    v_mfma_f32_16x16x32_bf16 v[208:211], a[148:151], v[32:35], v[208:211]
    v_rcp_f32 v28, v28
    v_mfma_f32_16x16x32_bf16 v[208:211], a[132:135], a[240:243], v[208:211]
    v_rcp_f32 v29, v29
    v_mfma_f32_16x16x32_bf16 v[224:227], a[136:139], a[240:243], v[224:227]
    s_xor_b32 s93, s49, 32768
    buffer_load_dwordx4 a[224:227], v23, s[20:23], s93 offen offset:0 sc1
    v_mfma_f32_16x16x32_bf16 v[224:227], a[152:155], v[32:35], v[224:227]
    v_rcp_f32 v30, v30
    v_mfma_f32_16x16x32_bf16 v[228:231], a[152:155], v[36:39], v[228:231]
    v_rcp_f32 v31, v31
    v_mfma_f32_16x16x32_bf16 v[228:231], a[136:139], a[244:247], v[228:231]
    v_mul_f32 v80, v80, v24
    v_mul_f32 v81, v81, v25
    v_mfma_f32_16x16x32_bf16 v[232:235], a[136:139], a[248:251], v[232:235]
    buffer_load_dwordx4 a[228:231], v23, s[20:23], s93 offen offset:1024 sc1
    v_mul_f32 v82, v82, v26
    v_mfma_f32_16x16x32_bf16 v[232:235], a[152:155], v[40:43], v[232:235]
    v_mul_f32 v83, v83, v27
    v_mul_f32 v84, v84, v28
    v_mfma_f32_16x16x32_bf16 v[236:239], a[152:155], v[44:47], v[236:239]
    v_mul_f32 v85, v85, v29
    v_mul_f32 v86, v86, v30
    v_mfma_f32_16x16x32_bf16 v[236:239], a[136:139], a[252:255], v[236:239]
    v_mul_f32 v87, v87, v31
    v_mul_f32 v24, s95, v88
    v_mfma_f32_16x16x32_bf16 v[252:255], a[140:143], a[252:255], v[252:255]
    buffer_load_dwordx4 a[232:235], v23, s[20:23], s93 offen offset:2048 sc1
    v_mul_f32 v25, s95, v89
    v_mfma_f32_16x16x32_bf16 v[252:255], a[156:159], v[44:47], v[252:255]
    v_mul_f32 v26, s95, v90
    v_mul_f32 v27, s95, v91
    v_mfma_f32_16x16x32_bf16 v[248:251], a[156:159], v[40:43], v[248:251]
    v_mul_f32 v28, s95, v92
    v_mul_f32 v29, s95, v93
    v_mfma_f32_16x16x32_bf16 v[248:251], a[140:143], a[248:251], v[248:251]
    v_mul_f32 v30, s95, v94
    v_mul_f32 v31, s95, v95
    v_mfma_f32_16x16x32_bf16 v[244:247], a[140:143], a[244:247], v[244:247]
    buffer_load_dwordx4 a[236:239], v23, s[20:23], s93 offen offset:3072 sc1
    v_mfma_f32_16x16x32_bf16 v[244:247], a[156:159], v[36:39], v[244:247]
    v_exp_f32 v24, v24
    v_mfma_f32_16x16x32_bf16 v[240:243], a[156:159], v[32:35], v[240:243]
    v_exp_f32 v25, v25
    v_mfma_f32_16x16x32_bf16 v[240:243], a[140:143], a[240:243], v[240:243]
    v_exp_f32 v26, v26
    s_waitcnt vmcnt(12)
    v_mfma_f32_16x16x32_bf16 v[240:243], a[172:175], v[48:51], v[240:243]
    s_xor_b32 s93, s49, 36864
    buffer_load_dwordx4 a[128:131], v23, s[20:23], s93 offen offset:0 sc1
    v_mfma_f32_16x16x32_bf16 v[240:243], a[188:191], v[96:99], v[240:243]
    v_exp_f32 v27, v27
    v_mfma_f32_16x16x32_bf16 v[244:247], a[188:191], v[100:103], v[244:247]
    v_exp_f32 v28, v28
    v_mfma_f32_16x16x32_bf16 v[244:247], a[172:175], v[52:55], v[244:247]
    v_exp_f32 v29, v29
    v_mfma_f32_16x16x32_bf16 v[248:251], a[172:175], v[56:59], v[248:251]
    buffer_load_dwordx4 a[132:135], v23, s[20:23], s93 offen offset:1024 sc1
    v_mfma_f32_16x16x32_bf16 v[248:251], a[188:191], v[104:107], v[248:251]
    v_exp_f32 v30, v30
    v_mfma_f32_16x16x32_bf16 v[252:255], a[188:191], v[108:111], v[252:255]
    v_exp_f32 v31, v31
    v_mfma_f32_16x16x32_bf16 v[252:255], a[172:175], v[60:63], v[252:255]
    v_add_f32 v24, 1.0, v24
    v_add_f32 v25, 1.0, v25
    v_mfma_f32_16x16x32_bf16 v[236:239], a[168:171], v[60:63], v[236:239]
    buffer_load_dwordx4 a[136:139], v23, s[20:23], s93 offen offset:2048 sc1
    v_add_f32 v26, 1.0, v26
    v_mfma_f32_16x16x32_bf16 v[236:239], a[184:187], v[108:111], v[236:239]
    v_add_f32 v27, 1.0, v27
    v_add_f32 v28, 1.0, v28
    v_mfma_f32_16x16x32_bf16 v[232:235], a[184:187], v[104:107], v[232:235]
    v_add_f32 v29, 1.0, v29
    v_add_f32 v30, 1.0, v30
    v_mfma_f32_16x16x32_bf16 v[232:235], a[168:171], v[56:59], v[232:235]
    v_add_f32 v31, 1.0, v31
    v_mfma_f32_16x16x32_bf16 v[228:231], a[168:171], v[52:55], v[228:231]
    buffer_load_dwordx4 a[140:143], v23, s[20:23], s93 offen offset:3072 sc1
    v_mfma_f32_16x16x32_bf16 v[228:231], a[184:187], v[100:103], v[228:231]
    v_rcp_f32 v24, v24
    v_mfma_f32_16x16x32_bf16 v[224:227], a[184:187], v[96:99], v[224:227]
    v_rcp_f32 v25, v25
    v_mfma_f32_16x16x32_bf16 v[224:227], a[168:171], v[48:51], v[224:227]
    v_rcp_f32 v26, v26
    v_mfma_f32_16x16x32_bf16 v[208:211], a[164:167], v[48:51], v[208:211]
    s_xor_b32 s93, s49, 40960
    buffer_load_dwordx4 a[240:243], v23, s[20:23], s93 offen offset:0 sc1
    v_mfma_f32_16x16x32_bf16 v[208:211], a[180:183], v[96:99], v[208:211]
    v_rcp_f32 v27, v27
    v_mfma_f32_16x16x32_bf16 v[212:215], a[180:183], v[100:103], v[212:215]
    v_rcp_f32 v28, v28
    v_mfma_f32_16x16x32_bf16 v[212:215], a[164:167], v[52:55], v[212:215]
    v_rcp_f32 v29, v29
    v_mfma_f32_16x16x32_bf16 v[216:219], a[164:167], v[56:59], v[216:219]
    buffer_load_dwordx4 a[244:247], v23, s[20:23], s93 offen offset:1024 sc1
    v_mfma_f32_16x16x32_bf16 v[216:219], a[180:183], v[104:107], v[216:219]
    v_rcp_f32 v30, v30
    v_mfma_f32_16x16x32_bf16 v[220:223], a[180:183], v[108:111], v[220:223]
    v_rcp_f32 v31, v31
    v_mfma_f32_16x16x32_bf16 v[220:223], a[164:167], v[60:63], v[220:223]
    v_mul_f32 v88, v88, v24
    v_mul_f32 v89, v89, v25
    v_mfma_f32_16x16x32_bf16 v[204:207], a[160:163], v[60:63], v[204:207]
    buffer_load_dwordx4 a[248:251], v23, s[20:23], s93 offen offset:2048 sc1
    v_mul_f32 v90, v90, v26
    v_mfma_f32_16x16x32_bf16 v[204:207], a[176:179], v[108:111], v[204:207]
    v_mul_f32 v91, v91, v27
    v_mul_f32 v92, v92, v28
    v_mfma_f32_16x16x32_bf16 v[200:203], a[176:179], v[104:107], v[200:203]
    v_mul_f32 v93, v93, v29
    v_mul_f32 v94, v94, v30
    v_mfma_f32_16x16x32_bf16 v[200:203], a[160:163], v[56:59], v[200:203]
    v_mul_f32 v95, v95, v31
    v_mfma_f32_16x16x32_bf16 v[196:199], a[160:163], v[52:55], v[196:199]
    buffer_load_dwordx4 a[252:255], v23, s[20:23], s93 offen offset:3072 sc1
    v_mfma_f32_16x16x32_bf16 v[196:199], a[176:179], v[100:103], v[196:199]
    v_mfma_f32_16x16x32_bf16 v[192:195], a[176:179], v[96:99], v[192:195]
    v_mfma_f32_16x16x32_bf16 v[192:195], a[160:163], v[48:51], v[192:195]
    s_waitcnt vmcnt(12)
    v_mfma_f32_16x16x32_bf16 v[192:195], a[192:195], a[112:115], v[192:195]
    s_xor_b32 s93, s49, 45056
    buffer_load_dwordx4 a[144:147], v23, s[20:23], s93 offen offset:0 sc1
    v_mfma_f32_16x16x32_bf16 v[192:195], a[208:211], v[112:115], v[192:195]
    v_mfma_f32_16x16x32_bf16 v[196:199], a[208:211], v[116:119], v[196:199]
    v_mfma_f32_16x16x32_bf16 v[196:199], a[192:195], a[116:119], v[196:199]
    v_mfma_f32_16x16x32_bf16 v[200:203], a[192:195], a[120:123], v[200:203]
    buffer_load_dwordx4 a[148:151], v23, s[20:23], s93 offen offset:1024 sc1
    v_mfma_f32_16x16x32_bf16 v[200:203], a[208:211], v[120:123], v[200:203]
    v_mfma_f32_16x16x32_bf16 v[204:207], a[208:211], v[124:127], v[204:207]
    v_mfma_f32_16x16x32_bf16 v[204:207], a[192:195], a[124:127], v[204:207]
    v_mfma_f32_16x16x32_bf16 v[220:223], a[196:199], a[124:127], v[220:223]
    buffer_load_dwordx4 a[152:155], v23, s[20:23], s93 offen offset:2048 sc1
    v_mfma_f32_16x16x32_bf16 v[220:223], a[212:215], v[124:127], v[220:223]
    v_mfma_f32_16x16x32_bf16 v[216:219], a[212:215], v[120:123], v[216:219]
    v_mfma_f32_16x16x32_bf16 v[216:219], a[196:199], a[120:123], v[216:219]
    v_mfma_f32_16x16x32_bf16 v[212:215], a[196:199], a[116:119], v[212:215]
    buffer_load_dwordx4 a[156:159], v23, s[20:23], s93 offen offset:3072 sc1
    v_mfma_f32_16x16x32_bf16 v[212:215], a[212:215], v[116:119], v[212:215]
    v_mfma_f32_16x16x32_bf16 v[208:211], a[212:215], v[112:115], v[208:211]
    v_mfma_f32_16x16x32_bf16 v[208:211], a[196:199], a[112:115], v[208:211]
    v_mfma_f32_16x16x32_bf16 v[224:227], a[200:203], a[112:115], v[224:227]
    s_xor_b32 s93, s49, 49152
    buffer_load_dwordx4 v[32:35], v23, s[20:23], s93 offen offset:0 sc1
    v_mfma_f32_16x16x32_bf16 v[224:227], a[216:219], v[112:115], v[224:227]
    v_mfma_f32_16x16x32_bf16 v[228:231], a[216:219], v[116:119], v[228:231]
    v_mfma_f32_16x16x32_bf16 v[228:231], a[200:203], a[116:119], v[228:231]
    v_mfma_f32_16x16x32_bf16 v[232:235], a[200:203], a[120:123], v[232:235]
    buffer_load_dwordx4 v[36:39], v23, s[20:23], s93 offen offset:1024 sc1
    v_mfma_f32_16x16x32_bf16 v[232:235], a[216:219], v[120:123], v[232:235]
    v_mfma_f32_16x16x32_bf16 v[236:239], a[216:219], v[124:127], v[236:239]
    v_mfma_f32_16x16x32_bf16 v[236:239], a[200:203], a[124:127], v[236:239]
    v_mfma_f32_16x16x32_bf16 v[252:255], a[204:207], a[124:127], v[252:255]
    buffer_load_dwordx4 v[40:43], v23, s[20:23], s93 offen offset:2048 sc1
    v_mfma_f32_16x16x32_bf16 v[252:255], a[220:223], v[124:127], v[252:255]
    v_mfma_f32_16x16x32_bf16 v[248:251], a[220:223], v[120:123], v[248:251]
    v_mfma_f32_16x16x32_bf16 v[248:251], a[204:207], a[120:123], v[248:251]
    v_mfma_f32_16x16x32_bf16 v[244:247], a[204:207], a[116:119], v[244:247]
    buffer_load_dwordx4 v[44:47], v23, s[20:23], s93 offen offset:3072 sc1
    v_mfma_f32_16x16x32_bf16 v[244:247], a[220:223], v[116:119], v[244:247]
    v_mfma_f32_16x16x32_bf16 v[240:243], a[220:223], v[112:115], v[240:243]
    v_mfma_f32_16x16x32_bf16 v[240:243], a[204:207], a[112:115], v[240:243]
    s_waitcnt vmcnt(12)
    v_mfma_f32_16x16x32_bf16 v[240:243], v[140:143], a[224:227], v[240:243]
    s_xor_b32 s93, s49, 53248
    buffer_load_dwordx4 a[160:163], v23, s[20:23], s93 offen offset:0 sc1
    v_mfma_f32_16x16x32_bf16 v[240:243], v[156:159], a[128:131], v[240:243]
    v_mfma_f32_16x16x32_bf16 v[244:247], v[156:159], a[132:135], v[244:247]
    buffer_load_dwordx4 a[164:167], v23, s[20:23], s93 offen offset:1024 sc1
    v_mfma_f32_16x16x32_bf16 v[244:247], v[140:143], a[228:231], v[244:247]
    v_mfma_f32_16x16x32_bf16 v[248:251], v[140:143], a[232:235], v[248:251]
    buffer_load_dwordx4 a[168:171], v23, s[20:23], s93 offen offset:2048 sc1
    v_mfma_f32_16x16x32_bf16 v[248:251], v[156:159], a[136:139], v[248:251]
    v_mfma_f32_16x16x32_bf16 v[252:255], v[156:159], a[140:143], v[252:255]
    buffer_load_dwordx4 a[172:175], v23, s[20:23], s93 offen offset:3072 sc1
    v_mfma_f32_16x16x32_bf16 v[252:255], v[140:143], a[236:239], v[252:255]
    v_mfma_f32_16x16x32_bf16 v[236:239], v[136:139], a[236:239], v[236:239]
    s_xor_b32 s93, s49, 57344
    buffer_load_dwordx4 v[48:51], v23, s[20:23], s93 offen offset:0 sc1
    v_mfma_f32_16x16x32_bf16 v[236:239], v[152:155], a[140:143], v[236:239]
    v_mfma_f32_16x16x32_bf16 v[232:235], v[152:155], a[136:139], v[232:235]
    buffer_load_dwordx4 v[52:55], v23, s[20:23], s93 offen offset:1024 sc1
    v_mfma_f32_16x16x32_bf16 v[232:235], v[136:139], a[232:235], v[232:235]
    v_mfma_f32_16x16x32_bf16 v[228:231], v[136:139], a[228:231], v[228:231]
    buffer_load_dwordx4 v[56:59], v23, s[20:23], s93 offen offset:2048 sc1
    v_mfma_f32_16x16x32_bf16 v[228:231], v[152:155], a[132:135], v[228:231]
    v_mfma_f32_16x16x32_bf16 v[224:227], v[152:155], a[128:131], v[224:227]
    buffer_load_dwordx4 v[60:63], v23, s[20:23], s93 offen offset:3072 sc1
    v_mfma_f32_16x16x32_bf16 v[224:227], v[136:139], a[224:227], v[224:227]
    v_mfma_f32_16x16x32_bf16 v[208:211], v[132:135], a[224:227], v[208:211]
    s_xor_b32 s92, s48, 118784
    buffer_load_dwordx4 a[176:179], v23, s[20:23], s92 offen offset:0 sc1
    v_mfma_f32_16x16x32_bf16 v[208:211], v[148:151], a[128:131], v[208:211]
    v_mfma_f32_16x16x32_bf16 v[212:215], v[148:151], a[132:135], v[212:215]
    buffer_load_dwordx4 a[180:183], v23, s[20:23], s92 offen offset:1024 sc1
    v_mfma_f32_16x16x32_bf16 v[212:215], v[132:135], a[228:231], v[212:215]
    v_mfma_f32_16x16x32_bf16 v[216:219], v[132:135], a[232:235], v[216:219]
    buffer_load_dwordx4 a[184:187], v23, s[20:23], s92 offen offset:2048 sc1
    v_mfma_f32_16x16x32_bf16 v[216:219], v[148:151], a[136:139], v[216:219]
    v_mfma_f32_16x16x32_bf16 v[220:223], v[148:151], a[140:143], v[220:223]
    buffer_load_dwordx4 a[188:191], v23, s[20:23], s92 offen offset:3072 sc1
    v_mfma_f32_16x16x32_bf16 v[220:223], v[132:135], a[236:239], v[220:223]
    v_mfma_f32_16x16x32_bf16 v[204:207], v[128:131], a[236:239], v[204:207]
    v_mfma_f32_16x16x32_bf16 v[204:207], v[144:147], a[140:143], v[204:207]
    v_mfma_f32_16x16x32_bf16 v[200:203], v[144:147], a[136:139], v[200:203]
    v_mfma_f32_16x16x32_bf16 v[200:203], v[128:131], a[232:235], v[200:203]
    v_mfma_f32_16x16x32_bf16 v[196:199], v[128:131], a[228:231], v[196:199]
    v_mfma_f32_16x16x32_bf16 v[196:199], v[144:147], a[132:135], v[196:199]
    v_mfma_f32_16x16x32_bf16 v[192:195], v[144:147], a[128:131], v[192:195]
    v_mfma_f32_16x16x32_bf16 v[192:195], v[128:131], a[224:227], v[192:195]
    s_waitcnt vmcnt(16)
    v_mfma_f32_16x16x32_bf16 v[192:195], v[160:163], a[240:243], v[192:195]
    s_xor_b32 s93, s49, 61440
    buffer_load_dwordx4 v[96:99], v23, s[20:23], s93 offen offset:0 sc1
    v_mfma_f32_16x16x32_bf16 v[192:195], v[176:179], a[144:147], v[192:195]
    v_mfma_f32_16x16x32_bf16 v[196:199], v[176:179], a[148:151], v[196:199]
    v_mfma_f32_16x16x32_bf16 v[196:199], v[160:163], a[244:247], v[196:199]
    v_mfma_f32_16x16x32_bf16 v[200:203], v[160:163], a[248:251], v[200:203]
    buffer_load_dwordx4 v[100:103], v23, s[20:23], s93 offen offset:1024 sc1
    v_mfma_f32_16x16x32_bf16 v[200:203], v[176:179], a[152:155], v[200:203]
    v_mfma_f32_16x16x32_bf16 v[204:207], v[176:179], a[156:159], v[204:207]
    v_mfma_f32_16x16x32_bf16 v[204:207], v[160:163], a[252:255], v[204:207]
    v_mfma_f32_16x16x32_bf16 v[220:223], v[164:167], a[252:255], v[220:223]
    buffer_load_dwordx4 v[104:107], v23, s[20:23], s93 offen offset:2048 sc1
    v_mfma_f32_16x16x32_bf16 v[220:223], v[180:183], a[156:159], v[220:223]
    v_mfma_f32_16x16x32_bf16 v[216:219], v[180:183], a[152:155], v[216:219]
    v_mfma_f32_16x16x32_bf16 v[216:219], v[164:167], a[248:251], v[216:219]
    v_mfma_f32_16x16x32_bf16 v[212:215], v[164:167], a[244:247], v[212:215]
    buffer_load_dwordx4 v[108:111], v23, s[20:23], s93 offen offset:3072 sc1
    v_mfma_f32_16x16x32_bf16 v[212:215], v[180:183], a[148:151], v[212:215]
    v_mfma_f32_16x16x32_bf16 v[208:211], v[180:183], a[144:147], v[208:211]
    v_mfma_f32_16x16x32_bf16 v[208:211], v[164:167], a[240:243], v[208:211]
    v_mfma_f32_16x16x32_bf16 v[224:227], v[168:171], a[240:243], v[224:227]
    s_xor_b32 s93, s49, 65536
    buffer_load_dwordx4 a[192:195], v23, s[20:23], s93 offen offset:0 sc1
    v_mfma_f32_16x16x32_bf16 v[224:227], v[184:187], a[144:147], v[224:227]
    v_mfma_f32_16x16x32_bf16 v[228:231], v[184:187], a[148:151], v[228:231]
    v_mfma_f32_16x16x32_bf16 v[228:231], v[168:171], a[244:247], v[228:231]
    v_mfma_f32_16x16x32_bf16 v[232:235], v[168:171], a[248:251], v[232:235]
    buffer_load_dwordx4 a[196:199], v23, s[20:23], s93 offen offset:1024 sc1
    v_mfma_f32_16x16x32_bf16 v[232:235], v[184:187], a[152:155], v[232:235]
    v_mfma_f32_16x16x32_bf16 v[236:239], v[184:187], a[156:159], v[236:239]
    v_mfma_f32_16x16x32_bf16 v[236:239], v[168:171], a[252:255], v[236:239]
    v_mfma_f32_16x16x32_bf16 v[252:255], v[172:175], a[252:255], v[252:255]
    buffer_load_dwordx4 a[200:203], v23, s[20:23], s93 offen offset:2048 sc1
    v_mfma_f32_16x16x32_bf16 v[252:255], v[188:191], a[156:159], v[252:255]
    v_mfma_f32_16x16x32_bf16 v[248:251], v[188:191], a[152:155], v[248:251]
    v_mfma_f32_16x16x32_bf16 v[248:251], v[172:175], a[248:251], v[248:251]
    v_mfma_f32_16x16x32_bf16 v[244:247], v[172:175], a[244:247], v[244:247]
    buffer_load_dwordx4 a[204:207], v23, s[20:23], s93 offen offset:3072 sc1
    v_mfma_f32_16x16x32_bf16 v[244:247], v[188:191], a[148:151], v[244:247]
    v_mfma_f32_16x16x32_bf16 v[240:243], v[188:191], a[144:147], v[240:243]
    v_mfma_f32_16x16x32_bf16 v[240:243], v[172:175], a[240:243], v[240:243]
    s_waitcnt vmcnt(16)
    v_mfma_f32_16x16x32_bf16 v[240:243], a[12:15], v[32:35], v[240:243]
    s_xor_b32 s93, s49, 69632
    buffer_load_dwordx4 a[112:115], v23, s[20:23], s93 offen offset:0 sc1
    v_mfma_f32_16x16x32_bf16 v[240:243], a[28:31], a[160:163], v[240:243]
    v_mfma_f32_16x16x32_bf16 v[244:247], a[28:31], a[164:167], v[244:247]
    v_mfma_f32_16x16x32_bf16 v[244:247], a[12:15], v[36:39], v[244:247]
    v_mfma_f32_16x16x32_bf16 v[248:251], a[12:15], v[40:43], v[248:251]
    buffer_load_dwordx4 a[116:119], v23, s[20:23], s93 offen offset:1024 sc1
    v_mfma_f32_16x16x32_bf16 v[248:251], a[28:31], a[168:171], v[248:251]
    v_mfma_f32_16x16x32_bf16 v[252:255], a[28:31], a[172:175], v[252:255]
    v_mfma_f32_16x16x32_bf16 v[252:255], a[12:15], v[44:47], v[252:255]
    v_mfma_f32_16x16x32_bf16 v[236:239], a[8:11], v[44:47], v[236:239]
    buffer_load_dwordx4 a[120:123], v23, s[20:23], s93 offen offset:2048 sc1
    v_mfma_f32_16x16x32_bf16 v[236:239], a[24:27], a[172:175], v[236:239]
    v_mfma_f32_16x16x32_bf16 v[232:235], a[24:27], a[168:171], v[232:235]
    v_mfma_f32_16x16x32_bf16 v[232:235], a[8:11], v[40:43], v[232:235]
    v_mfma_f32_16x16x32_bf16 v[228:231], a[8:11], v[36:39], v[228:231]
    buffer_load_dwordx4 a[124:127], v23, s[20:23], s93 offen offset:3072 sc1
    v_mfma_f32_16x16x32_bf16 v[228:231], a[24:27], a[164:167], v[228:231]
    v_mfma_f32_16x16x32_bf16 v[224:227], a[24:27], a[160:163], v[224:227]
    v_mfma_f32_16x16x32_bf16 v[224:227], a[8:11], v[32:35], v[224:227]
    v_mfma_f32_16x16x32_bf16 v[208:211], a[4:7], v[32:35], v[208:211]
    s_xor_b32 s93, s49, 73728
    buffer_load_dwordx4 a[208:211], v23, s[20:23], s93 offen offset:0 sc1
    v_mfma_f32_16x16x32_bf16 v[208:211], a[20:23], a[160:163], v[208:211]
    v_mfma_f32_16x16x32_bf16 v[212:215], a[20:23], a[164:167], v[212:215]
    v_mfma_f32_16x16x32_bf16 v[212:215], a[4:7], v[36:39], v[212:215]
    v_mfma_f32_16x16x32_bf16 v[216:219], a[4:7], v[40:43], v[216:219]
    buffer_load_dwordx4 a[212:215], v23, s[20:23], s93 offen offset:1024 sc1
    v_mfma_f32_16x16x32_bf16 v[216:219], a[20:23], a[168:171], v[216:219]
    v_mfma_f32_16x16x32_bf16 v[220:223], a[20:23], a[172:175], v[220:223]
    v_mfma_f32_16x16x32_bf16 v[220:223], a[4:7], v[44:47], v[220:223]
    v_mfma_f32_16x16x32_bf16 v[204:207], a[0:3], v[44:47], v[204:207]
    buffer_load_dwordx4 a[216:219], v23, s[20:23], s93 offen offset:2048 sc1
    v_mfma_f32_16x16x32_bf16 v[204:207], a[16:19], a[172:175], v[204:207]
    v_mfma_f32_16x16x32_bf16 v[200:203], a[16:19], a[168:171], v[200:203]
    v_mfma_f32_16x16x32_bf16 v[200:203], a[0:3], v[40:43], v[200:203]
    v_mfma_f32_16x16x32_bf16 v[196:199], a[0:3], v[36:39], v[196:199]
    buffer_load_dwordx4 a[220:223], v23, s[20:23], s93 offen offset:3072 sc1
    v_mfma_f32_16x16x32_bf16 v[196:199], a[16:19], a[164:167], v[196:199]
    v_mfma_f32_16x16x32_bf16 v[192:195], a[16:19], a[160:163], v[192:195]
    v_mfma_f32_16x16x32_bf16 v[192:195], a[0:3], v[32:35], v[192:195]
    s_waitcnt vmcnt(12)
    v_mfma_f32_16x16x32_bf16 v[192:195], a[32:35], v[48:51], v[192:195]
    s_xor_b32 s93, s49, 77824
    buffer_load_dwordx4 v[112:115], v23, s[20:23], s93 offen offset:0 sc1
    v_mfma_f32_16x16x32_bf16 v[192:195], a[48:51], v[96:99], v[192:195]
    v_mfma_f32_16x16x32_bf16 v[196:199], a[48:51], v[100:103], v[196:199]
    v_mfma_f32_16x16x32_bf16 v[196:199], a[32:35], v[52:55], v[196:199]
    v_mfma_f32_16x16x32_bf16 v[200:203], a[32:35], v[56:59], v[200:203]
    buffer_load_dwordx4 v[116:119], v23, s[20:23], s93 offen offset:1024 sc1
    v_mfma_f32_16x16x32_bf16 v[200:203], a[48:51], v[104:107], v[200:203]
    v_mfma_f32_16x16x32_bf16 v[204:207], a[48:51], v[108:111], v[204:207]
    v_mfma_f32_16x16x32_bf16 v[204:207], a[32:35], v[60:63], v[204:207]
    v_mfma_f32_16x16x32_bf16 v[220:223], a[36:39], v[60:63], v[220:223]
    buffer_load_dwordx4 v[120:123], v23, s[20:23], s93 offen offset:2048 sc1
    v_mfma_f32_16x16x32_bf16 v[220:223], a[52:55], v[108:111], v[220:223]
    v_mfma_f32_16x16x32_bf16 v[216:219], a[52:55], v[104:107], v[216:219]
    v_mfma_f32_16x16x32_bf16 v[216:219], a[36:39], v[56:59], v[216:219]
    v_mfma_f32_16x16x32_bf16 v[212:215], a[36:39], v[52:55], v[212:215]
    buffer_load_dwordx4 v[124:127], v23, s[20:23], s93 offen offset:3072 sc1
    v_mfma_f32_16x16x32_bf16 v[212:215], a[52:55], v[100:103], v[212:215]
    v_mfma_f32_16x16x32_bf16 v[208:211], a[52:55], v[96:99], v[208:211]
    v_mfma_f32_16x16x32_bf16 v[208:211], a[36:39], v[48:51], v[208:211]
    v_mfma_f32_16x16x32_bf16 v[224:227], a[40:43], v[48:51], v[224:227]
    s_xor_b32 s93, s49, 81920
    buffer_load_dwordx4 v[128:131], v23, s[20:23], s93 offen offset:0 sc1
    v_mfma_f32_16x16x32_bf16 v[224:227], a[56:59], v[96:99], v[224:227]
    v_mfma_f32_16x16x32_bf16 v[228:231], a[56:59], v[100:103], v[228:231]
    v_mfma_f32_16x16x32_bf16 v[228:231], a[40:43], v[52:55], v[228:231]
    v_mfma_f32_16x16x32_bf16 v[232:235], a[40:43], v[56:59], v[232:235]
    buffer_load_dwordx4 v[132:135], v23, s[20:23], s93 offen offset:1024 sc1
    v_mfma_f32_16x16x32_bf16 v[232:235], a[56:59], v[104:107], v[232:235]
    v_mfma_f32_16x16x32_bf16 v[236:239], a[56:59], v[108:111], v[236:239]
    v_mfma_f32_16x16x32_bf16 v[236:239], a[40:43], v[60:63], v[236:239]
    v_mfma_f32_16x16x32_bf16 v[252:255], a[44:47], v[60:63], v[252:255]
    buffer_load_dwordx4 v[136:139], v23, s[20:23], s93 offen offset:2048 sc1
    v_mfma_f32_16x16x32_bf16 v[252:255], a[60:63], v[108:111], v[252:255]
    v_mfma_f32_16x16x32_bf16 v[248:251], a[60:63], v[104:107], v[248:251]
    v_mfma_f32_16x16x32_bf16 v[248:251], a[44:47], v[56:59], v[248:251]
    v_mfma_f32_16x16x32_bf16 v[244:247], a[44:47], v[52:55], v[244:247]
    buffer_load_dwordx4 v[140:143], v23, s[20:23], s93 offen offset:3072 sc1
    v_mfma_f32_16x16x32_bf16 v[244:247], a[60:63], v[100:103], v[244:247]
    v_mfma_f32_16x16x32_bf16 v[240:243], a[60:63], v[96:99], v[240:243]
    v_mfma_f32_16x16x32_bf16 v[240:243], a[44:47], v[48:51], v[240:243]
    s_waitcnt vmcnt(12)
    v_mfma_f32_16x16x32_bf16 v[240:243], a[76:79], a[192:195], v[240:243]
    s_xor_b32 s93, s49, 86016
    buffer_load_dwordx4 v[144:147], v23, s[20:23], s93 offen offset:0 sc1
    v_mfma_f32_16x16x32_bf16 v[240:243], a[92:95], a[112:115], v[240:243]
    ds_read_b128 a[224:227], v12 offset:36864
    v_mfma_f32_16x16x32_bf16 v[244:247], a[92:95], a[116:119], v[244:247]
    buffer_load_dwordx4 v[148:151], v23, s[20:23], s93 offen offset:1024 sc1
    v_mfma_f32_16x16x32_bf16 v[244:247], a[76:79], a[196:199], v[244:247]
    ds_read_b128 a[228:231], v12 offset:37888
    v_mfma_f32_16x16x32_bf16 v[248:251], a[76:79], a[200:203], v[248:251]
    buffer_load_dwordx4 v[152:155], v23, s[20:23], s93 offen offset:2048 sc1
    v_mfma_f32_16x16x32_bf16 v[248:251], a[92:95], a[120:123], v[248:251]
    ds_read_b128 a[232:235], v12 offset:38912
    v_mfma_f32_16x16x32_bf16 v[252:255], a[92:95], a[124:127], v[252:255]
    buffer_load_dwordx4 v[156:159], v23, s[20:23], s93 offen offset:3072 sc1
    v_mfma_f32_16x16x32_bf16 v[252:255], a[76:79], a[204:207], v[252:255]
    ds_read_b128 a[236:239], v12 offset:39936
    v_mfma_f32_16x16x32_bf16 v[236:239], a[72:75], a[204:207], v[236:239]
    s_xor_b32 s93, s49, 90112
    buffer_load_dwordx4 a[128:131], v23, s[20:23], s93 offen offset:0 sc1
    v_mfma_f32_16x16x32_bf16 v[236:239], a[88:91], a[124:127], v[236:239]
    v_mfma_f32_16x16x32_bf16 v[232:235], a[88:91], a[120:123], v[232:235]
    buffer_load_dwordx4 a[132:135], v23, s[20:23], s93 offen offset:1024 sc1
    v_mfma_f32_16x16x32_bf16 v[232:235], a[72:75], a[200:203], v[232:235]
    v_mfma_f32_16x16x32_bf16 v[228:231], a[72:75], a[196:199], v[228:231]
    buffer_load_dwordx4 a[136:139], v23, s[20:23], s93 offen offset:2048 sc1
    v_mfma_f32_16x16x32_bf16 v[228:231], a[88:91], a[116:119], v[228:231]
    v_mfma_f32_16x16x32_bf16 v[224:227], a[88:91], a[112:115], v[224:227]
    buffer_load_dwordx4 a[140:143], v23, s[20:23], s93 offen offset:3072 sc1
    v_mfma_f32_16x16x32_bf16 v[224:227], a[72:75], a[192:195], v[224:227]
    v_mfma_f32_16x16x32_bf16 v[208:211], a[68:71], a[192:195], v[208:211]
    s_xor_b32 s92, s48, 122880
    buffer_load_dwordx4 v[160:163], v23, s[20:23], s92 offen offset:0 sc1
    v_mfma_f32_16x16x32_bf16 v[208:211], a[84:87], a[112:115], v[208:211]
    v_mfma_f32_16x16x32_bf16 v[212:215], a[84:87], a[116:119], v[212:215]
    buffer_load_dwordx4 v[164:167], v23, s[20:23], s92 offen offset:1024 sc1
    v_mfma_f32_16x16x32_bf16 v[212:215], a[68:71], a[196:199], v[212:215]
    v_mfma_f32_16x16x32_bf16 v[216:219], a[68:71], a[200:203], v[216:219]
    buffer_load_dwordx4 v[168:171], v23, s[20:23], s92 offen offset:2048 sc1
    v_mfma_f32_16x16x32_bf16 v[216:219], a[84:87], a[120:123], v[216:219]
    v_mfma_f32_16x16x32_bf16 v[220:223], a[84:87], a[124:127], v[220:223]
    buffer_load_dwordx4 v[172:175], v23, s[20:23], s92 offen offset:3072 sc1
    v_mfma_f32_16x16x32_bf16 v[220:223], a[68:71], a[204:207], v[220:223]
    v_mfma_f32_16x16x32_bf16 v[204:207], a[64:67], a[204:207], v[204:207]
    v_mfma_f32_16x16x32_bf16 v[204:207], a[80:83], a[124:127], v[204:207]
    v_mfma_f32_16x16x32_bf16 v[200:203], a[80:83], a[120:123], v[200:203]
    v_mfma_f32_16x16x32_bf16 v[200:203], a[64:67], a[200:203], v[200:203]
    v_mfma_f32_16x16x32_bf16 v[196:199], a[64:67], a[196:199], v[196:199]
    v_mfma_f32_16x16x32_bf16 v[196:199], a[80:83], a[116:119], v[196:199]
    v_mfma_f32_16x16x32_bf16 v[192:195], a[80:83], a[112:115], v[192:195]
    v_mfma_f32_16x16x32_bf16 v[192:195], a[64:67], a[192:195], v[192:195]
    s_waitcnt vmcnt(16) lgkmcnt(0)
    v_mfma_f32_16x16x32_bf16 v[192:195], a[96:99], a[208:211], v[192:195]
    s_xor_b32 s93, s49, 94208
    buffer_load_dwordx4 a[144:147], v23, s[20:23], s93 offen offset:0 sc1
    v_mfma_f32_16x16x32_bf16 v[192:195], a[224:227], v[112:115], v[192:195]
    ds_read_b128 a[240:243], v12 offset:32768
    v_mfma_f32_16x16x32_bf16 v[196:199], a[224:227], v[116:119], v[196:199]
    v_mfma_f32_16x16x32_bf16 v[196:199], a[96:99], a[212:215], v[196:199]
    ds_read_b128 a[244:247], v12 offset:33792
    v_mfma_f32_16x16x32_bf16 v[200:203], a[96:99], a[216:219], v[200:203]
    buffer_load_dwordx4 a[148:151], v23, s[20:23], s93 offen offset:1024 sc1
    v_mfma_f32_16x16x32_bf16 v[200:203], a[224:227], v[120:123], v[200:203]
    ds_read_b128 a[248:251], v12 offset:34816
    v_mfma_f32_16x16x32_bf16 v[204:207], a[224:227], v[124:127], v[204:207]
    v_mfma_f32_16x16x32_bf16 v[204:207], a[96:99], a[220:223], v[204:207]
    ds_read_b128 a[252:255], v12 offset:35840
    v_mfma_f32_16x16x32_bf16 v[220:223], a[100:103], a[220:223], v[220:223]
    buffer_load_dwordx4 a[152:155], v23, s[20:23], s93 offen offset:2048 sc1
    v_mfma_f32_16x16x32_bf16 v[220:223], a[228:231], v[124:127], v[220:223]
    ds_read_b128 v[176:179], v13 offset:32768
    v_mfma_f32_16x16x32_bf16 v[216:219], a[228:231], v[120:123], v[216:219]
    v_mfma_f32_16x16x32_bf16 v[216:219], a[100:103], a[216:219], v[216:219]
    ds_read_b128 v[180:183], v13 offset:33792
    v_mfma_f32_16x16x32_bf16 v[212:215], a[100:103], a[212:215], v[212:215]
    buffer_load_dwordx4 a[156:159], v23, s[20:23], s93 offen offset:3072 sc1
    v_mfma_f32_16x16x32_bf16 v[212:215], a[228:231], v[116:119], v[212:215]
    ds_read_b128 v[184:187], v13 offset:34816
    v_mfma_f32_16x16x32_bf16 v[208:211], a[228:231], v[112:115], v[208:211]
    v_mfma_f32_16x16x32_bf16 v[208:211], a[100:103], a[208:211], v[208:211]
    ds_read_b128 v[188:191], v13 offset:35840
    v_mfma_f32_16x16x32_bf16 v[224:227], a[104:107], a[208:211], v[224:227]
    s_xor_b32 s93, s49, 98304
    buffer_load_dwordx4 a[0:3], v23, s[20:23], s93 offen offset:0 sc1
    v_mfma_f32_16x16x32_bf16 v[224:227], a[232:235], v[112:115], v[224:227]
    v_mfma_f32_16x16x32_bf16 v[228:231], a[232:235], v[116:119], v[228:231]
    v_mfma_f32_16x16x32_bf16 v[228:231], a[104:107], a[212:215], v[228:231]
    v_mfma_f32_16x16x32_bf16 v[232:235], a[104:107], a[216:219], v[232:235]
    buffer_load_dwordx4 a[4:7], v23, s[20:23], s93 offen offset:1024 sc1
    v_mfma_f32_16x16x32_bf16 v[232:235], a[232:235], v[120:123], v[232:235]
    v_mfma_f32_16x16x32_bf16 v[236:239], a[232:235], v[124:127], v[236:239]
    v_mfma_f32_16x16x32_bf16 v[236:239], a[104:107], a[220:223], v[236:239]
    v_mfma_f32_16x16x32_bf16 v[252:255], a[108:111], a[220:223], v[252:255]
    buffer_load_dwordx4 a[8:11], v23, s[20:23], s93 offen offset:2048 sc1
    v_mfma_f32_16x16x32_bf16 v[252:255], a[236:239], v[124:127], v[252:255]
    v_mfma_f32_16x16x32_bf16 v[248:251], a[236:239], v[120:123], v[248:251]
    v_mfma_f32_16x16x32_bf16 v[248:251], a[108:111], a[216:219], v[248:251]
    v_mfma_f32_16x16x32_bf16 v[244:247], a[108:111], a[212:215], v[244:247]
    buffer_load_dwordx4 a[12:15], v23, s[20:23], s93 offen offset:3072 sc1
    v_mfma_f32_16x16x32_bf16 v[244:247], a[236:239], v[116:119], v[244:247]
    v_mfma_f32_16x16x32_bf16 v[240:243], a[236:239], v[112:115], v[240:243]
    v_mfma_f32_16x16x32_bf16 v[240:243], a[108:111], a[208:211], v[240:243]
    s_waitcnt vmcnt(16) lgkmcnt(0)
    v_mfma_f32_16x16x32_bf16 v[240:243], a[252:255], v[128:131], v[240:243]
    s_xor_b32 s93, s49, 102400
    buffer_load_dwordx4 a[160:163], v23, s[20:23], s93 offen offset:0 sc1
    v_mfma_f32_16x16x32_bf16 v[240:243], v[188:191], v[144:147], v[240:243]
    ds_read_b128 v[32:35], v13 offset:36864
    v_mfma_f32_16x16x32_bf16 v[244:247], v[188:191], v[148:151], v[244:247]
    v_mfma_f32_16x16x32_bf16 v[244:247], a[252:255], v[132:135], v[244:247]
    ds_read_b128 v[36:39], v13 offset:37888
    v_mfma_f32_16x16x32_bf16 v[248:251], a[252:255], v[136:139], v[248:251]
    buffer_load_dwordx4 a[164:167], v23, s[20:23], s93 offen offset:1024 sc1
    v_mfma_f32_16x16x32_bf16 v[248:251], v[188:191], v[152:155], v[248:251]
    ds_read_b128 v[40:43], v13 offset:38912
    v_mfma_f32_16x16x32_bf16 v[252:255], v[188:191], v[156:159], v[252:255]
    v_mfma_f32_16x16x32_bf16 v[252:255], a[252:255], v[140:143], v[252:255]
    ds_read_b128 v[44:47], v13 offset:39936
    v_mfma_f32_16x16x32_bf16 v[236:239], a[248:251], v[140:143], v[236:239]
    buffer_load_dwordx4 a[168:171], v23, s[20:23], s93 offen offset:2048 sc1
    v_mfma_f32_16x16x32_bf16 v[236:239], v[184:187], v[156:159], v[236:239]
    ds_read_b128 a[16:19], v14 offset:0
    v_mfma_f32_16x16x32_bf16 v[232:235], v[184:187], v[152:155], v[232:235]
    v_mfma_f32_16x16x32_bf16 v[232:235], a[248:251], v[136:139], v[232:235]
    ds_read_b128 a[20:23], v14 offset:1024
    v_mfma_f32_16x16x32_bf16 v[228:231], a[248:251], v[132:135], v[228:231]
    buffer_load_dwordx4 a[172:175], v23, s[20:23], s93 offen offset:3072 sc1
    v_mfma_f32_16x16x32_bf16 v[228:231], v[184:187], v[148:151], v[228:231]
    ds_read_b128 a[24:27], v14 offset:2048
    v_mfma_f32_16x16x32_bf16 v[224:227], v[184:187], v[144:147], v[224:227]
    v_mfma_f32_16x16x32_bf16 v[224:227], a[248:251], v[128:131], v[224:227]
    ds_read_b128 a[28:31], v14 offset:3072
    v_mfma_f32_16x16x32_bf16 v[208:211], a[244:247], v[128:131], v[208:211]
    s_xor_b32 s93, s49, 106496
    buffer_load_dwordx4 a[32:35], v23, s[20:23], s93 offen offset:0 sc1
    v_mfma_f32_16x16x32_bf16 v[208:211], v[180:183], v[144:147], v[208:211]
    v_mfma_f32_16x16x32_bf16 v[212:215], v[180:183], v[148:151], v[212:215]
    v_mfma_f32_16x16x32_bf16 v[212:215], a[244:247], v[132:135], v[212:215]
    v_mfma_f32_16x16x32_bf16 v[216:219], a[244:247], v[136:139], v[216:219]
    buffer_load_dwordx4 a[36:39], v23, s[20:23], s93 offen offset:1024 sc1
    v_mfma_f32_16x16x32_bf16 v[216:219], v[180:183], v[152:155], v[216:219]
    v_mfma_f32_16x16x32_bf16 v[220:223], v[180:183], v[156:159], v[220:223]
    v_mfma_f32_16x16x32_bf16 v[220:223], a[244:247], v[140:143], v[220:223]
    v_mfma_f32_16x16x32_bf16 v[204:207], a[240:243], v[140:143], v[204:207]
    buffer_load_dwordx4 a[40:43], v23, s[20:23], s93 offen offset:2048 sc1
    v_mfma_f32_16x16x32_bf16 v[204:207], v[176:179], v[156:159], v[204:207]
    v_mfma_f32_16x16x32_bf16 v[200:203], v[176:179], v[152:155], v[200:203]
    v_mfma_f32_16x16x32_bf16 v[200:203], a[240:243], v[136:139], v[200:203]
    v_mfma_f32_16x16x32_bf16 v[196:199], a[240:243], v[132:135], v[196:199]
    buffer_load_dwordx4 a[44:47], v23, s[20:23], s93 offen offset:3072 sc1
    v_mfma_f32_16x16x32_bf16 v[196:199], v[176:179], v[148:151], v[196:199]
    v_mfma_f32_16x16x32_bf16 v[192:195], v[176:179], v[144:147], v[192:195]
    v_mfma_f32_16x16x32_bf16 v[192:195], a[240:243], v[128:131], v[192:195]
    s_waitcnt vmcnt(12) lgkmcnt(0)
    v_mfma_f32_16x16x32_bf16 v[192:195], v[32:35], a[128:131], v[192:195]
    s_xor_b32 s93, s49, 110592
    buffer_load_dwordx4 v[96:99], v23, s[20:23], s93 offen offset:0 sc1
    v_mfma_f32_16x16x32_bf16 v[192:195], a[16:19], a[144:147], v[192:195]
    ds_read_b128 v[48:51], v14 offset:4096
    v_mfma_f32_16x16x32_bf16 v[196:199], a[16:19], a[148:151], v[196:199]
    v_mfma_f32_16x16x32_bf16 v[196:199], v[32:35], a[132:135], v[196:199]
    ds_read_b128 v[52:55], v14 offset:5120
    v_mfma_f32_16x16x32_bf16 v[200:203], v[32:35], a[136:139], v[200:203]
    buffer_load_dwordx4 v[100:103], v23, s[20:23], s93 offen offset:1024 sc1
    v_mfma_f32_16x16x32_bf16 v[200:203], a[16:19], a[152:155], v[200:203]
    ds_read_b128 v[56:59], v14 offset:6144
    v_mfma_f32_16x16x32_bf16 v[204:207], a[16:19], a[156:159], v[204:207]
    v_mfma_f32_16x16x32_bf16 v[204:207], v[32:35], a[140:143], v[204:207]
    ds_read_b128 v[60:63], v14 offset:7168
    v_mfma_f32_16x16x32_bf16 v[220:223], v[36:39], a[140:143], v[220:223]
    buffer_load_dwordx4 v[104:107], v23, s[20:23], s93 offen offset:2048 sc1
    v_mfma_f32_16x16x32_bf16 v[220:223], a[20:23], a[156:159], v[220:223]
    ds_read_b128 a[48:51], v12 offset:0
    v_mfma_f32_16x16x32_bf16 v[216:219], a[20:23], a[152:155], v[216:219]
    v_mfma_f32_16x16x32_bf16 v[216:219], v[36:39], a[136:139], v[216:219]
    ds_read_b128 a[52:55], v12 offset:1024
    v_mfma_f32_16x16x32_bf16 v[212:215], v[36:39], a[132:135], v[212:215]
    buffer_load_dwordx4 v[108:111], v23, s[20:23], s93 offen offset:3072 sc1
    v_mfma_f32_16x16x32_bf16 v[212:215], a[20:23], a[148:151], v[212:215]
    ds_read_b128 a[56:59], v12 offset:2048
    v_mfma_f32_16x16x32_bf16 v[208:211], a[20:23], a[144:147], v[208:211]
    v_mfma_f32_16x16x32_bf16 v[208:211], v[36:39], a[128:131], v[208:211]
    ds_read_b128 a[60:63], v12 offset:3072
    v_mfma_f32_16x16x32_bf16 v[224:227], v[40:43], a[128:131], v[224:227]
    s_xor_b32 s93, s49, 114688
    buffer_load_dwordx4 a[64:67], v23, s[20:23], s93 offen offset:0 sc1
    v_mfma_f32_16x16x32_bf16 v[224:227], a[24:27], a[144:147], v[224:227]
    v_mfma_f32_16x16x32_bf16 v[228:231], a[24:27], a[148:151], v[228:231]
    v_mfma_f32_16x16x32_bf16 v[228:231], v[40:43], a[132:135], v[228:231]
    v_mfma_f32_16x16x32_bf16 v[232:235], v[40:43], a[136:139], v[232:235]
    buffer_load_dwordx4 a[68:71], v23, s[20:23], s93 offen offset:1024 sc1
    v_mfma_f32_16x16x32_bf16 v[232:235], a[24:27], a[152:155], v[232:235]
    v_mfma_f32_16x16x32_bf16 v[236:239], a[24:27], a[156:159], v[236:239]
    v_mfma_f32_16x16x32_bf16 v[236:239], v[40:43], a[140:143], v[236:239]
    v_mfma_f32_16x16x32_bf16 v[252:255], v[44:47], a[140:143], v[252:255]
    buffer_load_dwordx4 a[72:75], v23, s[20:23], s93 offen offset:2048 sc1
    v_mfma_f32_16x16x32_bf16 v[252:255], a[28:31], a[156:159], v[252:255]
    v_mfma_f32_16x16x32_bf16 v[248:251], a[28:31], a[152:155], v[248:251]
    v_mfma_f32_16x16x32_bf16 v[248:251], v[44:47], a[136:139], v[248:251]
    v_mfma_f32_16x16x32_bf16 v[244:247], v[44:47], a[132:135], v[244:247]
    buffer_load_dwordx4 a[76:79], v23, s[20:23], s93 offen offset:3072 sc1
    v_mfma_f32_16x16x32_bf16 v[244:247], a[28:31], a[148:151], v[244:247]
    v_mfma_f32_16x16x32_bf16 v[240:243], a[28:31], a[144:147], v[240:243]
    v_mfma_f32_16x16x32_bf16 v[240:243], v[44:47], a[128:131], v[240:243]
    s_waitcnt vmcnt(12) lgkmcnt(0)
    v_mfma_f32_16x16x32_bf16 v[240:243], v[60:63], a[0:3], v[240:243]
    s_xor_b32 s93, s49, 118784
    buffer_load_dwordx4 a[112:115], v23, s[20:23], s93 offen offset:0 sc1
    v_mfma_f32_16x16x32_bf16 v[240:243], a[60:63], a[160:163], v[240:243]
    ds_read_b128 a[192:195], v12 offset:4096
    v_mfma_f32_16x16x32_bf16 v[244:247], a[60:63], a[164:167], v[244:247]
    buffer_load_dwordx4 a[116:119], v23, s[20:23], s93 offen offset:1024 sc1
    v_mfma_f32_16x16x32_bf16 v[244:247], v[60:63], a[4:7], v[244:247]
    ds_read_b128 a[196:199], v12 offset:5120
    v_mfma_f32_16x16x32_bf16 v[248:251], v[60:63], a[8:11], v[248:251]
    buffer_load_dwordx4 a[120:123], v23, s[20:23], s93 offen offset:2048 sc1
    v_mfma_f32_16x16x32_bf16 v[248:251], a[60:63], a[168:171], v[248:251]
    ds_read_b128 a[200:203], v12 offset:6144
    v_mfma_f32_16x16x32_bf16 v[252:255], a[60:63], a[172:175], v[252:255]
    buffer_load_dwordx4 a[124:127], v23, s[20:23], s93 offen offset:3072 sc1
    v_mfma_f32_16x16x32_bf16 v[252:255], v[60:63], a[12:15], v[252:255]
    ds_read_b128 a[204:207], v12 offset:7168
    v_mfma_f32_16x16x32_bf16 v[236:239], v[56:59], a[12:15], v[236:239]
    s_xor_b32 s93, s49, 122880
    buffer_load_dwordx4 a[96:99], v23, s[20:23], s93 offen offset:0 sc1
    v_mfma_f32_16x16x32_bf16 v[236:239], a[56:59], a[172:175], v[236:239]
    ds_read_b128 a[80:83], v13 offset:0
    v_mfma_f32_16x16x32_bf16 v[232:235], a[56:59], a[168:171], v[232:235]
    buffer_load_dwordx4 a[100:103], v23, s[20:23], s93 offen offset:1024 sc1
    v_mfma_f32_16x16x32_bf16 v[232:235], v[56:59], a[8:11], v[232:235]
    ds_read_b128 a[84:87], v13 offset:1024
    v_mfma_f32_16x16x32_bf16 v[228:231], v[56:59], a[4:7], v[228:231]
    buffer_load_dwordx4 a[104:107], v23, s[20:23], s93 offen offset:2048 sc1
    v_mfma_f32_16x16x32_bf16 v[228:231], a[56:59], a[164:167], v[228:231]
    ds_read_b128 a[88:91], v13 offset:2048
    v_mfma_f32_16x16x32_bf16 v[224:227], a[56:59], a[160:163], v[224:227]
    buffer_load_dwordx4 a[108:111], v23, s[20:23], s93 offen offset:3072 sc1
    v_mfma_f32_16x16x32_bf16 v[224:227], v[56:59], a[0:3], v[224:227]
    ds_read_b128 a[92:95], v13 offset:3072
    v_mfma_f32_16x16x32_bf16 v[208:211], v[52:55], a[0:3], v[208:211]
    s_xor_b32 s92, s48, 126976
    buffer_load_dwordx4 a[208:211], v23, s[20:23], s92 offen offset:0 sc1
    v_mfma_f32_16x16x32_bf16 v[208:211], a[52:55], a[160:163], v[208:211]
    v_mfma_f32_16x16x32_bf16 v[212:215], a[52:55], a[164:167], v[212:215]
    buffer_load_dwordx4 a[212:215], v23, s[20:23], s92 offen offset:1024 sc1
    v_mfma_f32_16x16x32_bf16 v[212:215], v[52:55], a[4:7], v[212:215]
    v_mfma_f32_16x16x32_bf16 v[216:219], v[52:55], a[8:11], v[216:219]
    buffer_load_dwordx4 a[216:219], v23, s[20:23], s92 offen offset:2048 sc1
    v_mfma_f32_16x16x32_bf16 v[216:219], a[52:55], a[168:171], v[216:219]
    v_mfma_f32_16x16x32_bf16 v[220:223], a[52:55], a[172:175], v[220:223]
    buffer_load_dwordx4 a[220:223], v23, s[20:23], s92 offen offset:3072 sc1
    v_mfma_f32_16x16x32_bf16 v[220:223], v[52:55], a[12:15], v[220:223]
    v_mfma_f32_16x16x32_bf16 v[204:207], v[48:51], a[12:15], v[204:207]
    v_mfma_f32_16x16x32_bf16 v[204:207], a[48:51], a[172:175], v[204:207]
    v_mfma_f32_16x16x32_bf16 v[200:203], a[48:51], a[168:171], v[200:203]
    v_mfma_f32_16x16x32_bf16 v[200:203], v[48:51], a[8:11], v[200:203]
    v_mfma_f32_16x16x32_bf16 v[196:199], v[48:51], a[4:7], v[196:199]
    v_mfma_f32_16x16x32_bf16 v[196:199], a[48:51], a[164:167], v[196:199]
    v_mfma_f32_16x16x32_bf16 v[192:195], a[48:51], a[160:163], v[192:195]
    v_mfma_f32_16x16x32_bf16 v[192:195], v[48:51], a[0:3], v[192:195]
    s_waitcnt vmcnt(16) lgkmcnt(0)
    v_mfma_f32_16x16x32_bf16 v[192:195], a[192:195], a[32:35], v[192:195]
    s_xor_b32 s93, s49, 126976
    buffer_load_dwordx4 v[112:115], v23, s[20:23], s93 offen offset:0 sc1
    v_mfma_f32_16x16x32_bf16 v[192:195], a[80:83], v[96:99], v[192:195]
    ds_read_b128 a[224:227], v13 offset:4096
    v_mfma_f32_16x16x32_bf16 v[196:199], a[80:83], v[100:103], v[196:199]
    v_mfma_f32_16x16x32_bf16 v[196:199], a[192:195], a[36:39], v[196:199]
    ds_read_b128 a[228:231], v13 offset:5120
    v_mfma_f32_16x16x32_bf16 v[200:203], a[192:195], a[40:43], v[200:203]
    v_mfma_f32_16x16x32_bf16 v[200:203], a[80:83], v[104:107], v[200:203]
    ds_read_b128 a[232:235], v13 offset:6144
    v_mfma_f32_16x16x32_bf16 v[204:207], a[80:83], v[108:111], v[204:207]
    v_mfma_f32_16x16x32_bf16 v[204:207], a[192:195], a[44:47], v[204:207]
    ds_read_b128 a[236:239], v13 offset:7168
    v_mfma_f32_16x16x32_bf16 v[220:223], a[196:199], a[44:47], v[220:223]
    buffer_load_dwordx4 v[116:119], v23, s[20:23], s93 offen offset:1024 sc1
    v_mfma_f32_16x16x32_bf16 v[220:223], a[84:87], v[108:111], v[220:223]
    v_mfma_f32_16x16x32_bf16 v[216:219], a[84:87], v[104:107], v[216:219]
    v_mfma_f32_16x16x32_bf16 v[216:219], a[196:199], a[40:43], v[216:219]
    v_mfma_f32_16x16x32_bf16 v[212:215], a[196:199], a[36:39], v[212:215]
    v_mfma_f32_16x16x32_bf16 v[212:215], a[84:87], v[100:103], v[212:215]
    v_mfma_f32_16x16x32_bf16 v[208:211], a[84:87], v[96:99], v[208:211]
    v_mfma_f32_16x16x32_bf16 v[208:211], a[196:199], a[32:35], v[208:211]
    v_mfma_f32_16x16x32_bf16 v[224:227], a[200:203], a[32:35], v[224:227]
    buffer_load_dwordx4 v[120:123], v23, s[20:23], s93 offen offset:2048 sc1
    v_mfma_f32_16x16x32_bf16 v[224:227], a[88:91], v[96:99], v[224:227]
    v_mfma_f32_16x16x32_bf16 v[228:231], a[88:91], v[100:103], v[228:231]
    v_mfma_f32_16x16x32_bf16 v[228:231], a[200:203], a[36:39], v[228:231]
    v_mfma_f32_16x16x32_bf16 v[232:235], a[200:203], a[40:43], v[232:235]
    v_mfma_f32_16x16x32_bf16 v[232:235], a[88:91], v[104:107], v[232:235]
    v_mfma_f32_16x16x32_bf16 v[236:239], a[88:91], v[108:111], v[236:239]
    v_mfma_f32_16x16x32_bf16 v[236:239], a[200:203], a[44:47], v[236:239]
    v_mfma_f32_16x16x32_bf16 v[252:255], a[204:207], a[44:47], v[252:255]
    buffer_load_dwordx4 v[124:127], v23, s[20:23], s93 offen offset:3072 sc1
    v_mfma_f32_16x16x32_bf16 v[252:255], a[92:95], v[108:111], v[252:255]
    v_mfma_f32_16x16x32_bf16 v[248:251], a[92:95], v[104:107], v[248:251]
    v_mfma_f32_16x16x32_bf16 v[248:251], a[204:207], a[40:43], v[248:251]
    v_mfma_f32_16x16x32_bf16 v[244:247], a[204:207], a[36:39], v[244:247]
    v_mfma_f32_16x16x32_bf16 v[244:247], a[92:95], v[100:103], v[244:247]
    v_mfma_f32_16x16x32_bf16 v[240:243], a[92:95], v[96:99], v[240:243]
    v_mfma_f32_16x16x32_bf16 v[240:243], a[204:207], a[32:35], v[240:243]
    s_waitcnt vmcnt(12) lgkmcnt(0)
    v_mfma_f32_16x16x32_bf16 v[240:243], a[236:239], a[64:67], v[240:243]
    buffer_load_dwordx4 v[68:71], v9, s[12:15], 0 offen
    v_mfma_f32_16x16x32_bf16 v[240:243], a[188:191], a[112:115], v[240:243]
    v_mfma_f32_16x16x32_bf16 v[244:247], a[188:191], a[116:119], v[244:247]
    v_mfma_f32_16x16x32_bf16 v[244:247], a[236:239], a[68:71], v[244:247]
    v_mfma_f32_16x16x32_bf16 v[248:251], a[236:239], a[72:75], v[248:251]
    buffer_load_dwordx4 v[72:75], v10, s[12:15], 0 offen
    v_mfma_f32_16x16x32_bf16 v[248:251], a[188:191], a[120:123], v[248:251]
    v_mfma_f32_16x16x32_bf16 v[252:255], a[188:191], a[124:127], v[252:255]
    v_mfma_f32_16x16x32_bf16 v[252:255], a[236:239], a[76:79], v[252:255]
    v_mfma_f32_16x16x32_bf16 v[236:239], a[232:235], a[76:79], v[236:239]
    v_mfma_f32_16x16x32_bf16 v[236:239], a[184:187], a[124:127], v[236:239]
    v_mfma_f32_16x16x32_bf16 v[232:235], a[184:187], a[120:123], v[232:235]
    v_mfma_f32_16x16x32_bf16 v[232:235], a[232:235], a[72:75], v[232:235]
    v_mfma_f32_16x16x32_bf16 v[228:231], a[232:235], a[68:71], v[228:231]
    v_mfma_f32_16x16x32_bf16 v[228:231], a[184:187], a[116:119], v[228:231]
    v_mfma_f32_16x16x32_bf16 v[224:227], a[184:187], a[112:115], v[224:227]
    v_mfma_f32_16x16x32_bf16 v[224:227], a[232:235], a[64:67], v[224:227]
    v_mfma_f32_16x16x32_bf16 v[208:211], a[228:231], a[64:67], v[208:211]
    v_mfma_f32_16x16x32_bf16 v[208:211], a[180:183], a[112:115], v[208:211]
    v_mfma_f32_16x16x32_bf16 v[212:215], a[180:183], a[116:119], v[212:215]
    v_mfma_f32_16x16x32_bf16 v[212:215], a[228:231], a[68:71], v[212:215]
    v_mfma_f32_16x16x32_bf16 v[216:219], a[228:231], a[72:75], v[216:219]
    v_mfma_f32_16x16x32_bf16 v[216:219], a[180:183], a[120:123], v[216:219]
    v_mfma_f32_16x16x32_bf16 v[220:223], a[180:183], a[124:127], v[220:223]
    v_mfma_f32_16x16x32_bf16 v[220:223], a[228:231], a[76:79], v[220:223]
    v_mfma_f32_16x16x32_bf16 v[204:207], a[224:227], a[76:79], v[204:207]
    v_mfma_f32_16x16x32_bf16 v[204:207], a[176:179], a[124:127], v[204:207]
    v_mfma_f32_16x16x32_bf16 v[200:203], a[176:179], a[120:123], v[200:203]
    v_mfma_f32_16x16x32_bf16 v[200:203], a[224:227], a[72:75], v[200:203]
    v_mfma_f32_16x16x32_bf16 v[196:199], a[224:227], a[68:71], v[196:199]
    v_mfma_f32_16x16x32_bf16 v[196:199], a[176:179], a[116:119], v[196:199]
    v_mfma_f32_16x16x32_bf16 v[192:195], a[176:179], a[112:115], v[192:195]
    v_mfma_f32_16x16x32_bf16 v[192:195], a[224:227], a[64:67], v[192:195]
    s_waitcnt vmcnt(2)
    v_mfma_f32_16x16x32_bf16 v[192:195], v[160:163], a[96:99], v[192:195]
    v_mfma_f32_16x16x32_bf16 v[192:195], a[208:211], v[112:115], v[192:195]
    v_mfma_f32_16x16x32_bf16 v[196:199], a[208:211], v[116:119], v[196:199]
    v_mfma_f32_16x16x32_bf16 v[196:199], v[160:163], a[100:103], v[196:199]
    v_mfma_f32_16x16x32_bf16 v[200:203], v[160:163], a[104:107], v[200:203]
    ds_write_b128 v12, v[192:195] offset:0
    v_mfma_f32_16x16x32_bf16 v[200:203], a[208:211], v[120:123], v[200:203]
    v_mfma_f32_16x16x32_bf16 v[204:207], a[208:211], v[124:127], v[204:207]
    ds_write_b128 v12, v[196:199] offset:1024
    v_mfma_f32_16x16x32_bf16 v[204:207], v[160:163], a[108:111], v[204:207]
    v_mfma_f32_16x16x32_bf16 v[208:211], v[164:167], a[96:99], v[208:211]
    ds_write_b128 v12, v[200:203] offset:2048
    v_mfma_f32_16x16x32_bf16 v[208:211], a[212:215], v[112:115], v[208:211]
    v_mfma_f32_16x16x32_bf16 v[212:215], a[212:215], v[116:119], v[212:215]
    ds_write_b128 v12, v[204:207] offset:3072
    v_mfma_f32_16x16x32_bf16 v[212:215], v[164:167], a[100:103], v[212:215]
    v_mfma_f32_16x16x32_bf16 v[216:219], v[164:167], a[104:107], v[216:219]
    ds_write_b128 v12, v[208:211] offset:4096
    v_mfma_f32_16x16x32_bf16 v[216:219], a[212:215], v[120:123], v[216:219]
    v_mfma_f32_16x16x32_bf16 v[220:223], a[212:215], v[124:127], v[220:223]
    ds_write_b128 v12, v[212:215] offset:5120
    v_mfma_f32_16x16x32_bf16 v[220:223], v[164:167], a[108:111], v[220:223]
    v_mfma_f32_16x16x32_bf16 v[224:227], v[168:171], a[96:99], v[224:227]
    ds_write_b128 v12, v[216:219] offset:6144
    v_mfma_f32_16x16x32_bf16 v[224:227], a[216:219], v[112:115], v[224:227]
    v_mfma_f32_16x16x32_bf16 v[228:231], a[216:219], v[116:119], v[228:231]
    ds_write_b128 v12, v[220:223] offset:7168
    v_mfma_f32_16x16x32_bf16 v[228:231], v[168:171], a[100:103], v[228:231]
    v_mfma_f32_16x16x32_bf16 v[232:235], v[168:171], a[104:107], v[232:235]
    ds_write_b128 v12, v[224:227] offset:32768
    v_mfma_f32_16x16x32_bf16 v[232:235], a[216:219], v[120:123], v[232:235]
    v_mfma_f32_16x16x32_bf16 v[236:239], a[216:219], v[124:127], v[236:239]
    ds_write_b128 v12, v[228:231] offset:33792
    s_waitcnt vmcnt(0)
    v_mfma_f32_16x16x32_bf16 v[236:239], v[168:171], a[108:111], v[236:239]
    v_mfma_f32_16x16x32_bf16 v[240:243], v[172:175], a[96:99], v[240:243]
    ds_write_b128 v12, v[232:235] offset:34816
    v_mfma_f32_16x16x32_bf16 v[240:243], a[220:223], v[112:115], v[240:243]
    v_mfma_f32_16x16x32_bf16 v[244:247], a[220:223], v[116:119], v[244:247]
    ds_write_b128 v12, v[236:239] offset:35840
    s_waitcnt lgkmcnt(4)
    v_mfma_f32_16x16x32_bf16 v[244:247], v[172:175], a[100:103], v[244:247]
    v_mfma_f32_16x16x32_bf16 v[248:251], v[172:175], a[104:107], v[248:251]
    ds_write_b128 v12, v[240:243] offset:36864
    v_mfma_f32_16x16x32_bf16 v[248:251], a[220:223], v[120:123], v[248:251]
    v_mfma_f32_16x16x32_bf16 v[252:255], a[220:223], v[124:127], v[252:255]
    ds_write_b128 v12, v[244:247] offset:37888
    v_mfma_f32_16x16x32_bf16 v[252:255], v[172:175], a[108:111], v[252:255]
    s_nop 2
    v_lshlrev_b32 v32, 16, v68
    v_and_b32 v33, 0xffff0000, v68
    v_lshlrev_b32 v34, 16, v69
    v_and_b32 v35, 0xffff0000, v69
    ds_write_b128 v12, v[248:251] offset:38912
    v_lshlrev_b32 v36, 16, v70
    v_and_b32 v37, 0xffff0000, v70
    v_lshlrev_b32 v38, 16, v71
    v_and_b32 v39, 0xffff0000, v71
    ds_write_b128 v12, v[252:255] offset:39936
    v_lshlrev_b32 v40, 16, v72
    v_and_b32 v41, 0xffff0000, v72
    v_lshlrev_b32 v42, 16, v73
    v_and_b32 v43, 0xffff0000, v73
    v_lshlrev_b32 v44, 16, v74
    v_and_b32 v45, 0xffff0000, v74
    v_lshlrev_b32 v46, 16, v75
    v_and_b32 v47, 0xffff0000, v75
    s_waitcnt lgkmcnt(0)
    s_barrier
    ds_read_b128 v[128:131], v15 offset:0
    ds_read_b128 v[132:135], v15 offset:8192
    ds_read_b128 v[136:139], v15 offset:16384
    ds_read_b128 v[140:143], v15 offset:24576
    ds_read_b128 v[144:147], v15 offset:4096
    ds_read_b128 v[148:151], v15 offset:12288
    ds_read_b128 v[152:155], v15 offset:20480
    ds_read_b128 v[156:159], v15 offset:28672
    s_waitcnt lgkmcnt(4)
    ds_read_b128 v[160:163], v15 offset:1024
    ds_read_b128 v[164:167], v15 offset:9216
    ds_read_b128 v[168:171], v15 offset:17408
    ds_read_b128 v[172:175], v15 offset:25600
    ds_read_b128 v[176:179], v15 offset:5120
    ds_read_b128 v[180:183], v15 offset:13312
    ds_read_b128 v[184:187], v15 offset:21504
    ds_read_b128 v[188:191], v15 offset:29696
    s_waitcnt lgkmcnt(8)
    v_add_f32 v128, v128, v132
    v_add_f32 v136, v136, v140
    v_add_f32 v129, v129, v133
    v_add_f32 v137, v137, v141
    v_add_f32 v130, v130, v134
    v_add_f32 v138, v138, v142
    v_add_f32 v131, v131, v135
    v_add_f32 v139, v139, v143
    v_add_f32 v128, v128, v136
    v_add_f32 v129, v129, v137
    v_add_f32 v130, v130, v138
    v_add_f32 v131, v131, v139
    v_fma_f32 v32, v128, v80, v32
    v_fma_f32 v33, v129, v81, v33
    v_fma_f32 v34, v130, v82, v34
    v_fma_f32 v35, v131, v83, v35
    v_add_f32 v144, v144, v148
    v_add_f32 v152, v152, v156
    v_add_f32 v145, v145, v149
    v_add_f32 v153, v153, v157
    v_add_f32 v146, v146, v150
    v_add_f32 v154, v154, v158
    v_add_f32 v147, v147, v151
    v_add_f32 v155, v155, v159
    v_add_f32 v144, v144, v152
    v_add_f32 v145, v145, v153
    v_add_f32 v146, v146, v154
    v_add_f32 v147, v147, v155
    v_fma_f32 v36, v144, v88, v36
    v_fma_f32 v37, v145, v89, v37
    v_fma_f32 v38, v146, v90, v38
    v_fma_f32 v39, v147, v91, v39
    v_cvt_pk_bf16_f32 v48, v32, v33
    v_cvt_pk_bf16_f32 v49, v34, v35
    v_cvt_pk_bf16_f32 v50, v36, v37
    v_cvt_pk_bf16_f32 v51, v38, v39
    buffer_store_dwordx4 v[48:51], v9, s[16:19], 0 offen
    s_waitcnt lgkmcnt(0)
    v_add_f32 v160, v160, v164
    v_add_f32 v168, v168, v172
    v_add_f32 v161, v161, v165
    v_add_f32 v169, v169, v173
    v_add_f32 v162, v162, v166
    v_add_f32 v170, v170, v174
    v_add_f32 v163, v163, v167
    v_add_f32 v171, v171, v175
    v_add_f32 v160, v160, v168
    v_add_f32 v161, v161, v169
    v_add_f32 v162, v162, v170
    v_add_f32 v163, v163, v171
    v_fma_f32 v40, v160, v84, v40
    v_fma_f32 v41, v161, v85, v41
    v_fma_f32 v42, v162, v86, v42
    v_fma_f32 v43, v163, v87, v43
    v_add_f32 v176, v176, v180
    v_add_f32 v184, v184, v188
    v_add_f32 v177, v177, v181
    v_add_f32 v185, v185, v189
    v_add_f32 v178, v178, v182
    v_add_f32 v186, v186, v190
    v_add_f32 v179, v179, v183
    v_add_f32 v187, v187, v191
    v_add_f32 v176, v176, v184
    v_add_f32 v177, v177, v185
    v_add_f32 v178, v178, v186
    v_add_f32 v179, v179, v187
    v_fma_f32 v44, v176, v92, v44
    v_fma_f32 v45, v177, v93, v45
    v_fma_f32 v46, v178, v94, v46
    v_fma_f32 v47, v179, v95, v47
    v_cvt_pk_bf16_f32 v52, v40, v41
    v_cvt_pk_bf16_f32 v53, v42, v43
    v_cvt_pk_bf16_f32 v54, v44, v45
    v_cvt_pk_bf16_f32 v55, v46, v47
    buffer_store_dwordx4 v[52:55], v10, s[16:19], 0 offen
K2_END:
    s_endpgm
K2_SPIN0:
    s_mov_b32 s94, 200000
K2_SPINL0:
    buffer_load_dword v29, v24, s[40:43], 0 offen sc1
    s_waitcnt vmcnt(0)
    v_cmp_gt_u32 vcc, 64, v29
    s_sub_u32 s94, s94, 1
    s_cbranch_scc1 K2_BACK0
    s_nop 2
    s_cbranch_vccnz K2_SPINL0
    s_branch K2_BACK0
K2_SPIN1:
    s_mov_b32 s94, 200000
K2_SPINL1:
    buffer_load_dword v29, v24, s[40:43], 0 offen offset:128 sc1
    s_waitcnt vmcnt(0)
    v_cmp_ne_u32 vcc, 1, v29
    s_sub_u32 s94, s94, 1
    s_cbranch_scc1 K2_BACK1
    s_nop 2
    s_cbranch_vccnz K2_SPINL1
    s_branch K2_BACK1
K2_SLOW:
    s_mov_b32 s96, 1
    s_waitcnt vmcnt(0) lgkmcnt(0)
    s_nop 7
    s_barrier
    s_lshl_b32 s95, s89, 6
    v_add_u32 v0, s95, v2
    s_branch K2_TOP
K2_MAXP:
    s_mov_b32 s92, s91
    s_mov_b32 s94, 16
    s_waitcnt vmcnt(0)
    v_mov_b32 v96, 0xff800000
    v_mov_b32 v97, 0xff800000
    v_mov_b32 v98, 0xff800000
    v_mov_b32 v99, 0xff800000
K2_MAXL:
    s_barrier
    s_add_u32 m0, s91, 0
    s_nop 0
    buffer_load_dwordx4 v20, s[4:7], s92 offen offset:0 nt lds
    buffer_load_dwordx4 v20, s[4:7], s92 offen offset:1024 nt lds
    buffer_load_dwordx4 v20, s[4:7], s92 offen offset:2048 nt lds
    buffer_load_dwordx4 v20, s[4:7], s92 offen offset:3072 nt lds
    s_add_u32 s92, s92, 4096
    s_add_u32 m0, s91, 4096
    s_nop 0
    buffer_load_dwordx4 v20, s[4:7], s92 offen offset:0 nt lds
    buffer_load_dwordx4 v20, s[4:7], s92 offen offset:1024 nt lds
    buffer_load_dwordx4 v20, s[4:7], s92 offen offset:2048 nt lds
    buffer_load_dwordx4 v20, s[4:7], s92 offen offset:3072 nt lds
    s_add_u32 s92, s92, 28672
    s_waitcnt vmcnt(0)
    s_barrier
    ds_read_b128 a[192:195], v8 offset:0
    ds_read_b128 a[196:199], v9 offset:0
    ds_read_b128 a[200:203], v10 offset:0
    ds_read_b128 a[204:207], v11 offset:0
    s_waitcnt lgkmcnt(0)
    v_mfma_f32_16x16x32_bf16 v[32:35], a[192:195], a[128:131], 0
    v_mfma_f32_16x16x32_bf16 v[32:35], a[196:199], a[132:135], v[32:35]
    v_mfma_f32_16x16x32_bf16 v[32:35], a[200:203], a[136:139], v[32:35]
    v_mfma_f32_16x16x32_bf16 v[32:35], a[204:207], a[140:143], v[32:35]
    v_mfma_f32_16x16x32_bf16 v[36:39], a[192:195], a[144:147], 0
    v_mfma_f32_16x16x32_bf16 v[36:39], a[196:199], a[148:151], v[36:39]
    v_mfma_f32_16x16x32_bf16 v[36:39], a[200:203], a[152:155], v[36:39]
    v_mfma_f32_16x16x32_bf16 v[36:39], a[204:207], a[156:159], v[36:39]
    v_mfma_f32_16x16x32_bf16 v[40:43], a[192:195], a[160:163], 0
    v_mfma_f32_16x16x32_bf16 v[40:43], a[196:199], a[164:167], v[40:43]
    v_mfma_f32_16x16x32_bf16 v[40:43], a[200:203], a[168:171], v[40:43]
    v_mfma_f32_16x16x32_bf16 v[40:43], a[204:207], a[172:175], v[40:43]
    v_mfma_f32_16x16x32_bf16 v[44:47], a[192:195], a[176:179], 0
    v_mfma_f32_16x16x32_bf16 v[44:47], a[196:199], a[180:183], v[44:47]
    v_mfma_f32_16x16x32_bf16 v[44:47], a[200:203], a[184:187], v[44:47]
    v_mfma_f32_16x16x32_bf16 v[44:47], a[204:207], a[188:191], v[44:47]
    s_nop 7
    v_max3_f32 v96, v96, v32, v33
    v_max3_f32 v97, v97, v36, v37
    v_max3_f32 v98, v98, v40, v41
    v_max3_f32 v99, v99, v44, v45
    v_max3_f32 v96, v96, v34, v35
    v_max3_f32 v97, v97, v38, v39
    v_max3_f32 v98, v98, v42, v43
    v_max3_f32 v99, v99, v46, v47
    ds_read_b128 a[192:195], v8 offset:1024
    ds_read_b128 a[196:199], v9 offset:1024
    ds_read_b128 a[200:203], v10 offset:1024
    ds_read_b128 a[204:207], v11 offset:1024
    s_waitcnt lgkmcnt(0)
    v_mfma_f32_16x16x32_bf16 v[32:35], a[192:195], a[128:131], 0
    v_mfma_f32_16x16x32_bf16 v[32:35], a[196:199], a[132:135], v[32:35]
    v_mfma_f32_16x16x32_bf16 v[32:35], a[200:203], a[136:139], v[32:35]
    v_mfma_f32_16x16x32_bf16 v[32:35], a[204:207], a[140:143], v[32:35]
    v_mfma_f32_16x16x32_bf16 v[36:39], a[192:195], a[144:147], 0
    v_mfma_f32_16x16x32_bf16 v[36:39], a[196:199], a[148:151], v[36:39]
    v_mfma_f32_16x16x32_bf16 v[36:39], a[200:203], a[152:155], v[36:39]
    v_mfma_f32_16x16x32_bf16 v[36:39], a[204:207], a[156:159], v[36:39]
    v_mfma_f32_16x16x32_bf16 v[40:43], a[192:195], a[160:163], 0
    v_mfma_f32_16x16x32_bf16 v[40:43], a[196:199], a[164:167], v[40:43]
    v_mfma_f32_16x16x32_bf16 v[40:43], a[200:203], a[168:171], v[40:43]
    v_mfma_f32_16x16x32_bf16 v[40:43], a[204:207], a[172:175], v[40:43]
    v_mfma_f32_16x16x32_bf16 v[44:47], a[192:195], a[176:179], 0
    v_mfma_f32_16x16x32_bf16 v[44:47], a[196:199], a[180:183], v[44:47]
    v_mfma_f32_16x16x32_bf16 v[44:47], a[200:203], a[184:187], v[44:47]
    v_mfma_f32_16x16x32_bf16 v[44:47], a[204:207], a[188:191], v[44:47]
    s_nop 7
    v_max3_f32 v96, v96, v32, v33
    v_max3_f32 v97, v97, v36, v37
    v_max3_f32 v98, v98, v40, v41
    v_max3_f32 v99, v99, v44, v45
    v_max3_f32 v96, v96, v34, v35
    v_max3_f32 v97, v97, v38, v39
    v_max3_f32 v98, v98, v42, v43
    v_max3_f32 v99, v99, v46, v47
    ds_read_b128 a[192:195], v8 offset:2048
    ds_read_b128 a[196:199], v9 offset:2048
    ds_read_b128 a[200:203], v10 offset:2048
    ds_read_b128 a[204:207], v11 offset:2048
    s_waitcnt lgkmcnt(0)
    v_mfma_f32_16x16x32_bf16 v[32:35], a[192:195], a[128:131], 0
    v_mfma_f32_16x16x32_bf16 v[32:35], a[196:199], a[132:135], v[32:35]
    v_mfma_f32_16x16x32_bf16 v[32:35], a[200:203], a[136:139], v[32:35]
    v_mfma_f32_16x16x32_bf16 v[32:35], a[204:207], a[140:143], v[32:35]
    v_mfma_f32_16x16x32_bf16 v[36:39], a[192:195], a[144:147], 0
    v_mfma_f32_16x16x32_bf16 v[36:39], a[196:199], a[148:151], v[36:39]
    v_mfma_f32_16x16x32_bf16 v[36:39], a[200:203], a[152:155], v[36:39]
    v_mfma_f32_16x16x32_bf16 v[36:39], a[204:207], a[156:159], v[36:39]
    v_mfma_f32_16x16x32_bf16 v[40:43], a[192:195], a[160:163], 0
    v_mfma_f32_16x16x32_bf16 v[40:43], a[196:199], a[164:167], v[40:43]
    v_mfma_f32_16x16x32_bf16 v[40:43], a[200:203], a[168:171], v[40:43]
    v_mfma_f32_16x16x32_bf16 v[40:43], a[204:207], a[172:175], v[40:43]
    v_mfma_f32_16x16x32_bf16 v[44:47], a[192:195], a[176:179], 0
    v_mfma_f32_16x16x32_bf16 v[44:47], a[196:199], a[180:183], v[44:47]
    v_mfma_f32_16x16x32_bf16 v[44:47], a[200:203], a[184:187], v[44:47]
    v_mfma_f32_16x16x32_bf16 v[44:47], a[204:207], a[188:191], v[44:47]
    s_nop 7
    v_max3_f32 v96, v96, v32, v33
    v_max3_f32 v97, v97, v36, v37
    v_max3_f32 v98, v98, v40, v41
    v_max3_f32 v99, v99, v44, v45
    v_max3_f32 v96, v96, v34, v35
    v_max3_f32 v97, v97, v38, v39
    v_max3_f32 v98, v98, v42, v43
    v_max3_f32 v99, v99, v46, v47
    ds_read_b128 a[192:195], v8 offset:3072
    ds_read_b128 a[196:199], v9 offset:3072
    ds_read_b128 a[200:203], v10 offset:3072
    ds_read_b128 a[204:207], v11 offset:3072
    s_waitcnt lgkmcnt(0)
    v_mfma_f32_16x16x32_bf16 v[32:35], a[192:195], a[128:131], 0
    v_mfma_f32_16x16x32_bf16 v[32:35], a[196:199], a[132:135], v[32:35]
    v_mfma_f32_16x16x32_bf16 v[32:35], a[200:203], a[136:139], v[32:35]
    v_mfma_f32_16x16x32_bf16 v[32:35], a[204:207], a[140:143], v[32:35]
    v_mfma_f32_16x16x32_bf16 v[36:39], a[192:195], a[144:147], 0
    v_mfma_f32_16x16x32_bf16 v[36:39], a[196:199], a[148:151], v[36:39]
    v_mfma_f32_16x16x32_bf16 v[36:39], a[200:203], a[152:155], v[36:39]
    v_mfma_f32_16x16x32_bf16 v[36:39], a[204:207], a[156:159], v[36:39]
    v_mfma_f32_16x16x32_bf16 v[40:43], a[192:195], a[160:163], 0
    v_mfma_f32_16x16x32_bf16 v[40:43], a[196:199], a[164:167], v[40:43]
    v_mfma_f32_16x16x32_bf16 v[40:43], a[200:203], a[168:171], v[40:43]
    v_mfma_f32_16x16x32_bf16 v[40:43], a[204:207], a[172:175], v[40:43]
    v_mfma_f32_16x16x32_bf16 v[44:47], a[192:195], a[176:179], 0
    v_mfma_f32_16x16x32_bf16 v[44:47], a[196:199], a[180:183], v[44:47]
    v_mfma_f32_16x16x32_bf16 v[44:47], a[200:203], a[184:187], v[44:47]
    v_mfma_f32_16x16x32_bf16 v[44:47], a[204:207], a[188:191], v[44:47]
    s_nop 7
    v_max3_f32 v96, v96, v32, v33
    v_max3_f32 v97, v97, v36, v37
    v_max3_f32 v98, v98, v40, v41
    v_max3_f32 v99, v99, v44, v45
    v_max3_f32 v96, v96, v34, v35
    v_max3_f32 v97, v97, v38, v39
    v_max3_f32 v98, v98, v42, v43
    v_max3_f32 v99, v99, v46, v47
    ds_read_b128 a[192:195], v8 offset:4096
    ds_read_b128 a[196:199], v9 offset:4096
    ds_read_b128 a[200:203], v10 offset:4096
    ds_read_b128 a[204:207], v11 offset:4096
    s_waitcnt lgkmcnt(0)
    v_mfma_f32_16x16x32_bf16 v[32:35], a[192:195], a[128:131], 0
    v_mfma_f32_16x16x32_bf16 v[32:35], a[196:199], a[132:135], v[32:35]
    v_mfma_f32_16x16x32_bf16 v[32:35], a[200:203], a[136:139], v[32:35]
    v_mfma_f32_16x16x32_bf16 v[32:35], a[204:207], a[140:143], v[32:35]
    v_mfma_f32_16x16x32_bf16 v[36:39], a[192:195], a[144:147], 0
    v_mfma_f32_16x16x32_bf16 v[36:39], a[196:199], a[148:151], v[36:39]
    v_mfma_f32_16x16x32_bf16 v[36:39], a[200:203], a[152:155], v[36:39]
    v_mfma_f32_16x16x32_bf16 v[36:39], a[204:207], a[156:159], v[36:39]
    v_mfma_f32_16x16x32_bf16 v[40:43], a[192:195], a[160:163], 0
    v_mfma_f32_16x16x32_bf16 v[40:43], a[196:199], a[164:167], v[40:43]
    v_mfma_f32_16x16x32_bf16 v[40:43], a[200:203], a[168:171], v[40:43]
    v_mfma_f32_16x16x32_bf16 v[40:43], a[204:207], a[172:175], v[40:43]
    v_mfma_f32_16x16x32_bf16 v[44:47], a[192:195], a[176:179], 0
    v_mfma_f32_16x16x32_bf16 v[44:47], a[196:199], a[180:183], v[44:47]
    v_mfma_f32_16x16x32_bf16 v[44:47], a[200:203], a[184:187], v[44:47]
    v_mfma_f32_16x16x32_bf16 v[44:47], a[204:207], a[188:191], v[44:47]
    s_nop 7
    v_max3_f32 v96, v96, v32, v33
    v_max3_f32 v97, v97, v36, v37
    v_max3_f32 v98, v98, v40, v41
    v_max3_f32 v99, v99, v44, v45
    v_max3_f32 v96, v96, v34, v35
    v_max3_f32 v97, v97, v38, v39
    v_max3_f32 v98, v98, v42, v43
    v_max3_f32 v99, v99, v46, v47
    ds_read_b128 a[192:195], v8 offset:5120
    ds_read_b128 a[196:199], v9 offset:5120
    ds_read_b128 a[200:203], v10 offset:5120
    ds_read_b128 a[204:207], v11 offset:5120
    s_waitcnt lgkmcnt(0)
    v_mfma_f32_16x16x32_bf16 v[32:35], a[192:195], a[128:131], 0
    v_mfma_f32_16x16x32_bf16 v[32:35], a[196:199], a[132:135], v[32:35]
    v_mfma_f32_16x16x32_bf16 v[32:35], a[200:203], a[136:139], v[32:35]
    v_mfma_f32_16x16x32_bf16 v[32:35], a[204:207], a[140:143], v[32:35]
    v_mfma_f32_16x16x32_bf16 v[36:39], a[192:195], a[144:147], 0
    v_mfma_f32_16x16x32_bf16 v[36:39], a[196:199], a[148:151], v[36:39]
    v_mfma_f32_16x16x32_bf16 v[36:39], a[200:203], a[152:155], v[36:39]
    v_mfma_f32_16x16x32_bf16 v[36:39], a[204:207], a[156:159], v[36:39]
    v_mfma_f32_16x16x32_bf16 v[40:43], a[192:195], a[160:163], 0
    v_mfma_f32_16x16x32_bf16 v[40:43], a[196:199], a[164:167], v[40:43]
    v_mfma_f32_16x16x32_bf16 v[40:43], a[200:203], a[168:171], v[40:43]
    v_mfma_f32_16x16x32_bf16 v[40:43], a[204:207], a[172:175], v[40:43]
    v_mfma_f32_16x16x32_bf16 v[44:47], a[192:195], a[176:179], 0
    v_mfma_f32_16x16x32_bf16 v[44:47], a[196:199], a[180:183], v[44:47]
    v_mfma_f32_16x16x32_bf16 v[44:47], a[200:203], a[184:187], v[44:47]
    v_mfma_f32_16x16x32_bf16 v[44:47], a[204:207], a[188:191], v[44:47]
    s_nop 7
    v_max3_f32 v96, v96, v32, v33
    v_max3_f32 v97, v97, v36, v37
    v_max3_f32 v98, v98, v40, v41
    v_max3_f32 v99, v99, v44, v45
    v_max3_f32 v96, v96, v34, v35
    v_max3_f32 v97, v97, v38, v39
    v_max3_f32 v98, v98, v42, v43
    v_max3_f32 v99, v99, v46, v47
    ds_read_b128 a[192:195], v8 offset:6144
    ds_read_b128 a[196:199], v9 offset:6144
    ds_read_b128 a[200:203], v10 offset:6144
    ds_read_b128 a[204:207], v11 offset:6144
    s_waitcnt lgkmcnt(0)
    v_mfma_f32_16x16x32_bf16 v[32:35], a[192:195], a[128:131], 0
    v_mfma_f32_16x16x32_bf16 v[32:35], a[196:199], a[132:135], v[32:35]
    v_mfma_f32_16x16x32_bf16 v[32:35], a[200:203], a[136:139], v[32:35]
    v_mfma_f32_16x16x32_bf16 v[32:35], a[204:207], a[140:143], v[32:35]
    v_mfma_f32_16x16x32_bf16 v[36:39], a[192:195], a[144:147], 0
    v_mfma_f32_16x16x32_bf16 v[36:39], a[196:199], a[148:151], v[36:39]
    v_mfma_f32_16x16x32_bf16 v[36:39], a[200:203], a[152:155], v[36:39]
    v_mfma_f32_16x16x32_bf16 v[36:39], a[204:207], a[156:159], v[36:39]
    v_mfma_f32_16x16x32_bf16 v[40:43], a[192:195], a[160:163], 0
    v_mfma_f32_16x16x32_bf16 v[40:43], a[196:199], a[164:167], v[40:43]
    v_mfma_f32_16x16x32_bf16 v[40:43], a[200:203], a[168:171], v[40:43]
    v_mfma_f32_16x16x32_bf16 v[40:43], a[204:207], a[172:175], v[40:43]
    v_mfma_f32_16x16x32_bf16 v[44:47], a[192:195], a[176:179], 0
    v_mfma_f32_16x16x32_bf16 v[44:47], a[196:199], a[180:183], v[44:47]
    v_mfma_f32_16x16x32_bf16 v[44:47], a[200:203], a[184:187], v[44:47]
    v_mfma_f32_16x16x32_bf16 v[44:47], a[204:207], a[188:191], v[44:47]
    s_nop 7
    v_max3_f32 v96, v96, v32, v33
    v_max3_f32 v97, v97, v36, v37
    v_max3_f32 v98, v98, v40, v41
    v_max3_f32 v99, v99, v44, v45
    v_max3_f32 v96, v96, v34, v35
    v_max3_f32 v97, v97, v38, v39
    v_max3_f32 v98, v98, v42, v43
    v_max3_f32 v99, v99, v46, v47
    ds_read_b128 a[192:195], v8 offset:7168
    ds_read_b128 a[196:199], v9 offset:7168
    ds_read_b128 a[200:203], v10 offset:7168
    ds_read_b128 a[204:207], v11 offset:7168
    s_waitcnt lgkmcnt(0)
    v_mfma_f32_16x16x32_bf16 v[32:35], a[192:195], a[128:131], 0
    v_mfma_f32_16x16x32_bf16 v[32:35], a[196:199], a[132:135], v[32:35]
    v_mfma_f32_16x16x32_bf16 v[32:35], a[200:203], a[136:139], v[32:35]
    v_mfma_f32_16x16x32_bf16 v[32:35], a[204:207], a[140:143], v[32:35]
    v_mfma_f32_16x16x32_bf16 v[36:39], a[192:195], a[144:147], 0
    v_mfma_f32_16x16x32_bf16 v[36:39], a[196:199], a[148:151], v[36:39]
    v_mfma_f32_16x16x32_bf16 v[36:39], a[200:203], a[152:155], v[36:39]
    v_mfma_f32_16x16x32_bf16 v[36:39], a[204:207], a[156:159], v[36:39]
    v_mfma_f32_16x16x32_bf16 v[40:43], a[192:195], a[160:163], 0
    v_mfma_f32_16x16x32_bf16 v[40:43], a[196:199], a[164:167], v[40:43]
    v_mfma_f32_16x16x32_bf16 v[40:43], a[200:203], a[168:171], v[40:43]
    v_mfma_f32_16x16x32_bf16 v[40:43], a[204:207], a[172:175], v[40:43]
    v_mfma_f32_16x16x32_bf16 v[44:47], a[192:195], a[176:179], 0
    v_mfma_f32_16x16x32_bf16 v[44:47], a[196:199], a[180:183], v[44:47]
    v_mfma_f32_16x16x32_bf16 v[44:47], a[200:203], a[184:187], v[44:47]
    v_mfma_f32_16x16x32_bf16 v[44:47], a[204:207], a[188:191], v[44:47]
    s_nop 7
    v_max3_f32 v96, v96, v32, v33
    v_max3_f32 v97, v97, v36, v37
    v_max3_f32 v98, v98, v40, v41
    v_max3_f32 v99, v99, v44, v45
    v_max3_f32 v96, v96, v34, v35
    v_max3_f32 v97, v97, v38, v39
    v_max3_f32 v98, v98, v42, v43
    v_max3_f32 v99, v99, v46, v47
    s_sub_u32 s94, s94, 1
    s_cmp_lg_u32 s94, 0
    s_cbranch_scc1 K2_MAXL
    v_mov_b32 v100, v96
    v_mov_b32 v101, v97
    v_mov_b32 v102, v98
    v_mov_b32 v103, v99
    s_nop 0
    v_permlane32_swap_b32 v96, v100
    v_permlane32_swap_b32 v97, v101
    v_permlane32_swap_b32 v98, v102
    v_permlane32_swap_b32 v99, v103
    s_nop 0
    v_max_f32 v96, v96, v100
    v_max_f32 v97, v97, v101
    v_max_f32 v98, v98, v102
    v_max_f32 v99, v99, v103
    v_mov_b32 v100, v96
    v_mov_b32 v101, v97
    v_mov_b32 v102, v98
    v_mov_b32 v103, v99
    s_nop 0
    v_permlane16_swap_b32 v96, v100
    v_permlane16_swap_b32 v97, v101
    v_permlane16_swap_b32 v98, v102
    v_permlane16_swap_b32 v99, v103
    s_nop 0
    v_max_f32 v96, v96, v100
    v_max_f32 v97, v97, v101
    v_max_f32 v98, v98, v102
    v_max_f32 v99, v99, v103
    v_sub_f32 v48, 0xc2340000, v96
    v_sub_f32 v49, 0xc2340000, v96
    v_sub_f32 v50, 0xc2340000, v96
    v_sub_f32 v51, 0xc2340000, v96
    v_sub_f32 v52, 0xc2340000, v97
    v_sub_f32 v53, 0xc2340000, v97
    v_sub_f32 v54, 0xc2340000, v97
    v_sub_f32 v55, 0xc2340000, v97
    v_sub_f32 v56, 0xc2340000, v98
    v_sub_f32 v57, 0xc2340000, v98
    v_sub_f32 v58, 0xc2340000, v98
    v_sub_f32 v59, 0xc2340000, v98
    v_sub_f32 v60, 0xc2340000, v99
    v_sub_f32 v61, 0xc2340000, v99
    v_sub_f32 v62, 0xc2340000, v99
    v_sub_f32 v63, 0xc2340000, v99
    s_mov_b32 s92, s91
    s_barrier
    s_add_u32 m0, s91, 0
    s_nop 0
    buffer_load_dwordx4 v20, s[4:7], s92 offen offset:0 nt lds
    buffer_load_dwordx4 v20, s[4:7], s92 offen offset:1024 nt lds
    buffer_load_dwordx4 v20, s[4:7], s92 offen offset:2048 nt lds
    buffer_load_dwordx4 v20, s[4:7], s92 offen offset:3072 nt lds
    s_add_u32 s92, s92, 4096
    s_add_u32 m0, s91, 4096
    s_nop 0
    buffer_load_dwordx4 v20, s[4:7], s92 offen offset:0 nt lds
    buffer_load_dwordx4 v20, s[4:7], s92 offen offset:1024 nt lds
    buffer_load_dwordx4 v20, s[4:7], s92 offen offset:2048 nt lds
    buffer_load_dwordx4 v20, s[4:7], s92 offen offset:3072 nt lds
    s_add_u32 s92, s92, 28672
    s_add_u32 s92, s92, 32768
    s_waitcnt vmcnt(0)
    s_barrier
    ds_read_b128 a[192:195], v8 offset:0
    ds_read_b128 a[196:199], v9 offset:0
    ds_read_b128 a[200:203], v10 offset:0
    ds_read_b128 a[204:207], v11 offset:0
    s_waitcnt lgkmcnt(0)
K2_LAST:
    s_branch K2_ATT
.section .rodata,"a"
.p2align 6
.amdhsa_kernel recurrent_scan__mha_block_cached__mixer_channel_mlp__prompt_kernel
  .amdhsa_next_free_vgpr 512
  .amdhsa_next_free_sgpr 102
  .amdhsa_accum_offset 256
  .amdhsa_group_segment_fixed_size 0
  .amdhsa_kernarg_size 104
  .amdhsa_user_sgpr_count 2
  .amdhsa_user_sgpr_kernarg_segment_ptr 1
  .amdhsa_system_sgpr_workgroup_id_x 1
.end_amdhsa_kernel
```
